```python
import torch

def _softmax(x, axis=-1):
    return torch.softmax(x, dim=axis)
def _gelu(x):
    return torch.nn.functional.gelu(x, approximate="tanh")
def _silu(x):
    return torch.nn.functional.silu(x)
def _sigmoid(x):
    return torch.sigmoid(x)
def _layernorm(x, axis=-1, eps=1e-5):
    m = x.mean(dim=axis, keepdim=True)
    v = x.var(dim=axis, keepdim=True, unbiased=False)
    return (x - m) / torch.sqrt(v + eps)
def _scatter_add(tgt, idx, src, axis=0):
    return tgt.clone().index_add_(axis, idx, src)
def _segment_sum(src, seg, n):
    out = torch.zeros((n,) + src.shape[1:], dtype=src.dtype)
    return out.index_add_(0, seg, src)
def _pad(x, pw):
    flat = tuple(v for pair in reversed(pw) for v in pair)
    return torch.nn.functional.pad(x, flat)

kernel_name = 'parallel_sum__compressed_kv_cla__geglu_ffn__prompt'

def setup_inputs():

    _w = (lambda a: (lambda t: t.to(torch.bfloat16) if t.is_floating_point() else t)(torch.as_tensor(a)))
    def _A_setup():
        B, H, Sq, Sk, D, M = 1, 32, 2048, 2048, 128, 640
        Dc = 4 * D
        return {
            "x": _w((lambda *s: torch.randn(*s, dtype=torch.bfloat16) * 0.05)(B, Sq, M)),
            "c_kv": _w((lambda *s: torch.randn(*s, dtype=torch.bfloat16) * 1.6)(B, Sk, Dc)),
            "w_q": _w((lambda *s: torch.randn(*s, dtype=torch.bfloat16) * 0.8)(M, H, D) * (M ** -0.5)),
            "w_uk": _w((lambda *s: torch.randn(*s, dtype=torch.bfloat16) * 0.8)(Dc, H, D) * (Dc ** -0.5)),
            "w_uv": _w((lambda *s: torch.randn(*s, dtype=torch.bfloat16) * 1.6)(Dc, H, D) * (Dc ** -0.5)),
            "w_o": _w((lambda *s: torch.randn(*s, dtype=torch.bfloat16) * 1.6)(H, D, M) * ((H * D) ** -0.5)),
        }
    _A_in = _A_setup()

    def _B_setup():
        B, S, D, F = 1, 2048, 640, 1728
        return {
            "x": _w((lambda *s: torch.randn(*s, dtype=torch.bfloat16) * 0.05)(B, S, D)),
            "w_gate": _w((lambda *s: torch.randn(*s, dtype=torch.bfloat16) * 0.05)(D, F)),
            "w_up": _w((lambda *s: torch.randn(*s, dtype=torch.bfloat16) * 0.05)(D, F)),
            "w_down": _w((lambda *s: torch.randn(*s, dtype=torch.bfloat16) * 0.05)(F, D)),
        }
    _B_in = _B_setup()

    return {
        "A_x": _A_in["x"],
        "A_c_kv": _A_in["c_kv"],
        "A_w_q": _A_in["w_q"],
        "A_w_uk": _A_in["w_uk"],
        "A_w_uv": _A_in["w_uv"],
        "A_w_o": _A_in["w_o"],
        "B_x": _B_in["x"],
        "B_w_gate": _B_in["w_gate"],
        "B_w_up": _B_in["w_up"],
        "B_w_down": _B_in["w_down"],
    }

def reference(A_x, A_c_kv, A_w_q, A_w_uk, A_w_uv, A_w_o, B_x, B_w_gate, B_w_up, B_w_down):
    def _A_ref(x, c_kv, w_q, w_uk, w_uv, w_o):
        B, Sq, M = x.shape[0], x.shape[1], x.shape[2]
        Sk = c_kv.shape[1]
        H, D = w_q.shape[1], w_q.shape[2]
        q = torch.einsum("bqm,mhd->bhqd", x, w_q)
        k = torch.einsum("bkc,chd->bhkd", c_kv, w_uk)
        v = torch.einsum("bkc,chd->bhkd", c_kv, w_uv)
        scores = torch.einsum("bhqd,bhkd->bhqk", q, k) * (D ** -0.5)
        off = Sk - Sq
        qi = torch.arange(Sq)[:, None]
        kj = torch.arange(Sk)[None, :]
        cmask = kj <= (qi + off)
        scores = torch.where(cmask[None, None], scores, -1e9)
        p = _softmax(scores, axis=-1)
        ctx = torch.einsum("bhqk,bhkd->bhqd", p, v)
        return torch.einsum("bhqd,hdm->bqm", ctx, w_o)

    def _B_ref(x, w_gate, w_up, w_down):
        return (_gelu(x @ w_gate) * (x @ w_up)) @ w_down

    x = A_x
    xn = _layernorm(x, axis=-1)
    return x + _A_ref(xn, A_c_kv, A_w_q, A_w_uk, A_w_uv, A_w_o) + _B_ref(xn, B_w_gate, B_w_up, B_w_down)
```

```asm
; @launch grid=(256,1,1) block=(256,1,1) lds=163840
.amdgcn_target "amdgcn-amd-amdhsa--gfx950"
.text
.p2align 8
.globl parallel_sum__compressed_kv_cla__geglu_ffn__prompt_kernel
.type parallel_sum__compressed_kv_cla__geglu_ffn__prompt_kernel,@function
parallel_sum__compressed_kv_cla__geglu_ffn__prompt_kernel:
    s_cmp_ge_u32 s2, 256
    s_cbranch_scc1 L_end
    s_load_dwordx2 s[72:73], s[0:1], 8
    s_load_dwordx2 s[60:61], s[0:1], 24
    s_load_dwordx2 s[64:65], s[0:1], 32
    s_load_dwordx2 s[68:69], s[0:1], 32
    s_load_dwordx2 s[44:45], s[0:1], 96
    s_load_dwordx2 s[4:5], s[0:1], 0
    v_lshrrev_b32 v3, 6, v0
    v_and_b32 v2, 63, v0
    v_readfirstlane_b32 s52, v3
    v_lshlrev_b32 v1, 4, v2
    s_getpc_b64 s[88:89]
L_pc:
    s_lshr_b32 s55, s2, 3
    s_and_b32 s55, s55, 31
    s_mul_i32 s55, s55, 2048
    s_add_u32 s55, s55, L_main-L_pc
    v_lshl_add_u32 v48, v0, 7, s55
    s_mov_b32 s55, L_end-L_pc
    v_min_u32 v48, s55, v48
    v_mov_b32 v49, s89
    v_add_co_u32 v48, vcc, s88, v48
    v_cmp_gt_u32 s[90:91], 16, v0
    s_nop 0
    v_addc_co_u32 v49, vcc, 0, v49, vcc
    s_and_saveexec_b64 s[88:89], s[90:91]
    s_cbranch_execz L_nocp
    global_load_dword a254, v[48:49], off
L_nocp:
    s_mov_b64 exec, -1
    s_mov_b32 s74, 2097152
    s_mov_b32 s75, 0x20000
    s_mov_b32 s62, 4194304
    s_mov_b32 s63, 0x20000
    s_mov_b32 s66, 4194304
    s_mov_b32 s67, 0x20000
    s_mov_b32 s70, 4194304
    s_mov_b32 s71, 0x20000
    s_mov_b32 s46, 268435456
    s_mov_b32 s47, 0x20000
    s_mov_b32 s6, 2621440
    s_mov_b32 s7, 0x20000
    s_and_b32 s53, s2, 7
    s_lshl_b32 s53, s53, 2
    s_bfe_u32 s55, s2, 0x20003
    s_add_u32 s53, s53, s55
    s_lshr_b32 s54, s2, 5
    s_lshl_b32 s85, s52, 12
    s_add_u32 s84, s85, 32768
    s_add_u32 s83, s85, 65536
    s_lshl_b32 s86, s52, 13
    s_add_u32 s86, s86, 98304
    v_lshrrev_b32 v44, 3, v2
    v_lshrrev_b32 v45, 4, v2
    v_and_b32 v46, 7, v2
    v_xor_b32 v47, v45, v46
    v_lshlrev_b32 v47, 4, v47
    v_lshl_add_u32 v28, v44, 10, v47
    v_xor_b32 v47, 64, v28
    v_add_u32 v29, 7168, v47
    v_add_u32 v30, 14336, v28
    v_add_u32 v31, 14336, v29
    s_lshl_b32 s78, s54, 2
    s_add_u32 s78, s78, s52
    s_lshl_b32 s90, s78, 15
    s_lshl_b32 s78, s78, 16
    s_add_u32 s79, s78, 32768
    s_mov_b32 s82, 128
    s_lshl_b32 s76, s52, 17
    s_lshl_b32 s55, s53, 8
    s_add_u32 s76, s76, s55
    s_mov_b32 s77, s76
    s_mov_b32 s80, 524288
    s_mov_b32 s81, 524288
    v_lshrrev_b32 v44, 4, v2
    v_and_b32 v45, 15, v2
    v_lshlrev_b32 v46, 1, v44
    v_xor_b32 v46, v46, v45
    v_lshlrev_b32 v46, 4, v46
    v_lshl_add_u32 v20, v44, 13, v46
    v_add_u32 v21, 31744, v20
    v_xor_b32 v46, 128, v20
    v_add_u32 v22, 63488, v46
    v_add_u32 v23, 95232, v46
    s_waitcnt lgkmcnt(0)
    s_load_dwordx2 s[12:13], s[0:1], 16
    s_load_dwordx2 s[24:25], s[0:1], 40
    s_load_dwordx2 s[28:29], s[0:1], 56
    s_load_dwordx2 s[32:33], s[0:1], 64
    s_load_dwordx2 s[36:37], s[0:1], 72
    s_load_dwordx2 s[40:41], s[0:1], 80
    s_load_dwordx2 s[48:49], s[0:1], 88
    s_add_u32 m0, s86, 0
    s_nop 0
    buffer_load_dwordx4 v28, s[72:75], s78 offen offset:0 lds
    buffer_load_dwordx4 v29, s[72:75], s78 offen offset:1024 lds
    buffer_load_dwordx4 v30, s[72:75], s78 offen offset:2048 lds
    buffer_load_dwordx4 v31, s[72:75], s78 offen offset:3072 lds
    s_add_u32 s78, s78, s82
    s_add_u32 m0, s86, 4096
    s_nop 0
    buffer_load_dwordx4 v28, s[72:75], s79 offen offset:0 lds
    buffer_load_dwordx4 v29, s[72:75], s79 offen offset:1024 lds
    buffer_load_dwordx4 v30, s[72:75], s79 offen offset:2048 lds
    buffer_load_dwordx4 v31, s[72:75], s79 offen offset:3072 lds
    s_add_u32 s79, s79, s82
    s_mov_b32 m0, s85
    s_nop 0
    buffer_load_dwordx4 v20, s[60:63], s76 offen offset:0 lds
    buffer_load_dwordx4 v21, s[60:63], s76 offen offset:1024 lds
    buffer_load_dwordx4 v22, s[60:63], s76 offen offset:2048 lds
    buffer_load_dwordx4 v23, s[60:63], s76 offen offset:3072 lds
    s_add_u32 s76, s76, s80
    s_lshl_b32 s55, s2, 3
    s_lshl_b32 s56, s52, 1
    s_add_u32 s55, s55, s56
    s_mul_i32 s89, s55, 1280
    s_mov_b32 s98, 0xffff
    s_mov_b32 s99, 0xffff
    v_lshrrev_b32 v44, 5, v2
    v_and_b32 v45, 31, v2
    v_mul_u32_u24 v46, 1280, v44
    v_lshl_add_u32 v6, v45, 4, v46
    v_mov_b32 v44, 0x7fff0000
    v_cndmask_b32 v60, v44, v6, s[98:99]
    buffer_load_dwordx4 v[32:35], v6, s[4:7], s89 offen offset:0
    buffer_load_dwordx4 v[36:39], v6, s[4:7], s89 offen offset:512
    buffer_load_dwordx4 v[40:43], v60, s[4:7], s89 offen offset:1024
    v_mov_b32 v24, v20
    v_mov_b32 v25, v21
    v_mov_b32 v26, v22
    v_mov_b32 v27, v23
    s_lshl_b32 s55, s2, 2
    s_add_u32 s101, s55, s52
    s_lshl_b32 s100, s101, 7
    s_add_u32 s100, s100, 83886080
    s_lshl_b32 s55, s101, 11
    s_add_u32 s55, s55, 83886080
    s_cmp_lt_u32 s2, 16
    s_cselect_b32 s46, s46, 0
    v_mov_b64 v[52:53], 0
    v_mov_b64 v[54:55], 0
    buffer_store_dwordx4 v[52:55], v1, s[44:47], s55 offen sc1
    buffer_store_dwordx4 v[52:55], v1, s[44:47], s55 offen offset:1024 sc1
    s_mov_b32 s46, 268435456
    s_cmp_lt_u32 s52, 2
    s_cbranch_scc1 L_hop0
    s_bitcmp1_b32 s52, 0
    s_cbranch_scc1 L_pad3
    s_branch L_pad2
L_hop0:
    s_bitcmp1_b32 s52, 0
    s_cbranch_scc1 L_pad1
    s_branch L_pad0
L_tour_ret0:
    s_mov_b32 s14, 5242880
    s_mov_b32 s15, 0x20000
    s_mov_b32 s26, 5242880
    s_mov_b32 s27, 0x20000
    s_mov_b32 s30, 2211840
    s_mov_b32 s31, 0x20000
    s_mov_b32 s34, 2211840
    s_mov_b32 s35, 0x20000
    s_mov_b32 s38, 2211840
    s_mov_b32 s39, 0x20000
    s_mov_b32 s42, 2621440
    s_mov_b32 s43, 0x20000
    s_mov_b32 s50, 256
    s_mov_b32 s51, 0x20000
    v_lshrrev_b32 v45, 4, v2
    v_and_b32 v44, 15, v2
    v_lshrrev_b32 v46, 1, v44
    v_xor_b32 v46, v46, v45
    v_lshlrev_b32 v46, 4, v46
    v_lshl_add_u32 v46, v44, 7, v46
    v_add_u32 v4, s86, v46
    v_xor_b32 v5, 64, v4
    s_lshl_b32 s55, s53, 20
    s_add_u32 s90, s90, s55
    s_add_u32 s90, s90, 4194304
    v_lshrrev_b32 v44, 4, v2
    v_bfe_u32 v45, v2, 2, 2
    v_and_b32 v46, 1, v44
    v_lshl_or_b32 v47, v46, 2, v45
    v_lshl_add_u32 v48, v44, 3, v45
    v_and_b32 v49, 3, v2
    v_lshlrev_b32 v49, 3, v49
    v_lshl_add_u32 v48, v48, 8, v49
    v_xor_b32 v50, 0, v47
    v_lshl_add_u32 v8, v50, 5, v48
    v_xor_b32 v50, 1, v47
    v_lshl_add_u32 v9, v50, 5, v48
    v_xor_b32 v50, 2, v47
    v_lshl_add_u32 v10, v50, 5, v48
    v_xor_b32 v50, 3, v47
    v_lshl_add_u32 v11, v50, 5, v48
    v_xor_b32 v50, 4, v47
    v_lshl_add_u32 v12, v50, 5, v48
    v_xor_b32 v50, 5, v47
    v_lshl_add_u32 v13, v50, 5, v48
    v_xor_b32 v50, 6, v47
    v_lshl_add_u32 v14, v50, 5, v48
    v_xor_b32 v50, 7, v47
    v_lshl_add_u32 v15, v50, 5, v48
    v_lshrrev_b32 v50, 1, v44
    v_lshl_add_u32 v48, v50, 12, v49
    v_lshl_add_u32 v48, v46, 10, v48
    v_lshl_add_u32 v48, v45, 7, v48
    v_lshrrev_b32 v47, 1, v45
    v_lshl_or_b32 v47, v46, 1, v47
    v_xor_b32 v50, 0, v47
    v_lshl_add_u32 v16, v50, 5, v48
    v_xor_b32 v50, 1, v47
    v_lshl_add_u32 v17, v50, 5, v48
    v_xor_b32 v50, 2, v47
    v_lshl_add_u32 v18, v50, 5, v48
    v_xor_b32 v50, 3, v47
    v_lshl_add_u32 v19, v50, 5, v48
    v_add_u32 v16, 65536, v16
    v_add_u32 v17, 65536, v17
    v_add_u32 v18, 65536, v18
    v_add_u32 v19, 65536, v19
    s_add_u32 m0, s85, 16384
    s_nop 0
    buffer_load_dwordx4 v24, s[64:67], s77 offen offset:0 lds
    buffer_load_dwordx4 v25, s[64:67], s77 offen offset:1024 lds
    buffer_load_dwordx4 v26, s[68:71], s77 offen offset:2048 lds
    buffer_load_dwordx4 v27, s[68:71], s77 offen offset:3072 lds
    s_add_u32 s77, s77, s81
    s_branch L_main
L_mask0:
    v_pk_add_f32 v[16:17], v[16:17], v[112:113]
    v_pk_add_f32 v[18:19], v[18:19], v[114:115]
    v_pk_add_f32 v[28:29], v[28:29], v[112:113]
    v_pk_add_f32 v[30:31], v[30:31], v[114:115]
    v_mov_b64 v[24:25], v[116:117]
    v_mov_b64 v[26:27], v[116:117]
    s_nop 0
    s_branch L_mask0_back
L_spin3d:
    s_mov_b32 s3, 0
L_spin3d_l:
    buffer_load_dword v108, v122, s[44:47], 0 offen offset:4 sc1
    s_add_u32 s3, s3, 1
    s_waitcnt vmcnt(0)
    v_cmp_ne_u32 vcc, -1, v108
    s_cmp_ge_u32 s3, 131072
    s_cbranch_scc1 L_s3d
    s_nop 0
    s_cbranch_vccz L_s3d
    s_branch L_spin3d_l
L_spin3s:
    s_mov_b32 s3, 0
L_spin3s_l:
    buffer_load_dword v108, v122, s[44:47], 0 offen offset:4 sc1
    s_add_u32 s3, s3, 1
    s_waitcnt vmcnt(0)
    v_cmp_ne_u32 vcc, -1, v108
    s_cmp_ge_u32 s3, 131072
    s_cbranch_scc1 L_s3s
    s_nop 0
    s_cbranch_vccz L_s3s
    s_branch L_spin3s_l
L_slowb:
    s_mov_b32 s84, 1
    s_mov_b32 s87, s36
    s_mov_b32 s85, s37
    v_mov_b64 v[32:33], v[40:41]
    v_mov_b64 v[34:35], v[42:43]
    v_mov_b64 v[36:37], v[44:45]
    v_mov_b64 v[38:39], v[46:47]
    v_mov_b64 v[48:49], v[56:57]
    v_mov_b64 v[50:51], v[58:59]
    v_mov_b64 v[52:53], v[60:61]
    v_mov_b64 v[54:55], v[62:63]
    v_mov_b64 v[64:65], v[72:73]
    v_mov_b64 v[66:67], v[74:75]
    v_mov_b64 v[68:69], v[76:77]
    v_mov_b64 v[70:71], v[78:79]
    v_mov_b64 v[80:81], v[88:89]
    v_mov_b64 v[82:83], v[90:91]
    v_mov_b64 v[84:85], v[92:93]
    v_mov_b64 v[86:87], v[94:95]
    s_branch L_slow
L_slowb_x:
    s_waitcnt vmcnt(0)
    s_branch L_post_x
L_nogu:
    s_waitcnt vmcnt(16)
    s_barrier
    ds_read_b128 a[72:75], v4 offset:0
    ds_read_b128 a[76:79], v4 offset:1024
    ds_read_b128 a[80:83], v4 offset:2048
    ds_read_b128 a[84:87], v4 offset:3072
    ds_read_b128 a[88:91], v4 offset:8192
    ds_read_b128 a[92:95], v4 offset:9216
    ds_read_b128 a[96:99], v4 offset:10240
    ds_read_b128 a[100:103], v4 offset:11264
    s_branch L_attn
L_spin2:
    s_mov_b32 s3, 0
L_spin2_l:
    buffer_load_dword v28, v29, s[44:47], 0 offen offset:0 sc1
    s_add_u32 s3, s3, 1
    s_waitcnt vmcnt(0)
    v_cmp_ne_u32 vcc, -1, v28
    s_cmp_ge_u32 s3, 131072
    s_cbranch_scc1 L_spin2_back
    s_nop 0
    s_cbranch_vccz L_spin2_back
    s_branch L_spin2_l
L_spin0:
    s_mov_b32 s3, 0
L_spin0_l:
    buffer_load_dword v47, v63, s[48:51], 0 offen sc1
    s_add_u32 s3, s3, 1
    s_waitcnt vmcnt(0)
    v_cmp_ne_u32 vcc, -1, v47
    s_cmp_ge_u32 s3, 131072
    s_cbranch_scc1 L_spin0_back
    s_nop 0
    s_cbranch_vccz L_spin0_back
    s_branch L_spin0_l
L_spin1:
    s_mov_b32 s3, 0
L_spin1_l:
    buffer_load_dword v47, v45, s[44:47], 0 offen offset:20 sc1
    s_add_u32 s3, s3, 1
    s_waitcnt vmcnt(0)
    v_cmp_ne_u32 vcc, -1, v47
    s_cmp_ge_u32 s3, 131072
    s_cbranch_scc1 L_spin1_back
    s_nop 0
    s_cbranch_vccz L_spin1_back
    s_branch L_spin1_l
.p2align 12
L_main:
    s_branch L_pado0
L_pad0:
    s_branch L_tour_ret0
L_pado0:
    s_waitcnt vmcnt(13) lgkmcnt(0)
    ds_read_b128 a[0:3], v4 offset:0
    ds_read_b128 a[4:7], v5 offset:0
    ds_read_b128 a[8:11], v4 offset:2048
    ds_read_b128 a[12:15], v5 offset:2048
    ds_read_b128 a[16:19], v4 offset:4096
    ds_read_b128 a[20:23], v5 offset:4096
    ds_read_b128 a[24:27], v4 offset:6144
    ds_read_b128 a[28:31], v5 offset:6144
    s_waitcnt vmcnt(9) lgkmcnt(0)
    s_barrier
    ds_read_b64_tr_b16 a[64:65], v8 offset:0
    ds_read_b64_tr_b16 a[66:67], v8 offset:1024
    ds_read_b64_tr_b16 a[68:69], v8 offset:8192
    ds_read_b64_tr_b16 a[70:71], v8 offset:9216
    ds_read_b64_tr_b16 a[72:73], v9 offset:0
    ds_read_b64_tr_b16 a[74:75], v9 offset:1024
    ds_read_b64_tr_b16 a[76:77], v9 offset:8192
    ds_read_b64_tr_b16 a[78:79], v9 offset:9216
    s_waitcnt lgkmcnt(6)
    v_mfma_f32_16x16x32_bf16 a[128:131], a[64:67], a[0:3], 0
    s_waitcnt lgkmcnt(4)
    v_mfma_f32_16x16x32_bf16 a[128:131], a[68:71], a[4:7], a[128:131]
    s_add_u32 m0, s86, 32768
    s_waitcnt vmcnt(6)
    ds_read_b64_tr_b16 a[80:81], v10 offset:0
    v_lshlrev_b32 v44, 16, v32
    v_and_b32 v32, 0xffff0000, v32
    v_lshlrev_b32 v45, 16, v33
    v_and_b32 v33, 0xffff0000, v33
    v_lshlrev_b32 v46, 16, v34
    v_and_b32 v34, 0xffff0000, v34
    v_lshlrev_b32 v47, 16, v35
    v_and_b32 v35, 0xffff0000, v35
    v_lshlrev_b32 v48, 16, v36
    v_mfma_f32_16x16x32_bf16 a[132:135], a[64:67], a[8:11], 0
    buffer_load_dwordx4 v28, s[72:75], s78 offen offset:0 lds
    v_and_b32 v36, 0xffff0000, v36
    v_lshlrev_b32 v49, 16, v37
    v_and_b32 v37, 0xffff0000, v37
    v_lshlrev_b32 v50, 16, v38
    v_and_b32 v38, 0xffff0000, v38
    v_lshlrev_b32 v51, 16, v39
    v_and_b32 v39, 0xffff0000, v39
    v_lshlrev_b32 v52, 16, v40
    v_mfma_f32_16x16x32_bf16 a[132:135], a[68:71], a[12:15], a[132:135]
    ds_read_b64_tr_b16 a[82:83], v10 offset:1024
    v_and_b32 v40, 0xffff0000, v40
    v_lshlrev_b32 v53, 16, v41
    v_and_b32 v41, 0xffff0000, v41
    v_lshlrev_b32 v54, 16, v42
    v_and_b32 v42, 0xffff0000, v42
    v_lshlrev_b32 v55, 16, v43
    v_and_b32 v43, 0xffff0000, v43
    v_add_f32 v56, v44, v32
    v_add_f32 v56, v56, v45
    v_mfma_f32_16x16x32_bf16 a[136:139], a[64:67], a[16:19], 0
    v_add_f32 v56, v56, v33
    v_add_f32 v56, v56, v46
    v_add_f32 v56, v56, v34
    v_add_f32 v56, v56, v47
    v_add_f32 v56, v56, v35
    v_add_f32 v56, v56, v48
    v_add_f32 v56, v56, v36
    v_add_f32 v56, v56, v49
    v_add_f32 v56, v56, v37
    v_add_f32 v56, v56, v50
    v_mfma_f32_16x16x32_bf16 a[136:139], a[68:71], a[20:23], a[136:139]
    ds_read_b64_tr_b16 a[84:85], v10 offset:8192
    v_add_f32 v56, v56, v38
    v_add_f32 v56, v56, v51
    v_add_f32 v56, v56, v39
    v_add_f32 v56, v56, v52
    v_add_f32 v56, v56, v40
    v_add_f32 v56, v56, v53
    v_add_f32 v56, v56, v41
    v_add_f32 v56, v56, v54
    v_add_f32 v56, v56, v42
    v_mfma_f32_16x16x32_bf16 a[140:143], a[64:67], a[24:27], 0
    buffer_load_dwordx4 v29, s[72:75], s78 offen offset:1024 lds
    v_add_f32 v56, v56, v55
    v_add_f32 v56, v56, v43
    v_mfma_f32_16x16x32_bf16 a[140:143], a[68:71], a[28:31], a[140:143]
    s_waitcnt lgkmcnt(5)
    ds_read_b64_tr_b16 a[86:87], v10 offset:9216
    v_mfma_f32_16x16x32_bf16 a[144:147], a[72:75], a[0:3], 0
    s_waitcnt lgkmcnt(4)
    v_add_f32_dpp v56, v56, v56 row_ror:8 row_mask:0xf bank_mask:0xf
    v_mfma_f32_16x16x32_bf16 a[144:147], a[76:79], a[4:7], a[144:147]
    ds_read_b64_tr_b16 a[88:89], v11 offset:0
    v_mfma_f32_16x16x32_bf16 a[148:151], a[72:75], a[8:11], 0
    buffer_load_dwordx4 v30, s[72:75], s78 offen offset:2048 lds
    v_add_f32_dpp v56, v56, v56 row_ror:4 row_mask:0xf bank_mask:0xf
    v_mfma_f32_16x16x32_bf16 a[148:151], a[76:79], a[12:15], a[148:151]
    ds_read_b64_tr_b16 a[90:91], v11 offset:1024
    v_mfma_f32_16x16x32_bf16 a[152:155], a[72:75], a[16:19], 0
    v_add_f32_dpp v56, v56, v56 row_ror:2 row_mask:0xf bank_mask:0xf
    v_mfma_f32_16x16x32_bf16 a[152:155], a[76:79], a[20:23], a[152:155]
    ds_read_b64_tr_b16 a[92:93], v11 offset:8192
    v_mfma_f32_16x16x32_bf16 a[156:159], a[72:75], a[24:27], 0
    buffer_load_dwordx4 v31, s[72:75], s78 offen offset:3072 lds
    v_add_f32_dpp v56, v56, v56 row_ror:1 row_mask:0xf bank_mask:0xf
    v_mov_b32 v57, v56
    v_mfma_f32_16x16x32_bf16 a[156:159], a[76:79], a[28:31], a[156:159]
    s_waitcnt lgkmcnt(5)
    s_add_u32 s78, s78, s82
    ds_read_b64_tr_b16 a[94:95], v11 offset:9216
    v_mfma_f32_16x16x32_bf16 a[160:163], a[80:83], a[0:3], 0
    s_waitcnt lgkmcnt(4)
    v_permlane16_swap_b32 v56, v57
    v_add_f32 v56, v56, v57
    v_mul_f32 v59, 0x3acccccd, v56
    v_cvt_pk_bf16_f32 v58, v59, v59
    v_lshlrev_b32 v58, 16, v58
    v_sub_f32 v59, v59, v58
    v_sub_f32 v44, v44, v58
    v_sub_f32 v32, v32, v58
    v_sub_f32 v45, v45, v58
    v_sub_f32 v33, v33, v58
    v_mfma_f32_16x16x32_bf16 a[160:163], a[84:87], a[4:7], a[160:163]
    s_add_u32 m0, s86, 36864
    ds_read_b64_tr_b16 a[64:65], v12 offset:0
    v_sub_f32 v46, v46, v58
    v_sub_f32 v34, v34, v58
    v_sub_f32 v47, v47, v58
    v_sub_f32 v35, v35, v58
    v_sub_f32 v48, v48, v58
    v_sub_f32 v36, v36, v58
    v_sub_f32 v49, v49, v58
    v_sub_f32 v37, v37, v58
    v_sub_f32 v50, v50, v58
    v_mfma_f32_16x16x32_bf16 a[164:167], a[80:83], a[8:11], 0
    buffer_load_dwordx4 v28, s[72:75], s79 offen offset:0 lds
    v_sub_f32 v38, v38, v58
    v_sub_f32 v51, v51, v58
    v_sub_f32 v39, v39, v58
    v_cndmask_b32 v58, 0, v58, s[98:99]
    v_sub_f32 v52, v52, v58
    v_sub_f32 v40, v40, v58
    v_sub_f32 v53, v53, v58
    v_sub_f32 v41, v41, v58
    v_mfma_f32_16x16x32_bf16 a[164:167], a[84:87], a[12:15], a[164:167]
    ds_read_b64_tr_b16 a[66:67], v12 offset:1024
    v_sub_f32 v54, v54, v58
    v_sub_f32 v42, v42, v58
    v_sub_f32 v55, v55, v58
    v_sub_f32 v43, v43, v58
    v_mul_f32 v56, v44, v44
    v_fmac_f32 v56, v32, v32
    v_fmac_f32 v56, v45, v45
    v_fmac_f32 v56, v33, v33
    v_fmac_f32 v56, v46, v46
    v_mfma_f32_16x16x32_bf16 a[168:171], a[80:83], a[16:19], 0
    v_fmac_f32 v56, v34, v34
    v_fmac_f32 v56, v47, v47
    v_fmac_f32 v56, v35, v35
    v_fmac_f32 v56, v48, v48
    v_fmac_f32 v56, v36, v36
    v_fmac_f32 v56, v49, v49
    v_fmac_f32 v56, v37, v37
    v_fmac_f32 v56, v50, v50
    v_fmac_f32 v56, v38, v38
    v_fmac_f32 v56, v51, v51
    v_mfma_f32_16x16x32_bf16 a[168:171], a[84:87], a[20:23], a[168:171]
    ds_read_b64_tr_b16 a[68:69], v12 offset:8192
    v_fmac_f32 v56, v39, v39
    v_fmac_f32 v56, v52, v52
    v_fmac_f32 v56, v40, v40
    v_fmac_f32 v56, v53, v53
    v_fmac_f32 v56, v41, v41
    v_fmac_f32 v56, v54, v54
    v_fmac_f32 v56, v42, v42
    v_fmac_f32 v56, v55, v55
    v_fmac_f32 v56, v43, v43
    v_mfma_f32_16x16x32_bf16 a[172:175], a[80:83], a[24:27], 0
    buffer_load_dwordx4 v29, s[72:75], s79 offen offset:1024 lds
    v_mfma_f32_16x16x32_bf16 a[172:175], a[84:87], a[28:31], a[172:175]
    s_waitcnt lgkmcnt(5)
    ds_read_b64_tr_b16 a[70:71], v12 offset:9216
    v_add_f32_dpp v56, v56, v56 row_ror:8 row_mask:0xf bank_mask:0xf
    v_mfma_f32_16x16x32_bf16 a[176:179], a[88:91], a[0:3], 0
    s_waitcnt lgkmcnt(4)
    v_mfma_f32_16x16x32_bf16 a[176:179], a[92:95], a[4:7], a[176:179]
    ds_read_b64_tr_b16 a[72:73], v13 offset:0
    v_add_f32_dpp v56, v56, v56 row_ror:4 row_mask:0xf bank_mask:0xf
    v_mfma_f32_16x16x32_bf16 a[180:183], a[88:91], a[8:11], 0
    buffer_load_dwordx4 v30, s[72:75], s79 offen offset:2048 lds
    v_mfma_f32_16x16x32_bf16 a[180:183], a[92:95], a[12:15], a[180:183]
    ds_read_b64_tr_b16 a[74:75], v13 offset:1024
    v_add_f32_dpp v56, v56, v56 row_ror:2 row_mask:0xf bank_mask:0xf
    v_mfma_f32_16x16x32_bf16 a[184:187], a[88:91], a[16:19], 0
    v_mfma_f32_16x16x32_bf16 a[184:187], a[92:95], a[20:23], a[184:187]
    ds_read_b64_tr_b16 a[76:77], v13 offset:8192
    v_add_f32_dpp v56, v56, v56 row_ror:1 row_mask:0xf bank_mask:0xf
    v_mov_b32 v57, v56
    v_mfma_f32_16x16x32_bf16 a[188:191], a[88:91], a[24:27], 0
    buffer_load_dwordx4 v31, s[72:75], s79 offen offset:3072 lds
    v_mfma_f32_16x16x32_bf16 a[188:191], a[92:95], a[28:31], a[188:191]
    s_waitcnt lgkmcnt(5)
    s_add_u32 s79, s79, s82
    ds_read_b64_tr_b16 a[78:79], v13 offset:9216
    v_permlane16_swap_b32 v56, v57
    v_add_f32 v56, v56, v57
    v_mul_f32 v56, 0x3acccccd, v56
    v_fma_f32 v56, -v59, v59, v56
    v_max_f32 v56, 0, v56
    v_cvt_pk_bf16_f32 v56, v56, v56
    v_lshlrev_b32 v56, 16, v56
    v_add_f32 v56, 0x3727c5ac, v56
    v_cvt_pk_bf16_f32 v56, v56, v56
    v_mfma_f32_16x16x32_bf16 v[64:67], a[64:67], a[0:3], 0
    s_waitcnt lgkmcnt(4)
    v_lshlrev_b32 v56, 16, v56
    v_sqrt_f32 v56, v56
    v_mfma_f32_16x16x32_bf16 v[64:67], a[68:71], a[4:7], v[64:67]
    s_mov_b32 m0, s84
    ds_read_b64_tr_b16 a[80:81], v14 offset:0
    v_cvt_pk_bf16_f32 v56, v56, v56
    v_lshlrev_b32 v56, 16, v56
    v_rcp_f32 v56, v56
    v_mfma_f32_16x16x32_bf16 v[68:71], a[64:67], a[8:11], 0
    buffer_load_dwordx4 v20, s[60:63], s76 offen offset:0 lds
    v_mul_f32 v56, 0x3e0293ee, v56
    v_mul_f32 v44, v44, v56
    v_mul_f32 v32, v32, v56
    v_cvt_pk_bf16_f32 v32, v44, v32
    v_mul_f32 v45, v45, v56
    v_mul_f32 v33, v33, v56
    v_cvt_pk_bf16_f32 v33, v45, v33
    v_mul_f32 v46, v46, v56
    v_mfma_f32_16x16x32_bf16 v[68:71], a[68:71], a[12:15], v[68:71]
    ds_read_b64_tr_b16 a[82:83], v14 offset:1024
    v_mul_f32 v34, v34, v56
    v_cvt_pk_bf16_f32 v34, v46, v34
    v_mul_f32 v47, v47, v56
    v_mul_f32 v35, v35, v56
    v_cvt_pk_bf16_f32 v35, v47, v35
    v_mfma_f32_16x16x32_bf16 v[72:75], a[64:67], a[16:19], 0
    buffer_store_dwordx4 v[32:35], v6, s[44:47], s89 offen offset:0 sc1
    v_mul_f32 v48, v48, v56
    v_mul_f32 v36, v36, v56
    v_cvt_pk_bf16_f32 v36, v48, v36
    v_mul_f32 v49, v49, v56
    v_mul_f32 v37, v37, v56
    v_cvt_pk_bf16_f32 v37, v49, v37
    v_mul_f32 v50, v50, v56
    v_mul_f32 v38, v38, v56
    v_mfma_f32_16x16x32_bf16 v[72:75], a[68:71], a[20:23], v[72:75]
    ds_read_b64_tr_b16 a[84:85], v14 offset:8192
    v_cvt_pk_bf16_f32 v38, v50, v38
    v_mul_f32 v51, v51, v56
    v_mul_f32 v39, v39, v56
    v_cvt_pk_bf16_f32 v39, v51, v39
    v_mfma_f32_16x16x32_bf16 v[76:79], a[64:67], a[24:27], 0
    buffer_load_dwordx4 v21, s[60:63], s76 offen offset:1024 lds
    buffer_store_dwordx4 v[36:39], v6, s[44:47], s89 offen offset:512 sc1
    v_mul_f32 v52, v52, v56
    v_mul_f32 v40, v40, v56
    v_cvt_pk_bf16_f32 v40, v52, v40
    v_mul_f32 v53, v53, v56
    v_mul_f32 v41, v41, v56
    v_cvt_pk_bf16_f32 v41, v53, v41
    v_mfma_f32_16x16x32_bf16 v[76:79], a[68:71], a[28:31], v[76:79]
    s_waitcnt lgkmcnt(5)
    ds_read_b64_tr_b16 a[86:87], v14 offset:9216
    v_mul_f32 v54, v54, v56
    v_mul_f32 v42, v42, v56
    v_cvt_pk_bf16_f32 v42, v54, v42
    v_mul_f32 v55, v55, v56
    v_mul_f32 v43, v43, v56
    v_cvt_pk_bf16_f32 v43, v55, v43
    v_mfma_f32_16x16x32_bf16 v[80:83], a[72:75], a[0:3], 0
    s_waitcnt lgkmcnt(4)
    buffer_store_dwordx4 v[40:43], v60, s[44:47], s89 offen offset:1024 sc1
    v_mfma_f32_16x16x32_bf16 v[80:83], a[76:79], a[4:7], v[80:83]
    ds_read_b64_tr_b16 a[88:89], v15 offset:0
    v_mfma_f32_16x16x32_bf16 v[84:87], a[72:75], a[8:11], 0
    buffer_load_dwordx4 v22, s[60:63], s76 offen offset:2048 lds
    v_mfma_f32_16x16x32_bf16 v[84:87], a[76:79], a[12:15], v[84:87]
    ds_read_b64_tr_b16 a[90:91], v15 offset:1024
    v_mfma_f32_16x16x32_bf16 v[88:91], a[72:75], a[16:19], 0
    s_waitcnt vmcnt(14)
    s_barrier
    s_lshl_b32 s55, s2, 4
    v_mfma_f32_16x16x32_bf16 v[88:91], a[76:79], a[20:23], v[88:91]
    ds_read_b64_tr_b16 a[92:93], v15 offset:8192
    v_mfma_f32_16x16x32_bf16 v[92:95], a[72:75], a[24:27], 0
    buffer_load_dwordx4 v23, s[60:63], s76 offen offset:3072 lds
    v_mfma_f32_16x16x32_bf16 v[92:95], a[76:79], a[28:31], v[92:95]
    s_waitcnt lgkmcnt(5)
    s_add_u32 s76, s76, s80
    ds_read_b64_tr_b16 a[94:95], v15 offset:9216
    v_mov_b32 v56, s55
    v_mfma_f32_16x16x32_bf16 v[96:99], a[80:83], a[0:3], 0
    s_waitcnt lgkmcnt(4)
    v_cmp_eq_u32 vcc, 0, v0
    v_mov_b32 v57, 0x7ffffff0
    v_mfma_f32_16x16x32_bf16 v[96:99], a[84:87], a[4:7], v[96:99]
    s_add_u32 m0, s84, 16384
    ds_read_b64_tr_b16 a[64:65], v8 offset:16384
    v_and_b32 v63, 15, v2
    v_mfma_f32_16x16x32_bf16 v[100:103], a[80:83], a[8:11], 0
    buffer_load_dwordx4 v24, s[64:67], s77 offen offset:0 lds
    v_mfma_f32_16x16x32_bf16 v[100:103], a[84:87], a[12:15], v[100:103]
    ds_read_b64_tr_b16 a[66:67], v8 offset:17408
    v_cndmask_b32 v56, v57, v56, vcc
    v_mfma_f32_16x16x32_bf16 v[104:107], a[80:83], a[16:19], 0
    v_mov_b32 v57, -1
    v_lshlrev_b32 v63, 4, v63
    v_mfma_f32_16x16x32_bf16 v[104:107], a[84:87], a[20:23], v[104:107]
    ds_read_b64_tr_b16 a[68:69], v8 offset:24576
    v_mfma_f32_16x16x32_bf16 v[108:111], a[80:83], a[24:27], 0
    buffer_load_dwordx4 v25, s[64:67], s77 offen offset:1024 lds
    v_mfma_f32_16x16x32_bf16 v[108:111], a[84:87], a[28:31], v[108:111]
    s_waitcnt lgkmcnt(5)
    ds_read_b64_tr_b16 a[70:71], v8 offset:25600
    v_mfma_f32_16x16x32_bf16 v[112:115], a[88:91], a[0:3], 0
    s_waitcnt lgkmcnt(4)
    buffer_store_dword v57, v56, s[48:51], 0 offen sc1
    v_mfma_f32_16x16x32_bf16 v[112:115], a[92:95], a[4:7], v[112:115]
    ds_read_b64_tr_b16 a[72:73], v9 offset:16384
    v_mfma_f32_16x16x32_bf16 v[116:119], a[88:91], a[8:11], 0
    buffer_load_dwordx4 v26, s[68:71], s77 offen offset:2048 lds
    v_mfma_f32_16x16x32_bf16 v[116:119], a[92:95], a[12:15], v[116:119]
    ds_read_b64_tr_b16 a[74:75], v9 offset:17408
    v_mfma_f32_16x16x32_bf16 v[120:123], a[88:91], a[16:19], 0
    s_cmp_lt_u32 s52, 2
    s_cbranch_scc1 L_hop1
    s_bitcmp1_b32 s52, 0
    s_cbranch_scc1 L_pad7
    s_branch L_pad6
L_hop1:
    s_bitcmp1_b32 s52, 0
    s_cbranch_scc1 L_pad5
    s_branch L_pad4
L_tour_ret1:
    v_mfma_f32_16x16x32_bf16 v[120:123], a[92:95], a[20:23], v[120:123]
    ds_read_b64_tr_b16 a[76:77], v9 offset:24576
    v_mfma_f32_16x16x32_bf16 v[124:127], a[88:91], a[24:27], 0
    buffer_load_dwordx4 v27, s[68:71], s77 offen offset:3072 lds
    v_mfma_f32_16x16x32_bf16 v[124:127], a[92:95], a[28:31], v[124:127]
    s_waitcnt lgkmcnt(5)
    s_add_u32 s77, s77, s81
    s_add_u32 m0, s86, 0
    ds_read_b64_tr_b16 a[78:79], v9 offset:25600
    v_mfma_f32_16x16x32_bf16 v[128:131], a[0:3], a[64:67], 0
    s_waitcnt lgkmcnt(4)
    buffer_load_dwordx4 v28, s[72:75], s78 offen offset:0 sc1 lds
    v_mfma_f32_16x16x32_bf16 v[128:131], a[4:7], a[68:71], v[128:131]
    ds_read_b64_tr_b16 a[80:81], v10 offset:16384
    v_mfma_f32_16x16x32_bf16 v[132:135], a[8:11], a[64:67], 0
    v_mfma_f32_16x16x32_bf16 v[132:135], a[12:15], a[68:71], v[132:135]
    ds_read_b64_tr_b16 a[82:83], v10 offset:17408
    v_mfma_f32_16x16x32_bf16 v[136:139], a[16:19], a[64:67], 0
    buffer_load_dwordx4 v29, s[72:75], s78 offen offset:1024 sc1 lds
    v_mfma_f32_16x16x32_bf16 v[136:139], a[20:23], a[68:71], v[136:139]
    ds_read_b64_tr_b16 a[84:85], v10 offset:24576
    v_mfma_f32_16x16x32_bf16 v[140:143], a[24:27], a[64:67], 0
    v_mfma_f32_16x16x32_bf16 v[140:143], a[28:31], a[68:71], v[140:143]
    s_waitcnt lgkmcnt(5)
    ds_read_b64_tr_b16 a[86:87], v10 offset:25600
    v_mfma_f32_16x16x32_bf16 v[144:147], a[0:3], a[72:75], 0
    s_waitcnt lgkmcnt(4)
    buffer_load_dwordx4 v30, s[72:75], s78 offen offset:2048 sc1 lds
    v_mfma_f32_16x16x32_bf16 v[144:147], a[4:7], a[76:79], v[144:147]
    ds_read_b64_tr_b16 a[88:89], v11 offset:16384
    v_mfma_f32_16x16x32_bf16 v[148:151], a[8:11], a[72:75], 0
    v_mfma_f32_16x16x32_bf16 v[148:151], a[12:15], a[76:79], v[148:151]
    ds_read_b64_tr_b16 a[90:91], v11 offset:17408
    v_mfma_f32_16x16x32_bf16 v[152:155], a[16:19], a[72:75], 0
    buffer_load_dwordx4 v31, s[72:75], s78 offen offset:3072 sc1 lds
    v_mfma_f32_16x16x32_bf16 v[152:155], a[20:23], a[76:79], v[152:155]
    ds_read_b64_tr_b16 a[92:93], v11 offset:24576
    v_mfma_f32_16x16x32_bf16 v[156:159], a[24:27], a[72:75], 0
    v_mfma_f32_16x16x32_bf16 v[156:159], a[28:31], a[76:79], v[156:159]
    s_waitcnt lgkmcnt(5)
    s_add_u32 m0, s86, 4096
    ds_read_b64_tr_b16 a[94:95], v11 offset:25600
    v_mfma_f32_16x16x32_bf16 v[160:163], a[0:3], a[80:83], 0
    s_waitcnt lgkmcnt(4)
    buffer_load_dwordx4 v28, s[72:75], s79 offen offset:0 sc1 lds
    v_mfma_f32_16x16x32_bf16 v[160:163], a[4:7], a[84:87], v[160:163]
    ds_read_b64_tr_b16 a[64:65], v12 offset:16384
    v_mfma_f32_16x16x32_bf16 v[164:167], a[8:11], a[80:83], 0
    v_mfma_f32_16x16x32_bf16 v[164:167], a[12:15], a[84:87], v[164:167]
    ds_read_b64_tr_b16 a[66:67], v12 offset:17408
    v_mfma_f32_16x16x32_bf16 v[168:171], a[16:19], a[80:83], 0
    s_waitcnt vmcnt(17)
    buffer_load_dwordx4 v29, s[72:75], s79 offen offset:1024 sc1 lds
    s_lshr_b32 s55, s2, 3
    s_lshl_b32 s55, s55, 2
    s_add_u32 s55, s55, s52
    s_lshr_b32 s56, s53, 3
    s_mul_i32 s57, s56, 3
    s_add_u32 s57, s57, 16
    s_lshl_b32 s56, s56, 2
    s_bitcmp1_b32 s2, 0
    s_cselect_b32 s57, s57, s56
    s_lshr_b32 s56, s53, 2
    s_lshl_b32 s56, s56, 3
    s_lshl_b32 s3, s55, 6
    s_add_u32 s56, s56, s3
    s_mul_i32 s55, s55, 27
    s_add_u32 s55, s55, s57
    s_sub_u32 s57, 27, s57
    s_min_u32 s57, s57, 4
    v_mov_b32 v55, 0x7fff0000
    v_cmp_gt_u32 vcc, 8, v2
    v_add_u32 v52, s56, v2
    v_lshlrev_b32 v52, 7, v52
    v_cndmask_b32 v61, v55, v52, vcc
    v_cmp_gt_u32 vcc, s57, v2
    v_add_u32 v52, s55, v2
    v_lshlrev_b32 v52, 7, v52
    v_cndmask_b32 v62, v55, v52, vcc
    v_mfma_f32_16x16x32_bf16 v[168:171], a[20:23], a[84:87], v[168:171]
    ds_read_b64_tr_b16 a[68:69], v12 offset:24576
    ds_read_b128 a[32:35], v4 offset:32768
    v_mfma_f32_16x16x32_bf16 v[172:175], a[24:27], a[80:83], 0
    ds_read_b128 a[36:39], v5 offset:32768
    v_mfma_f32_16x16x32_bf16 v[172:175], a[28:31], a[84:87], v[172:175]
    s_waitcnt lgkmcnt(7)
    ds_read_b64_tr_b16 a[70:71], v12 offset:25600
    ds_read_b128 a[40:43], v4 offset:34816
    v_mfma_f32_16x16x32_bf16 v[176:179], a[0:3], a[88:91], 0
    s_waitcnt lgkmcnt(7)
    buffer_load_dwordx4 v30, s[72:75], s79 offen offset:2048 sc1 lds
    v_mfma_f32_16x16x32_bf16 v[176:179], a[4:7], a[92:95], v[176:179]
    ds_read_b64_tr_b16 a[72:73], v13 offset:16384
    ds_read_b128 a[44:47], v5 offset:34816
    v_mfma_f32_16x16x32_bf16 v[180:183], a[8:11], a[88:91], 0
    ds_read_b128 a[48:51], v4 offset:36864
    v_mfma_f32_16x16x32_bf16 v[180:183], a[12:15], a[92:95], v[180:183]
    ds_read_b64_tr_b16 a[74:75], v13 offset:17408
    ds_read_b128 a[52:55], v5 offset:36864
    v_mfma_f32_16x16x32_bf16 v[184:187], a[16:19], a[88:91], 0
    buffer_load_dwordx4 v31, s[72:75], s79 offen offset:3072 sc1 lds
    v_mfma_f32_16x16x32_bf16 v[184:187], a[20:23], a[92:95], v[184:187]
    s_add_u32 s78, s78, s82
    ds_read_b64_tr_b16 a[76:77], v13 offset:24576
    ds_read_b128 a[56:59], v4 offset:38912
    v_mfma_f32_16x16x32_bf16 v[188:191], a[24:27], a[88:91], 0
    s_add_u32 s79, s79, s82
    ds_read_b128 a[60:63], v5 offset:38912
    v_mfma_f32_16x16x32_bf16 v[188:191], a[28:31], a[92:95], v[188:191]
    s_waitcnt lgkmcnt(13)
    s_mov_b32 m0, s83
    ds_read_b64_tr_b16 a[78:79], v13 offset:25600
    v_mfma_f32_16x16x32_bf16 v[192:195], a[0:3], a[64:67], 0
    s_waitcnt lgkmcnt(10)
    buffer_load_dwordx4 v20, s[60:63], s76 offen offset:0 lds
    v_mfma_f32_16x16x32_bf16 v[192:195], a[4:7], a[68:71], v[192:195]
    ds_read_b64_tr_b16 a[80:81], v14 offset:16384
    v_mfma_f32_16x16x32_bf16 v[196:199], a[8:11], a[64:67], 0
    s_sub_u32 s87, s84, s85
    ds_read_b64_tr_b16 a[88:89], v15 offset:16384
    v_mfma_f32_16x16x32_bf16 v[196:199], a[12:15], a[68:71], v[196:199]
    ds_read_b64_tr_b16 a[82:83], v14 offset:17408
    v_mfma_f32_16x16x32_bf16 v[200:203], a[16:19], a[64:67], 0
    ds_read_b64_tr_b16 a[90:91], v15 offset:17408
    v_add_u32 v8, s87, v8
    v_mfma_f32_16x16x32_bf16 v[200:203], a[20:23], a[68:71], v[200:203]
    ds_read_b64_tr_b16 a[84:85], v14 offset:24576
    v_add_u32 v9, s87, v9
    v_mfma_f32_16x16x32_bf16 v[204:207], a[24:27], a[64:67], 0
    ds_read_b64_tr_b16 a[92:93], v15 offset:24576
    v_add_u32 v10, s87, v10
    v_mfma_f32_16x16x32_bf16 v[204:207], a[28:31], a[68:71], v[204:207]
    s_waitcnt lgkmcnt(11)
    ds_read_b64_tr_b16 a[86:87], v14 offset:25600
    v_add_u32 v11, s87, v11
    v_mfma_f32_16x16x32_bf16 v[208:211], a[0:3], a[72:75], 0
    s_waitcnt lgkmcnt(7)
    ds_read_b64_tr_b16 a[94:95], v15 offset:25600
    v_add_u32 v12, s87, v12
    v_mfma_f32_16x16x32_bf16 v[208:211], a[4:7], a[76:79], v[208:211]
    buffer_load_dwordx4 v21, s[60:63], s76 offen offset:1024 lds
    v_add_u32 v13, s87, v13
    v_mfma_f32_16x16x32_bf16 v[212:215], a[8:11], a[72:75], 0
    v_add_u32 v14, s87, v14
    v_mfma_f32_16x16x32_bf16 v[212:215], a[12:15], a[76:79], v[212:215]
    buffer_load_dwordx4 v22, s[60:63], s76 offen offset:2048 lds
    v_add_u32 v15, s87, v15
    v_mfma_f32_16x16x32_bf16 v[216:219], a[16:19], a[72:75], 0
    v_mfma_f32_16x16x32_bf16 v[216:219], a[20:23], a[76:79], v[216:219]
    buffer_load_dwordx4 v23, s[60:63], s76 offen offset:3072 lds
    v_mfma_f32_16x16x32_bf16 v[220:223], a[24:27], a[72:75], 0
    s_add_u32 m0, s83, 16384
    s_add_u32 s76, s76, s80
    v_mfma_f32_16x16x32_bf16 v[220:223], a[28:31], a[76:79], v[220:223]
    s_waitcnt lgkmcnt(5)
    s_mov_b32 s58, s85
    buffer_load_dwordx4 v24, s[64:67], s77 offen offset:0 lds
    s_cmp_lt_u32 s52, 2
    s_cbranch_scc1 L_hop2
    s_bitcmp1_b32 s52, 0
    s_cbranch_scc1 L_pad11
    s_branch L_pad10
L_hop2:
    s_bitcmp1_b32 s52, 0
    s_cbranch_scc1 L_pad9
    s_branch L_pad8
L_tour_ret2:
    v_mfma_f32_16x16x32_bf16 v[224:227], a[0:3], a[80:83], 0
    s_waitcnt vmcnt(13) lgkmcnt(0)
    s_barrier
    s_mov_b32 s85, s84
    v_mfma_f32_16x16x32_bf16 v[224:227], a[4:7], a[84:87], v[224:227]
    s_mov_b32 s84, s83
    ds_read_b64_tr_b16 a[64:65], v8 offset:0
    v_mfma_f32_16x16x32_bf16 v[228:231], a[8:11], a[80:83], 0
    s_mov_b32 s83, s58
    buffer_load_dwordx4 v25, s[64:67], s77 offen offset:1024 lds
    v_mfma_f32_16x16x32_bf16 v[228:231], a[12:15], a[84:87], v[228:231]
    ds_read_b64_tr_b16 a[66:67], v8 offset:1024
    v_mfma_f32_16x16x32_bf16 v[232:235], a[16:19], a[80:83], 0
    v_mfma_f32_16x16x32_bf16 v[232:235], a[20:23], a[84:87], v[232:235]
    ds_read_b64_tr_b16 a[68:69], v8 offset:8192
    v_mfma_f32_16x16x32_bf16 v[236:239], a[24:27], a[80:83], 0
    buffer_load_dwordx4 v26, s[68:71], s77 offen offset:2048 lds
    v_mfma_f32_16x16x32_bf16 v[236:239], a[28:31], a[84:87], v[236:239]
    ds_read_b64_tr_b16 a[70:71], v8 offset:9216
    v_mfma_f32_16x16x32_bf16 v[240:243], a[0:3], a[88:91], 0
    ds_read_b64_tr_b16 a[72:73], v9 offset:0
    v_mfma_f32_16x16x32_bf16 v[240:243], a[4:7], a[92:95], v[240:243]
    v_mfma_f32_16x16x32_bf16 v[244:247], a[8:11], a[88:91], 0
    ds_read_b64_tr_b16 a[74:75], v9 offset:1024
    v_mfma_f32_16x16x32_bf16 v[244:247], a[12:15], a[92:95], v[244:247]
    buffer_load_dwordx4 v27, s[68:71], s77 offen offset:3072 lds
    v_mfma_f32_16x16x32_bf16 v[248:251], a[16:19], a[88:91], 0
    s_add_u32 s77, s77, s81
    ds_read_b64_tr_b16 a[76:77], v9 offset:8192
    v_mfma_f32_16x16x32_bf16 v[248:251], a[20:23], a[92:95], v[248:251]
    v_mfma_f32_16x16x32_bf16 v[252:255], a[24:27], a[88:91], 0
    ds_read_b64_tr_b16 a[78:79], v9 offset:9216
    v_mfma_f32_16x16x32_bf16 v[252:255], a[28:31], a[92:95], v[252:255]
    s_waitcnt lgkmcnt(6)
    v_mfma_f32_16x16x32_bf16 a[128:131], a[64:67], a[32:35], a[128:131]
    s_waitcnt lgkmcnt(4)
    v_mfma_f32_16x16x32_bf16 a[128:131], a[68:71], a[36:39], a[128:131]
    s_add_u32 m0, s86, 32768
    ds_read_b64_tr_b16 a[80:81], v10 offset:0
    v_mfma_f32_16x16x32_bf16 a[132:135], a[64:67], a[40:43], a[132:135]
    buffer_load_dwordx4 v28, s[72:75], s78 offen offset:0 sc1 lds
    v_lshrrev_b32 v32, 3, v2
    v_add_u32 v33, 0, v32
    v_lshl_add_u32 v48, v33, 8, v28
    v_add_u32 v33, 8, v32
    v_lshl_add_u32 v49, v33, 8, v29
    v_add_u32 v33, 16, v32
    v_lshl_add_u32 v50, v33, 8, v30
    v_add_u32 v33, 24, v32
    v_lshl_add_u32 v51, v33, 8, v31
    v_lshrrev_b32 v32, 3, v2
    v_and_b32 v33, 7, v2
    v_bfe_u32 v34, v2, 4, 1
    v_mul_u32_u24 v32, 3456, v32
    v_or_b32 v35, 0, v34
    v_lshlrev_b32 v35, 1, v35
    v_xor_b32 v35, v35, v33
    v_lshl_add_u32 v35, v35, 4, v32
    v_add_u32 v52, 2048, v35
    v_add_u32 v54, 0, v35
    v_or_b32 v35, 2, v34
    v_lshlrev_b32 v35, 1, v35
    v_xor_b32 v35, v35, v33
    v_lshl_add_u32 v35, v35, 4, v32
    v_add_u32 v53, 28672, v35
    v_add_u32 v55, 26624, v35
    v_mfma_f32_16x16x32_bf16 a[132:135], a[68:71], a[44:47], a[132:135]
    ds_read_b64_tr_b16 a[82:83], v10 offset:1024
    v_mfma_f32_16x16x32_bf16 a[136:139], a[64:67], a[48:51], a[136:139]
    v_mfma_f32_16x16x32_bf16 a[136:139], a[68:71], a[52:55], a[136:139]
    ds_read_b64_tr_b16 a[84:85], v10 offset:8192
    v_mfma_f32_16x16x32_bf16 a[140:143], a[64:67], a[56:59], a[140:143]
    v_mfma_f32_16x16x32_bf16 a[140:143], a[68:71], a[60:63], a[140:143]
    s_waitcnt lgkmcnt(5)
    ds_read_b64_tr_b16 a[86:87], v10 offset:9216
    v_mfma_f32_16x16x32_bf16 a[144:147], a[72:75], a[32:35], a[144:147]
    s_waitcnt lgkmcnt(4)
    v_mfma_f32_16x16x32_bf16 a[144:147], a[76:79], a[36:39], a[144:147]
    ds_read_b64_tr_b16 a[88:89], v11 offset:0
    v_mfma_f32_16x16x32_bf16 a[148:151], a[72:75], a[40:43], a[148:151]
    buffer_load_dwordx4 v29, s[72:75], s78 offen offset:1024 sc1 lds
    v_mfma_f32_16x16x32_bf16 a[148:151], a[76:79], a[44:47], a[148:151]
    ds_read_b64_tr_b16 a[90:91], v11 offset:1024
    v_mfma_f32_16x16x32_bf16 a[152:155], a[72:75], a[48:51], a[152:155]
    v_mfma_f32_16x16x32_bf16 a[152:155], a[76:79], a[52:55], a[152:155]
    ds_read_b64_tr_b16 a[92:93], v11 offset:8192
    v_mfma_f32_16x16x32_bf16 a[156:159], a[72:75], a[56:59], a[156:159]
    v_mfma_f32_16x16x32_bf16 a[156:159], a[76:79], a[60:63], a[156:159]
    s_waitcnt lgkmcnt(5)
    ds_read_b64_tr_b16 a[94:95], v11 offset:9216
    v_mfma_f32_16x16x32_bf16 a[160:163], a[80:83], a[32:35], a[160:163]
    s_waitcnt lgkmcnt(4)
    v_mfma_f32_16x16x32_bf16 a[160:163], a[84:87], a[36:39], a[160:163]
    ds_read_b64_tr_b16 a[64:65], v12 offset:0
    v_mfma_f32_16x16x32_bf16 a[164:167], a[80:83], a[40:43], a[164:167]
    buffer_load_dwordx4 v30, s[72:75], s78 offen offset:2048 sc1 lds
    v_mfma_f32_16x16x32_bf16 a[164:167], a[84:87], a[44:47], a[164:167]
    ds_read_b64_tr_b16 a[66:67], v12 offset:1024
    v_mfma_f32_16x16x32_bf16 a[168:171], a[80:83], a[48:51], a[168:171]
    v_mfma_f32_16x16x32_bf16 a[168:171], a[84:87], a[52:55], a[168:171]
    s_mov_b32 s88, 0
    ds_read_b64_tr_b16 a[68:69], v12 offset:8192
    v_mfma_f32_16x16x32_bf16 a[172:175], a[80:83], a[56:59], a[172:175]
    buffer_load_dword a232, v61, s[12:15], s88 offen
    v_mfma_f32_16x16x32_bf16 a[172:175], a[84:87], a[60:63], a[172:175]
    s_waitcnt lgkmcnt(5)
    ds_read_b64_tr_b16 a[70:71], v12 offset:9216
    v_mfma_f32_16x16x32_bf16 a[176:179], a[88:91], a[32:35], a[176:179]
    s_waitcnt lgkmcnt(4)
    v_mfma_f32_16x16x32_bf16 a[176:179], a[92:95], a[36:39], a[176:179]
    ds_read_b64_tr_b16 a[72:73], v13 offset:0
    v_mfma_f32_16x16x32_bf16 a[180:183], a[88:91], a[40:43], a[180:183]
    buffer_load_dwordx4 v31, s[72:75], s78 offen offset:3072 sc1 lds
    v_mfma_f32_16x16x32_bf16 a[180:183], a[92:95], a[44:47], a[180:183]
    ds_read_b64_tr_b16 a[74:75], v13 offset:1024
    v_mfma_f32_16x16x32_bf16 a[184:187], a[88:91], a[48:51], a[184:187]
    v_mfma_f32_16x16x32_bf16 a[184:187], a[92:95], a[52:55], a[184:187]
    ds_read_b64_tr_b16 a[76:77], v13 offset:8192
    v_mfma_f32_16x16x32_bf16 a[188:191], a[88:91], a[56:59], a[188:191]
    v_mfma_f32_16x16x32_bf16 a[188:191], a[92:95], a[60:63], a[188:191]
    s_waitcnt lgkmcnt(5)
    ds_read_b64_tr_b16 a[78:79], v13 offset:9216
    v_mfma_f32_16x16x32_bf16 v[64:67], a[64:67], a[32:35], v[64:67]
    s_waitcnt lgkmcnt(4)
    s_cmp_lt_u32 s52, 2
    s_cbranch_scc1 L_hop3
    s_bitcmp1_b32 s52, 0
    s_cbranch_scc1 L_pad15
    s_branch L_pad14
L_hop3:
    s_bitcmp1_b32 s52, 0
    s_cbranch_scc1 L_pad13
    s_branch L_pad12
L_tour_ret3:
    v_mfma_f32_16x16x32_bf16 v[64:67], a[68:71], a[36:39], v[64:67]
    s_add_u32 m0, s86, 36864
    ds_read_b64_tr_b16 a[80:81], v14 offset:0
    v_mfma_f32_16x16x32_bf16 v[68:71], a[64:67], a[40:43], v[68:71]
    buffer_load_dwordx4 v28, s[72:75], s79 offen offset:0 sc1 lds
    v_mfma_f32_16x16x32_bf16 v[68:71], a[68:71], a[44:47], v[68:71]
    ds_read_b64_tr_b16 a[82:83], v14 offset:1024
    v_mfma_f32_16x16x32_bf16 v[72:75], a[64:67], a[48:51], v[72:75]
    v_mfma_f32_16x16x32_bf16 v[72:75], a[68:71], a[52:55], v[72:75]
    ds_read_b64_tr_b16 a[84:85], v14 offset:8192
    v_mfma_f32_16x16x32_bf16 v[76:79], a[64:67], a[56:59], v[76:79]
    v_mfma_f32_16x16x32_bf16 v[76:79], a[68:71], a[60:63], v[76:79]
    s_branch L_pado1
L_pad1:
    s_branch L_tour_ret0
L_pado1:
    s_waitcnt lgkmcnt(5)
    ds_read_b64_tr_b16 a[86:87], v14 offset:9216
    v_mfma_f32_16x16x32_bf16 v[80:83], a[72:75], a[32:35], v[80:83]
    s_waitcnt lgkmcnt(4)
    v_mfma_f32_16x16x32_bf16 v[80:83], a[76:79], a[36:39], v[80:83]
    ds_read_b64_tr_b16 a[88:89], v15 offset:0
    v_mfma_f32_16x16x32_bf16 v[84:87], a[72:75], a[40:43], v[84:87]
    buffer_load_dwordx4 v29, s[72:75], s79 offen offset:1024 sc1 lds
    v_mfma_f32_16x16x32_bf16 v[84:87], a[76:79], a[44:47], v[84:87]
    ds_read_b64_tr_b16 a[90:91], v15 offset:1024
    v_mfma_f32_16x16x32_bf16 v[88:91], a[72:75], a[48:51], v[88:91]
    v_mfma_f32_16x16x32_bf16 v[88:91], a[76:79], a[52:55], v[88:91]
    ds_read_b64_tr_b16 a[92:93], v15 offset:8192
    v_mfma_f32_16x16x32_bf16 v[92:95], a[72:75], a[56:59], v[92:95]
    v_mfma_f32_16x16x32_bf16 v[92:95], a[76:79], a[60:63], v[92:95]
    s_waitcnt lgkmcnt(5)
    ds_read_b64_tr_b16 a[94:95], v15 offset:9216
    v_mfma_f32_16x16x32_bf16 v[96:99], a[80:83], a[32:35], v[96:99]
    s_waitcnt lgkmcnt(4)
    v_mfma_f32_16x16x32_bf16 v[96:99], a[84:87], a[36:39], v[96:99]
    ds_read_b64_tr_b16 a[64:65], v8 offset:16384
    v_mfma_f32_16x16x32_bf16 v[100:103], a[80:83], a[40:43], v[100:103]
    buffer_load_dwordx4 v30, s[72:75], s79 offen offset:2048 sc1 lds
    v_mfma_f32_16x16x32_bf16 v[100:103], a[84:87], a[44:47], v[100:103]
    ds_read_b64_tr_b16 a[66:67], v8 offset:17408
    v_mfma_f32_16x16x32_bf16 v[104:107], a[80:83], a[48:51], v[104:107]
    s_sub_u32 s55, 15, s54
    s_lshl_b32 s55, s55, 2
    s_add_u32 s55, s55, s52
    s_lshl_b32 s55, s55, 11
    s_add_u32 s55, s55, 83886080
    s_lshl_b32 s56, s54, 2
    s_add_u32 s56, s56, 3
    s_sub_u32 s56, s56, s52
    s_lshl_b32 s56, s56, 11
    s_add_u32 s56, s56, 83886080
    v_mov_b32 v32, s55
    v_mov_b32 v33, s56
    v_cndmask_b32 v32, v33, v32, s[98:99]
    v_and_b32 v33, 15, v2
    v_lshl_add_u32 v45, v33, 7, v32
    s_and_b32 s55, s53, 3
    s_lshr_b32 s56, s53, 3
    s_mul_i32 s57, s56, 3
    s_add_u32 s57, s57, 16
    s_lshl_b32 s56, s56, 2
    s_cmp_eq_u32 s55, 3
    s_cselect_b32 s57, 27, s57
    s_bitcmp1_b32 s2, 0
    s_cselect_b32 s91, s57, s56
    s_add_u32 s91, s91, s55
    s_mul_i32 s55, s101, 13108
    s_lshr_b32 s55, s55, 16
    s_cmp_lt_u32 s55, 128
    s_cselect_b64 s[24:25], s[24:25], s[36:37]
    s_cselect_b32 s26, s26, s38
    s_cmp_lt_u32 s101, 910
    s_cselect_b32 s26, s26, 0
    s_mul_i32 s56, s55, 5
    s_sub_u32 s56, s101, s56
    s_lshl_b32 s56, s56, 8
    s_and_b32 s57, s55, 127
    s_mul_i32 s57, s57, 40960
    s_add_u32 s36, s57, s56
    v_mfma_f32_16x16x32_bf16 v[104:107], a[84:87], a[52:55], v[104:107]
    ds_read_b64_tr_b16 a[68:69], v8 offset:24576
    v_mfma_f32_16x16x32_bf16 v[108:111], a[80:83], a[56:59], v[108:111]
    v_mfma_f32_16x16x32_bf16 v[108:111], a[84:87], a[60:63], v[108:111]
    s_waitcnt lgkmcnt(5)
    ds_read_b64_tr_b16 a[70:71], v8 offset:25600
    v_mfma_f32_16x16x32_bf16 v[112:115], a[88:91], a[32:35], v[112:115]
    s_waitcnt lgkmcnt(4)
    v_mfma_f32_16x16x32_bf16 v[112:115], a[92:95], a[36:39], v[112:115]
    ds_read_b64_tr_b16 a[72:73], v9 offset:16384
    v_mfma_f32_16x16x32_bf16 v[116:119], a[88:91], a[40:43], v[116:119]
    buffer_load_dwordx4 v31, s[72:75], s79 offen offset:3072 sc1 lds
    v_mfma_f32_16x16x32_bf16 v[116:119], a[92:95], a[44:47], v[116:119]
    s_add_u32 s78, s78, s82
    ds_read_b64_tr_b16 a[74:75], v9 offset:17408
    v_mfma_f32_16x16x32_bf16 v[120:123], a[88:91], a[48:51], v[120:123]
    s_add_u32 s79, s79, s82
    v_mfma_f32_16x16x32_bf16 v[120:123], a[92:95], a[52:55], v[120:123]
    s_mov_b32 s88, 0
    ds_read_b64_tr_b16 a[76:77], v9 offset:24576
    v_mfma_f32_16x16x32_bf16 v[124:127], a[88:91], a[56:59], v[124:127]
    buffer_load_dword a233, v62, s[28:31], s88 offen
    v_mfma_f32_16x16x32_bf16 v[124:127], a[92:95], a[60:63], v[124:127]
    s_waitcnt lgkmcnt(5)
    ds_read_b64_tr_b16 a[78:79], v9 offset:25600
    v_mfma_f32_16x16x32_bf16 v[128:131], a[32:35], a[64:67], v[128:131]
    s_waitcnt lgkmcnt(4)
    v_mfma_f32_16x16x32_bf16 v[128:131], a[36:39], a[68:71], v[128:131]
    s_mov_b32 m0, s83
    ds_read_b64_tr_b16 a[80:81], v10 offset:16384
    v_mfma_f32_16x16x32_bf16 v[132:135], a[40:43], a[64:67], v[132:135]
    buffer_load_dwordx4 v20, s[60:63], s76 offen offset:0 lds
    v_mfma_f32_16x16x32_bf16 v[132:135], a[44:47], a[68:71], v[132:135]
    ds_read_b64_tr_b16 a[82:83], v10 offset:17408
    v_mfma_f32_16x16x32_bf16 v[136:139], a[48:51], a[64:67], v[136:139]
    s_waitcnt vmcnt(19)
    v_mfma_f32_16x16x32_bf16 v[136:139], a[52:55], a[68:71], v[136:139]
    ds_read_b64_tr_b16 a[84:85], v10 offset:24576
    v_mfma_f32_16x16x32_bf16 v[140:143], a[56:59], a[64:67], v[140:143]
    ds_read_b128 a[0:3], v4 offset:0
    v_mfma_f32_16x16x32_bf16 v[140:143], a[60:63], a[68:71], v[140:143]
    s_waitcnt lgkmcnt(6)
    ds_read_b64_tr_b16 a[86:87], v10 offset:25600
    v_mfma_f32_16x16x32_bf16 v[144:147], a[32:35], a[72:75], v[144:147]
    s_waitcnt lgkmcnt(5)
    ds_read_b128 a[4:7], v5 offset:0
    v_mfma_f32_16x16x32_bf16 v[144:147], a[36:39], a[76:79], v[144:147]
    ds_read_b64_tr_b16 a[88:89], v11 offset:16384
    v_mfma_f32_16x16x32_bf16 v[148:151], a[40:43], a[72:75], v[148:151]
    buffer_load_dwordx4 v21, s[60:63], s76 offen offset:1024 lds
    v_mfma_f32_16x16x32_bf16 v[148:151], a[44:47], a[76:79], v[148:151]
    ds_read_b64_tr_b16 a[90:91], v11 offset:17408
    v_mfma_f32_16x16x32_bf16 v[152:155], a[48:51], a[72:75], v[152:155]
    ds_read_b128 a[8:11], v4 offset:2048
    v_mfma_f32_16x16x32_bf16 v[152:155], a[52:55], a[76:79], v[152:155]
    ds_read_b64_tr_b16 a[92:93], v11 offset:24576
    v_mfma_f32_16x16x32_bf16 v[156:159], a[56:59], a[72:75], v[156:159]
    ds_read_b128 a[12:15], v5 offset:2048
    v_mfma_f32_16x16x32_bf16 v[156:159], a[60:63], a[76:79], v[156:159]
    s_waitcnt lgkmcnt(9)
    ds_read_b64_tr_b16 a[94:95], v11 offset:25600
    v_mfma_f32_16x16x32_bf16 v[160:163], a[32:35], a[80:83], v[160:163]
    s_waitcnt lgkmcnt(7)
    ds_read_b128 a[16:19], v4 offset:4096
    v_mfma_f32_16x16x32_bf16 v[160:163], a[36:39], a[84:87], v[160:163]
    ds_read_b64_tr_b16 a[64:65], v12 offset:16384
    v_mfma_f32_16x16x32_bf16 v[164:167], a[40:43], a[80:83], v[164:167]
    buffer_load_dwordx4 v22, s[60:63], s76 offen offset:2048 lds
    v_mfma_f32_16x16x32_bf16 v[164:167], a[44:47], a[84:87], v[164:167]
    ds_read_b64_tr_b16 a[66:67], v12 offset:17408
    v_mfma_f32_16x16x32_bf16 v[168:171], a[48:51], a[80:83], v[168:171]
    ds_read_b128 a[20:23], v5 offset:4096
    v_mfma_f32_16x16x32_bf16 v[168:171], a[52:55], a[84:87], v[168:171]
    ds_read_b64_tr_b16 a[68:69], v12 offset:24576
    v_mfma_f32_16x16x32_bf16 v[172:175], a[56:59], a[80:83], v[172:175]
    ds_read_b128 a[24:27], v4 offset:6144
    v_mfma_f32_16x16x32_bf16 v[172:175], a[60:63], a[84:87], v[172:175]
    s_waitcnt lgkmcnt(10)
    ds_read_b64_tr_b16 a[70:71], v12 offset:25600
    v_mfma_f32_16x16x32_bf16 v[176:179], a[32:35], a[88:91], v[176:179]
    s_waitcnt lgkmcnt(7)
    ds_read_b128 a[28:31], v5 offset:6144
    v_mfma_f32_16x16x32_bf16 v[176:179], a[36:39], a[92:95], v[176:179]
    ds_read_b64_tr_b16 a[72:73], v13 offset:16384
    v_mfma_f32_16x16x32_bf16 v[180:183], a[40:43], a[88:91], v[180:183]
    buffer_load_dwordx4 v23, s[60:63], s76 offen offset:3072 lds
    v_mfma_f32_16x16x32_bf16 v[180:183], a[44:47], a[92:95], v[180:183]
    s_add_u32 s76, s76, s80
    ds_read_b64_tr_b16 a[74:75], v13 offset:17408
    v_mfma_f32_16x16x32_bf16 v[184:187], a[48:51], a[88:91], v[184:187]
    v_mfma_f32_16x16x32_bf16 v[184:187], a[52:55], a[92:95], v[184:187]
    ds_read_b64_tr_b16 a[76:77], v13 offset:24576
    v_mfma_f32_16x16x32_bf16 v[188:191], a[56:59], a[88:91], v[188:191]
    v_mfma_f32_16x16x32_bf16 v[188:191], a[60:63], a[92:95], v[188:191]
    s_waitcnt lgkmcnt(8)
    ds_read_b64_tr_b16 a[78:79], v13 offset:25600
    v_mfma_f32_16x16x32_bf16 v[192:195], a[32:35], a[64:67], v[192:195]
    s_waitcnt lgkmcnt(5)
    v_mfma_f32_16x16x32_bf16 v[192:195], a[36:39], a[68:71], v[192:195]
    ds_read_b64_tr_b16 a[80:81], v14 offset:16384
    v_mfma_f32_16x16x32_bf16 v[196:199], a[40:43], a[64:67], v[196:199]
    s_sub_u32 s87, s84, s85
    ds_read_b64_tr_b16 a[88:89], v15 offset:16384
    v_mfma_f32_16x16x32_bf16 v[196:199], a[44:47], a[68:71], v[196:199]
    ds_read_b64_tr_b16 a[82:83], v14 offset:17408
    v_mfma_f32_16x16x32_bf16 v[200:203], a[48:51], a[64:67], v[200:203]
    ds_read_b64_tr_b16 a[90:91], v15 offset:17408
    v_add_u32 v8, s87, v8
    v_mfma_f32_16x16x32_bf16 v[200:203], a[52:55], a[68:71], v[200:203]
    ds_read_b64_tr_b16 a[84:85], v14 offset:24576
    v_add_u32 v9, s87, v9
    v_mfma_f32_16x16x32_bf16 v[204:207], a[56:59], a[64:67], v[204:207]
    ds_read_b64_tr_b16 a[92:93], v15 offset:24576
    v_add_u32 v10, s87, v10
    v_mfma_f32_16x16x32_bf16 v[204:207], a[60:63], a[68:71], v[204:207]
    s_waitcnt lgkmcnt(8)
    ds_read_b64_tr_b16 a[86:87], v14 offset:25600
    v_add_u32 v11, s87, v11
    v_mfma_f32_16x16x32_bf16 v[208:211], a[32:35], a[72:75], v[208:211]
    s_waitcnt lgkmcnt(7)
    s_add_u32 m0, s83, 16384
    ds_read_b64_tr_b16 a[94:95], v15 offset:25600
    v_add_u32 v12, s87, v12
    v_mfma_f32_16x16x32_bf16 v[208:211], a[36:39], a[76:79], v[208:211]
    s_mov_b32 s58, s85
    buffer_load_dwordx4 v24, s[64:67], s77 offen offset:0 lds
    v_add_u32 v13, s87, v13
    v_mfma_f32_16x16x32_bf16 v[212:215], a[40:43], a[72:75], v[212:215]
    s_mov_b32 s85, s84
    v_add_u32 v14, s87, v14
    v_mfma_f32_16x16x32_bf16 v[212:215], a[44:47], a[76:79], v[212:215]
    s_mov_b32 s84, s83
    s_mov_b32 s88, 0
    buffer_load_dwordx4 v25, s[64:67], s77 offen offset:1024 lds
    v_add_u32 v15, s87, v15
    v_mfma_f32_16x16x32_bf16 v[216:219], a[48:51], a[72:75], v[216:219]
    s_mov_b32 s83, s58
    buffer_load_dword a234, v62, s[32:35], s88 offen
    v_mfma_f32_16x16x32_bf16 v[216:219], a[52:55], a[76:79], v[216:219]
    v_mfma_f32_16x16x32_bf16 v[220:223], a[56:59], a[72:75], v[220:223]
    v_mfma_f32_16x16x32_bf16 v[220:223], a[60:63], a[76:79], v[220:223]
    s_waitcnt lgkmcnt(5)
    v_mfma_f32_16x16x32_bf16 v[224:227], a[32:35], a[80:83], v[224:227]
    s_waitcnt vmcnt(17) lgkmcnt(0)
    s_barrier
    v_mfma_f32_16x16x32_bf16 v[224:227], a[36:39], a[84:87], v[224:227]
    ds_read_b64_tr_b16 a[64:65], v8 offset:0
    v_mfma_f32_16x16x32_bf16 v[228:231], a[40:43], a[80:83], v[228:231]
    buffer_load_dwordx4 v26, s[68:71], s77 offen offset:2048 lds
    v_mfma_f32_16x16x32_bf16 v[228:231], a[44:47], a[84:87], v[228:231]
    ds_read_b64_tr_b16 a[66:67], v8 offset:1024
    v_mfma_f32_16x16x32_bf16 v[232:235], a[48:51], a[80:83], v[232:235]
    v_mfma_f32_16x16x32_bf16 v[232:235], a[52:55], a[84:87], v[232:235]
    ds_read_b64_tr_b16 a[68:69], v8 offset:8192
    v_mfma_f32_16x16x32_bf16 v[236:239], a[56:59], a[80:83], v[236:239]
    v_mfma_f32_16x16x32_bf16 v[236:239], a[60:63], a[84:87], v[236:239]
    ds_read_b64_tr_b16 a[70:71], v8 offset:9216
    v_mfma_f32_16x16x32_bf16 v[240:243], a[32:35], a[88:91], v[240:243]
    ds_read_b64_tr_b16 a[72:73], v9 offset:0
    v_mfma_f32_16x16x32_bf16 v[240:243], a[36:39], a[92:95], v[240:243]
    v_mfma_f32_16x16x32_bf16 v[244:247], a[40:43], a[88:91], v[244:247]
    ds_read_b64_tr_b16 a[74:75], v9 offset:1024
    v_mfma_f32_16x16x32_bf16 v[244:247], a[44:47], a[92:95], v[244:247]
    buffer_load_dwordx4 v27, s[68:71], s77 offen offset:3072 lds
    v_mfma_f32_16x16x32_bf16 v[248:251], a[48:51], a[88:91], v[248:251]
    s_add_u32 s77, s77, s81
    ds_read_b64_tr_b16 a[76:77], v9 offset:8192
    v_mfma_f32_16x16x32_bf16 v[248:251], a[52:55], a[92:95], v[248:251]
    v_mfma_f32_16x16x32_bf16 v[252:255], a[56:59], a[88:91], v[252:255]
    ds_read_b64_tr_b16 a[78:79], v9 offset:9216
    v_mfma_f32_16x16x32_bf16 v[252:255], a[60:63], a[92:95], v[252:255]
    s_waitcnt lgkmcnt(6)
    v_mfma_f32_16x16x32_bf16 a[128:131], a[64:67], a[0:3], a[128:131]
    s_waitcnt lgkmcnt(4)
    v_mfma_f32_16x16x32_bf16 a[128:131], a[68:71], a[4:7], a[128:131]
    s_add_u32 m0, s86, 0
    ds_read_b64_tr_b16 a[80:81], v10 offset:0
    v_mfma_f32_16x16x32_bf16 a[132:135], a[64:67], a[8:11], a[132:135]
    buffer_load_dwordx4 v28, s[72:75], s78 offen offset:0 sc1 lds
    v_mfma_f32_16x16x32_bf16 a[132:135], a[68:71], a[12:15], a[132:135]
    ds_read_b64_tr_b16 a[82:83], v10 offset:1024
    v_mfma_f32_16x16x32_bf16 a[136:139], a[64:67], a[16:19], a[136:139]
    v_mfma_f32_16x16x32_bf16 a[136:139], a[68:71], a[20:23], a[136:139]
    ds_read_b64_tr_b16 a[84:85], v10 offset:8192
    v_mfma_f32_16x16x32_bf16 a[140:143], a[64:67], a[24:27], a[140:143]
    v_mfma_f32_16x16x32_bf16 a[140:143], a[68:71], a[28:31], a[140:143]
    s_waitcnt lgkmcnt(5)
    ds_read_b64_tr_b16 a[86:87], v10 offset:9216
    v_mfma_f32_16x16x32_bf16 a[144:147], a[72:75], a[0:3], a[144:147]
    s_waitcnt lgkmcnt(4)
    v_mfma_f32_16x16x32_bf16 a[144:147], a[76:79], a[4:7], a[144:147]
    ds_read_b64_tr_b16 a[88:89], v11 offset:0
    v_mfma_f32_16x16x32_bf16 a[148:151], a[72:75], a[8:11], a[148:151]
    buffer_load_dwordx4 v29, s[72:75], s78 offen offset:1024 sc1 lds
    v_mfma_f32_16x16x32_bf16 a[148:151], a[76:79], a[12:15], a[148:151]
    ds_read_b64_tr_b16 a[90:91], v11 offset:1024
    v_mfma_f32_16x16x32_bf16 a[152:155], a[72:75], a[16:19], a[152:155]
    v_mfma_f32_16x16x32_bf16 a[152:155], a[76:79], a[20:23], a[152:155]
    s_mov_b32 s88, 1048576
    ds_read_b64_tr_b16 a[92:93], v11 offset:8192
    v_mfma_f32_16x16x32_bf16 a[156:159], a[72:75], a[24:27], a[156:159]
    buffer_load_dword a235, v61, s[12:15], s88 offen
    v_mfma_f32_16x16x32_bf16 a[156:159], a[76:79], a[28:31], a[156:159]
    s_waitcnt lgkmcnt(5)
    ds_read_b64_tr_b16 a[94:95], v11 offset:9216
    v_mfma_f32_16x16x32_bf16 a[160:163], a[80:83], a[0:3], a[160:163]
    s_waitcnt lgkmcnt(4)
    v_mfma_f32_16x16x32_bf16 a[160:163], a[84:87], a[4:7], a[160:163]
    ds_read_b64_tr_b16 a[64:65], v12 offset:0
    v_mfma_f32_16x16x32_bf16 a[164:167], a[80:83], a[8:11], a[164:167]
    buffer_load_dwordx4 v30, s[72:75], s78 offen offset:2048 sc1 lds
    v_mfma_f32_16x16x32_bf16 a[164:167], a[84:87], a[12:15], a[164:167]
    ds_read_b64_tr_b16 a[66:67], v12 offset:1024
    v_mfma_f32_16x16x32_bf16 a[168:171], a[80:83], a[16:19], a[168:171]
    v_mfma_f32_16x16x32_bf16 a[168:171], a[84:87], a[20:23], a[168:171]
    ds_read_b64_tr_b16 a[68:69], v12 offset:8192
    v_mfma_f32_16x16x32_bf16 a[172:175], a[80:83], a[24:27], a[172:175]
    v_mfma_f32_16x16x32_bf16 a[172:175], a[84:87], a[28:31], a[172:175]
    s_waitcnt lgkmcnt(5)
    ds_read_b64_tr_b16 a[70:71], v12 offset:9216
    v_mfma_f32_16x16x32_bf16 a[176:179], a[88:91], a[0:3], a[176:179]
    s_waitcnt lgkmcnt(4)
    v_mfma_f32_16x16x32_bf16 a[176:179], a[92:95], a[4:7], a[176:179]
    ds_read_b64_tr_b16 a[72:73], v13 offset:0
    v_mfma_f32_16x16x32_bf16 a[180:183], a[88:91], a[8:11], a[180:183]
    buffer_load_dwordx4 v31, s[72:75], s78 offen offset:3072 sc1 lds
    v_mfma_f32_16x16x32_bf16 a[180:183], a[92:95], a[12:15], a[180:183]
    ds_read_b64_tr_b16 a[74:75], v13 offset:1024
    v_mfma_f32_16x16x32_bf16 a[184:187], a[88:91], a[16:19], a[184:187]
    v_mfma_f32_16x16x32_bf16 a[184:187], a[92:95], a[20:23], a[184:187]
    ds_read_b64_tr_b16 a[76:77], v13 offset:8192
    v_mfma_f32_16x16x32_bf16 a[188:191], a[88:91], a[24:27], a[188:191]
    v_mfma_f32_16x16x32_bf16 a[188:191], a[92:95], a[28:31], a[188:191]
    s_waitcnt lgkmcnt(5)
    ds_read_b64_tr_b16 a[78:79], v13 offset:9216
    v_mfma_f32_16x16x32_bf16 v[64:67], a[64:67], a[0:3], v[64:67]
    s_waitcnt lgkmcnt(4)
    v_mfma_f32_16x16x32_bf16 v[64:67], a[68:71], a[4:7], v[64:67]
    s_add_u32 m0, s86, 4096
    ds_read_b64_tr_b16 a[80:81], v14 offset:0
    v_mfma_f32_16x16x32_bf16 v[68:71], a[64:67], a[8:11], v[68:71]
    buffer_load_dwordx4 v28, s[72:75], s79 offen offset:0 sc1 lds
    v_mfma_f32_16x16x32_bf16 v[68:71], a[68:71], a[12:15], v[68:71]
    ds_read_b64_tr_b16 a[82:83], v14 offset:1024
    v_mfma_f32_16x16x32_bf16 v[72:75], a[64:67], a[16:19], v[72:75]
    v_mfma_f32_16x16x32_bf16 v[72:75], a[68:71], a[20:23], v[72:75]
    ds_read_b64_tr_b16 a[84:85], v14 offset:8192
    v_mfma_f32_16x16x32_bf16 v[76:79], a[64:67], a[24:27], v[76:79]
    v_mfma_f32_16x16x32_bf16 v[76:79], a[68:71], a[28:31], v[76:79]
    s_waitcnt lgkmcnt(5)
    ds_read_b64_tr_b16 a[86:87], v14 offset:9216
    v_mfma_f32_16x16x32_bf16 v[80:83], a[72:75], a[0:3], v[80:83]
    s_waitcnt lgkmcnt(4)
    v_mfma_f32_16x16x32_bf16 v[80:83], a[76:79], a[4:7], v[80:83]
    ds_read_b64_tr_b16 a[88:89], v15 offset:0
    v_mfma_f32_16x16x32_bf16 v[84:87], a[72:75], a[8:11], v[84:87]
    buffer_load_dwordx4 v29, s[72:75], s79 offen offset:1024 sc1 lds
    v_mfma_f32_16x16x32_bf16 v[84:87], a[76:79], a[12:15], v[84:87]
    ds_read_b64_tr_b16 a[90:91], v15 offset:1024
    v_mfma_f32_16x16x32_bf16 v[88:91], a[72:75], a[16:19], v[88:91]
    v_mfma_f32_16x16x32_bf16 v[88:91], a[76:79], a[20:23], v[88:91]
    ds_read_b64_tr_b16 a[92:93], v15 offset:8192
    v_mfma_f32_16x16x32_bf16 v[92:95], a[72:75], a[24:27], v[92:95]
    v_mfma_f32_16x16x32_bf16 v[92:95], a[76:79], a[28:31], v[92:95]
    s_waitcnt lgkmcnt(5)
    ds_read_b64_tr_b16 a[94:95], v15 offset:9216
    v_mfma_f32_16x16x32_bf16 v[96:99], a[80:83], a[0:3], v[96:99]
    s_waitcnt lgkmcnt(4)
    v_mfma_f32_16x16x32_bf16 v[96:99], a[84:87], a[4:7], v[96:99]
    ds_read_b64_tr_b16 a[64:65], v8 offset:16384
    v_mfma_f32_16x16x32_bf16 v[100:103], a[80:83], a[8:11], v[100:103]
    buffer_load_dwordx4 v30, s[72:75], s79 offen offset:2048 sc1 lds
    v_mfma_f32_16x16x32_bf16 v[100:103], a[84:87], a[12:15], v[100:103]
    ds_read_b64_tr_b16 a[66:67], v8 offset:17408
    v_mfma_f32_16x16x32_bf16 v[104:107], a[80:83], a[16:19], v[104:107]
    v_mfma_f32_16x16x32_bf16 v[104:107], a[84:87], a[20:23], v[104:107]
    s_mov_b32 s88, 442368
    ds_read_b64_tr_b16 a[68:69], v8 offset:24576
    v_mfma_f32_16x16x32_bf16 v[108:111], a[80:83], a[24:27], v[108:111]
    buffer_load_dword a236, v62, s[28:31], s88 offen
    v_mfma_f32_16x16x32_bf16 v[108:111], a[84:87], a[28:31], v[108:111]
    s_waitcnt lgkmcnt(5)
    ds_read_b64_tr_b16 a[70:71], v8 offset:25600
    v_mfma_f32_16x16x32_bf16 v[112:115], a[88:91], a[0:3], v[112:115]
    s_waitcnt lgkmcnt(4)
    v_mfma_f32_16x16x32_bf16 v[112:115], a[92:95], a[4:7], v[112:115]
    ds_read_b64_tr_b16 a[72:73], v9 offset:16384
    v_mfma_f32_16x16x32_bf16 v[116:119], a[88:91], a[8:11], v[116:119]
    buffer_load_dwordx4 v31, s[72:75], s79 offen offset:3072 sc1 lds
    v_mfma_f32_16x16x32_bf16 v[116:119], a[92:95], a[12:15], v[116:119]
    s_add_u32 s78, s78, s82
    ds_read_b64_tr_b16 a[74:75], v9 offset:17408
    v_mfma_f32_16x16x32_bf16 v[120:123], a[88:91], a[16:19], v[120:123]
    s_add_u32 s79, s79, s82
    v_mfma_f32_16x16x32_bf16 v[120:123], a[92:95], a[20:23], v[120:123]
    ds_read_b64_tr_b16 a[76:77], v9 offset:24576
    v_mfma_f32_16x16x32_bf16 v[124:127], a[88:91], a[24:27], v[124:127]
    v_mfma_f32_16x16x32_bf16 v[124:127], a[92:95], a[28:31], v[124:127]
    s_waitcnt lgkmcnt(5)
    ds_read_b64_tr_b16 a[78:79], v9 offset:25600
    v_mfma_f32_16x16x32_bf16 v[128:131], a[0:3], a[64:67], v[128:131]
    s_waitcnt lgkmcnt(4)
    v_mfma_f32_16x16x32_bf16 v[128:131], a[4:7], a[68:71], v[128:131]
    s_mov_b32 m0, s83
    ds_read_b64_tr_b16 a[80:81], v10 offset:16384
    v_mfma_f32_16x16x32_bf16 v[132:135], a[8:11], a[64:67], v[132:135]
    buffer_load_dwordx4 v20, s[60:63], s76 offen offset:0 lds
    v_mfma_f32_16x16x32_bf16 v[132:135], a[12:15], a[68:71], v[132:135]
    ds_read_b64_tr_b16 a[82:83], v10 offset:17408
    v_mfma_f32_16x16x32_bf16 v[136:139], a[16:19], a[64:67], v[136:139]
    s_waitcnt vmcnt(21)
    v_mfma_f32_16x16x32_bf16 v[136:139], a[20:23], a[68:71], v[136:139]
    ds_read_b64_tr_b16 a[84:85], v10 offset:24576
    v_mfma_f32_16x16x32_bf16 v[140:143], a[24:27], a[64:67], v[140:143]
    ds_read_b128 a[32:35], v4 offset:32768
    v_mfma_f32_16x16x32_bf16 v[140:143], a[28:31], a[68:71], v[140:143]
    s_waitcnt lgkmcnt(6)
    ds_read_b64_tr_b16 a[86:87], v10 offset:25600
    v_mfma_f32_16x16x32_bf16 v[144:147], a[0:3], a[72:75], v[144:147]
    s_waitcnt lgkmcnt(5)
    ds_read_b128 a[36:39], v5 offset:32768
    v_mfma_f32_16x16x32_bf16 v[144:147], a[4:7], a[76:79], v[144:147]
    ds_read_b64_tr_b16 a[88:89], v11 offset:16384
    v_mfma_f32_16x16x32_bf16 v[148:151], a[8:11], a[72:75], v[148:151]
    buffer_load_dwordx4 v21, s[60:63], s76 offen offset:1024 lds
    v_mfma_f32_16x16x32_bf16 v[148:151], a[12:15], a[76:79], v[148:151]
    ds_read_b64_tr_b16 a[90:91], v11 offset:17408
    v_mfma_f32_16x16x32_bf16 v[152:155], a[16:19], a[72:75], v[152:155]
    ds_read_b128 a[40:43], v4 offset:34816
    v_mfma_f32_16x16x32_bf16 v[152:155], a[20:23], a[76:79], v[152:155]
    ds_read_b64_tr_b16 a[92:93], v11 offset:24576
    v_mfma_f32_16x16x32_bf16 v[156:159], a[24:27], a[72:75], v[156:159]
    ds_read_b128 a[44:47], v5 offset:34816
    v_mfma_f32_16x16x32_bf16 v[156:159], a[28:31], a[76:79], v[156:159]
    s_waitcnt lgkmcnt(9)
    ds_read_b64_tr_b16 a[94:95], v11 offset:25600
    v_mfma_f32_16x16x32_bf16 v[160:163], a[0:3], a[80:83], v[160:163]
    s_waitcnt lgkmcnt(7)
    ds_read_b128 a[48:51], v4 offset:36864
    v_mfma_f32_16x16x32_bf16 v[160:163], a[4:7], a[84:87], v[160:163]
    ds_read_b64_tr_b16 a[64:65], v12 offset:16384
    v_mfma_f32_16x16x32_bf16 v[164:167], a[8:11], a[80:83], v[164:167]
    buffer_load_dwordx4 v22, s[60:63], s76 offen offset:2048 lds
    v_mfma_f32_16x16x32_bf16 v[164:167], a[12:15], a[84:87], v[164:167]
    ds_read_b64_tr_b16 a[66:67], v12 offset:17408
    v_mfma_f32_16x16x32_bf16 v[168:171], a[16:19], a[80:83], v[168:171]
    ds_read_b128 a[52:55], v5 offset:36864
    v_mfma_f32_16x16x32_bf16 v[168:171], a[20:23], a[84:87], v[168:171]
    ds_read_b64_tr_b16 a[68:69], v12 offset:24576
    v_mfma_f32_16x16x32_bf16 v[172:175], a[24:27], a[80:83], v[172:175]
    ds_read_b128 a[56:59], v4 offset:38912
    v_mfma_f32_16x16x32_bf16 v[172:175], a[28:31], a[84:87], v[172:175]
    s_waitcnt lgkmcnt(10)
    ds_read_b64_tr_b16 a[70:71], v12 offset:25600
    v_mfma_f32_16x16x32_bf16 v[176:179], a[0:3], a[88:91], v[176:179]
    s_waitcnt lgkmcnt(7)
    ds_read_b128 a[60:63], v5 offset:38912
    v_mfma_f32_16x16x32_bf16 v[176:179], a[4:7], a[92:95], v[176:179]
    ds_read_b64_tr_b16 a[72:73], v13 offset:16384
    v_mfma_f32_16x16x32_bf16 v[180:183], a[8:11], a[88:91], v[180:183]
    buffer_load_dwordx4 v23, s[60:63], s76 offen offset:3072 lds
    v_mfma_f32_16x16x32_bf16 v[180:183], a[12:15], a[92:95], v[180:183]
    s_add_u32 s76, s76, s80
    ds_read_b64_tr_b16 a[74:75], v13 offset:17408
    v_mfma_f32_16x16x32_bf16 v[184:187], a[16:19], a[88:91], v[184:187]
    v_mfma_f32_16x16x32_bf16 v[184:187], a[20:23], a[92:95], v[184:187]
    s_mov_b32 s88, 442368
    ds_read_b64_tr_b16 a[76:77], v13 offset:24576
    v_mfma_f32_16x16x32_bf16 v[188:191], a[24:27], a[88:91], v[188:191]
    buffer_load_dword a237, v62, s[32:35], s88 offen
    v_mfma_f32_16x16x32_bf16 v[188:191], a[28:31], a[92:95], v[188:191]
    s_waitcnt lgkmcnt(8)
    ds_read_b64_tr_b16 a[78:79], v13 offset:25600
    v_mfma_f32_16x16x32_bf16 v[192:195], a[0:3], a[64:67], v[192:195]
    s_waitcnt lgkmcnt(5)
    v_mfma_f32_16x16x32_bf16 v[192:195], a[4:7], a[68:71], v[192:195]
    ds_read_b64_tr_b16 a[80:81], v14 offset:16384
    v_mfma_f32_16x16x32_bf16 v[196:199], a[8:11], a[64:67], v[196:199]
    s_sub_u32 s87, s84, s85
    ds_read_b64_tr_b16 a[88:89], v15 offset:16384
    v_mfma_f32_16x16x32_bf16 v[196:199], a[12:15], a[68:71], v[196:199]
    ds_read_b64_tr_b16 a[82:83], v14 offset:17408
    v_mfma_f32_16x16x32_bf16 v[200:203], a[16:19], a[64:67], v[200:203]
    ds_read_b64_tr_b16 a[90:91], v15 offset:17408
    v_add_u32 v8, s87, v8
    v_mfma_f32_16x16x32_bf16 v[200:203], a[20:23], a[68:71], v[200:203]
    ds_read_b64_tr_b16 a[84:85], v14 offset:24576
    v_add_u32 v9, s87, v9
    v_mfma_f32_16x16x32_bf16 v[204:207], a[24:27], a[64:67], v[204:207]
    ds_read_b64_tr_b16 a[92:93], v15 offset:24576
    v_add_u32 v10, s87, v10
    v_mfma_f32_16x16x32_bf16 v[204:207], a[28:31], a[68:71], v[204:207]
    s_waitcnt lgkmcnt(8)
    ds_read_b64_tr_b16 a[86:87], v14 offset:25600
    v_add_u32 v11, s87, v11
    v_mfma_f32_16x16x32_bf16 v[208:211], a[0:3], a[72:75], v[208:211]
    s_waitcnt lgkmcnt(7)
    s_add_u32 m0, s83, 16384
    ds_read_b64_tr_b16 a[94:95], v15 offset:25600
    v_add_u32 v12, s87, v12
    v_mfma_f32_16x16x32_bf16 v[208:211], a[4:7], a[76:79], v[208:211]
    s_mov_b32 s58, s85
    buffer_load_dwordx4 v24, s[64:67], s77 offen offset:0 lds
    v_add_u32 v13, s87, v13
    v_mfma_f32_16x16x32_bf16 v[212:215], a[8:11], a[72:75], v[212:215]
    s_mov_b32 s85, s84
    v_add_u32 v14, s87, v14
    v_mfma_f32_16x16x32_bf16 v[212:215], a[12:15], a[76:79], v[212:215]
    s_mov_b32 s84, s83
    buffer_load_dwordx4 v25, s[64:67], s77 offen offset:1024 lds
    v_add_u32 v15, s87, v15
    v_mfma_f32_16x16x32_bf16 v[216:219], a[16:19], a[72:75], v[216:219]
    s_mov_b32 s83, s58
    v_mfma_f32_16x16x32_bf16 v[216:219], a[20:23], a[76:79], v[216:219]
    v_mfma_f32_16x16x32_bf16 v[220:223], a[24:27], a[72:75], v[220:223]
    v_mfma_f32_16x16x32_bf16 v[220:223], a[28:31], a[76:79], v[220:223]
    s_waitcnt lgkmcnt(5)
    v_mfma_f32_16x16x32_bf16 v[224:227], a[0:3], a[80:83], v[224:227]
    s_waitcnt vmcnt(17) lgkmcnt(0)
    s_barrier
    v_mfma_f32_16x16x32_bf16 v[224:227], a[4:7], a[84:87], v[224:227]
    ds_read_b64_tr_b16 a[64:65], v8 offset:0
    v_mfma_f32_16x16x32_bf16 v[228:231], a[8:11], a[80:83], v[228:231]
    buffer_load_dwordx4 v26, s[68:71], s77 offen offset:2048 lds
    v_mfma_f32_16x16x32_bf16 v[228:231], a[12:15], a[84:87], v[228:231]
    ds_read_b64_tr_b16 a[66:67], v8 offset:1024
    v_mfma_f32_16x16x32_bf16 v[232:235], a[16:19], a[80:83], v[232:235]
    v_mfma_f32_16x16x32_bf16 v[232:235], a[20:23], a[84:87], v[232:235]
    ds_read_b64_tr_b16 a[68:69], v8 offset:8192
    v_mfma_f32_16x16x32_bf16 v[236:239], a[24:27], a[80:83], v[236:239]
    v_mfma_f32_16x16x32_bf16 v[236:239], a[28:31], a[84:87], v[236:239]
    ds_read_b64_tr_b16 a[70:71], v8 offset:9216
    v_mfma_f32_16x16x32_bf16 v[240:243], a[0:3], a[88:91], v[240:243]
    ds_read_b64_tr_b16 a[72:73], v9 offset:0
    v_mfma_f32_16x16x32_bf16 v[240:243], a[4:7], a[92:95], v[240:243]
    v_mfma_f32_16x16x32_bf16 v[244:247], a[8:11], a[88:91], v[244:247]
    ds_read_b64_tr_b16 a[74:75], v9 offset:1024
    v_mfma_f32_16x16x32_bf16 v[244:247], a[12:15], a[92:95], v[244:247]
    buffer_load_dwordx4 v27, s[68:71], s77 offen offset:3072 lds
    v_mfma_f32_16x16x32_bf16 v[248:251], a[16:19], a[88:91], v[248:251]
    s_add_u32 s77, s77, s81
    ds_read_b64_tr_b16 a[76:77], v9 offset:8192
    v_mfma_f32_16x16x32_bf16 v[248:251], a[20:23], a[92:95], v[248:251]
    v_mfma_f32_16x16x32_bf16 v[252:255], a[24:27], a[88:91], v[252:255]
    ds_read_b64_tr_b16 a[78:79], v9 offset:9216
    v_mfma_f32_16x16x32_bf16 v[252:255], a[28:31], a[92:95], v[252:255]
    s_waitcnt lgkmcnt(6)
    v_mfma_f32_16x16x32_bf16 a[128:131], a[64:67], a[32:35], a[128:131]
    s_waitcnt lgkmcnt(4)
    v_mfma_f32_16x16x32_bf16 a[128:131], a[68:71], a[36:39], a[128:131]
    s_add_u32 m0, s86, 32768
    ds_read_b64_tr_b16 a[80:81], v10 offset:0
    v_mfma_f32_16x16x32_bf16 a[132:135], a[64:67], a[40:43], a[132:135]
    buffer_load_dwordx4 v28, s[72:75], s78 offen offset:0 sc1 lds
    v_mfma_f32_16x16x32_bf16 a[132:135], a[68:71], a[44:47], a[132:135]
    ds_read_b64_tr_b16 a[82:83], v10 offset:1024
    v_mfma_f32_16x16x32_bf16 a[136:139], a[64:67], a[48:51], a[136:139]
    buffer_load_dword v47, v63, s[48:51], 0 offen sc1
    v_mfma_f32_16x16x32_bf16 a[136:139], a[68:71], a[52:55], a[136:139]
    s_mov_b32 s88, 2097152
    ds_read_b64_tr_b16 a[84:85], v10 offset:8192
    v_mfma_f32_16x16x32_bf16 a[140:143], a[64:67], a[56:59], a[140:143]
    buffer_load_dword a238, v61, s[12:15], s88 offen
    v_mfma_f32_16x16x32_bf16 a[140:143], a[68:71], a[60:63], a[140:143]
    s_waitcnt lgkmcnt(5)
    ds_read_b64_tr_b16 a[86:87], v10 offset:9216
    v_mfma_f32_16x16x32_bf16 a[144:147], a[72:75], a[32:35], a[144:147]
    s_waitcnt lgkmcnt(4)
    v_mfma_f32_16x16x32_bf16 a[144:147], a[76:79], a[36:39], a[144:147]
    ds_read_b64_tr_b16 a[88:89], v11 offset:0
    v_mfma_f32_16x16x32_bf16 a[148:151], a[72:75], a[40:43], a[148:151]
    buffer_load_dwordx4 v29, s[72:75], s78 offen offset:1024 sc1 lds
    v_mfma_f32_16x16x32_bf16 a[148:151], a[76:79], a[44:47], a[148:151]
    ds_read_b64_tr_b16 a[90:91], v11 offset:1024
    v_mfma_f32_16x16x32_bf16 a[152:155], a[72:75], a[48:51], a[152:155]
    v_mfma_f32_16x16x32_bf16 a[152:155], a[76:79], a[52:55], a[152:155]
    ds_read_b64_tr_b16 a[92:93], v11 offset:8192
    v_mfma_f32_16x16x32_bf16 a[156:159], a[72:75], a[56:59], a[156:159]
    v_mfma_f32_16x16x32_bf16 a[156:159], a[76:79], a[60:63], a[156:159]
    s_waitcnt lgkmcnt(5)
    ds_read_b64_tr_b16 a[94:95], v11 offset:9216
    v_mfma_f32_16x16x32_bf16 a[160:163], a[80:83], a[32:35], a[160:163]
    s_waitcnt lgkmcnt(4)
    v_mfma_f32_16x16x32_bf16 a[160:163], a[84:87], a[36:39], a[160:163]
    ds_read_b64_tr_b16 a[64:65], v12 offset:0
    v_mfma_f32_16x16x32_bf16 a[164:167], a[80:83], a[40:43], a[164:167]
    buffer_load_dwordx4 v30, s[72:75], s78 offen offset:2048 sc1 lds
    v_mfma_f32_16x16x32_bf16 a[164:167], a[84:87], a[44:47], a[164:167]
    ds_read_b64_tr_b16 a[66:67], v12 offset:1024
    v_mfma_f32_16x16x32_bf16 a[168:171], a[80:83], a[48:51], a[168:171]
    v_mfma_f32_16x16x32_bf16 a[168:171], a[84:87], a[52:55], a[168:171]
    ds_read_b64_tr_b16 a[68:69], v12 offset:8192
    v_mfma_f32_16x16x32_bf16 a[172:175], a[80:83], a[56:59], a[172:175]
    v_mfma_f32_16x16x32_bf16 a[172:175], a[84:87], a[60:63], a[172:175]
    s_waitcnt lgkmcnt(5)
    ds_read_b64_tr_b16 a[70:71], v12 offset:9216
    v_mfma_f32_16x16x32_bf16 a[176:179], a[88:91], a[32:35], a[176:179]
    s_waitcnt lgkmcnt(4)
    v_mfma_f32_16x16x32_bf16 a[176:179], a[92:95], a[36:39], a[176:179]
    ds_read_b64_tr_b16 a[72:73], v13 offset:0
    v_mfma_f32_16x16x32_bf16 a[180:183], a[88:91], a[40:43], a[180:183]
    buffer_load_dwordx4 v31, s[72:75], s78 offen offset:3072 sc1 lds
    v_mfma_f32_16x16x32_bf16 a[180:183], a[92:95], a[44:47], a[180:183]
    ds_read_b64_tr_b16 a[74:75], v13 offset:1024
    v_mfma_f32_16x16x32_bf16 a[184:187], a[88:91], a[48:51], a[184:187]
    v_mfma_f32_16x16x32_bf16 a[184:187], a[92:95], a[52:55], a[184:187]
    ds_read_b64_tr_b16 a[76:77], v13 offset:8192
    v_mfma_f32_16x16x32_bf16 a[188:191], a[88:91], a[56:59], a[188:191]
    v_mfma_f32_16x16x32_bf16 a[188:191], a[92:95], a[60:63], a[188:191]
    s_waitcnt lgkmcnt(5)
    ds_read_b64_tr_b16 a[78:79], v13 offset:9216
    v_mfma_f32_16x16x32_bf16 v[64:67], a[64:67], a[32:35], v[64:67]
    s_waitcnt lgkmcnt(4)
    v_mfma_f32_16x16x32_bf16 v[64:67], a[68:71], a[36:39], v[64:67]
    s_branch L_pado2
L_pad2:
    s_branch L_tour_ret0
L_pado2:
    s_add_u32 m0, s86, 36864
    ds_read_b64_tr_b16 a[80:81], v14 offset:0
    v_mfma_f32_16x16x32_bf16 v[68:71], a[64:67], a[40:43], v[68:71]
    buffer_load_dwordx4 v28, s[72:75], s79 offen offset:0 sc1 lds
    v_mfma_f32_16x16x32_bf16 v[68:71], a[68:71], a[44:47], v[68:71]
    ds_read_b64_tr_b16 a[82:83], v14 offset:1024
    v_mfma_f32_16x16x32_bf16 v[72:75], a[64:67], a[48:51], v[72:75]
    v_mfma_f32_16x16x32_bf16 v[72:75], a[68:71], a[52:55], v[72:75]
    ds_read_b64_tr_b16 a[84:85], v14 offset:8192
    v_mfma_f32_16x16x32_bf16 v[76:79], a[64:67], a[56:59], v[76:79]
    v_mfma_f32_16x16x32_bf16 v[76:79], a[68:71], a[60:63], v[76:79]
    s_waitcnt lgkmcnt(5)
    ds_read_b64_tr_b16 a[86:87], v14 offset:9216
    v_mfma_f32_16x16x32_bf16 v[80:83], a[72:75], a[32:35], v[80:83]
    s_waitcnt lgkmcnt(4)
    v_mfma_f32_16x16x32_bf16 v[80:83], a[76:79], a[36:39], v[80:83]
    ds_read_b64_tr_b16 a[88:89], v15 offset:0
    v_mfma_f32_16x16x32_bf16 v[84:87], a[72:75], a[40:43], v[84:87]
    buffer_load_dwordx4 v29, s[72:75], s79 offen offset:1024 sc1 lds
    v_mfma_f32_16x16x32_bf16 v[84:87], a[76:79], a[44:47], v[84:87]
    ds_read_b64_tr_b16 a[90:91], v15 offset:1024
    v_mfma_f32_16x16x32_bf16 v[88:91], a[72:75], a[48:51], v[88:91]
    v_mfma_f32_16x16x32_bf16 v[88:91], a[76:79], a[52:55], v[88:91]
    s_mov_b32 s88, 884736
    ds_read_b64_tr_b16 a[92:93], v15 offset:8192
    v_mfma_f32_16x16x32_bf16 v[92:95], a[72:75], a[56:59], v[92:95]
    buffer_load_dword a239, v62, s[28:31], s88 offen
    v_mfma_f32_16x16x32_bf16 v[92:95], a[76:79], a[60:63], v[92:95]
    s_waitcnt lgkmcnt(5)
    ds_read_b64_tr_b16 a[94:95], v15 offset:9216
    v_mfma_f32_16x16x32_bf16 v[96:99], a[80:83], a[32:35], v[96:99]
    s_waitcnt lgkmcnt(4)
    v_mfma_f32_16x16x32_bf16 v[96:99], a[84:87], a[36:39], v[96:99]
    ds_read_b64_tr_b16 a[64:65], v8 offset:16384
    v_mfma_f32_16x16x32_bf16 v[100:103], a[80:83], a[40:43], v[100:103]
    buffer_load_dwordx4 v30, s[72:75], s79 offen offset:2048 sc1 lds
    v_mfma_f32_16x16x32_bf16 v[100:103], a[84:87], a[44:47], v[100:103]
    ds_read_b64_tr_b16 a[66:67], v8 offset:17408
    v_mfma_f32_16x16x32_bf16 v[104:107], a[80:83], a[48:51], v[104:107]
    v_mfma_f32_16x16x32_bf16 v[104:107], a[84:87], a[52:55], v[104:107]
    ds_read_b64_tr_b16 a[68:69], v8 offset:24576
    v_mfma_f32_16x16x32_bf16 v[108:111], a[80:83], a[56:59], v[108:111]
    v_mfma_f32_16x16x32_bf16 v[108:111], a[84:87], a[60:63], v[108:111]
    s_waitcnt lgkmcnt(5)
    ds_read_b64_tr_b16 a[70:71], v8 offset:25600
    v_mfma_f32_16x16x32_bf16 v[112:115], a[88:91], a[32:35], v[112:115]
    s_waitcnt lgkmcnt(4)
    v_mfma_f32_16x16x32_bf16 v[112:115], a[92:95], a[36:39], v[112:115]
    ds_read_b64_tr_b16 a[72:73], v9 offset:16384
    v_mfma_f32_16x16x32_bf16 v[116:119], a[88:91], a[40:43], v[116:119]
    buffer_load_dwordx4 v31, s[72:75], s79 offen offset:3072 sc1 lds
    v_mfma_f32_16x16x32_bf16 v[116:119], a[92:95], a[44:47], v[116:119]
    s_add_u32 s78, s78, s82
    ds_read_b64_tr_b16 a[74:75], v9 offset:17408
    v_mfma_f32_16x16x32_bf16 v[120:123], a[88:91], a[48:51], v[120:123]
    s_add_u32 s79, s79, s82
    v_mfma_f32_16x16x32_bf16 v[120:123], a[92:95], a[52:55], v[120:123]
    ds_read_b64_tr_b16 a[76:77], v9 offset:24576
    v_mfma_f32_16x16x32_bf16 v[124:127], a[88:91], a[56:59], v[124:127]
    v_mfma_f32_16x16x32_bf16 v[124:127], a[92:95], a[60:63], v[124:127]
    s_waitcnt lgkmcnt(5)
    ds_read_b64_tr_b16 a[78:79], v9 offset:25600
    v_mfma_f32_16x16x32_bf16 v[128:131], a[32:35], a[64:67], v[128:131]
    s_waitcnt lgkmcnt(4)
    v_mfma_f32_16x16x32_bf16 v[128:131], a[36:39], a[68:71], v[128:131]
    s_mov_b32 m0, s83
    ds_read_b64_tr_b16 a[80:81], v10 offset:16384
    v_mfma_f32_16x16x32_bf16 v[132:135], a[40:43], a[64:67], v[132:135]
    buffer_load_dwordx4 v20, s[60:63], s76 offen offset:0 lds
    v_mfma_f32_16x16x32_bf16 v[132:135], a[44:47], a[68:71], v[132:135]
    ds_read_b64_tr_b16 a[82:83], v10 offset:17408
    v_mfma_f32_16x16x32_bf16 v[136:139], a[48:51], a[64:67], v[136:139]
    s_waitcnt vmcnt(21)
    v_mfma_f32_16x16x32_bf16 v[136:139], a[52:55], a[68:71], v[136:139]
    ds_read_b64_tr_b16 a[84:85], v10 offset:24576
    v_mfma_f32_16x16x32_bf16 v[140:143], a[56:59], a[64:67], v[140:143]
    ds_read_b128 a[0:3], v4 offset:0
    v_mfma_f32_16x16x32_bf16 v[140:143], a[60:63], a[68:71], v[140:143]
    s_waitcnt lgkmcnt(6)
    ds_read_b64_tr_b16 a[86:87], v10 offset:25600
    v_mfma_f32_16x16x32_bf16 v[144:147], a[32:35], a[72:75], v[144:147]
    s_waitcnt lgkmcnt(5)
    ds_read_b128 a[4:7], v5 offset:0
    v_mfma_f32_16x16x32_bf16 v[144:147], a[36:39], a[76:79], v[144:147]
    ds_read_b64_tr_b16 a[88:89], v11 offset:16384
    v_mfma_f32_16x16x32_bf16 v[148:151], a[40:43], a[72:75], v[148:151]
    buffer_load_dwordx4 v21, s[60:63], s76 offen offset:1024 lds
    v_mfma_f32_16x16x32_bf16 v[148:151], a[44:47], a[76:79], v[148:151]
    ds_read_b64_tr_b16 a[90:91], v11 offset:17408
    v_mfma_f32_16x16x32_bf16 v[152:155], a[48:51], a[72:75], v[152:155]
    ds_read_b128 a[8:11], v4 offset:2048
    v_mfma_f32_16x16x32_bf16 v[152:155], a[52:55], a[76:79], v[152:155]
    ds_read_b64_tr_b16 a[92:93], v11 offset:24576
    v_mfma_f32_16x16x32_bf16 v[156:159], a[56:59], a[72:75], v[156:159]
    ds_read_b128 a[12:15], v5 offset:2048
    v_mfma_f32_16x16x32_bf16 v[156:159], a[60:63], a[76:79], v[156:159]
    s_waitcnt lgkmcnt(9)
    ds_read_b64_tr_b16 a[94:95], v11 offset:25600
    v_mfma_f32_16x16x32_bf16 v[160:163], a[32:35], a[80:83], v[160:163]
    s_waitcnt lgkmcnt(7)
    ds_read_b128 a[16:19], v4 offset:4096
    v_mfma_f32_16x16x32_bf16 v[160:163], a[36:39], a[84:87], v[160:163]
    ds_read_b64_tr_b16 a[64:65], v12 offset:16384
    v_mfma_f32_16x16x32_bf16 v[164:167], a[40:43], a[80:83], v[164:167]
    buffer_load_dwordx4 v22, s[60:63], s76 offen offset:2048 lds
    v_mfma_f32_16x16x32_bf16 v[164:167], a[44:47], a[84:87], v[164:167]
    ds_read_b64_tr_b16 a[66:67], v12 offset:17408
    v_mfma_f32_16x16x32_bf16 v[168:171], a[48:51], a[80:83], v[168:171]
    ds_read_b128 a[20:23], v5 offset:4096
    v_mfma_f32_16x16x32_bf16 v[168:171], a[52:55], a[84:87], v[168:171]
    ds_read_b64_tr_b16 a[68:69], v12 offset:24576
    v_mfma_f32_16x16x32_bf16 v[172:175], a[56:59], a[80:83], v[172:175]
    ds_read_b128 a[24:27], v4 offset:6144
    v_mfma_f32_16x16x32_bf16 v[172:175], a[60:63], a[84:87], v[172:175]
    s_waitcnt lgkmcnt(10)
    ds_read_b64_tr_b16 a[70:71], v12 offset:25600
    v_mfma_f32_16x16x32_bf16 v[176:179], a[32:35], a[88:91], v[176:179]
    s_waitcnt lgkmcnt(7)
    ds_read_b128 a[28:31], v5 offset:6144
    v_mfma_f32_16x16x32_bf16 v[176:179], a[36:39], a[92:95], v[176:179]
    ds_read_b64_tr_b16 a[72:73], v13 offset:16384
    v_mfma_f32_16x16x32_bf16 v[180:183], a[40:43], a[88:91], v[180:183]
    buffer_load_dwordx4 v23, s[60:63], s76 offen offset:3072 lds
    v_mfma_f32_16x16x32_bf16 v[180:183], a[44:47], a[92:95], v[180:183]
    s_add_u32 s76, s76, s80
    ds_read_b64_tr_b16 a[74:75], v13 offset:17408
    v_mfma_f32_16x16x32_bf16 v[184:187], a[48:51], a[88:91], v[184:187]
    s_waitcnt vmcnt(13)
    v_cmp_ne_u32 vcc, -1, v47
    v_mov_b32 v46, -1
    v_mfma_f32_16x16x32_bf16 v[184:187], a[52:55], a[92:95], v[184:187]
    s_mov_b32 s88, 884736
    ds_read_b64_tr_b16 a[76:77], v13 offset:24576
    v_mfma_f32_16x16x32_bf16 v[188:191], a[56:59], a[88:91], v[188:191]
    buffer_load_dword a240, v62, s[32:35], s88 offen
    s_cbranch_vccnz L_spin0
L_spin0_back:
    v_mfma_f32_16x16x32_bf16 v[188:191], a[60:63], a[92:95], v[188:191]
    s_waitcnt lgkmcnt(8)
    ds_read_b64_tr_b16 a[78:79], v13 offset:25600
    v_mfma_f32_16x16x32_bf16 v[192:195], a[32:35], a[64:67], v[192:195]
    s_waitcnt lgkmcnt(5)
    buffer_store_dword v46, off, s[44:47], s100 offset:20 sc1
    v_mfma_f32_16x16x32_bf16 v[192:195], a[36:39], a[68:71], v[192:195]
    ds_read_b64_tr_b16 a[80:81], v14 offset:16384
    v_mfma_f32_16x16x32_bf16 v[196:199], a[40:43], a[64:67], v[196:199]
    s_sub_u32 s87, s84, s85
    ds_read_b64_tr_b16 a[88:89], v15 offset:16384
    v_mfma_f32_16x16x32_bf16 v[196:199], a[44:47], a[68:71], v[196:199]
    ds_read_b64_tr_b16 a[82:83], v14 offset:17408
    v_mfma_f32_16x16x32_bf16 v[200:203], a[48:51], a[64:67], v[200:203]
    ds_read_b64_tr_b16 a[90:91], v15 offset:17408
    v_add_u32 v8, s87, v8
    v_mfma_f32_16x16x32_bf16 v[200:203], a[52:55], a[68:71], v[200:203]
    ds_read_b64_tr_b16 a[84:85], v14 offset:24576
    v_add_u32 v9, s87, v9
    v_mfma_f32_16x16x32_bf16 v[204:207], a[56:59], a[64:67], v[204:207]
    ds_read_b64_tr_b16 a[92:93], v15 offset:24576
    v_add_u32 v10, s87, v10
    v_mfma_f32_16x16x32_bf16 v[204:207], a[60:63], a[68:71], v[204:207]
    s_waitcnt lgkmcnt(8)
    ds_read_b64_tr_b16 a[86:87], v14 offset:25600
    v_add_u32 v11, s87, v11
    v_mfma_f32_16x16x32_bf16 v[208:211], a[32:35], a[72:75], v[208:211]
    s_waitcnt lgkmcnt(7)
    s_add_u32 m0, s83, 16384
    ds_read_b64_tr_b16 a[94:95], v15 offset:25600
    v_add_u32 v12, s87, v12
    v_mfma_f32_16x16x32_bf16 v[208:211], a[36:39], a[76:79], v[208:211]
    s_mov_b32 s58, s85
    buffer_load_dwordx4 v24, s[64:67], s77 offen offset:0 lds
    v_add_u32 v13, s87, v13
    v_mfma_f32_16x16x32_bf16 v[212:215], a[40:43], a[72:75], v[212:215]
    s_mov_b32 s85, s84
    v_add_u32 v14, s87, v14
    v_mfma_f32_16x16x32_bf16 v[212:215], a[44:47], a[76:79], v[212:215]
    s_mov_b32 s84, s83
    buffer_load_dwordx4 v25, s[64:67], s77 offen offset:1024 lds
    v_add_u32 v15, s87, v15
    v_mfma_f32_16x16x32_bf16 v[216:219], a[48:51], a[72:75], v[216:219]
    s_mov_b32 s83, s58
    v_mfma_f32_16x16x32_bf16 v[216:219], a[52:55], a[76:79], v[216:219]
    v_mfma_f32_16x16x32_bf16 v[220:223], a[56:59], a[72:75], v[220:223]
    v_mfma_f32_16x16x32_bf16 v[220:223], a[60:63], a[76:79], v[220:223]
    s_waitcnt lgkmcnt(5)
    v_mfma_f32_16x16x32_bf16 v[224:227], a[32:35], a[80:83], v[224:227]
    s_waitcnt vmcnt(19) lgkmcnt(0)
    s_barrier
    v_mfma_f32_16x16x32_bf16 v[224:227], a[36:39], a[84:87], v[224:227]
    ds_read_b64_tr_b16 a[64:65], v8 offset:0
    v_mfma_f32_16x16x32_bf16 v[228:231], a[40:43], a[80:83], v[228:231]
    buffer_load_dwordx4 v26, s[68:71], s77 offen offset:2048 lds
    v_mfma_f32_16x16x32_bf16 v[228:231], a[44:47], a[84:87], v[228:231]
    ds_read_b64_tr_b16 a[66:67], v8 offset:1024
    v_mfma_f32_16x16x32_bf16 v[232:235], a[48:51], a[80:83], v[232:235]
    v_mfma_f32_16x16x32_bf16 v[232:235], a[52:55], a[84:87], v[232:235]
    ds_read_b64_tr_b16 a[68:69], v8 offset:8192
    v_mfma_f32_16x16x32_bf16 v[236:239], a[56:59], a[80:83], v[236:239]
    v_mfma_f32_16x16x32_bf16 v[236:239], a[60:63], a[84:87], v[236:239]
    ds_read_b64_tr_b16 a[70:71], v8 offset:9216
    v_mfma_f32_16x16x32_bf16 v[240:243], a[32:35], a[88:91], v[240:243]
    ds_read_b64_tr_b16 a[72:73], v9 offset:0
    v_mfma_f32_16x16x32_bf16 v[240:243], a[36:39], a[92:95], v[240:243]
    v_mfma_f32_16x16x32_bf16 v[244:247], a[40:43], a[88:91], v[244:247]
    ds_read_b64_tr_b16 a[74:75], v9 offset:1024
    v_mfma_f32_16x16x32_bf16 v[244:247], a[44:47], a[92:95], v[244:247]
    buffer_load_dwordx4 v27, s[68:71], s77 offen offset:3072 lds
    v_mfma_f32_16x16x32_bf16 v[248:251], a[48:51], a[88:91], v[248:251]
    s_add_u32 s77, s77, s81
    ds_read_b64_tr_b16 a[76:77], v9 offset:8192
    v_mfma_f32_16x16x32_bf16 v[248:251], a[52:55], a[92:95], v[248:251]
    v_mfma_f32_16x16x32_bf16 v[252:255], a[56:59], a[88:91], v[252:255]
    s_mov_b32 s88, 3145728
    ds_read_b64_tr_b16 a[78:79], v9 offset:9216
    v_mfma_f32_16x16x32_bf16 v[252:255], a[60:63], a[92:95], v[252:255]
    s_waitcnt lgkmcnt(6)
    buffer_load_dword a241, v61, s[12:15], s88 offen
    v_mfma_f32_16x16x32_bf16 a[128:131], a[64:67], a[0:3], a[128:131]
    s_waitcnt lgkmcnt(4)
    v_mfma_f32_16x16x32_bf16 a[128:131], a[68:71], a[4:7], a[128:131]
    s_add_u32 m0, s86, 0
    ds_read_b64_tr_b16 a[80:81], v10 offset:0
    v_mfma_f32_16x16x32_bf16 a[132:135], a[64:67], a[8:11], a[132:135]
    buffer_load_dwordx4 v28, s[72:75], s78 offen offset:0 sc1 lds
    v_mfma_f32_16x16x32_bf16 a[132:135], a[68:71], a[12:15], a[132:135]
    ds_read_b64_tr_b16 a[82:83], v10 offset:1024
    v_mfma_f32_16x16x32_bf16 a[136:139], a[64:67], a[16:19], a[136:139]
    v_mfma_f32_16x16x32_bf16 a[136:139], a[68:71], a[20:23], a[136:139]
    ds_read_b64_tr_b16 a[84:85], v10 offset:8192
    v_mfma_f32_16x16x32_bf16 a[140:143], a[64:67], a[24:27], a[140:143]
    v_mfma_f32_16x16x32_bf16 a[140:143], a[68:71], a[28:31], a[140:143]
    s_waitcnt lgkmcnt(5)
    ds_read_b64_tr_b16 a[86:87], v10 offset:9216
    v_mfma_f32_16x16x32_bf16 a[144:147], a[72:75], a[0:3], a[144:147]
    s_waitcnt lgkmcnt(4)
    v_mfma_f32_16x16x32_bf16 a[144:147], a[76:79], a[4:7], a[144:147]
    ds_read_b64_tr_b16 a[88:89], v11 offset:0
    v_mfma_f32_16x16x32_bf16 a[148:151], a[72:75], a[8:11], a[148:151]
    buffer_load_dwordx4 v29, s[72:75], s78 offen offset:1024 sc1 lds
    v_mfma_f32_16x16x32_bf16 a[148:151], a[76:79], a[12:15], a[148:151]
    ds_read_b64_tr_b16 a[90:91], v11 offset:1024
    v_mfma_f32_16x16x32_bf16 a[152:155], a[72:75], a[16:19], a[152:155]
    v_mfma_f32_16x16x32_bf16 a[152:155], a[76:79], a[20:23], a[152:155]
    ds_read_b64_tr_b16 a[92:93], v11 offset:8192
    v_mfma_f32_16x16x32_bf16 a[156:159], a[72:75], a[24:27], a[156:159]
    v_mfma_f32_16x16x32_bf16 a[156:159], a[76:79], a[28:31], a[156:159]
    s_waitcnt lgkmcnt(5)
    ds_read_b64_tr_b16 a[94:95], v11 offset:9216
    v_mfma_f32_16x16x32_bf16 a[160:163], a[80:83], a[0:3], a[160:163]
    s_waitcnt lgkmcnt(4)
    v_mfma_f32_16x16x32_bf16 a[160:163], a[84:87], a[4:7], a[160:163]
    ds_read_b64_tr_b16 a[64:65], v12 offset:0
    v_mfma_f32_16x16x32_bf16 a[164:167], a[80:83], a[8:11], a[164:167]
    buffer_load_dwordx4 v30, s[72:75], s78 offen offset:2048 sc1 lds
    v_mfma_f32_16x16x32_bf16 a[164:167], a[84:87], a[12:15], a[164:167]
    ds_read_b64_tr_b16 a[66:67], v12 offset:1024
    v_mfma_f32_16x16x32_bf16 a[168:171], a[80:83], a[16:19], a[168:171]
    v_mfma_f32_16x16x32_bf16 a[168:171], a[84:87], a[20:23], a[168:171]
    ds_read_b64_tr_b16 a[68:69], v12 offset:8192
    v_mfma_f32_16x16x32_bf16 a[172:175], a[80:83], a[24:27], a[172:175]
    v_mfma_f32_16x16x32_bf16 a[172:175], a[84:87], a[28:31], a[172:175]
    s_waitcnt lgkmcnt(5)
    ds_read_b64_tr_b16 a[70:71], v12 offset:9216
    v_mfma_f32_16x16x32_bf16 a[176:179], a[88:91], a[0:3], a[176:179]
    s_waitcnt lgkmcnt(4)
    v_mfma_f32_16x16x32_bf16 a[176:179], a[92:95], a[4:7], a[176:179]
    ds_read_b64_tr_b16 a[72:73], v13 offset:0
    v_mfma_f32_16x16x32_bf16 a[180:183], a[88:91], a[8:11], a[180:183]
    buffer_load_dwordx4 v31, s[72:75], s78 offen offset:3072 sc1 lds
    v_mfma_f32_16x16x32_bf16 a[180:183], a[92:95], a[12:15], a[180:183]
    ds_read_b64_tr_b16 a[74:75], v13 offset:1024
    v_mfma_f32_16x16x32_bf16 a[184:187], a[88:91], a[16:19], a[184:187]
    v_mfma_f32_16x16x32_bf16 a[184:187], a[92:95], a[20:23], a[184:187]
    ds_read_b64_tr_b16 a[76:77], v13 offset:8192
    v_mfma_f32_16x16x32_bf16 a[188:191], a[88:91], a[24:27], a[188:191]
    v_mfma_f32_16x16x32_bf16 a[188:191], a[92:95], a[28:31], a[188:191]
    s_waitcnt lgkmcnt(5)
    ds_read_b64_tr_b16 a[78:79], v13 offset:9216
    v_mfma_f32_16x16x32_bf16 v[64:67], a[64:67], a[0:3], v[64:67]
    s_waitcnt lgkmcnt(4)
    v_mfma_f32_16x16x32_bf16 v[64:67], a[68:71], a[4:7], v[64:67]
    s_add_u32 m0, s86, 4096
    ds_read_b64_tr_b16 a[80:81], v14 offset:0
    v_mfma_f32_16x16x32_bf16 v[68:71], a[64:67], a[8:11], v[68:71]
    buffer_load_dwordx4 v28, s[72:75], s79 offen offset:0 sc1 lds
    v_mfma_f32_16x16x32_bf16 v[68:71], a[68:71], a[12:15], v[68:71]
    ds_read_b64_tr_b16 a[82:83], v14 offset:1024
    v_mfma_f32_16x16x32_bf16 v[72:75], a[64:67], a[16:19], v[72:75]
    v_mfma_f32_16x16x32_bf16 v[72:75], a[68:71], a[20:23], v[72:75]
    s_mov_b32 s88, 1327104
    ds_read_b64_tr_b16 a[84:85], v14 offset:8192
    v_mfma_f32_16x16x32_bf16 v[76:79], a[64:67], a[24:27], v[76:79]
    buffer_load_dword a242, v62, s[28:31], s88 offen
    v_mfma_f32_16x16x32_bf16 v[76:79], a[68:71], a[28:31], v[76:79]
    s_waitcnt lgkmcnt(5)
    ds_read_b64_tr_b16 a[86:87], v14 offset:9216
    v_mfma_f32_16x16x32_bf16 v[80:83], a[72:75], a[0:3], v[80:83]
    s_waitcnt lgkmcnt(4)
    v_mfma_f32_16x16x32_bf16 v[80:83], a[76:79], a[4:7], v[80:83]
    ds_read_b64_tr_b16 a[88:89], v15 offset:0
    v_mfma_f32_16x16x32_bf16 v[84:87], a[72:75], a[8:11], v[84:87]
    buffer_load_dwordx4 v29, s[72:75], s79 offen offset:1024 sc1 lds
    v_mfma_f32_16x16x32_bf16 v[84:87], a[76:79], a[12:15], v[84:87]
    ds_read_b64_tr_b16 a[90:91], v15 offset:1024
    v_mfma_f32_16x16x32_bf16 v[88:91], a[72:75], a[16:19], v[88:91]
    v_mfma_f32_16x16x32_bf16 v[88:91], a[76:79], a[20:23], v[88:91]
    ds_read_b64_tr_b16 a[92:93], v15 offset:8192
    v_mfma_f32_16x16x32_bf16 v[92:95], a[72:75], a[24:27], v[92:95]
    v_mfma_f32_16x16x32_bf16 v[92:95], a[76:79], a[28:31], v[92:95]
    s_waitcnt lgkmcnt(5)
    ds_read_b64_tr_b16 a[94:95], v15 offset:9216
    v_mfma_f32_16x16x32_bf16 v[96:99], a[80:83], a[0:3], v[96:99]
    s_waitcnt lgkmcnt(4)
    v_mfma_f32_16x16x32_bf16 v[96:99], a[84:87], a[4:7], v[96:99]
    ds_read_b64_tr_b16 a[64:65], v8 offset:16384
    v_mfma_f32_16x16x32_bf16 v[100:103], a[80:83], a[8:11], v[100:103]
    buffer_load_dwordx4 v30, s[72:75], s79 offen offset:2048 sc1 lds
    v_mfma_f32_16x16x32_bf16 v[100:103], a[84:87], a[12:15], v[100:103]
    ds_read_b64_tr_b16 a[66:67], v8 offset:17408
    v_mfma_f32_16x16x32_bf16 v[104:107], a[80:83], a[16:19], v[104:107]
    v_mfma_f32_16x16x32_bf16 v[104:107], a[84:87], a[20:23], v[104:107]
    ds_read_b64_tr_b16 a[68:69], v8 offset:24576
    v_mfma_f32_16x16x32_bf16 v[108:111], a[80:83], a[24:27], v[108:111]
    v_mfma_f32_16x16x32_bf16 v[108:111], a[84:87], a[28:31], v[108:111]
    s_waitcnt lgkmcnt(5)
    ds_read_b64_tr_b16 a[70:71], v8 offset:25600
    v_mfma_f32_16x16x32_bf16 v[112:115], a[88:91], a[0:3], v[112:115]
    s_waitcnt lgkmcnt(4)
    v_mfma_f32_16x16x32_bf16 v[112:115], a[92:95], a[4:7], v[112:115]
    ds_read_b64_tr_b16 a[72:73], v9 offset:16384
    v_mfma_f32_16x16x32_bf16 v[116:119], a[88:91], a[8:11], v[116:119]
    buffer_load_dwordx4 v31, s[72:75], s79 offen offset:3072 sc1 lds
    v_mfma_f32_16x16x32_bf16 v[116:119], a[92:95], a[12:15], v[116:119]
    s_add_u32 s78, s78, s82
    ds_read_b64_tr_b16 a[74:75], v9 offset:17408
    v_mfma_f32_16x16x32_bf16 v[120:123], a[88:91], a[16:19], v[120:123]
    s_add_u32 s79, s79, s82
    v_mfma_f32_16x16x32_bf16 v[120:123], a[92:95], a[20:23], v[120:123]
    ds_read_b64_tr_b16 a[76:77], v9 offset:24576
    v_mfma_f32_16x16x32_bf16 v[124:127], a[88:91], a[24:27], v[124:127]
    v_mfma_f32_16x16x32_bf16 v[124:127], a[92:95], a[28:31], v[124:127]
    s_waitcnt lgkmcnt(5)
    ds_read_b64_tr_b16 a[78:79], v9 offset:25600
    v_mfma_f32_16x16x32_bf16 v[128:131], a[0:3], a[64:67], v[128:131]
    s_waitcnt lgkmcnt(4)
    v_mfma_f32_16x16x32_bf16 v[128:131], a[4:7], a[68:71], v[128:131]
    s_mov_b32 m0, s83
    ds_read_b64_tr_b16 a[80:81], v10 offset:16384
    v_mfma_f32_16x16x32_bf16 v[132:135], a[8:11], a[64:67], v[132:135]
    buffer_load_dwordx4 v20, s[60:63], s76 offen offset:0 lds
    v_mfma_f32_16x16x32_bf16 v[132:135], a[12:15], a[68:71], v[132:135]
    ds_read_b64_tr_b16 a[82:83], v10 offset:17408
    v_mfma_f32_16x16x32_bf16 v[136:139], a[16:19], a[64:67], v[136:139]
    s_waitcnt vmcnt(21)
    v_mfma_f32_16x16x32_bf16 v[136:139], a[20:23], a[68:71], v[136:139]
    ds_read_b64_tr_b16 a[84:85], v10 offset:24576
    v_mfma_f32_16x16x32_bf16 v[140:143], a[24:27], a[64:67], v[140:143]
    ds_read_b128 a[32:35], v4 offset:32768
    v_mfma_f32_16x16x32_bf16 v[140:143], a[28:31], a[68:71], v[140:143]
    s_waitcnt lgkmcnt(6)
    ds_read_b64_tr_b16 a[86:87], v10 offset:25600
    v_mfma_f32_16x16x32_bf16 v[144:147], a[0:3], a[72:75], v[144:147]
    s_waitcnt lgkmcnt(5)
    ds_read_b128 a[36:39], v5 offset:32768
    v_mfma_f32_16x16x32_bf16 v[144:147], a[4:7], a[76:79], v[144:147]
    ds_read_b64_tr_b16 a[88:89], v11 offset:16384
    v_mfma_f32_16x16x32_bf16 v[148:151], a[8:11], a[72:75], v[148:151]
    buffer_load_dwordx4 v21, s[60:63], s76 offen offset:1024 lds
    v_mfma_f32_16x16x32_bf16 v[148:151], a[12:15], a[76:79], v[148:151]
    ds_read_b64_tr_b16 a[90:91], v11 offset:17408
    v_mfma_f32_16x16x32_bf16 v[152:155], a[16:19], a[72:75], v[152:155]
    ds_read_b128 a[40:43], v4 offset:34816
    v_mfma_f32_16x16x32_bf16 v[152:155], a[20:23], a[76:79], v[152:155]
    ds_read_b64_tr_b16 a[92:93], v11 offset:24576
    v_mfma_f32_16x16x32_bf16 v[156:159], a[24:27], a[72:75], v[156:159]
    ds_read_b128 a[44:47], v5 offset:34816
    v_mfma_f32_16x16x32_bf16 v[156:159], a[28:31], a[76:79], v[156:159]
    s_waitcnt lgkmcnt(9)
    ds_read_b64_tr_b16 a[94:95], v11 offset:25600
    v_mfma_f32_16x16x32_bf16 v[160:163], a[0:3], a[80:83], v[160:163]
    s_waitcnt lgkmcnt(7)
    ds_read_b128 a[48:51], v4 offset:36864
    v_mfma_f32_16x16x32_bf16 v[160:163], a[4:7], a[84:87], v[160:163]
    ds_read_b64_tr_b16 a[64:65], v12 offset:16384
    v_mfma_f32_16x16x32_bf16 v[164:167], a[8:11], a[80:83], v[164:167]
    buffer_load_dwordx4 v22, s[60:63], s76 offen offset:2048 lds
    v_mfma_f32_16x16x32_bf16 v[164:167], a[12:15], a[84:87], v[164:167]
    ds_read_b64_tr_b16 a[66:67], v12 offset:17408
    v_mfma_f32_16x16x32_bf16 v[168:171], a[16:19], a[80:83], v[168:171]
    ds_read_b128 a[52:55], v5 offset:36864
    v_mfma_f32_16x16x32_bf16 v[168:171], a[20:23], a[84:87], v[168:171]
    ds_read_b64_tr_b16 a[68:69], v12 offset:24576
    v_mfma_f32_16x16x32_bf16 v[172:175], a[24:27], a[80:83], v[172:175]
    ds_read_b128 a[56:59], v4 offset:38912
    v_mfma_f32_16x16x32_bf16 v[172:175], a[28:31], a[84:87], v[172:175]
    s_waitcnt lgkmcnt(10)
    ds_read_b64_tr_b16 a[70:71], v12 offset:25600
    v_mfma_f32_16x16x32_bf16 v[176:179], a[0:3], a[88:91], v[176:179]
    s_waitcnt lgkmcnt(7)
    ds_read_b128 a[60:63], v5 offset:38912
    v_mfma_f32_16x16x32_bf16 v[176:179], a[4:7], a[92:95], v[176:179]
    ds_read_b64_tr_b16 a[72:73], v13 offset:16384
    v_mfma_f32_16x16x32_bf16 v[180:183], a[8:11], a[88:91], v[180:183]
    buffer_load_dwordx4 v23, s[60:63], s76 offen offset:3072 lds
    v_mfma_f32_16x16x32_bf16 v[180:183], a[12:15], a[92:95], v[180:183]
    s_add_u32 s76, s76, s80
    s_mov_b32 s88, 1327104
    ds_read_b64_tr_b16 a[74:75], v13 offset:17408
    v_mfma_f32_16x16x32_bf16 v[184:187], a[16:19], a[88:91], v[184:187]
    buffer_load_dword a243, v62, s[32:35], s88 offen
    v_mfma_f32_16x16x32_bf16 v[184:187], a[20:23], a[92:95], v[184:187]
    ds_read_b64_tr_b16 a[76:77], v13 offset:24576
    v_mfma_f32_16x16x32_bf16 v[188:191], a[24:27], a[88:91], v[188:191]
    v_mfma_f32_16x16x32_bf16 v[188:191], a[28:31], a[92:95], v[188:191]
    s_waitcnt lgkmcnt(8)
    ds_read_b64_tr_b16 a[78:79], v13 offset:25600
    v_mfma_f32_16x16x32_bf16 v[192:195], a[0:3], a[64:67], v[192:195]
    s_waitcnt lgkmcnt(5)
    v_mfma_f32_16x16x32_bf16 v[192:195], a[4:7], a[68:71], v[192:195]
    ds_read_b64_tr_b16 a[80:81], v14 offset:16384
    v_mfma_f32_16x16x32_bf16 v[196:199], a[8:11], a[64:67], v[196:199]
    s_sub_u32 s87, s84, s85
    ds_read_b64_tr_b16 a[88:89], v15 offset:16384
    v_mfma_f32_16x16x32_bf16 v[196:199], a[12:15], a[68:71], v[196:199]
    ds_read_b64_tr_b16 a[82:83], v14 offset:17408
    v_mfma_f32_16x16x32_bf16 v[200:203], a[16:19], a[64:67], v[200:203]
    ds_read_b64_tr_b16 a[90:91], v15 offset:17408
    v_add_u32 v8, s87, v8
    v_mfma_f32_16x16x32_bf16 v[200:203], a[20:23], a[68:71], v[200:203]
    ds_read_b64_tr_b16 a[84:85], v14 offset:24576
    v_add_u32 v9, s87, v9
    v_mfma_f32_16x16x32_bf16 v[204:207], a[24:27], a[64:67], v[204:207]
    ds_read_b64_tr_b16 a[92:93], v15 offset:24576
    v_add_u32 v10, s87, v10
    v_mfma_f32_16x16x32_bf16 v[204:207], a[28:31], a[68:71], v[204:207]
    s_waitcnt lgkmcnt(8)
    ds_read_b64_tr_b16 a[86:87], v14 offset:25600
    v_add_u32 v11, s87, v11
    v_mfma_f32_16x16x32_bf16 v[208:211], a[0:3], a[72:75], v[208:211]
    s_waitcnt lgkmcnt(7)
    s_add_u32 m0, s83, 16384
    ds_read_b64_tr_b16 a[94:95], v15 offset:25600
    v_add_u32 v12, s87, v12
    v_mfma_f32_16x16x32_bf16 v[208:211], a[4:7], a[76:79], v[208:211]
    s_mov_b32 s58, s85
    buffer_load_dwordx4 v24, s[64:67], s77 offen offset:0 lds
    v_add_u32 v13, s87, v13
    v_mfma_f32_16x16x32_bf16 v[212:215], a[8:11], a[72:75], v[212:215]
    s_mov_b32 s85, s84
    v_add_u32 v14, s87, v14
    v_mfma_f32_16x16x32_bf16 v[212:215], a[12:15], a[76:79], v[212:215]
    s_mov_b32 s84, s83
    buffer_load_dwordx4 v25, s[64:67], s77 offen offset:1024 lds
    v_add_u32 v15, s87, v15
    v_mfma_f32_16x16x32_bf16 v[216:219], a[16:19], a[72:75], v[216:219]
    s_mov_b32 s83, s58
    v_mfma_f32_16x16x32_bf16 v[216:219], a[20:23], a[76:79], v[216:219]
    v_mfma_f32_16x16x32_bf16 v[220:223], a[24:27], a[72:75], v[220:223]
    v_mfma_f32_16x16x32_bf16 v[220:223], a[28:31], a[76:79], v[220:223]
    s_waitcnt lgkmcnt(5)
    v_mfma_f32_16x16x32_bf16 v[224:227], a[0:3], a[80:83], v[224:227]
    s_waitcnt vmcnt(17) lgkmcnt(0)
    s_barrier
    v_mfma_f32_16x16x32_bf16 v[224:227], a[4:7], a[84:87], v[224:227]
    ds_read_b64_tr_b16 a[64:65], v8 offset:0
    v_mfma_f32_16x16x32_bf16 v[228:231], a[8:11], a[80:83], v[228:231]
    buffer_load_dwordx4 v26, s[68:71], s77 offen offset:2048 lds
    v_mfma_f32_16x16x32_bf16 v[228:231], a[12:15], a[84:87], v[228:231]
    ds_read_b64_tr_b16 a[66:67], v8 offset:1024
    v_mfma_f32_16x16x32_bf16 v[232:235], a[16:19], a[80:83], v[232:235]
    v_mfma_f32_16x16x32_bf16 v[232:235], a[20:23], a[84:87], v[232:235]
    s_mov_b32 s88, 4194304
    ds_read_b64_tr_b16 a[68:69], v8 offset:8192
    v_mfma_f32_16x16x32_bf16 v[236:239], a[24:27], a[80:83], v[236:239]
    buffer_load_dword a244, v61, s[12:15], s88 offen
    v_mfma_f32_16x16x32_bf16 v[236:239], a[28:31], a[84:87], v[236:239]
    ds_read_b64_tr_b16 a[70:71], v8 offset:9216
    v_mfma_f32_16x16x32_bf16 v[240:243], a[0:3], a[88:91], v[240:243]
    ds_read_b64_tr_b16 a[72:73], v9 offset:0
    v_mfma_f32_16x16x32_bf16 v[240:243], a[4:7], a[92:95], v[240:243]
    v_mfma_f32_16x16x32_bf16 v[244:247], a[8:11], a[88:91], v[244:247]
    ds_read_b64_tr_b16 a[74:75], v9 offset:1024
    v_mfma_f32_16x16x32_bf16 v[244:247], a[12:15], a[92:95], v[244:247]
    buffer_load_dwordx4 v27, s[68:71], s77 offen offset:3072 lds
    v_mfma_f32_16x16x32_bf16 v[248:251], a[16:19], a[88:91], v[248:251]
    s_add_u32 s77, s77, s81
    ds_read_b64_tr_b16 a[76:77], v9 offset:8192
    v_mfma_f32_16x16x32_bf16 v[248:251], a[20:23], a[92:95], v[248:251]
    v_mfma_f32_16x16x32_bf16 v[252:255], a[24:27], a[88:91], v[252:255]
    ds_read_b64_tr_b16 a[78:79], v9 offset:9216
    v_mfma_f32_16x16x32_bf16 v[252:255], a[28:31], a[92:95], v[252:255]
    s_waitcnt lgkmcnt(6)
    v_mfma_f32_16x16x32_bf16 a[128:131], a[64:67], a[32:35], a[128:131]
    s_waitcnt lgkmcnt(4)
    v_mfma_f32_16x16x32_bf16 a[128:131], a[68:71], a[36:39], a[128:131]
    s_add_u32 m0, s86, 32768
    ds_read_b64_tr_b16 a[80:81], v10 offset:0
    v_mfma_f32_16x16x32_bf16 a[132:135], a[64:67], a[40:43], a[132:135]
    buffer_load_dwordx4 v28, s[72:75], s78 offen offset:0 sc1 lds
    v_mfma_f32_16x16x32_bf16 a[132:135], a[68:71], a[44:47], a[132:135]
    ds_read_b64_tr_b16 a[82:83], v10 offset:1024
    v_mfma_f32_16x16x32_bf16 a[136:139], a[64:67], a[48:51], a[136:139]
    v_mfma_f32_16x16x32_bf16 a[136:139], a[68:71], a[52:55], a[136:139]
    ds_read_b64_tr_b16 a[84:85], v10 offset:8192
    v_mfma_f32_16x16x32_bf16 a[140:143], a[64:67], a[56:59], a[140:143]
    v_mfma_f32_16x16x32_bf16 a[140:143], a[68:71], a[60:63], a[140:143]
    s_waitcnt lgkmcnt(5)
    ds_read_b64_tr_b16 a[86:87], v10 offset:9216
    v_mfma_f32_16x16x32_bf16 a[144:147], a[72:75], a[32:35], a[144:147]
    s_waitcnt lgkmcnt(4)
    v_mfma_f32_16x16x32_bf16 a[144:147], a[76:79], a[36:39], a[144:147]
    ds_read_b64_tr_b16 a[88:89], v11 offset:0
    v_mfma_f32_16x16x32_bf16 a[148:151], a[72:75], a[40:43], a[148:151]
    buffer_load_dwordx4 v29, s[72:75], s78 offen offset:1024 sc1 lds
    v_mfma_f32_16x16x32_bf16 a[148:151], a[76:79], a[44:47], a[148:151]
    ds_read_b64_tr_b16 a[90:91], v11 offset:1024
    v_mfma_f32_16x16x32_bf16 a[152:155], a[72:75], a[48:51], a[152:155]
    v_mfma_f32_16x16x32_bf16 a[152:155], a[76:79], a[52:55], a[152:155]
    ds_read_b64_tr_b16 a[92:93], v11 offset:8192
    v_mfma_f32_16x16x32_bf16 a[156:159], a[72:75], a[56:59], a[156:159]
    v_mfma_f32_16x16x32_bf16 a[156:159], a[76:79], a[60:63], a[156:159]
    s_waitcnt lgkmcnt(5)
    ds_read_b64_tr_b16 a[94:95], v11 offset:9216
    v_mfma_f32_16x16x32_bf16 a[160:163], a[80:83], a[32:35], a[160:163]
    s_waitcnt lgkmcnt(4)
    v_mfma_f32_16x16x32_bf16 a[160:163], a[84:87], a[36:39], a[160:163]
    ds_read_b64_tr_b16 a[64:65], v12 offset:0
    v_mfma_f32_16x16x32_bf16 a[164:167], a[80:83], a[40:43], a[164:167]
    buffer_load_dwordx4 v30, s[72:75], s78 offen offset:2048 sc1 lds
    v_mfma_f32_16x16x32_bf16 a[164:167], a[84:87], a[44:47], a[164:167]
    ds_read_b64_tr_b16 a[66:67], v12 offset:1024
    v_mfma_f32_16x16x32_bf16 a[168:171], a[80:83], a[48:51], a[168:171]
    v_mfma_f32_16x16x32_bf16 a[168:171], a[84:87], a[52:55], a[168:171]
    ds_read_b64_tr_b16 a[68:69], v12 offset:8192
    v_mfma_f32_16x16x32_bf16 a[172:175], a[80:83], a[56:59], a[172:175]
    v_mfma_f32_16x16x32_bf16 a[172:175], a[84:87], a[60:63], a[172:175]
    s_waitcnt lgkmcnt(5)
    ds_read_b64_tr_b16 a[70:71], v12 offset:9216
    v_mfma_f32_16x16x32_bf16 a[176:179], a[88:91], a[32:35], a[176:179]
    s_waitcnt lgkmcnt(4)
    v_mfma_f32_16x16x32_bf16 a[176:179], a[92:95], a[36:39], a[176:179]
    ds_read_b64_tr_b16 a[72:73], v13 offset:0
    v_mfma_f32_16x16x32_bf16 a[180:183], a[88:91], a[40:43], a[180:183]
    buffer_load_dwordx4 v31, s[72:75], s78 offen offset:3072 sc1 lds
    v_mfma_f32_16x16x32_bf16 a[180:183], a[92:95], a[44:47], a[180:183]
    ds_read_b64_tr_b16 a[74:75], v13 offset:1024
    v_mfma_f32_16x16x32_bf16 a[184:187], a[88:91], a[48:51], a[184:187]
    v_mfma_f32_16x16x32_bf16 a[184:187], a[92:95], a[52:55], a[184:187]
    s_mov_b32 s88, 1769472
    ds_read_b64_tr_b16 a[76:77], v13 offset:8192
    v_mfma_f32_16x16x32_bf16 a[188:191], a[88:91], a[56:59], a[188:191]
    buffer_load_dword a245, v62, s[28:31], s88 offen
    v_mfma_f32_16x16x32_bf16 a[188:191], a[92:95], a[60:63], a[188:191]
    s_waitcnt lgkmcnt(5)
    ds_read_b64_tr_b16 a[78:79], v13 offset:9216
    v_mfma_f32_16x16x32_bf16 v[64:67], a[64:67], a[32:35], v[64:67]
    s_waitcnt lgkmcnt(4)
    v_mfma_f32_16x16x32_bf16 v[64:67], a[68:71], a[36:39], v[64:67]
    s_add_u32 m0, s86, 36864
    ds_read_b64_tr_b16 a[80:81], v14 offset:0
    v_mfma_f32_16x16x32_bf16 v[68:71], a[64:67], a[40:43], v[68:71]
    buffer_load_dwordx4 v28, s[72:75], s79 offen offset:0 sc1 lds
    v_mfma_f32_16x16x32_bf16 v[68:71], a[68:71], a[44:47], v[68:71]
    ds_read_b64_tr_b16 a[82:83], v14 offset:1024
    v_mfma_f32_16x16x32_bf16 v[72:75], a[64:67], a[48:51], v[72:75]
    s_branch L_pado3
L_pad3:
    s_branch L_tour_ret0
L_pado3:
    v_mfma_f32_16x16x32_bf16 v[72:75], a[68:71], a[52:55], v[72:75]
    ds_read_b64_tr_b16 a[84:85], v14 offset:8192
    v_mfma_f32_16x16x32_bf16 v[76:79], a[64:67], a[56:59], v[76:79]
    v_mfma_f32_16x16x32_bf16 v[76:79], a[68:71], a[60:63], v[76:79]
    s_waitcnt lgkmcnt(5)
    ds_read_b64_tr_b16 a[86:87], v14 offset:9216
    v_mfma_f32_16x16x32_bf16 v[80:83], a[72:75], a[32:35], v[80:83]
    s_waitcnt lgkmcnt(4)
    buffer_load_dword v47, v45, s[44:47], 0 offen offset:20 sc1
    v_mfma_f32_16x16x32_bf16 v[80:83], a[76:79], a[36:39], v[80:83]
    ds_read_b64_tr_b16 a[88:89], v15 offset:0
    v_mfma_f32_16x16x32_bf16 v[84:87], a[72:75], a[40:43], v[84:87]
    buffer_load_dwordx4 v29, s[72:75], s79 offen offset:1024 sc1 lds
    v_mfma_f32_16x16x32_bf16 v[84:87], a[76:79], a[44:47], v[84:87]
    ds_read_b64_tr_b16 a[90:91], v15 offset:1024
    v_mfma_f32_16x16x32_bf16 v[88:91], a[72:75], a[48:51], v[88:91]
    v_mfma_f32_16x16x32_bf16 v[88:91], a[76:79], a[52:55], v[88:91]
    ds_read_b64_tr_b16 a[92:93], v15 offset:8192
    v_mfma_f32_16x16x32_bf16 v[92:95], a[72:75], a[56:59], v[92:95]
    v_mfma_f32_16x16x32_bf16 v[92:95], a[76:79], a[60:63], v[92:95]
    s_waitcnt lgkmcnt(5)
    ds_read_b64_tr_b16 a[94:95], v15 offset:9216
    v_mfma_f32_16x16x32_bf16 v[96:99], a[80:83], a[32:35], v[96:99]
    s_waitcnt lgkmcnt(4)
    v_mfma_f32_16x16x32_bf16 v[96:99], a[84:87], a[36:39], v[96:99]
    ds_read_b64_tr_b16 a[64:65], v8 offset:16384
    v_mfma_f32_16x16x32_bf16 v[100:103], a[80:83], a[40:43], v[100:103]
    buffer_load_dwordx4 v30, s[72:75], s79 offen offset:2048 sc1 lds
    v_mfma_f32_16x16x32_bf16 v[100:103], a[84:87], a[44:47], v[100:103]
    ds_read_b64_tr_b16 a[66:67], v8 offset:17408
    v_mfma_f32_16x16x32_bf16 v[104:107], a[80:83], a[48:51], v[104:107]
    v_mfma_f32_16x16x32_bf16 v[104:107], a[84:87], a[52:55], v[104:107]
    ds_read_b64_tr_b16 a[68:69], v8 offset:24576
    v_mfma_f32_16x16x32_bf16 v[108:111], a[80:83], a[56:59], v[108:111]
    v_mfma_f32_16x16x32_bf16 v[108:111], a[84:87], a[60:63], v[108:111]
    s_waitcnt lgkmcnt(5)
    ds_read_b64_tr_b16 a[70:71], v8 offset:25600
    v_mfma_f32_16x16x32_bf16 v[112:115], a[88:91], a[32:35], v[112:115]
    s_waitcnt lgkmcnt(4)
    v_mfma_f32_16x16x32_bf16 v[112:115], a[92:95], a[36:39], v[112:115]
    ds_read_b64_tr_b16 a[72:73], v9 offset:16384
    v_mfma_f32_16x16x32_bf16 v[116:119], a[88:91], a[40:43], v[116:119]
    buffer_load_dwordx4 v31, s[72:75], s79 offen offset:3072 sc1 lds
    v_mfma_f32_16x16x32_bf16 v[116:119], a[92:95], a[44:47], v[116:119]
    s_add_u32 s78, s78, s82
    ds_read_b64_tr_b16 a[74:75], v9 offset:17408
    v_mfma_f32_16x16x32_bf16 v[120:123], a[88:91], a[48:51], v[120:123]
    s_add_u32 s79, s79, s82
    v_mfma_f32_16x16x32_bf16 v[120:123], a[92:95], a[52:55], v[120:123]
    ds_read_b64_tr_b16 a[76:77], v9 offset:24576
    v_mfma_f32_16x16x32_bf16 v[124:127], a[88:91], a[56:59], v[124:127]
    v_mov_b64 v[28:29], v[48:49]
    v_mov_b64 v[30:31], v[50:51]
    v_mfma_f32_16x16x32_bf16 v[124:127], a[92:95], a[60:63], v[124:127]
    s_waitcnt lgkmcnt(5)
    ds_read_b64_tr_b16 a[78:79], v9 offset:25600
    v_mfma_f32_16x16x32_bf16 v[128:131], a[32:35], a[64:67], v[128:131]
    s_waitcnt lgkmcnt(4)
    s_mov_b64 s[72:73], s[44:45]
    s_mov_b32 s74, 268435456
    v_mfma_f32_16x16x32_bf16 v[128:131], a[36:39], a[68:71], v[128:131]
    s_mov_b32 m0, s83
    s_sub_u32 s55, 15, s54
    ds_read_b64_tr_b16 a[80:81], v10 offset:16384
    v_mfma_f32_16x16x32_bf16 v[132:135], a[40:43], a[64:67], v[132:135]
    s_lshl_b32 s78, s55, 2
    buffer_load_dwordx4 v20, s[60:63], s76 offen offset:0 lds
    v_mfma_f32_16x16x32_bf16 v[132:135], a[44:47], a[68:71], v[132:135]
    s_add_u32 s78, s78, s52
    s_mul_i32 s78, s78, 40960
    ds_read_b64_tr_b16 a[82:83], v10 offset:17408
    v_mfma_f32_16x16x32_bf16 v[136:139], a[48:51], a[64:67], v[136:139]
    s_waitcnt vmcnt(21)
    s_lshl_b32 s79, s54, 2
    s_add_u32 s79, s79, 3
    v_mfma_f32_16x16x32_bf16 v[136:139], a[52:55], a[68:71], v[136:139]
    s_sub_u32 s79, s79, s52
    s_mul_i32 s79, s79, 40960
    ds_read_b64_tr_b16 a[84:85], v10 offset:24576
    v_mfma_f32_16x16x32_bf16 v[140:143], a[56:59], a[64:67], v[140:143]
    ds_read_b128 a[0:3], v4 offset:0
    v_mfma_f32_16x16x32_bf16 v[140:143], a[60:63], a[68:71], v[140:143]
    s_waitcnt lgkmcnt(6)
    ds_read_b64_tr_b16 a[86:87], v10 offset:25600
    v_mfma_f32_16x16x32_bf16 v[144:147], a[32:35], a[72:75], v[144:147]
    s_waitcnt lgkmcnt(5)
    ds_read_b128 a[4:7], v5 offset:0
    v_mfma_f32_16x16x32_bf16 v[144:147], a[36:39], a[76:79], v[144:147]
    ds_read_b64_tr_b16 a[88:89], v11 offset:16384
    v_mfma_f32_16x16x32_bf16 v[148:151], a[40:43], a[72:75], v[148:151]
    buffer_load_dwordx4 v21, s[60:63], s76 offen offset:1024 lds
    v_mfma_f32_16x16x32_bf16 v[148:151], a[44:47], a[76:79], v[148:151]
    ds_read_b64_tr_b16 a[90:91], v11 offset:17408
    v_mfma_f32_16x16x32_bf16 v[152:155], a[48:51], a[72:75], v[152:155]
    ds_read_b128 a[8:11], v4 offset:2048
    v_mfma_f32_16x16x32_bf16 v[152:155], a[52:55], a[76:79], v[152:155]
    ds_read_b64_tr_b16 a[92:93], v11 offset:24576
    v_mfma_f32_16x16x32_bf16 v[156:159], a[56:59], a[72:75], v[156:159]
    ds_read_b128 a[12:15], v5 offset:2048
    v_mfma_f32_16x16x32_bf16 v[156:159], a[60:63], a[76:79], v[156:159]
    s_waitcnt lgkmcnt(9)
    ds_read_b64_tr_b16 a[94:95], v11 offset:25600
    v_mfma_f32_16x16x32_bf16 v[160:163], a[32:35], a[80:83], v[160:163]
    s_waitcnt lgkmcnt(7)
    ds_read_b128 a[16:19], v4 offset:4096
    v_mfma_f32_16x16x32_bf16 v[160:163], a[36:39], a[84:87], v[160:163]
    ds_read_b64_tr_b16 a[64:65], v12 offset:16384
    v_mfma_f32_16x16x32_bf16 v[164:167], a[40:43], a[80:83], v[164:167]
    buffer_load_dwordx4 v22, s[60:63], s76 offen offset:2048 lds
    v_mfma_f32_16x16x32_bf16 v[164:167], a[44:47], a[84:87], v[164:167]
    ds_read_b64_tr_b16 a[66:67], v12 offset:17408
    v_mfma_f32_16x16x32_bf16 v[168:171], a[48:51], a[80:83], v[168:171]
    ds_read_b128 a[20:23], v5 offset:4096
    v_mfma_f32_16x16x32_bf16 v[168:171], a[52:55], a[84:87], v[168:171]
    ds_read_b64_tr_b16 a[68:69], v12 offset:24576
    v_mfma_f32_16x16x32_bf16 v[172:175], a[56:59], a[80:83], v[172:175]
    ds_read_b128 a[24:27], v4 offset:6144
    v_mfma_f32_16x16x32_bf16 v[172:175], a[60:63], a[84:87], v[172:175]
    s_waitcnt lgkmcnt(10)
    ds_read_b64_tr_b16 a[70:71], v12 offset:25600
    v_mfma_f32_16x16x32_bf16 v[176:179], a[32:35], a[88:91], v[176:179]
    s_waitcnt lgkmcnt(7)
    ds_read_b128 a[28:31], v5 offset:6144
    v_mfma_f32_16x16x32_bf16 v[176:179], a[36:39], a[92:95], v[176:179]
    ds_read_b64_tr_b16 a[72:73], v13 offset:16384
    v_mfma_f32_16x16x32_bf16 v[180:183], a[40:43], a[88:91], v[180:183]
    buffer_load_dwordx4 v23, s[60:63], s76 offen offset:3072 lds
    v_mfma_f32_16x16x32_bf16 v[180:183], a[44:47], a[92:95], v[180:183]
    s_add_u32 s76, s76, s80
    s_mov_b32 s88, 1769472
    ds_read_b64_tr_b16 a[74:75], v13 offset:17408
    v_mfma_f32_16x16x32_bf16 v[184:187], a[48:51], a[88:91], v[184:187]
    buffer_load_dword a246, v62, s[32:35], s88 offen
    v_mfma_f32_16x16x32_bf16 v[184:187], a[52:55], a[92:95], v[184:187]
    ds_read_b64_tr_b16 a[76:77], v13 offset:24576
    v_mfma_f32_16x16x32_bf16 v[188:191], a[56:59], a[88:91], v[188:191]
    v_mfma_f32_16x16x32_bf16 v[188:191], a[60:63], a[92:95], v[188:191]
    s_waitcnt lgkmcnt(8)
    ds_read_b64_tr_b16 a[78:79], v13 offset:25600
    v_mfma_f32_16x16x32_bf16 v[192:195], a[32:35], a[64:67], v[192:195]
    s_waitcnt lgkmcnt(5)
    v_mfma_f32_16x16x32_bf16 v[192:195], a[36:39], a[68:71], v[192:195]
    ds_read_b64_tr_b16 a[80:81], v14 offset:16384
    v_mfma_f32_16x16x32_bf16 v[196:199], a[40:43], a[64:67], v[196:199]
    s_sub_u32 s87, s84, s85
    ds_read_b64_tr_b16 a[88:89], v15 offset:16384
    v_mfma_f32_16x16x32_bf16 v[196:199], a[44:47], a[68:71], v[196:199]
    ds_read_b64_tr_b16 a[82:83], v14 offset:17408
    v_mfma_f32_16x16x32_bf16 v[200:203], a[48:51], a[64:67], v[200:203]
    ds_read_b64_tr_b16 a[90:91], v15 offset:17408
    v_add_u32 v8, s87, v8
    v_mfma_f32_16x16x32_bf16 v[200:203], a[52:55], a[68:71], v[200:203]
    ds_read_b64_tr_b16 a[84:85], v14 offset:24576
    v_add_u32 v9, s87, v9
    v_mfma_f32_16x16x32_bf16 v[204:207], a[56:59], a[64:67], v[204:207]
    ds_read_b64_tr_b16 a[92:93], v15 offset:24576
    v_add_u32 v10, s87, v10
    v_mfma_f32_16x16x32_bf16 v[204:207], a[60:63], a[68:71], v[204:207]
    s_waitcnt lgkmcnt(8)
    ds_read_b64_tr_b16 a[86:87], v14 offset:25600
    v_add_u32 v11, s87, v11
    v_mfma_f32_16x16x32_bf16 v[208:211], a[32:35], a[72:75], v[208:211]
    s_waitcnt lgkmcnt(7)
    s_add_u32 m0, s83, 16384
    ds_read_b64_tr_b16 a[94:95], v15 offset:25600
    v_add_u32 v12, s87, v12
    v_mfma_f32_16x16x32_bf16 v[208:211], a[36:39], a[76:79], v[208:211]
    s_mov_b32 s58, s85
    buffer_load_dwordx4 v24, s[64:67], s77 offen offset:0 lds
    v_add_u32 v13, s87, v13
    v_mfma_f32_16x16x32_bf16 v[212:215], a[40:43], a[72:75], v[212:215]
    s_mov_b32 s85, s84
    v_add_u32 v14, s87, v14
    v_mfma_f32_16x16x32_bf16 v[212:215], a[44:47], a[76:79], v[212:215]
    s_mov_b32 s84, s83
    buffer_load_dwordx4 v25, s[64:67], s77 offen offset:1024 lds
    v_add_u32 v15, s87, v15
    v_mfma_f32_16x16x32_bf16 v[216:219], a[48:51], a[72:75], v[216:219]
    s_mov_b32 s83, s58
    v_mfma_f32_16x16x32_bf16 v[216:219], a[52:55], a[76:79], v[216:219]
    v_mfma_f32_16x16x32_bf16 v[220:223], a[56:59], a[72:75], v[220:223]
    v_mfma_f32_16x16x32_bf16 v[220:223], a[60:63], a[76:79], v[220:223]
    s_waitcnt lgkmcnt(5)
    v_mfma_f32_16x16x32_bf16 v[224:227], a[32:35], a[80:83], v[224:227]
    s_waitcnt vmcnt(17) lgkmcnt(0)
    s_barrier
    v_mfma_f32_16x16x32_bf16 v[224:227], a[36:39], a[84:87], v[224:227]
    ds_read_b64_tr_b16 a[64:65], v8 offset:0
    v_mfma_f32_16x16x32_bf16 v[228:231], a[40:43], a[80:83], v[228:231]
    buffer_load_dwordx4 v26, s[68:71], s77 offen offset:2048 lds
    v_mfma_f32_16x16x32_bf16 v[228:231], a[44:47], a[84:87], v[228:231]
    ds_read_b64_tr_b16 a[66:67], v8 offset:1024
    v_mfma_f32_16x16x32_bf16 v[232:235], a[48:51], a[80:83], v[232:235]
    v_mfma_f32_16x16x32_bf16 v[232:235], a[52:55], a[84:87], v[232:235]
    ds_read_b64_tr_b16 a[68:69], v8 offset:8192
    v_mfma_f32_16x16x32_bf16 v[236:239], a[56:59], a[80:83], v[236:239]
    v_mfma_f32_16x16x32_bf16 v[236:239], a[60:63], a[84:87], v[236:239]
    ds_read_b64_tr_b16 a[70:71], v8 offset:9216
    v_mfma_f32_16x16x32_bf16 v[240:243], a[32:35], a[88:91], v[240:243]
    ds_read_b64_tr_b16 a[72:73], v9 offset:0
    v_mfma_f32_16x16x32_bf16 v[240:243], a[36:39], a[92:95], v[240:243]
    s_waitcnt vmcnt(11)
    v_cmp_ne_u32 vcc, -1, v47
    v_mfma_f32_16x16x32_bf16 v[244:247], a[40:43], a[88:91], v[244:247]
    ds_read_b64_tr_b16 a[74:75], v9 offset:1024
    v_mfma_f32_16x16x32_bf16 v[244:247], a[44:47], a[92:95], v[244:247]
    buffer_load_dwordx4 v27, s[68:71], s77 offen offset:3072 lds
    s_cbranch_vccnz L_spin1
L_spin1_back:
    v_mfma_f32_16x16x32_bf16 v[248:251], a[48:51], a[88:91], v[248:251]
    s_add_u32 s77, s77, s81
    ds_read_b64_tr_b16 a[76:77], v9 offset:8192
    v_mfma_f32_16x16x32_bf16 v[248:251], a[52:55], a[92:95], v[248:251]
    v_mfma_f32_16x16x32_bf16 v[252:255], a[56:59], a[88:91], v[252:255]
    ds_read_b64_tr_b16 a[78:79], v9 offset:9216
    v_mfma_f32_16x16x32_bf16 v[252:255], a[60:63], a[92:95], v[252:255]
    s_waitcnt lgkmcnt(6)
    v_mfma_f32_16x16x32_bf16 a[128:131], a[64:67], a[0:3], a[128:131]
    s_waitcnt lgkmcnt(4)
    v_mfma_f32_16x16x32_bf16 a[128:131], a[68:71], a[4:7], a[128:131]
    s_add_u32 m0, s86, 0
    ds_read_b64_tr_b16 a[80:81], v10 offset:0
    v_mfma_f32_16x16x32_bf16 a[132:135], a[64:67], a[8:11], a[132:135]
    s_mov_b64 s[60:61], s[12:13]
    buffer_load_dwordx4 v28, s[72:75], s78 offen offset:0 sc1 lds
    v_mfma_f32_16x16x32_bf16 a[132:135], a[68:71], a[12:15], a[132:135]
    s_mov_b32 s62, s14
    s_sub_u32 s76, s76, 4194304
    ds_read_b64_tr_b16 a[82:83], v10 offset:1024
    v_mov_b64 v[24:25], v[52:53]
    v_mfma_f32_16x16x32_bf16 a[136:139], a[64:67], a[16:19], a[136:139]
    s_sub_u32 s64, s28, 2048
    s_subb_u32 s65, s29, 0
    v_mov_b64 v[26:27], v[54:55]
    v_mfma_f32_16x16x32_bf16 a[136:139], a[68:71], a[20:23], a[136:139]
    s_cmp_lt_u32 s91, 27
    s_cselect_b32 s66, 2213888, 0
    ds_read_b64_tr_b16 a[84:85], v10 offset:8192
    v_mfma_f32_16x16x32_bf16 a[140:143], a[64:67], a[24:27], a[140:143]
    s_sub_u32 s68, s32, 2048
    s_subb_u32 s69, s33, 0
    v_mfma_f32_16x16x32_bf16 a[140:143], a[68:71], a[28:31], a[140:143]
    s_waitcnt lgkmcnt(5)
    ds_read_b64_tr_b16 a[86:87], v10 offset:9216
    v_mfma_f32_16x16x32_bf16 a[144:147], a[72:75], a[0:3], a[144:147]
    s_waitcnt lgkmcnt(4)
    s_cmp_lt_u32 s91, 27
    s_cselect_b32 s70, 2213888, 0
    v_mfma_f32_16x16x32_bf16 a[144:147], a[76:79], a[4:7], a[144:147]
    s_mul_i32 s77, s52, 55296
    s_lshl_b32 s57, s91, 7
    ds_read_b64_tr_b16 a[88:89], v11 offset:0
    v_mfma_f32_16x16x32_bf16 a[148:151], a[72:75], a[8:11], a[148:151]
    s_add_u32 s77, s77, s57
    buffer_load_dwordx4 v29, s[72:75], s78 offen offset:1024 sc1 lds
    v_mfma_f32_16x16x32_bf16 a[148:151], a[76:79], a[12:15], a[148:151]
    s_mov_b32 s81, 221184
    ds_read_b64_tr_b16 a[90:91], v11 offset:1024
    v_mfma_f32_16x16x32_bf16 a[152:155], a[72:75], a[16:19], a[152:155]
    v_mfma_f32_16x16x32_bf16 a[152:155], a[76:79], a[20:23], a[152:155]
    ds_read_b64_tr_b16 a[92:93], v11 offset:8192
    v_mfma_f32_16x16x32_bf16 a[156:159], a[72:75], a[24:27], a[156:159]
    v_mfma_f32_16x16x32_bf16 a[156:159], a[76:79], a[28:31], a[156:159]
    s_waitcnt lgkmcnt(5)
    ds_read_b64_tr_b16 a[94:95], v11 offset:9216
    v_mfma_f32_16x16x32_bf16 a[160:163], a[80:83], a[0:3], a[160:163]
    s_waitcnt lgkmcnt(4)
    v_mfma_f32_16x16x32_bf16 a[160:163], a[84:87], a[4:7], a[160:163]
    ds_read_b64_tr_b16 a[64:65], v12 offset:0
    v_mfma_f32_16x16x32_bf16 a[164:167], a[80:83], a[8:11], a[164:167]
    buffer_load_dwordx4 v30, s[72:75], s78 offen offset:2048 sc1 lds
    v_mfma_f32_16x16x32_bf16 a[164:167], a[84:87], a[12:15], a[164:167]
    ds_read_b64_tr_b16 a[66:67], v12 offset:1024
    v_mfma_f32_16x16x32_bf16 a[168:171], a[80:83], a[16:19], a[168:171]
    v_mfma_f32_16x16x32_bf16 a[168:171], a[84:87], a[20:23], a[168:171]
    ds_read_b64_tr_b16 a[68:69], v12 offset:8192
    v_mfma_f32_16x16x32_bf16 a[172:175], a[80:83], a[24:27], a[172:175]
    v_mfma_f32_16x16x32_bf16 a[172:175], a[84:87], a[28:31], a[172:175]
    s_waitcnt lgkmcnt(5)
    ds_read_b64_tr_b16 a[70:71], v12 offset:9216
    v_mfma_f32_16x16x32_bf16 a[176:179], a[88:91], a[0:3], a[176:179]
    s_waitcnt lgkmcnt(4)
    v_mfma_f32_16x16x32_bf16 a[176:179], a[92:95], a[4:7], a[176:179]
    ds_read_b64_tr_b16 a[72:73], v13 offset:0
    v_mfma_f32_16x16x32_bf16 a[180:183], a[88:91], a[8:11], a[180:183]
    buffer_load_dwordx4 v31, s[72:75], s78 offen offset:3072 sc1 lds
    v_mfma_f32_16x16x32_bf16 a[180:183], a[92:95], a[12:15], a[180:183]
    ds_read_b64_tr_b16 a[74:75], v13 offset:1024
    v_mfma_f32_16x16x32_bf16 a[184:187], a[88:91], a[16:19], a[184:187]
    v_mfma_f32_16x16x32_bf16 a[184:187], a[92:95], a[20:23], a[184:187]
    ds_read_b64_tr_b16 a[76:77], v13 offset:8192
    v_mfma_f32_16x16x32_bf16 a[188:191], a[88:91], a[24:27], a[188:191]
    v_mfma_f32_16x16x32_bf16 a[188:191], a[92:95], a[28:31], a[188:191]
    s_waitcnt lgkmcnt(5)
    ds_read_b64_tr_b16 a[78:79], v13 offset:9216
    v_mfma_f32_16x16x32_bf16 v[64:67], a[64:67], a[0:3], v[64:67]
    s_waitcnt lgkmcnt(4)
    v_mfma_f32_16x16x32_bf16 v[64:67], a[68:71], a[4:7], v[64:67]
    s_add_u32 m0, s86, 4096
    ds_read_b64_tr_b16 a[80:81], v14 offset:0
    v_mfma_f32_16x16x32_bf16 v[68:71], a[64:67], a[8:11], v[68:71]
    buffer_load_dwordx4 v28, s[72:75], s79 offen offset:0 sc1 lds
    v_mfma_f32_16x16x32_bf16 v[68:71], a[68:71], a[12:15], v[68:71]
    ds_read_b64_tr_b16 a[82:83], v14 offset:1024
    v_mfma_f32_16x16x32_bf16 v[72:75], a[64:67], a[16:19], v[72:75]
    v_mfma_f32_16x16x32_bf16 v[72:75], a[68:71], a[20:23], v[72:75]
    ds_read_b64_tr_b16 a[84:85], v14 offset:8192
    v_mfma_f32_16x16x32_bf16 v[76:79], a[64:67], a[24:27], v[76:79]
    v_mfma_f32_16x16x32_bf16 v[76:79], a[68:71], a[28:31], v[76:79]
    s_waitcnt lgkmcnt(5)
    ds_read_b64_tr_b16 a[86:87], v14 offset:9216
    v_mfma_f32_16x16x32_bf16 v[80:83], a[72:75], a[0:3], v[80:83]
    s_waitcnt lgkmcnt(4)
    v_mfma_f32_16x16x32_bf16 v[80:83], a[76:79], a[4:7], v[80:83]
    ds_read_b64_tr_b16 a[88:89], v15 offset:0
    v_mfma_f32_16x16x32_bf16 v[84:87], a[72:75], a[8:11], v[84:87]
    buffer_load_dwordx4 v29, s[72:75], s79 offen offset:1024 sc1 lds
    v_mfma_f32_16x16x32_bf16 v[84:87], a[76:79], a[12:15], v[84:87]
    ds_read_b64_tr_b16 a[90:91], v15 offset:1024
    v_mfma_f32_16x16x32_bf16 v[88:91], a[72:75], a[16:19], v[88:91]
    v_mfma_f32_16x16x32_bf16 v[88:91], a[76:79], a[20:23], v[88:91]
    ds_read_b64_tr_b16 a[92:93], v15 offset:8192
    v_mfma_f32_16x16x32_bf16 v[92:95], a[72:75], a[24:27], v[92:95]
    v_mfma_f32_16x16x32_bf16 v[92:95], a[76:79], a[28:31], v[92:95]
    s_waitcnt lgkmcnt(5)
    ds_read_b64_tr_b16 a[94:95], v15 offset:9216
    v_mfma_f32_16x16x32_bf16 v[96:99], a[80:83], a[0:3], v[96:99]
    s_waitcnt lgkmcnt(4)
    v_mfma_f32_16x16x32_bf16 v[96:99], a[84:87], a[4:7], v[96:99]
    ds_read_b64_tr_b16 a[64:65], v8 offset:16384
    v_mfma_f32_16x16x32_bf16 v[100:103], a[80:83], a[8:11], v[100:103]
    buffer_load_dwordx4 v30, s[72:75], s79 offen offset:2048 sc1 lds
    v_mfma_f32_16x16x32_bf16 v[100:103], a[84:87], a[12:15], v[100:103]
    ds_read_b64_tr_b16 a[66:67], v8 offset:17408
    v_mfma_f32_16x16x32_bf16 v[104:107], a[80:83], a[16:19], v[104:107]
    v_mfma_f32_16x16x32_bf16 v[104:107], a[84:87], a[20:23], v[104:107]
    ds_read_b64_tr_b16 a[68:69], v8 offset:24576
    v_mfma_f32_16x16x32_bf16 v[108:111], a[80:83], a[24:27], v[108:111]
    v_mfma_f32_16x16x32_bf16 v[108:111], a[84:87], a[28:31], v[108:111]
    s_waitcnt lgkmcnt(5)
    ds_read_b64_tr_b16 a[70:71], v8 offset:25600
    v_mfma_f32_16x16x32_bf16 v[112:115], a[88:91], a[0:3], v[112:115]
    s_waitcnt lgkmcnt(4)
    v_mfma_f32_16x16x32_bf16 v[112:115], a[92:95], a[4:7], v[112:115]
    ds_read_b64_tr_b16 a[72:73], v9 offset:16384
    v_mfma_f32_16x16x32_bf16 v[116:119], a[88:91], a[8:11], v[116:119]
    buffer_load_dwordx4 v31, s[72:75], s79 offen offset:3072 sc1 lds
    v_mfma_f32_16x16x32_bf16 v[116:119], a[92:95], a[12:15], v[116:119]
    s_add_u32 s78, s78, s82
    ds_read_b64_tr_b16 a[74:75], v9 offset:17408
    v_mfma_f32_16x16x32_bf16 v[120:123], a[88:91], a[16:19], v[120:123]
    s_add_u32 s79, s79, s82
    v_mfma_f32_16x16x32_bf16 v[120:123], a[92:95], a[20:23], v[120:123]
    ds_read_b64_tr_b16 a[76:77], v9 offset:24576
    v_mfma_f32_16x16x32_bf16 v[124:127], a[88:91], a[24:27], v[124:127]
    v_mfma_f32_16x16x32_bf16 v[124:127], a[92:95], a[28:31], v[124:127]
    s_waitcnt lgkmcnt(5)
    ds_read_b64_tr_b16 a[78:79], v9 offset:25600
    v_mfma_f32_16x16x32_bf16 v[128:131], a[0:3], a[64:67], v[128:131]
    s_waitcnt lgkmcnt(4)
    v_mfma_f32_16x16x32_bf16 v[128:131], a[4:7], a[68:71], v[128:131]
    s_mov_b32 m0, s83
    ds_read_b64_tr_b16 a[80:81], v10 offset:16384
    v_mfma_f32_16x16x32_bf16 v[132:135], a[8:11], a[64:67], v[132:135]
    buffer_load_dwordx4 v20, s[60:63], s76 offen offset:0 lds
    v_mfma_f32_16x16x32_bf16 v[132:135], a[12:15], a[68:71], v[132:135]
    ds_read_b64_tr_b16 a[82:83], v10 offset:17408
    v_mfma_f32_16x16x32_bf16 v[136:139], a[16:19], a[64:67], v[136:139]
    s_waitcnt vmcnt(18)
    v_mfma_f32_16x16x32_bf16 v[136:139], a[20:23], a[68:71], v[136:139]
    ds_read_b64_tr_b16 a[84:85], v10 offset:24576
    v_mfma_f32_16x16x32_bf16 v[140:143], a[24:27], a[64:67], v[140:143]
    ds_read_b128 a[32:35], v4 offset:32768
    v_mfma_f32_16x16x32_bf16 v[140:143], a[28:31], a[68:71], v[140:143]
    s_waitcnt lgkmcnt(6)
    ds_read_b64_tr_b16 a[86:87], v10 offset:25600
    v_mfma_f32_16x16x32_bf16 v[144:147], a[0:3], a[72:75], v[144:147]
    s_waitcnt lgkmcnt(5)
    ds_read_b128 a[36:39], v5 offset:32768
    v_mfma_f32_16x16x32_bf16 v[144:147], a[4:7], a[76:79], v[144:147]
    ds_read_b64_tr_b16 a[88:89], v11 offset:16384
    v_mfma_f32_16x16x32_bf16 v[148:151], a[8:11], a[72:75], v[148:151]
    buffer_load_dwordx4 v21, s[60:63], s76 offen offset:1024 lds
    v_mfma_f32_16x16x32_bf16 v[148:151], a[12:15], a[76:79], v[148:151]
    ds_read_b64_tr_b16 a[90:91], v11 offset:17408
    v_mfma_f32_16x16x32_bf16 v[152:155], a[16:19], a[72:75], v[152:155]
    ds_read_b128 a[40:43], v4 offset:34816
    v_mfma_f32_16x16x32_bf16 v[152:155], a[20:23], a[76:79], v[152:155]
    ds_read_b64_tr_b16 a[92:93], v11 offset:24576
    v_mfma_f32_16x16x32_bf16 v[156:159], a[24:27], a[72:75], v[156:159]
    ds_read_b128 a[44:47], v5 offset:34816
    v_mfma_f32_16x16x32_bf16 v[156:159], a[28:31], a[76:79], v[156:159]
    s_waitcnt lgkmcnt(9)
    ds_read_b64_tr_b16 a[94:95], v11 offset:25600
    v_mfma_f32_16x16x32_bf16 v[160:163], a[0:3], a[80:83], v[160:163]
    s_waitcnt lgkmcnt(7)
    ds_read_b128 a[48:51], v4 offset:36864
    v_mfma_f32_16x16x32_bf16 v[160:163], a[4:7], a[84:87], v[160:163]
    ds_read_b64_tr_b16 a[64:65], v12 offset:16384
    v_mfma_f32_16x16x32_bf16 v[164:167], a[8:11], a[80:83], v[164:167]
    buffer_load_dwordx4 v22, s[60:63], s76 offen offset:2048 lds
    v_mfma_f32_16x16x32_bf16 v[164:167], a[12:15], a[84:87], v[164:167]
    ds_read_b64_tr_b16 a[66:67], v12 offset:17408
    v_mfma_f32_16x16x32_bf16 v[168:171], a[16:19], a[80:83], v[168:171]
    ds_read_b128 a[52:55], v5 offset:36864
    v_mfma_f32_16x16x32_bf16 v[168:171], a[20:23], a[84:87], v[168:171]
    ds_read_b64_tr_b16 a[68:69], v12 offset:24576
    v_mfma_f32_16x16x32_bf16 v[172:175], a[24:27], a[80:83], v[172:175]
    ds_read_b128 a[56:59], v4 offset:38912
    v_mfma_f32_16x16x32_bf16 v[172:175], a[28:31], a[84:87], v[172:175]
    s_waitcnt lgkmcnt(10)
    ds_read_b64_tr_b16 a[70:71], v12 offset:25600
    v_mfma_f32_16x16x32_bf16 v[176:179], a[0:3], a[88:91], v[176:179]
    s_waitcnt lgkmcnt(7)
    ds_read_b128 a[60:63], v5 offset:38912
    v_mfma_f32_16x16x32_bf16 v[176:179], a[4:7], a[92:95], v[176:179]
    ds_read_b64_tr_b16 a[72:73], v13 offset:16384
    v_mfma_f32_16x16x32_bf16 v[180:183], a[8:11], a[88:91], v[180:183]
    buffer_load_dwordx4 v23, s[60:63], s76 offen offset:3072 lds
    v_mfma_f32_16x16x32_bf16 v[180:183], a[12:15], a[92:95], v[180:183]
    s_add_u32 s76, s76, s80
    ds_read_b64_tr_b16 a[74:75], v13 offset:17408
    v_mfma_f32_16x16x32_bf16 v[184:187], a[16:19], a[88:91], v[184:187]
    v_mfma_f32_16x16x32_bf16 v[184:187], a[20:23], a[92:95], v[184:187]
    ds_read_b64_tr_b16 a[76:77], v13 offset:24576
    v_mfma_f32_16x16x32_bf16 v[188:191], a[24:27], a[88:91], v[188:191]
    v_mfma_f32_16x16x32_bf16 v[188:191], a[28:31], a[92:95], v[188:191]
    s_waitcnt lgkmcnt(8)
    ds_read_b64_tr_b16 a[78:79], v13 offset:25600
    v_mfma_f32_16x16x32_bf16 v[192:195], a[0:3], a[64:67], v[192:195]
    s_waitcnt lgkmcnt(5)
    v_mfma_f32_16x16x32_bf16 v[192:195], a[4:7], a[68:71], v[192:195]
    ds_read_b64_tr_b16 a[80:81], v14 offset:16384
    v_mfma_f32_16x16x32_bf16 v[196:199], a[8:11], a[64:67], v[196:199]
    s_sub_u32 s87, s84, s85
    ds_read_b64_tr_b16 a[88:89], v15 offset:16384
    v_mfma_f32_16x16x32_bf16 v[196:199], a[12:15], a[68:71], v[196:199]
    ds_read_b64_tr_b16 a[82:83], v14 offset:17408
    v_mfma_f32_16x16x32_bf16 v[200:203], a[16:19], a[64:67], v[200:203]
    ds_read_b64_tr_b16 a[90:91], v15 offset:17408
    v_add_u32 v8, s87, v8
    v_mfma_f32_16x16x32_bf16 v[200:203], a[20:23], a[68:71], v[200:203]
    ds_read_b64_tr_b16 a[84:85], v14 offset:24576
    v_add_u32 v9, s87, v9
    v_mfma_f32_16x16x32_bf16 v[204:207], a[24:27], a[64:67], v[204:207]
    ds_read_b64_tr_b16 a[92:93], v15 offset:24576
    v_add_u32 v10, s87, v10
    v_mfma_f32_16x16x32_bf16 v[204:207], a[28:31], a[68:71], v[204:207]
    s_waitcnt lgkmcnt(8)
    ds_read_b64_tr_b16 a[86:87], v14 offset:25600
    v_add_u32 v11, s87, v11
    v_mfma_f32_16x16x32_bf16 v[208:211], a[0:3], a[72:75], v[208:211]
    s_waitcnt lgkmcnt(7)
    s_add_u32 m0, s83, 16384
    ds_read_b64_tr_b16 a[94:95], v15 offset:25600
    v_add_u32 v12, s87, v12
    v_mfma_f32_16x16x32_bf16 v[208:211], a[4:7], a[76:79], v[208:211]
    s_mov_b32 s58, s85
    buffer_load_dwordx4 v24, s[64:67], s77 offen offset:0 lds
    v_add_u32 v13, s87, v13
    v_mfma_f32_16x16x32_bf16 v[212:215], a[8:11], a[72:75], v[212:215]
    s_mov_b32 s85, s84
    v_add_u32 v14, s87, v14
    v_mfma_f32_16x16x32_bf16 v[212:215], a[12:15], a[76:79], v[212:215]
    s_mov_b32 s84, s83
    buffer_load_dwordx4 v25, s[64:67], s77 offen offset:1024 lds
    v_add_u32 v15, s87, v15
    v_mfma_f32_16x16x32_bf16 v[216:219], a[16:19], a[72:75], v[216:219]
    s_mov_b32 s83, s58
    v_mfma_f32_16x16x32_bf16 v[216:219], a[20:23], a[76:79], v[216:219]
    v_mfma_f32_16x16x32_bf16 v[220:223], a[24:27], a[72:75], v[220:223]
    v_mfma_f32_16x16x32_bf16 v[220:223], a[28:31], a[76:79], v[220:223]
    s_waitcnt lgkmcnt(5)
    v_mfma_f32_16x16x32_bf16 v[224:227], a[0:3], a[80:83], v[224:227]
    s_waitcnt vmcnt(14) lgkmcnt(0)
    s_barrier
    v_mfma_f32_16x16x32_bf16 v[224:227], a[4:7], a[84:87], v[224:227]
    ds_read_b64_tr_b16 a[64:65], v8 offset:0
    v_mfma_f32_16x16x32_bf16 v[228:231], a[8:11], a[80:83], v[228:231]
    buffer_load_dwordx4 v26, s[68:71], s77 offen offset:2048 lds
    v_mfma_f32_16x16x32_bf16 v[228:231], a[12:15], a[84:87], v[228:231]
    ds_read_b64_tr_b16 a[66:67], v8 offset:1024
    v_mfma_f32_16x16x32_bf16 v[232:235], a[16:19], a[80:83], v[232:235]
    v_mfma_f32_16x16x32_bf16 v[232:235], a[20:23], a[84:87], v[232:235]
    ds_read_b64_tr_b16 a[68:69], v8 offset:8192
    v_mfma_f32_16x16x32_bf16 v[236:239], a[24:27], a[80:83], v[236:239]
    v_mfma_f32_16x16x32_bf16 v[236:239], a[28:31], a[84:87], v[236:239]
    ds_read_b64_tr_b16 a[70:71], v8 offset:9216
    v_mfma_f32_16x16x32_bf16 v[240:243], a[0:3], a[88:91], v[240:243]
    ds_read_b64_tr_b16 a[72:73], v9 offset:0
    v_mfma_f32_16x16x32_bf16 v[240:243], a[4:7], a[92:95], v[240:243]
    v_mfma_f32_16x16x32_bf16 v[244:247], a[8:11], a[88:91], v[244:247]
    ds_read_b64_tr_b16 a[74:75], v9 offset:1024
    v_mfma_f32_16x16x32_bf16 v[244:247], a[12:15], a[92:95], v[244:247]
    buffer_load_dwordx4 v27, s[68:71], s77 offen offset:3072 lds
    v_mfma_f32_16x16x32_bf16 v[248:251], a[16:19], a[88:91], v[248:251]
    s_add_u32 s77, s77, s81
    ds_read_b64_tr_b16 a[76:77], v9 offset:8192
    v_mfma_f32_16x16x32_bf16 v[248:251], a[20:23], a[92:95], v[248:251]
    v_mfma_f32_16x16x32_bf16 v[252:255], a[24:27], a[88:91], v[252:255]
    ds_read_b64_tr_b16 a[78:79], v9 offset:9216
    v_mfma_f32_16x16x32_bf16 v[252:255], a[28:31], a[92:95], v[252:255]
    s_waitcnt lgkmcnt(6)
L_q:
    v_mfma_f32_16x16x32_bf16 a[128:131], a[64:67], a[32:35], a[128:131]
    s_waitcnt lgkmcnt(4)
    v_mfma_f32_16x16x32_bf16 a[128:131], a[68:71], a[36:39], a[128:131]
    s_add_u32 m0, s86, 32768
    ds_read_b64_tr_b16 a[80:81], v10 offset:0
    v_mfma_f32_16x16x32_bf16 a[132:135], a[64:67], a[40:43], a[132:135]
    buffer_load_dwordx4 v28, s[72:75], s78 offen offset:0 sc1 lds
    v_mfma_f32_16x16x32_bf16 a[132:135], a[68:71], a[44:47], a[132:135]
    ds_read_b64_tr_b16 a[82:83], v10 offset:1024
    v_mfma_f32_16x16x32_bf16 a[136:139], a[64:67], a[48:51], a[136:139]
    v_mfma_f32_16x16x32_bf16 a[136:139], a[68:71], a[52:55], a[136:139]
    ds_read_b64_tr_b16 a[84:85], v10 offset:8192
    v_mfma_f32_16x16x32_bf16 a[140:143], a[64:67], a[56:59], a[140:143]
    v_mfma_f32_16x16x32_bf16 a[140:143], a[68:71], a[60:63], a[140:143]
    s_waitcnt lgkmcnt(5)
    ds_read_b64_tr_b16 a[86:87], v10 offset:9216
    v_mfma_f32_16x16x32_bf16 a[144:147], a[72:75], a[32:35], a[144:147]
    s_waitcnt lgkmcnt(4)
    v_mfma_f32_16x16x32_bf16 a[144:147], a[76:79], a[36:39], a[144:147]
    ds_read_b64_tr_b16 a[88:89], v11 offset:0
    v_accvgpr_read_b32 v32, a128
    v_mfma_f32_16x16x32_bf16 a[148:151], a[72:75], a[40:43], a[148:151]
    buffer_load_dwordx4 v29, s[72:75], s78 offen offset:1024 sc1 lds
    v_mfma_f32_16x16x32_bf16 a[148:151], a[76:79], a[44:47], a[148:151]
    ds_read_b64_tr_b16 a[90:91], v11 offset:1024
    v_accvgpr_read_b32 v6, a129
    v_mfma_f32_16x16x32_bf16 a[152:155], a[72:75], a[48:51], a[152:155]
    v_cvt_pk_bf16_f32 v32, v32, v6
    v_accvgpr_read_b32 v33, a130
    v_mfma_f32_16x16x32_bf16 a[152:155], a[76:79], a[52:55], a[152:155]
    ds_read_b64_tr_b16 a[92:93], v11 offset:8192
    v_accvgpr_read_b32 v6, a131
    v_mfma_f32_16x16x32_bf16 a[156:159], a[72:75], a[56:59], a[156:159]
    v_cvt_pk_bf16_f32 v33, v33, v6
    v_mfma_f32_16x16x32_bf16 a[156:159], a[76:79], a[60:63], a[156:159]
    s_waitcnt lgkmcnt(5)
    ds_read_b64_tr_b16 a[94:95], v11 offset:9216
    v_mfma_f32_16x16x32_bf16 a[160:163], a[80:83], a[32:35], a[160:163]
    s_waitcnt lgkmcnt(4)
    v_mfma_f32_16x16x32_bf16 a[160:163], a[84:87], a[36:39], a[160:163]
    ds_read_b64_tr_b16 a[64:65], v12 offset:0
    v_accvgpr_read_b32 v34, a144
    v_mfma_f32_16x16x32_bf16 a[164:167], a[80:83], a[40:43], a[164:167]
    buffer_load_dwordx4 v30, s[72:75], s78 offen offset:2048 sc1 lds
    v_mfma_f32_16x16x32_bf16 a[164:167], a[84:87], a[44:47], a[164:167]
    ds_read_b64_tr_b16 a[66:67], v12 offset:1024
    v_accvgpr_read_b32 v6, a145
    v_mfma_f32_16x16x32_bf16 a[168:171], a[80:83], a[48:51], a[168:171]
    v_cvt_pk_bf16_f32 v34, v34, v6
    v_accvgpr_read_b32 v35, a146
    v_mfma_f32_16x16x32_bf16 a[168:171], a[84:87], a[52:55], a[168:171]
    ds_read_b64_tr_b16 a[68:69], v12 offset:8192
    v_accvgpr_read_b32 v6, a147
    v_mfma_f32_16x16x32_bf16 a[172:175], a[80:83], a[56:59], a[172:175]
    v_cvt_pk_bf16_f32 v35, v35, v6
    v_accvgpr_read_b32 v36, a132
    v_mfma_f32_16x16x32_bf16 a[172:175], a[84:87], a[60:63], a[172:175]
    s_waitcnt lgkmcnt(5)
    ds_read_b64_tr_b16 a[70:71], v12 offset:9216
    v_accvgpr_read_b32 v6, a133
    v_mfma_f32_16x16x32_bf16 a[176:179], a[88:91], a[32:35], a[176:179]
    s_waitcnt lgkmcnt(4)
    v_cvt_pk_bf16_f32 v36, v36, v6
    v_accvgpr_read_b32 v37, a134
    v_mfma_f32_16x16x32_bf16 a[176:179], a[92:95], a[36:39], a[176:179]
    ds_read_b64_tr_b16 a[72:73], v13 offset:0
    v_accvgpr_read_b32 v6, a135
    v_mfma_f32_16x16x32_bf16 a[180:183], a[88:91], a[40:43], a[180:183]
    s_branch L_pado4
L_pad4:
    s_branch L_tour_ret1
L_pado4:
    buffer_load_dwordx4 v31, s[72:75], s78 offen offset:3072 sc1 lds
    v_mfma_f32_16x16x32_bf16 a[180:183], a[92:95], a[44:47], a[180:183]
    ds_read_b64_tr_b16 a[74:75], v13 offset:1024
    v_cvt_pk_bf16_f32 v37, v37, v6
    v_mfma_f32_16x16x32_bf16 a[184:187], a[88:91], a[48:51], a[184:187]
    v_accvgpr_read_b32 v38, a148
    v_accvgpr_read_b32 v6, a149
    v_mfma_f32_16x16x32_bf16 a[184:187], a[92:95], a[52:55], a[184:187]
    s_add_u32 s88, s90, 0
    ds_read_b64_tr_b16 a[76:77], v13 offset:8192
    v_cvt_pk_bf16_f32 v38, v38, v6
    v_mfma_f32_16x16x32_bf16 a[188:191], a[88:91], a[56:59], a[188:191]
    buffer_store_dwordx4 v[32:35], v1, s[44:47], s88 offen offset:0 sc1
    v_mfma_f32_16x16x32_bf16 a[188:191], a[92:95], a[60:63], a[188:191]
    s_waitcnt lgkmcnt(5)
    ds_read_b64_tr_b16 a[78:79], v13 offset:9216
    v_accvgpr_read_b32 v39, a150
    v_mfma_f32_16x16x32_bf16 v[64:67], a[64:67], a[32:35], v[64:67]
    s_waitcnt lgkmcnt(4)
    v_accvgpr_read_b32 v6, a151
    v_cvt_pk_bf16_f32 v39, v39, v6
    v_mfma_f32_16x16x32_bf16 v[64:67], a[68:71], a[36:39], v[64:67]
    s_add_u32 m0, s86, 36864
    ds_read_b64_tr_b16 a[80:81], v14 offset:0
    v_accvgpr_read_b32 v40, a136
    v_mfma_f32_16x16x32_bf16 v[68:71], a[64:67], a[40:43], v[68:71]
    buffer_load_dwordx4 v28, s[72:75], s79 offen offset:0 sc1 lds
    v_mfma_f32_16x16x32_bf16 v[68:71], a[68:71], a[44:47], v[68:71]
    ds_read_b64_tr_b16 a[82:83], v14 offset:1024
    v_accvgpr_read_b32 v6, a137
    v_mfma_f32_16x16x32_bf16 v[72:75], a[64:67], a[48:51], v[72:75]
    v_cvt_pk_bf16_f32 v40, v40, v6
    v_accvgpr_read_b32 v41, a138
    v_mfma_f32_16x16x32_bf16 v[72:75], a[68:71], a[52:55], v[72:75]
    ds_read_b64_tr_b16 a[84:85], v14 offset:8192
    v_accvgpr_read_b32 v6, a139
    v_mfma_f32_16x16x32_bf16 v[76:79], a[64:67], a[56:59], v[76:79]
    v_cvt_pk_bf16_f32 v41, v41, v6
    v_accvgpr_read_b32 v42, a152
    v_mfma_f32_16x16x32_bf16 v[76:79], a[68:71], a[60:63], v[76:79]
    s_waitcnt lgkmcnt(5)
    ds_read_b64_tr_b16 a[86:87], v14 offset:9216
    v_accvgpr_read_b32 v6, a153
    v_mfma_f32_16x16x32_bf16 v[80:83], a[72:75], a[32:35], v[80:83]
    s_waitcnt lgkmcnt(4)
    v_cvt_pk_bf16_f32 v42, v42, v6
    v_accvgpr_read_b32 v43, a154
    v_mfma_f32_16x16x32_bf16 v[80:83], a[76:79], a[36:39], v[80:83]
    ds_read_b64_tr_b16 a[88:89], v15 offset:0
    v_accvgpr_read_b32 v6, a155
    v_mfma_f32_16x16x32_bf16 v[84:87], a[72:75], a[40:43], v[84:87]
    buffer_load_dwordx4 v29, s[72:75], s79 offen offset:1024 sc1 lds
    v_mfma_f32_16x16x32_bf16 v[84:87], a[76:79], a[44:47], v[84:87]
    ds_read_b64_tr_b16 a[90:91], v15 offset:1024
    v_cvt_pk_bf16_f32 v43, v43, v6
    v_mfma_f32_16x16x32_bf16 v[88:91], a[72:75], a[48:51], v[88:91]
    v_accvgpr_read_b32 v44, a140
    v_accvgpr_read_b32 v6, a141
    v_mfma_f32_16x16x32_bf16 v[88:91], a[76:79], a[52:55], v[88:91]
    ds_read_b64_tr_b16 a[92:93], v15 offset:8192
    v_cvt_pk_bf16_f32 v44, v44, v6
    v_mfma_f32_16x16x32_bf16 v[92:95], a[72:75], a[56:59], v[92:95]
    v_accvgpr_read_b32 v45, a142
    v_accvgpr_read_b32 v6, a143
    v_mfma_f32_16x16x32_bf16 v[92:95], a[76:79], a[60:63], v[92:95]
    s_waitcnt lgkmcnt(5)
    ds_read_b64_tr_b16 a[94:95], v15 offset:9216
    v_cvt_pk_bf16_f32 v45, v45, v6
    v_mfma_f32_16x16x32_bf16 v[96:99], a[80:83], a[32:35], v[96:99]
    s_waitcnt lgkmcnt(4)
    v_accvgpr_read_b32 v46, a156
    v_accvgpr_read_b32 v6, a157
    v_mfma_f32_16x16x32_bf16 v[96:99], a[84:87], a[36:39], v[96:99]
    ds_read_b64_tr_b16 a[64:65], v8 offset:16384
    v_cvt_pk_bf16_f32 v46, v46, v6
    v_mfma_f32_16x16x32_bf16 v[100:103], a[80:83], a[40:43], v[100:103]
    buffer_load_dwordx4 v30, s[72:75], s79 offen offset:2048 sc1 lds
    v_mfma_f32_16x16x32_bf16 v[100:103], a[84:87], a[44:47], v[100:103]
    ds_read_b64_tr_b16 a[66:67], v8 offset:17408
    v_accvgpr_read_b32 v47, a158
    v_mfma_f32_16x16x32_bf16 v[104:107], a[80:83], a[48:51], v[104:107]
    v_accvgpr_read_b32 v6, a159
    v_cvt_pk_bf16_f32 v47, v47, v6
    v_mfma_f32_16x16x32_bf16 v[104:107], a[84:87], a[52:55], v[104:107]
    ds_read_b64_tr_b16 a[68:69], v8 offset:24576
    v_accvgpr_read_b32 v48, a160
    v_mfma_f32_16x16x32_bf16 v[108:111], a[80:83], a[56:59], v[108:111]
    v_accvgpr_read_b32 v6, a161
    v_cvt_pk_bf16_f32 v48, v48, v6
    v_mfma_f32_16x16x32_bf16 v[108:111], a[84:87], a[60:63], v[108:111]
    s_waitcnt lgkmcnt(5)
    s_add_u32 s59, s90, 4096
    ds_read_b64_tr_b16 a[70:71], v8 offset:25600
    v_accvgpr_read_b32 v49, a162
    v_mfma_f32_16x16x32_bf16 v[112:115], a[88:91], a[32:35], v[112:115]
    s_waitcnt lgkmcnt(4)
    buffer_store_dwordx4 v[36:39], v1, s[44:47], s59 offen offset:0 sc1
    v_mfma_f32_16x16x32_bf16 v[112:115], a[92:95], a[36:39], v[112:115]
    ds_read_b64_tr_b16 a[72:73], v9 offset:16384
    v_accvgpr_read_b32 v6, a163
    v_mfma_f32_16x16x32_bf16 v[116:119], a[88:91], a[40:43], v[116:119]
    buffer_load_dwordx4 v31, s[72:75], s79 offen offset:3072 sc1 lds
    v_mfma_f32_16x16x32_bf16 v[116:119], a[92:95], a[44:47], v[116:119]
    s_add_u32 s78, s78, s82
    ds_read_b64_tr_b16 a[74:75], v9 offset:17408
    v_cvt_pk_bf16_f32 v49, v49, v6
    v_mfma_f32_16x16x32_bf16 v[120:123], a[88:91], a[48:51], v[120:123]
    s_add_u32 s79, s79, s82
    v_accvgpr_read_b32 v50, a176
    v_accvgpr_read_b32 v6, a177
    v_mfma_f32_16x16x32_bf16 v[120:123], a[92:95], a[52:55], v[120:123]
    ds_read_b64_tr_b16 a[76:77], v9 offset:24576
    v_cvt_pk_bf16_f32 v50, v50, v6
    v_mfma_f32_16x16x32_bf16 v[124:127], a[88:91], a[56:59], v[124:127]
    v_accvgpr_read_b32 v51, a178
    v_accvgpr_read_b32 v6, a179
    v_mfma_f32_16x16x32_bf16 v[124:127], a[92:95], a[60:63], v[124:127]
    s_waitcnt lgkmcnt(5)
    ds_read_b64_tr_b16 a[78:79], v9 offset:25600
    v_cvt_pk_bf16_f32 v51, v51, v6
    v_mfma_f32_16x16x32_bf16 v[128:131], a[32:35], a[64:67], v[128:131]
    s_waitcnt lgkmcnt(4)
    v_accvgpr_read_b32 v52, a164
    v_accvgpr_read_b32 v6, a165
    v_mfma_f32_16x16x32_bf16 v[128:131], a[36:39], a[68:71], v[128:131]
    s_mov_b32 m0, s83
    ds_read_b64_tr_b16 a[80:81], v10 offset:16384
    v_cvt_pk_bf16_f32 v52, v52, v6
    v_mfma_f32_16x16x32_bf16 v[132:135], a[40:43], a[64:67], v[132:135]
    buffer_load_dwordx4 v20, s[60:63], s76 offen offset:0 lds
    v_mfma_f32_16x16x32_bf16 v[132:135], a[44:47], a[68:71], v[132:135]
    ds_read_b64_tr_b16 a[82:83], v10 offset:17408
    v_accvgpr_read_b32 v53, a166
    v_mfma_f32_16x16x32_bf16 v[136:139], a[48:51], a[64:67], v[136:139]
    s_waitcnt vmcnt(19)
    v_accvgpr_read_b32 v6, a167
    v_cvt_pk_bf16_f32 v53, v53, v6
    v_mfma_f32_16x16x32_bf16 v[136:139], a[52:55], a[68:71], v[136:139]
    ds_read_b64_tr_b16 a[84:85], v10 offset:24576
    v_accvgpr_read_b32 v54, a180
    v_mfma_f32_16x16x32_bf16 v[140:143], a[56:59], a[64:67], v[140:143]
    ds_read_b128 a[0:3], v4 offset:0
    v_accvgpr_read_b32 v6, a181
    v_mfma_f32_16x16x32_bf16 v[140:143], a[60:63], a[68:71], v[140:143]
    s_waitcnt lgkmcnt(6)
    ds_read_b64_tr_b16 a[86:87], v10 offset:25600
    v_cvt_pk_bf16_f32 v54, v54, v6
    v_mfma_f32_16x16x32_bf16 v[144:147], a[32:35], a[72:75], v[144:147]
    s_waitcnt lgkmcnt(5)
    ds_read_b128 a[4:7], v5 offset:0
    v_accvgpr_read_b32 v55, a182
    v_mfma_f32_16x16x32_bf16 v[144:147], a[36:39], a[76:79], v[144:147]
    ds_read_b64_tr_b16 a[88:89], v11 offset:16384
    v_accvgpr_read_b32 v6, a183
    v_mfma_f32_16x16x32_bf16 v[148:151], a[40:43], a[72:75], v[148:151]
    buffer_load_dwordx4 v21, s[60:63], s76 offen offset:1024 lds
    v_mfma_f32_16x16x32_bf16 v[148:151], a[44:47], a[76:79], v[148:151]
    ds_read_b64_tr_b16 a[90:91], v11 offset:17408
    v_cvt_pk_bf16_f32 v55, v55, v6
    v_mfma_f32_16x16x32_bf16 v[152:155], a[48:51], a[72:75], v[152:155]
    ds_read_b128 a[8:11], v4 offset:2048
    v_accvgpr_read_b32 v56, a168
    v_mfma_f32_16x16x32_bf16 v[152:155], a[52:55], a[76:79], v[152:155]
    ds_read_b64_tr_b16 a[92:93], v11 offset:24576
    v_accvgpr_read_b32 v6, a169
    v_mfma_f32_16x16x32_bf16 v[156:159], a[56:59], a[72:75], v[156:159]
    ds_read_b128 a[12:15], v5 offset:2048
    v_cvt_pk_bf16_f32 v56, v56, v6
    v_mfma_f32_16x16x32_bf16 v[156:159], a[60:63], a[76:79], v[156:159]
    s_waitcnt lgkmcnt(9)
    ds_read_b64_tr_b16 a[94:95], v11 offset:25600
    v_accvgpr_read_b32 v57, a170
    v_mfma_f32_16x16x32_bf16 v[160:163], a[32:35], a[80:83], v[160:163]
    s_waitcnt lgkmcnt(7)
    ds_read_b128 a[16:19], v4 offset:4096
    v_accvgpr_read_b32 v6, a171
    v_mfma_f32_16x16x32_bf16 v[160:163], a[36:39], a[84:87], v[160:163]
    ds_read_b64_tr_b16 a[64:65], v12 offset:16384
    v_cvt_pk_bf16_f32 v57, v57, v6
    v_mfma_f32_16x16x32_bf16 v[164:167], a[40:43], a[80:83], v[164:167]
    buffer_load_dwordx4 v22, s[60:63], s76 offen offset:2048 lds
    v_mfma_f32_16x16x32_bf16 v[164:167], a[44:47], a[84:87], v[164:167]
    ds_read_b64_tr_b16 a[66:67], v12 offset:17408
    v_accvgpr_read_b32 v58, a184
    v_mfma_f32_16x16x32_bf16 v[168:171], a[48:51], a[80:83], v[168:171]
    ds_read_b128 a[20:23], v5 offset:4096
    v_accvgpr_read_b32 v6, a185
    v_mfma_f32_16x16x32_bf16 v[168:171], a[52:55], a[84:87], v[168:171]
    ds_read_b64_tr_b16 a[68:69], v12 offset:24576
    v_cvt_pk_bf16_f32 v58, v58, v6
    v_mfma_f32_16x16x32_bf16 v[172:175], a[56:59], a[80:83], v[172:175]
    ds_read_b128 a[24:27], v4 offset:6144
    v_accvgpr_read_b32 v59, a186
    v_mfma_f32_16x16x32_bf16 v[172:175], a[60:63], a[84:87], v[172:175]
    s_waitcnt lgkmcnt(10)
    ds_read_b64_tr_b16 a[70:71], v12 offset:25600
    v_accvgpr_read_b32 v6, a187
    v_mfma_f32_16x16x32_bf16 v[176:179], a[32:35], a[88:91], v[176:179]
    s_waitcnt lgkmcnt(7)
    ds_read_b128 a[28:31], v5 offset:6144
    v_cvt_pk_bf16_f32 v59, v59, v6
    v_mfma_f32_16x16x32_bf16 v[176:179], a[36:39], a[92:95], v[176:179]
    ds_read_b64_tr_b16 a[72:73], v13 offset:16384
    v_accvgpr_read_b32 v60, a172
    v_mfma_f32_16x16x32_bf16 v[180:183], a[40:43], a[88:91], v[180:183]
    buffer_load_dwordx4 v23, s[60:63], s76 offen offset:3072 lds
    v_mfma_f32_16x16x32_bf16 v[180:183], a[44:47], a[92:95], v[180:183]
    s_add_u32 s76, s76, s80
    s_add_u32 s88, s90, 16384
    ds_read_b64_tr_b16 a[74:75], v13 offset:17408
    v_accvgpr_read_b32 v6, a173
    v_mfma_f32_16x16x32_bf16 v[184:187], a[48:51], a[88:91], v[184:187]
    buffer_store_dwordx4 v[40:43], v1, s[44:47], s88 offen offset:0 sc1
    v_mfma_f32_16x16x32_bf16 v[184:187], a[52:55], a[92:95], v[184:187]
    ds_read_b64_tr_b16 a[76:77], v13 offset:24576
    v_cvt_pk_bf16_f32 v60, v60, v6
    v_mfma_f32_16x16x32_bf16 v[188:191], a[56:59], a[88:91], v[188:191]
    v_accvgpr_read_b32 v61, a174
    v_accvgpr_read_b32 v6, a175
    v_mfma_f32_16x16x32_bf16 v[188:191], a[60:63], a[92:95], v[188:191]
    s_waitcnt lgkmcnt(8)
    ds_read_b64_tr_b16 a[78:79], v13 offset:25600
    v_cvt_pk_bf16_f32 v61, v61, v6
    v_mfma_f32_16x16x32_bf16 v[192:195], a[32:35], a[64:67], v[192:195]
    s_waitcnt lgkmcnt(5)
    v_accvgpr_read_b32 v62, a188
    v_accvgpr_read_b32 v6, a189
    v_mfma_f32_16x16x32_bf16 v[192:195], a[36:39], a[68:71], v[192:195]
    ds_read_b64_tr_b16 a[80:81], v14 offset:16384
    v_cvt_pk_bf16_f32 v62, v62, v6
    v_mfma_f32_16x16x32_bf16 v[196:199], a[40:43], a[64:67], v[196:199]
    s_sub_u32 s87, s84, s85
    ds_read_b64_tr_b16 a[88:89], v15 offset:16384
    v_accvgpr_read_b32 v63, a190
    v_mfma_f32_16x16x32_bf16 v[196:199], a[44:47], a[68:71], v[196:199]
    ds_read_b64_tr_b16 a[82:83], v14 offset:17408
    v_accvgpr_read_b32 v6, a191
    v_mfma_f32_16x16x32_bf16 v[200:203], a[48:51], a[64:67], v[200:203]
    ds_read_b64_tr_b16 a[90:91], v15 offset:17408
    v_add_u32 v8, s87, v8
    v_mfma_f32_16x16x32_bf16 v[200:203], a[52:55], a[68:71], v[200:203]
    ds_read_b64_tr_b16 a[84:85], v14 offset:24576
    v_add_u32 v9, s87, v9
    v_mfma_f32_16x16x32_bf16 v[204:207], a[56:59], a[64:67], v[204:207]
    ds_read_b64_tr_b16 a[92:93], v15 offset:24576
    v_add_u32 v10, s87, v10
    v_mfma_f32_16x16x32_bf16 v[204:207], a[60:63], a[68:71], v[204:207]
    s_waitcnt lgkmcnt(8)
    ds_read_b64_tr_b16 a[86:87], v14 offset:25600
    v_add_u32 v11, s87, v11
    v_mfma_f32_16x16x32_bf16 v[208:211], a[32:35], a[72:75], v[208:211]
    s_waitcnt lgkmcnt(7)
    s_add_u32 m0, s83, 16384
    ds_read_b64_tr_b16 a[94:95], v15 offset:25600
    v_add_u32 v12, s87, v12
    v_mfma_f32_16x16x32_bf16 v[208:211], a[36:39], a[76:79], v[208:211]
    s_mov_b32 s58, s85
    buffer_load_dwordx4 v24, s[64:67], s77 offen offset:0 lds
    v_add_u32 v13, s87, v13
    v_mfma_f32_16x16x32_bf16 v[212:215], a[40:43], a[72:75], v[212:215]
    s_mov_b32 s85, s84
    v_add_u32 v14, s87, v14
    v_cvt_pk_bf16_f32 v63, v63, v6
    v_mfma_f32_16x16x32_bf16 v[212:215], a[44:47], a[76:79], v[212:215]
    s_mov_b32 s84, s83
    s_add_u32 s59, s90, 20480
    buffer_load_dwordx4 v25, s[64:67], s77 offen offset:1024 lds
    v_add_u32 v15, s87, v15
    v_mfma_f32_16x16x32_bf16 v[216:219], a[48:51], a[72:75], v[216:219]
    s_mov_b32 s83, s58
    buffer_store_dwordx4 v[44:47], v1, s[44:47], s59 offen offset:0 sc1
    v_mfma_f32_16x16x32_bf16 v[216:219], a[52:55], a[76:79], v[216:219]
    v_cvt_pk_bf16_f32 v64, v64, v65
    v_cvt_pk_bf16_f32 v65, v66, v67
    v_mfma_f32_16x16x32_bf16 v[220:223], a[56:59], a[72:75], v[220:223]
    v_cvt_pk_bf16_f32 v66, v80, v81
    v_cvt_pk_bf16_f32 v67, v82, v83
    v_mfma_f32_16x16x32_bf16 v[220:223], a[60:63], a[76:79], v[220:223]
    s_waitcnt lgkmcnt(5)
    v_accvgpr_write_b32 a252, v64
    v_accvgpr_write_b32 a253, v65
    v_mfma_f32_16x16x32_bf16 v[224:227], a[32:35], a[80:83], v[224:227]
    s_waitcnt vmcnt(18) lgkmcnt(0)
    s_barrier
    v_mfma_f32_16x16x32_bf16 v[224:227], a[36:39], a[84:87], v[224:227]
    ds_read_b64_tr_b16 a[64:65], v8 offset:0
    v_accvgpr_write_b32 a254, v66
    v_mfma_f32_16x16x32_bf16 v[228:231], a[40:43], a[80:83], v[228:231]
    buffer_load_dwordx4 v26, s[68:71], s77 offen offset:2048 lds
    v_mfma_f32_16x16x32_bf16 v[228:231], a[44:47], a[84:87], v[228:231]
    ds_read_b64_tr_b16 a[66:67], v8 offset:1024
    v_accvgpr_write_b32 a255, v67
    v_mfma_f32_16x16x32_bf16 v[232:235], a[48:51], a[80:83], v[232:235]
    v_cvt_pk_bf16_f32 v68, v68, v69
    v_cvt_pk_bf16_f32 v69, v70, v71
    v_mfma_f32_16x16x32_bf16 v[232:235], a[52:55], a[84:87], v[232:235]
    ds_read_b64_tr_b16 a[68:69], v8 offset:8192
    v_cvt_pk_bf16_f32 v70, v84, v85
    v_mfma_f32_16x16x32_bf16 v[236:239], a[56:59], a[80:83], v[236:239]
    v_cvt_pk_bf16_f32 v71, v86, v87
    v_accvgpr_write_b32 a248, v68
    v_mfma_f32_16x16x32_bf16 v[236:239], a[60:63], a[84:87], v[236:239]
    ds_read_b64_tr_b16 a[70:71], v8 offset:9216
    v_accvgpr_write_b32 a249, v69
    v_mfma_f32_16x16x32_bf16 v[240:243], a[32:35], a[88:91], v[240:243]
    ds_read_b64_tr_b16 a[72:73], v9 offset:0
    v_accvgpr_write_b32 a250, v70
    v_mfma_f32_16x16x32_bf16 v[240:243], a[36:39], a[92:95], v[240:243]
    v_accvgpr_write_b32 a251, v71
    v_cvt_pk_bf16_f32 v72, v72, v73
    v_mfma_f32_16x16x32_bf16 v[244:247], a[40:43], a[88:91], v[244:247]
    ds_read_b64_tr_b16 a[74:75], v9 offset:1024
    v_cvt_pk_bf16_f32 v73, v74, v75
    v_mfma_f32_16x16x32_bf16 v[244:247], a[44:47], a[92:95], v[244:247]
    buffer_load_dwordx4 v27, s[68:71], s77 offen offset:3072 lds
    v_mfma_f32_16x16x32_bf16 v[248:251], a[48:51], a[88:91], v[248:251]
    s_add_u32 s77, s77, s81
    ds_read_b64_tr_b16 a[76:77], v9 offset:8192
    v_cvt_pk_bf16_f32 v74, v88, v89
    v_mfma_f32_16x16x32_bf16 v[248:251], a[52:55], a[92:95], v[248:251]
    v_cvt_pk_bf16_f32 v75, v90, v91
    v_accvgpr_write_b32 a244, v72
    v_mfma_f32_16x16x32_bf16 v[252:255], a[56:59], a[88:91], v[252:255]
    ds_read_b64_tr_b16 a[78:79], v9 offset:9216
    v_accvgpr_write_b32 a245, v73
    v_mfma_f32_16x16x32_bf16 v[252:255], a[60:63], a[92:95], v[252:255]
    s_waitcnt lgkmcnt(6)
    v_accvgpr_write_b32 a246, v74
    v_accvgpr_write_b32 a247, v75
    v_mfma_f32_16x16x32_bf16 a[128:131], a[64:67], a[0:3], 0
    s_waitcnt lgkmcnt(4)
    v_cvt_pk_bf16_f32 v76, v76, v77
    v_cvt_pk_bf16_f32 v77, v78, v79
    v_mfma_f32_16x16x32_bf16 a[128:131], a[68:71], a[4:7], a[128:131]
    s_add_u32 m0, s86, 0
    ds_read_b64_tr_b16 a[80:81], v10 offset:0
    v_cvt_pk_bf16_f32 v78, v92, v93
    v_mfma_f32_16x16x32_bf16 a[132:135], a[64:67], a[8:11], 0
    buffer_load_dwordx4 v28, s[72:75], s78 offen offset:0 sc1 lds
    v_mfma_f32_16x16x32_bf16 a[132:135], a[68:71], a[12:15], a[132:135]
    ds_read_b64_tr_b16 a[82:83], v10 offset:1024
    v_cvt_pk_bf16_f32 v79, v94, v95
    v_mfma_f32_16x16x32_bf16 a[136:139], a[64:67], a[16:19], 0
    v_accvgpr_write_b32 a240, v76
    v_accvgpr_write_b32 a241, v77
    v_mfma_f32_16x16x32_bf16 a[136:139], a[68:71], a[20:23], a[136:139]
    s_add_u32 s88, s90, 0
    ds_read_b64_tr_b16 a[84:85], v10 offset:8192
    v_accvgpr_write_b32 a242, v78
    v_mfma_f32_16x16x32_bf16 a[140:143], a[64:67], a[24:27], 0
    buffer_store_dwordx4 v[48:51], v1, s[44:47], s88 offen offset:1024 sc1
    v_mfma_f32_16x16x32_bf16 a[140:143], a[68:71], a[28:31], a[140:143]
    s_waitcnt lgkmcnt(5)
    ds_read_b64_tr_b16 a[86:87], v10 offset:9216
    v_accvgpr_write_b32 a243, v79
    v_mfma_f32_16x16x32_bf16 a[144:147], a[72:75], a[0:3], 0
    s_waitcnt lgkmcnt(4)
    v_cvt_pk_bf16_f32 v96, v96, v97
    v_cvt_pk_bf16_f32 v97, v98, v99
    v_mfma_f32_16x16x32_bf16 a[144:147], a[76:79], a[4:7], a[144:147]
    ds_read_b64_tr_b16 a[88:89], v11 offset:0
    v_cvt_pk_bf16_f32 v98, v112, v113
    v_mfma_f32_16x16x32_bf16 a[148:151], a[72:75], a[8:11], 0
    buffer_load_dwordx4 v29, s[72:75], s78 offen offset:1024 sc1 lds
    v_mfma_f32_16x16x32_bf16 a[148:151], a[76:79], a[12:15], a[148:151]
    ds_read_b64_tr_b16 a[90:91], v11 offset:1024
    v_cvt_pk_bf16_f32 v99, v114, v115
    v_mfma_f32_16x16x32_bf16 a[152:155], a[72:75], a[16:19], 0
    v_accvgpr_write_b32 a236, v96
    v_accvgpr_write_b32 a237, v97
    v_mfma_f32_16x16x32_bf16 a[152:155], a[76:79], a[20:23], a[152:155]
    ds_read_b64_tr_b16 a[92:93], v11 offset:8192
    v_accvgpr_write_b32 a238, v98
    v_mfma_f32_16x16x32_bf16 a[156:159], a[72:75], a[24:27], 0
    v_accvgpr_write_b32 a239, v99
    v_cvt_pk_bf16_f32 v100, v100, v101
    v_mfma_f32_16x16x32_bf16 a[156:159], a[76:79], a[28:31], a[156:159]
    s_waitcnt lgkmcnt(5)
    ds_read_b64_tr_b16 a[94:95], v11 offset:9216
    v_cvt_pk_bf16_f32 v101, v102, v103
    v_mfma_f32_16x16x32_bf16 a[160:163], a[80:83], a[0:3], 0
    s_waitcnt lgkmcnt(4)
    v_cvt_pk_bf16_f32 v102, v116, v117
    v_cvt_pk_bf16_f32 v103, v118, v119
    v_mfma_f32_16x16x32_bf16 a[160:163], a[84:87], a[4:7], a[160:163]
    ds_read_b64_tr_b16 a[64:65], v12 offset:0
    v_accvgpr_write_b32 a232, v100
    v_mfma_f32_16x16x32_bf16 a[164:167], a[80:83], a[8:11], 0
    buffer_load_dwordx4 v30, s[72:75], s78 offen offset:2048 sc1 lds
    v_mfma_f32_16x16x32_bf16 a[164:167], a[84:87], a[12:15], a[164:167]
    ds_read_b64_tr_b16 a[66:67], v12 offset:1024
    v_accvgpr_write_b32 a233, v101
    v_mfma_f32_16x16x32_bf16 a[168:171], a[80:83], a[16:19], 0
    v_accvgpr_write_b32 a234, v102
    v_accvgpr_write_b32 a235, v103
    v_mfma_f32_16x16x32_bf16 a[168:171], a[84:87], a[20:23], a[168:171]
    ds_read_b64_tr_b16 a[68:69], v12 offset:8192
    v_cvt_pk_bf16_f32 v104, v104, v105
    v_mfma_f32_16x16x32_bf16 a[172:175], a[80:83], a[24:27], 0
    v_cvt_pk_bf16_f32 v105, v106, v107
    v_cvt_pk_bf16_f32 v106, v120, v121
    v_mfma_f32_16x16x32_bf16 a[172:175], a[84:87], a[28:31], a[172:175]
    s_waitcnt lgkmcnt(5)
    ds_read_b64_tr_b16 a[70:71], v12 offset:9216
    v_cvt_pk_bf16_f32 v107, v122, v123
    v_mfma_f32_16x16x32_bf16 a[176:179], a[88:91], a[0:3], 0
    s_waitcnt lgkmcnt(4)
    v_accvgpr_write_b32 a228, v104
    v_accvgpr_write_b32 a229, v105
    v_mfma_f32_16x16x32_bf16 a[176:179], a[92:95], a[4:7], a[176:179]
    ds_read_b64_tr_b16 a[72:73], v13 offset:0
    v_accvgpr_write_b32 a230, v106
    v_mfma_f32_16x16x32_bf16 a[180:183], a[88:91], a[8:11], 0
    buffer_load_dwordx4 v31, s[72:75], s78 offen offset:3072 sc1 lds
    v_mfma_f32_16x16x32_bf16 a[180:183], a[92:95], a[12:15], a[180:183]
    ds_read_b64_tr_b16 a[74:75], v13 offset:1024
    v_accvgpr_write_b32 a231, v107
    v_mfma_f32_16x16x32_bf16 a[184:187], a[88:91], a[16:19], 0
    v_cvt_pk_bf16_f32 v108, v108, v109
    v_cvt_pk_bf16_f32 v109, v110, v111
    v_mfma_f32_16x16x32_bf16 a[184:187], a[92:95], a[20:23], a[184:187]
    ds_read_b64_tr_b16 a[76:77], v13 offset:8192
    v_cvt_pk_bf16_f32 v110, v124, v125
    v_mfma_f32_16x16x32_bf16 a[188:191], a[88:91], a[24:27], 0
    v_cvt_pk_bf16_f32 v111, v126, v127
    v_accvgpr_write_b32 a224, v108
    v_mfma_f32_16x16x32_bf16 a[188:191], a[92:95], a[28:31], a[188:191]
    s_waitcnt lgkmcnt(5)
    s_add_u32 s59, s90, 4096
    ds_read_b64_tr_b16 a[78:79], v13 offset:9216
    v_accvgpr_write_b32 a225, v109
    v_mfma_f32_16x16x32_bf16 v[64:67], a[64:67], a[0:3], 0
    s_waitcnt lgkmcnt(4)
    buffer_store_dwordx4 v[52:55], v1, s[44:47], s59 offen offset:1024 sc1
    v_mfma_f32_16x16x32_bf16 v[64:67], a[68:71], a[4:7], v[64:67]
    s_add_u32 m0, s86, 4096
    ds_read_b64_tr_b16 a[80:81], v14 offset:0
    v_accvgpr_write_b32 a226, v110
    v_mfma_f32_16x16x32_bf16 v[68:71], a[64:67], a[8:11], 0
    buffer_load_dwordx4 v28, s[72:75], s79 offen offset:0 sc1 lds
    v_mfma_f32_16x16x32_bf16 v[68:71], a[68:71], a[12:15], v[68:71]
    ds_read_b64_tr_b16 a[82:83], v14 offset:1024
    v_accvgpr_write_b32 a227, v111
    v_mfma_f32_16x16x32_bf16 v[72:75], a[64:67], a[16:19], 0
    v_cvt_pk_bf16_f32 v128, v128, v129
    v_cvt_pk_bf16_f32 v129, v130, v131
    v_mfma_f32_16x16x32_bf16 v[72:75], a[68:71], a[20:23], v[72:75]
    ds_read_b64_tr_b16 a[84:85], v14 offset:8192
    v_cvt_pk_bf16_f32 v130, v132, v133
    v_mfma_f32_16x16x32_bf16 v[76:79], a[64:67], a[24:27], 0
    v_cvt_pk_bf16_f32 v131, v134, v135
    v_accvgpr_write_b32 a220, v128
    v_mfma_f32_16x16x32_bf16 v[76:79], a[68:71], a[28:31], v[76:79]
    s_waitcnt lgkmcnt(5)
    ds_read_b64_tr_b16 a[86:87], v14 offset:9216
    v_accvgpr_write_b32 a221, v129
    v_mfma_f32_16x16x32_bf16 v[80:83], a[72:75], a[0:3], 0
    s_waitcnt lgkmcnt(4)
    v_accvgpr_write_b32 a222, v130
    v_accvgpr_write_b32 a223, v131
    v_mfma_f32_16x16x32_bf16 v[80:83], a[76:79], a[4:7], v[80:83]
    ds_read_b64_tr_b16 a[88:89], v15 offset:0
    v_cvt_pk_bf16_f32 v136, v136, v137
    v_mfma_f32_16x16x32_bf16 v[84:87], a[72:75], a[8:11], 0
    buffer_load_dwordx4 v29, s[72:75], s79 offen offset:1024 sc1 lds
    v_mfma_f32_16x16x32_bf16 v[84:87], a[76:79], a[12:15], v[84:87]
    ds_read_b64_tr_b16 a[90:91], v15 offset:1024
    v_cvt_pk_bf16_f32 v137, v138, v139
    v_mfma_f32_16x16x32_bf16 v[88:91], a[72:75], a[16:19], 0
    v_cvt_pk_bf16_f32 v138, v140, v141
    v_cvt_pk_bf16_f32 v139, v142, v143
    v_mfma_f32_16x16x32_bf16 v[88:91], a[76:79], a[20:23], v[88:91]
    ds_read_b64_tr_b16 a[92:93], v15 offset:8192
    v_accvgpr_write_b32 a216, v136
    v_mfma_f32_16x16x32_bf16 v[92:95], a[72:75], a[24:27], 0
    v_accvgpr_write_b32 a217, v137
    v_accvgpr_write_b32 a218, v138
    v_mfma_f32_16x16x32_bf16 v[92:95], a[76:79], a[28:31], v[92:95]
    s_waitcnt lgkmcnt(5)
    ds_read_b64_tr_b16 a[94:95], v15 offset:9216
    v_accvgpr_write_b32 a219, v139
    v_mfma_f32_16x16x32_bf16 v[96:99], a[80:83], a[0:3], 0
    s_waitcnt lgkmcnt(4)
    v_cvt_pk_bf16_f32 v144, v144, v145
    v_cvt_pk_bf16_f32 v145, v146, v147
    v_mfma_f32_16x16x32_bf16 v[96:99], a[84:87], a[4:7], v[96:99]
    ds_read_b64_tr_b16 a[64:65], v16 offset:16384
    v_cvt_pk_bf16_f32 v146, v148, v149
    v_mfma_f32_16x16x32_bf16 v[100:103], a[80:83], a[8:11], 0
    buffer_load_dwordx4 v30, s[72:75], s79 offen offset:2048 sc1 lds
    v_mfma_f32_16x16x32_bf16 v[100:103], a[84:87], a[12:15], v[100:103]
    ds_read_b64_tr_b16 a[66:67], v16 offset:16896
    v_cvt_pk_bf16_f32 v147, v150, v151
    v_mfma_f32_16x16x32_bf16 v[104:107], a[80:83], a[16:19], 0
    v_accvgpr_write_b32 a212, v144
    v_accvgpr_write_b32 a213, v145
    v_mfma_f32_16x16x32_bf16 v[104:107], a[84:87], a[20:23], v[104:107]
    ds_read_b64_tr_b16 a[68:69], v16 offset:24576
    v_accvgpr_write_b32 a214, v146
    v_mfma_f32_16x16x32_bf16 v[108:111], a[80:83], a[24:27], 0
    v_accvgpr_write_b32 a215, v147
    v_cvt_pk_bf16_f32 v152, v152, v153
    v_mfma_f32_16x16x32_bf16 v[108:111], a[84:87], a[28:31], v[108:111]
    s_waitcnt lgkmcnt(5)
    ds_read_b64_tr_b16 a[70:71], v16 offset:25088
    v_cvt_pk_bf16_f32 v153, v154, v155
    v_mfma_f32_16x16x32_bf16 v[112:115], a[88:91], a[0:3], 0
    s_waitcnt lgkmcnt(4)
    v_cvt_pk_bf16_f32 v154, v156, v157
    v_cvt_pk_bf16_f32 v155, v158, v159
    v_mfma_f32_16x16x32_bf16 v[112:115], a[92:95], a[4:7], v[112:115]
    ds_read_b64_tr_b16 a[72:73], v16 offset:18432
    v_accvgpr_write_b32 a208, v152
    v_mfma_f32_16x16x32_bf16 v[116:119], a[88:91], a[8:11], 0
    buffer_load_dwordx4 v31, s[72:75], s79 offen offset:3072 sc1 lds
    v_mfma_f32_16x16x32_bf16 v[116:119], a[92:95], a[12:15], v[116:119]
    s_add_u32 s78, s78, s82
    s_add_u32 s88, s90, 16384
    ds_read_b64_tr_b16 a[74:75], v16 offset:18944
    v_accvgpr_write_b32 a209, v153
    v_mfma_f32_16x16x32_bf16 v[120:123], a[88:91], a[16:19], 0
    s_add_u32 s79, s79, s82
    buffer_store_dwordx4 v[56:59], v1, s[44:47], s88 offen offset:1024 sc1
    v_mfma_f32_16x16x32_bf16 v[120:123], a[92:95], a[20:23], v[120:123]
    ds_read_b64_tr_b16 a[76:77], v16 offset:26624
    v_accvgpr_write_b32 a210, v154
    v_mfma_f32_16x16x32_bf16 v[124:127], a[88:91], a[24:27], 0
    v_accvgpr_write_b32 a211, v155
    v_cvt_pk_bf16_f32 v160, v160, v161
    v_mfma_f32_16x16x32_bf16 v[124:127], a[92:95], a[28:31], v[124:127]
    s_waitcnt lgkmcnt(5)
    ds_read_b64_tr_b16 a[78:79], v16 offset:27136
    v_cvt_pk_bf16_f32 v161, v162, v163
    v_mfma_f32_16x16x32_bf16 v[128:131], a[64:67], a[0:3], 0
    s_waitcnt lgkmcnt(4)
    v_cvt_pk_bf16_f32 v162, v164, v165
    v_cvt_pk_bf16_f32 v163, v166, v167
    v_mfma_f32_16x16x32_bf16 v[128:131], a[68:71], a[4:7], v[128:131]
    s_mov_b32 m0, s83
    ds_read_b64_tr_b16 a[80:81], v17 offset:16384
    v_accvgpr_write_b32 a204, v160
    v_mfma_f32_16x16x32_bf16 v[132:135], a[64:67], a[8:11], 0
    buffer_load_dwordx4 v20, s[60:63], s76 offen offset:0 lds
    v_mfma_f32_16x16x32_bf16 v[132:135], a[68:71], a[12:15], v[132:135]
    s_branch L_pado5
L_pad5:
    s_branch L_tour_ret1
L_pado5:
    ds_read_b64_tr_b16 a[82:83], v17 offset:16896
    v_accvgpr_write_b32 a205, v161
    v_mfma_f32_16x16x32_bf16 v[136:139], a[64:67], a[16:19], 0
    s_waitcnt vmcnt(22)
    v_accvgpr_write_b32 a206, v162
    v_accvgpr_write_b32 a207, v163
    v_mfma_f32_16x16x32_bf16 v[136:139], a[68:71], a[20:23], v[136:139]
    ds_read_b64_tr_b16 a[84:85], v17 offset:24576
    v_cvt_pk_bf16_f32 v168, v168, v169
    v_mfma_f32_16x16x32_bf16 v[140:143], a[64:67], a[24:27], 0
    ds_read_b128 a[32:35], v4 offset:32768
    v_cvt_pk_bf16_f32 v169, v170, v171
    v_mfma_f32_16x16x32_bf16 v[140:143], a[68:71], a[28:31], v[140:143]
    s_waitcnt lgkmcnt(6)
    ds_read_b64_tr_b16 a[86:87], v17 offset:25088
    v_cvt_pk_bf16_f32 v170, v172, v173
    v_mfma_f32_16x16x32_bf16 v[144:147], a[72:75], a[0:3], 0
    s_waitcnt lgkmcnt(5)
    ds_read_b128 a[36:39], v5 offset:32768
    v_cvt_pk_bf16_f32 v171, v174, v175
    v_mfma_f32_16x16x32_bf16 v[144:147], a[76:79], a[4:7], v[144:147]
    ds_read_b64_tr_b16 a[88:89], v17 offset:18432
    v_accvgpr_write_b32 a200, v168
    v_mfma_f32_16x16x32_bf16 v[148:151], a[72:75], a[8:11], 0
    buffer_load_dwordx4 v21, s[60:63], s76 offen offset:1024 lds
    v_mfma_f32_16x16x32_bf16 v[148:151], a[76:79], a[12:15], v[148:151]
    ds_read_b64_tr_b16 a[90:91], v17 offset:18944
    v_accvgpr_write_b32 a201, v169
    v_accvgpr_write_b32 a202, v170
    v_mfma_f32_16x16x32_bf16 v[152:155], a[72:75], a[16:19], 0
    ds_read_b128 a[40:43], v4 offset:34816
    v_accvgpr_write_b32 a203, v171
    v_cvt_pk_bf16_f32 v176, v176, v177
    v_mfma_f32_16x16x32_bf16 v[152:155], a[76:79], a[20:23], v[152:155]
    ds_read_b64_tr_b16 a[92:93], v17 offset:26624
    v_cvt_pk_bf16_f32 v177, v178, v179
    v_cvt_pk_bf16_f32 v178, v180, v181
    v_mfma_f32_16x16x32_bf16 v[156:159], a[72:75], a[24:27], 0
    ds_read_b128 a[44:47], v5 offset:34816
    v_cvt_pk_bf16_f32 v179, v182, v183
    v_accvgpr_write_b32 a196, v176
    v_mfma_f32_16x16x32_bf16 v[156:159], a[76:79], a[28:31], v[156:159]
    s_waitcnt lgkmcnt(9)
    ds_read_b64_tr_b16 a[94:95], v17 offset:27136
    v_accvgpr_write_b32 a197, v177
    v_accvgpr_write_b32 a198, v178
    v_mfma_f32_16x16x32_bf16 v[160:163], a[80:83], a[0:3], 0
    s_waitcnt lgkmcnt(7)
    ds_read_b128 a[48:51], v4 offset:36864
    v_accvgpr_write_b32 a199, v179
    v_cvt_pk_bf16_f32 v184, v184, v185
    v_mfma_f32_16x16x32_bf16 v[160:163], a[84:87], a[4:7], v[160:163]
    ds_read_b64_tr_b16 a[64:65], v18 offset:16384
    v_cvt_pk_bf16_f32 v185, v186, v187
    v_cvt_pk_bf16_f32 v186, v188, v189
    v_mfma_f32_16x16x32_bf16 v[164:167], a[80:83], a[8:11], 0
    buffer_load_dwordx4 v22, s[60:63], s76 offen offset:2048 lds
    v_cvt_pk_bf16_f32 v187, v190, v191
    v_mfma_f32_16x16x32_bf16 v[164:167], a[84:87], a[12:15], v[164:167]
    ds_read_b64_tr_b16 a[66:67], v18 offset:16896
    v_accvgpr_write_b32 a192, v184
    v_accvgpr_write_b32 a193, v185
    v_mfma_f32_16x16x32_bf16 v[168:171], a[80:83], a[16:19], 0
    ds_read_b128 a[52:55], v5 offset:36864
    v_accvgpr_write_b32 a194, v186
    v_accvgpr_write_b32 a195, v187
    v_mfma_f32_16x16x32_bf16 v[168:171], a[84:87], a[20:23], v[168:171]
    ds_read_b64_tr_b16 a[68:69], v18 offset:24576
    v_cvt_pk_bf16_f32 v192, v192, v193
    v_cvt_pk_bf16_f32 v193, v194, v195
    v_mfma_f32_16x16x32_bf16 v[172:175], a[80:83], a[24:27], 0
    ds_read_b128 a[56:59], v4 offset:38912
    v_cvt_pk_bf16_f32 v194, v196, v197
    v_cvt_pk_bf16_f32 v195, v198, v199
    v_mfma_f32_16x16x32_bf16 v[172:175], a[84:87], a[28:31], v[172:175]
    s_waitcnt lgkmcnt(10)
    ds_read_b64_tr_b16 a[70:71], v18 offset:25088
    v_accvgpr_write_b32 a96, v192
    v_accvgpr_write_b32 a97, v193
    v_mfma_f32_16x16x32_bf16 v[176:179], a[88:91], a[0:3], 0
    s_waitcnt lgkmcnt(7)
    ds_read_b128 a[60:63], v5 offset:38912
    v_accvgpr_write_b32 a98, v194
    v_accvgpr_write_b32 a99, v195
    v_mfma_f32_16x16x32_bf16 v[176:179], a[92:95], a[4:7], v[176:179]
    ds_read_b64_tr_b16 a[72:73], v18 offset:18432
    v_cvt_pk_bf16_f32 v200, v200, v201
    v_cvt_pk_bf16_f32 v201, v202, v203
    v_mfma_f32_16x16x32_bf16 v[180:183], a[88:91], a[8:11], 0
    buffer_load_dwordx4 v23, s[60:63], s76 offen offset:3072 lds
    v_cvt_pk_bf16_f32 v202, v204, v205
    v_mfma_f32_16x16x32_bf16 v[180:183], a[92:95], a[12:15], v[180:183]
    s_add_u32 s76, s76, s80
    s_add_u32 s59, s90, 20480
    ds_read_b64_tr_b16 a[74:75], v18 offset:18944
    v_cvt_pk_bf16_f32 v203, v206, v207
    v_accvgpr_write_b32 a100, v200
    v_mfma_f32_16x16x32_bf16 v[184:187], a[88:91], a[16:19], 0
    buffer_store_dwordx4 v[60:63], v1, s[44:47], s59 offen offset:1024 sc1
    v_accvgpr_write_b32 a101, v201
    v_mfma_f32_16x16x32_bf16 v[184:187], a[92:95], a[20:23], v[184:187]
    ds_read_b64_tr_b16 a[76:77], v18 offset:26624
    v_accvgpr_write_b32 a102, v202
    v_accvgpr_write_b32 a103, v203
    v_mfma_f32_16x16x32_bf16 v[188:191], a[88:91], a[24:27], 0
    v_cvt_pk_bf16_f32 v208, v208, v209
    v_cvt_pk_bf16_f32 v209, v210, v211
    v_cvt_pk_bf16_f32 v210, v212, v213
    v_mfma_f32_16x16x32_bf16 v[188:191], a[92:95], a[28:31], v[188:191]
    s_waitcnt lgkmcnt(8)
    ds_read_b64_tr_b16 a[78:79], v18 offset:27136
    v_cvt_pk_bf16_f32 v211, v214, v215
    v_accvgpr_write_b32 a104, v208
    v_mfma_f32_16x16x32_bf16 v[192:195], a[64:67], a[0:3], 0
    s_waitcnt lgkmcnt(5)
    v_accvgpr_write_b32 a105, v209
    v_accvgpr_write_b32 a106, v210
    v_accvgpr_write_b32 a107, v211
    v_mfma_f32_16x16x32_bf16 v[192:195], a[68:71], a[4:7], v[192:195]
    ds_read_b64_tr_b16 a[80:81], v19 offset:16384
    v_cvt_pk_bf16_f32 v216, v216, v217
    v_cvt_pk_bf16_f32 v217, v218, v219
    v_mfma_f32_16x16x32_bf16 v[196:199], a[64:67], a[8:11], 0
    s_sub_u32 s87, s84, s85
    ds_read_b64_tr_b16 a[88:89], v19 offset:18432
    v_cvt_pk_bf16_f32 v218, v220, v221
    v_cvt_pk_bf16_f32 v219, v222, v223
    v_mfma_f32_16x16x32_bf16 v[196:199], a[68:71], a[12:15], v[196:199]
    ds_read_b64_tr_b16 a[82:83], v19 offset:16896
    v_accvgpr_write_b32 a108, v216
    v_accvgpr_write_b32 a109, v217
    v_mfma_f32_16x16x32_bf16 v[200:203], a[64:67], a[16:19], 0
    ds_read_b64_tr_b16 a[90:91], v19 offset:18944
    v_add_u32 v8, s87, v8
    v_accvgpr_write_b32 a110, v218
    v_mfma_f32_16x16x32_bf16 v[200:203], a[68:71], a[20:23], v[200:203]
    ds_read_b64_tr_b16 a[84:85], v19 offset:24576
    v_add_u32 v9, s87, v9
    v_accvgpr_write_b32 a111, v219
    v_mfma_f32_16x16x32_bf16 v[204:207], a[64:67], a[24:27], 0
    ds_read_b64_tr_b16 a[92:93], v19 offset:26624
    v_add_u32 v10, s87, v10
    v_cvt_pk_bf16_f32 v224, v224, v225
    v_mfma_f32_16x16x32_bf16 v[204:207], a[68:71], a[28:31], v[204:207]
    s_waitcnt lgkmcnt(8)
    ds_read_b64_tr_b16 a[86:87], v19 offset:25088
    v_add_u32 v11, s87, v11
    v_cvt_pk_bf16_f32 v225, v226, v227
    v_mfma_f32_16x16x32_bf16 v[208:211], a[72:75], a[0:3], 0
    s_waitcnt lgkmcnt(7)
    s_add_u32 m0, s83, 16384
    ds_read_b64_tr_b16 a[94:95], v19 offset:27136
    v_add_u32 v12, s87, v12
    v_cvt_pk_bf16_f32 v226, v228, v229
    v_mfma_f32_16x16x32_bf16 v[208:211], a[76:79], a[4:7], v[208:211]
    s_mov_b32 s58, s85
    buffer_load_dwordx4 v24, s[64:67], s77 offen offset:0 lds
    v_add_u32 v13, s87, v13
    v_mfma_f32_16x16x32_bf16 v[212:215], a[72:75], a[8:11], 0
    s_mov_b32 s85, s84
    v_add_u32 v14, s87, v14
    v_cvt_pk_bf16_f32 v227, v230, v231
    v_accvgpr_write_b32 a112, v224
    v_mfma_f32_16x16x32_bf16 v[212:215], a[76:79], a[12:15], v[212:215]
    s_mov_b32 s84, s83
    buffer_load_dwordx4 v25, s[64:67], s77 offen offset:1024 lds
    v_add_u32 v15, s87, v15
    v_mfma_f32_16x16x32_bf16 v[216:219], a[72:75], a[16:19], 0
    s_mov_b32 s83, s58
    v_add_u32 v16, s87, v16
    v_accvgpr_write_b32 a113, v225
    v_accvgpr_write_b32 a114, v226
    v_mfma_f32_16x16x32_bf16 v[216:219], a[76:79], a[20:23], v[216:219]
    v_add_u32 v17, s87, v17
    v_accvgpr_write_b32 a115, v227
    v_cvt_pk_bf16_f32 v232, v232, v233
    v_mfma_f32_16x16x32_bf16 v[220:223], a[72:75], a[24:27], 0
    v_add_u32 v18, s87, v18
    v_cvt_pk_bf16_f32 v233, v234, v235
    v_cvt_pk_bf16_f32 v234, v236, v237
    v_mfma_f32_16x16x32_bf16 v[220:223], a[76:79], a[28:31], v[220:223]
    s_waitcnt lgkmcnt(5)
    v_add_u32 v19, s87, v19
    v_cvt_pk_bf16_f32 v235, v238, v239
    v_accvgpr_write_b32 a116, v232
    v_mfma_f32_16x16x32_bf16 v[224:227], a[80:83], a[0:3], 0
    s_waitcnt vmcnt(18) lgkmcnt(0)
    s_barrier
    v_mfma_f32_16x16x32_bf16 v[224:227], a[84:87], a[4:7], v[224:227]
    ds_read_b64_tr_b16 a[64:65], v8 offset:0
    v_accvgpr_write_b32 a117, v233
    v_accvgpr_write_b32 a118, v234
    v_mfma_f32_16x16x32_bf16 v[228:231], a[80:83], a[8:11], 0
    buffer_load_dwordx4 v26, s[68:71], s77 offen offset:2048 lds
    v_accvgpr_write_b32 a119, v235
    v_mfma_f32_16x16x32_bf16 v[228:231], a[84:87], a[12:15], v[228:231]
    s_add_u32 s88, s90, 0
    ds_read_b64_tr_b16 a[66:67], v8 offset:1024
    v_cvt_pk_bf16_f32 v240, v240, v241
    v_cvt_pk_bf16_f32 v241, v242, v243
    v_mfma_f32_16x16x32_bf16 v[232:235], a[80:83], a[16:19], 0
    buffer_store_dwordx4 a[252:255], v1, s[44:47], s88 offen offset:2048 sc1
    v_cvt_pk_bf16_f32 v242, v244, v245
    v_mfma_f32_16x16x32_bf16 v[232:235], a[84:87], a[20:23], v[232:235]
    ds_read_b64_tr_b16 a[68:69], v8 offset:8192
    v_cvt_pk_bf16_f32 v243, v246, v247
    v_accvgpr_write_b32 a120, v240
    v_mfma_f32_16x16x32_bf16 v[236:239], a[80:83], a[24:27], 0
    v_accvgpr_write_b32 a121, v241
    v_accvgpr_write_b32 a122, v242
    v_accvgpr_write_b32 a123, v243
    v_mfma_f32_16x16x32_bf16 v[236:239], a[84:87], a[28:31], v[236:239]
    ds_read_b64_tr_b16 a[70:71], v8 offset:9216
    v_cvt_pk_bf16_f32 v248, v248, v249
    v_mfma_f32_16x16x32_bf16 v[240:243], a[88:91], a[0:3], 0
    ds_read_b64_tr_b16 a[72:73], v9 offset:0
    v_cvt_pk_bf16_f32 v249, v250, v251
    v_cvt_pk_bf16_f32 v250, v252, v253
    v_mfma_f32_16x16x32_bf16 v[240:243], a[92:95], a[4:7], v[240:243]
    v_cvt_pk_bf16_f32 v251, v254, v255
    v_accvgpr_write_b32 a124, v248
    v_accvgpr_write_b32 a125, v249
    v_mfma_f32_16x16x32_bf16 v[244:247], a[88:91], a[8:11], 0
    ds_read_b64_tr_b16 a[74:75], v9 offset:1024
    v_accvgpr_write_b32 a126, v250
    v_accvgpr_write_b32 a127, v251
    v_mfma_f32_16x16x32_bf16 v[244:247], a[92:95], a[12:15], v[244:247]
    buffer_load_dwordx4 v27, s[68:71], s77 offen offset:3072 lds
    v_mfma_f32_16x16x32_bf16 v[248:251], a[88:91], a[16:19], 0
    s_add_u32 s77, s77, s81
    ds_read_b64_tr_b16 a[76:77], v9 offset:8192
    v_mfma_f32_16x16x32_bf16 v[248:251], a[92:95], a[20:23], v[248:251]
    v_mfma_f32_16x16x32_bf16 v[252:255], a[88:91], a[24:27], 0
    ds_read_b64_tr_b16 a[78:79], v9 offset:9216
    v_mfma_f32_16x16x32_bf16 v[252:255], a[92:95], a[28:31], v[252:255]
    s_waitcnt lgkmcnt(6)
    v_mfma_f32_16x16x32_bf16 a[128:131], a[64:67], a[32:35], a[128:131]
    s_waitcnt lgkmcnt(4)
    v_mfma_f32_16x16x32_bf16 a[128:131], a[68:71], a[36:39], a[128:131]
    s_add_u32 m0, s86, 32768
    ds_read_b64_tr_b16 a[80:81], v10 offset:0
    v_mfma_f32_16x16x32_bf16 a[132:135], a[64:67], a[40:43], a[132:135]
    buffer_load_dwordx4 v28, s[72:75], s78 offen offset:0 sc1 lds
    v_mfma_f32_16x16x32_bf16 a[132:135], a[68:71], a[44:47], a[132:135]
    ds_read_b64_tr_b16 a[82:83], v10 offset:1024
    v_mfma_f32_16x16x32_bf16 a[136:139], a[64:67], a[48:51], a[136:139]
    v_mfma_f32_16x16x32_bf16 a[136:139], a[68:71], a[52:55], a[136:139]
    ds_read_b64_tr_b16 a[84:85], v10 offset:8192
    v_mfma_f32_16x16x32_bf16 a[140:143], a[64:67], a[56:59], a[140:143]
    v_mfma_f32_16x16x32_bf16 a[140:143], a[68:71], a[60:63], a[140:143]
    s_waitcnt lgkmcnt(5)
    s_add_u32 s59, s90, 4096
    ds_read_b64_tr_b16 a[86:87], v10 offset:9216
    v_mfma_f32_16x16x32_bf16 a[144:147], a[72:75], a[32:35], a[144:147]
    s_waitcnt lgkmcnt(4)
    buffer_store_dwordx4 a[248:251], v1, s[44:47], s59 offen offset:2048 sc1
    v_mfma_f32_16x16x32_bf16 a[144:147], a[76:79], a[36:39], a[144:147]
    ds_read_b64_tr_b16 a[88:89], v11 offset:0
    v_mfma_f32_16x16x32_bf16 a[148:151], a[72:75], a[40:43], a[148:151]
    buffer_load_dwordx4 v29, s[72:75], s78 offen offset:1024 sc1 lds
    v_mfma_f32_16x16x32_bf16 a[148:151], a[76:79], a[44:47], a[148:151]
    ds_read_b64_tr_b16 a[90:91], v11 offset:1024
    v_mfma_f32_16x16x32_bf16 a[152:155], a[72:75], a[48:51], a[152:155]
    v_mfma_f32_16x16x32_bf16 a[152:155], a[76:79], a[52:55], a[152:155]
    ds_read_b64_tr_b16 a[92:93], v11 offset:8192
    v_mfma_f32_16x16x32_bf16 a[156:159], a[72:75], a[56:59], a[156:159]
    v_mfma_f32_16x16x32_bf16 a[156:159], a[76:79], a[60:63], a[156:159]
    s_waitcnt lgkmcnt(5)
    ds_read_b64_tr_b16 a[94:95], v11 offset:9216
    v_mfma_f32_16x16x32_bf16 a[160:163], a[80:83], a[32:35], a[160:163]
    s_waitcnt lgkmcnt(4)
    v_mfma_f32_16x16x32_bf16 a[160:163], a[84:87], a[36:39], a[160:163]
    ds_read_b64_tr_b16 a[64:65], v12 offset:0
    v_mfma_f32_16x16x32_bf16 a[164:167], a[80:83], a[40:43], a[164:167]
    buffer_load_dwordx4 v30, s[72:75], s78 offen offset:2048 sc1 lds
    v_mfma_f32_16x16x32_bf16 a[164:167], a[84:87], a[44:47], a[164:167]
    ds_read_b64_tr_b16 a[66:67], v12 offset:1024
    v_mfma_f32_16x16x32_bf16 a[168:171], a[80:83], a[48:51], a[168:171]
    v_mfma_f32_16x16x32_bf16 a[168:171], a[84:87], a[52:55], a[168:171]
    ds_read_b64_tr_b16 a[68:69], v12 offset:8192
    v_mfma_f32_16x16x32_bf16 a[172:175], a[80:83], a[56:59], a[172:175]
    v_mfma_f32_16x16x32_bf16 a[172:175], a[84:87], a[60:63], a[172:175]
    s_waitcnt lgkmcnt(5)
    ds_read_b64_tr_b16 a[70:71], v12 offset:9216
    v_mfma_f32_16x16x32_bf16 a[176:179], a[88:91], a[32:35], a[176:179]
    s_waitcnt lgkmcnt(4)
    v_mfma_f32_16x16x32_bf16 a[176:179], a[92:95], a[36:39], a[176:179]
    ds_read_b64_tr_b16 a[72:73], v13 offset:0
    v_mfma_f32_16x16x32_bf16 a[180:183], a[88:91], a[40:43], a[180:183]
    buffer_load_dwordx4 v31, s[72:75], s78 offen offset:3072 sc1 lds
    v_mfma_f32_16x16x32_bf16 a[180:183], a[92:95], a[44:47], a[180:183]
    ds_read_b64_tr_b16 a[74:75], v13 offset:1024
    v_mfma_f32_16x16x32_bf16 a[184:187], a[88:91], a[48:51], a[184:187]
    v_mfma_f32_16x16x32_bf16 a[184:187], a[92:95], a[52:55], a[184:187]
    ds_read_b64_tr_b16 a[76:77], v13 offset:8192
    v_mfma_f32_16x16x32_bf16 a[188:191], a[88:91], a[56:59], a[188:191]
    v_mfma_f32_16x16x32_bf16 a[188:191], a[92:95], a[60:63], a[188:191]
    s_waitcnt lgkmcnt(5)
    ds_read_b64_tr_b16 a[78:79], v13 offset:9216
    v_mfma_f32_16x16x32_bf16 v[64:67], a[64:67], a[32:35], v[64:67]
    s_waitcnt lgkmcnt(4)
    v_mfma_f32_16x16x32_bf16 v[64:67], a[68:71], a[36:39], v[64:67]
    s_add_u32 m0, s86, 36864
    ds_read_b64_tr_b16 a[80:81], v14 offset:0
    v_mfma_f32_16x16x32_bf16 v[68:71], a[64:67], a[40:43], v[68:71]
    buffer_load_dwordx4 v28, s[72:75], s79 offen offset:0 sc1 lds
    v_mfma_f32_16x16x32_bf16 v[68:71], a[68:71], a[44:47], v[68:71]
    s_add_u32 s88, s90, 16384
    ds_read_b64_tr_b16 a[82:83], v14 offset:1024
    v_mfma_f32_16x16x32_bf16 v[72:75], a[64:67], a[48:51], v[72:75]
    buffer_store_dwordx4 a[244:247], v1, s[44:47], s88 offen offset:2048 sc1
    v_mfma_f32_16x16x32_bf16 v[72:75], a[68:71], a[52:55], v[72:75]
    ds_read_b64_tr_b16 a[84:85], v14 offset:8192
    v_mfma_f32_16x16x32_bf16 v[76:79], a[64:67], a[56:59], v[76:79]
    v_mfma_f32_16x16x32_bf16 v[76:79], a[68:71], a[60:63], v[76:79]
    s_waitcnt lgkmcnt(5)
    ds_read_b64_tr_b16 a[86:87], v14 offset:9216
    v_mfma_f32_16x16x32_bf16 v[80:83], a[72:75], a[32:35], v[80:83]
    s_waitcnt lgkmcnt(4)
    v_mfma_f32_16x16x32_bf16 v[80:83], a[76:79], a[36:39], v[80:83]
    ds_read_b64_tr_b16 a[88:89], v15 offset:0
    v_mfma_f32_16x16x32_bf16 v[84:87], a[72:75], a[40:43], v[84:87]
    buffer_load_dwordx4 v29, s[72:75], s79 offen offset:1024 sc1 lds
    v_mfma_f32_16x16x32_bf16 v[84:87], a[76:79], a[44:47], v[84:87]
    ds_read_b64_tr_b16 a[90:91], v15 offset:1024
    v_mfma_f32_16x16x32_bf16 v[88:91], a[72:75], a[48:51], v[88:91]
    v_mfma_f32_16x16x32_bf16 v[88:91], a[76:79], a[52:55], v[88:91]
    ds_read_b64_tr_b16 a[92:93], v15 offset:8192
    v_mfma_f32_16x16x32_bf16 v[92:95], a[72:75], a[56:59], v[92:95]
    v_mfma_f32_16x16x32_bf16 v[92:95], a[76:79], a[60:63], v[92:95]
    s_waitcnt lgkmcnt(5)
    ds_read_b64_tr_b16 a[94:95], v15 offset:9216
    v_mfma_f32_16x16x32_bf16 v[96:99], a[80:83], a[32:35], v[96:99]
    s_waitcnt lgkmcnt(4)
    v_mfma_f32_16x16x32_bf16 v[96:99], a[84:87], a[36:39], v[96:99]
    ds_read_b64_tr_b16 a[64:65], v16 offset:16384
    v_mfma_f32_16x16x32_bf16 v[100:103], a[80:83], a[40:43], v[100:103]
    buffer_load_dwordx4 v30, s[72:75], s79 offen offset:2048 sc1 lds
    v_mfma_f32_16x16x32_bf16 v[100:103], a[84:87], a[44:47], v[100:103]
    ds_read_b64_tr_b16 a[66:67], v16 offset:16896
    v_mfma_f32_16x16x32_bf16 v[104:107], a[80:83], a[48:51], v[104:107]
    v_mfma_f32_16x16x32_bf16 v[104:107], a[84:87], a[52:55], v[104:107]
    ds_read_b64_tr_b16 a[68:69], v16 offset:24576
    v_mfma_f32_16x16x32_bf16 v[108:111], a[80:83], a[56:59], v[108:111]
    v_mfma_f32_16x16x32_bf16 v[108:111], a[84:87], a[60:63], v[108:111]
    s_waitcnt lgkmcnt(5)
    ds_read_b64_tr_b16 a[70:71], v16 offset:25088
    v_mfma_f32_16x16x32_bf16 v[112:115], a[88:91], a[32:35], v[112:115]
    s_waitcnt lgkmcnt(4)
    v_mfma_f32_16x16x32_bf16 v[112:115], a[92:95], a[36:39], v[112:115]
    ds_read_b64_tr_b16 a[72:73], v16 offset:18432
    v_mfma_f32_16x16x32_bf16 v[116:119], a[88:91], a[40:43], v[116:119]
    buffer_load_dwordx4 v31, s[72:75], s79 offen offset:3072 sc1 lds
    v_mfma_f32_16x16x32_bf16 v[116:119], a[92:95], a[44:47], v[116:119]
    s_add_u32 s78, s78, s82
    s_add_u32 s59, s90, 20480
    ds_read_b64_tr_b16 a[74:75], v16 offset:18944
    v_mfma_f32_16x16x32_bf16 v[120:123], a[88:91], a[48:51], v[120:123]
    s_add_u32 s79, s79, s82
    buffer_store_dwordx4 a[240:243], v1, s[44:47], s59 offen offset:2048 sc1
    v_mfma_f32_16x16x32_bf16 v[120:123], a[92:95], a[52:55], v[120:123]
    ds_read_b64_tr_b16 a[76:77], v16 offset:26624
    v_mfma_f32_16x16x32_bf16 v[124:127], a[88:91], a[56:59], v[124:127]
    v_mfma_f32_16x16x32_bf16 v[124:127], a[92:95], a[60:63], v[124:127]
    s_waitcnt lgkmcnt(5)
    ds_read_b64_tr_b16 a[78:79], v16 offset:27136
    v_mfma_f32_16x16x32_bf16 v[128:131], a[64:67], a[32:35], v[128:131]
    s_waitcnt lgkmcnt(4)
    v_mfma_f32_16x16x32_bf16 v[128:131], a[68:71], a[36:39], v[128:131]
    s_mov_b32 m0, s83
    ds_read_b64_tr_b16 a[80:81], v17 offset:16384
    v_mfma_f32_16x16x32_bf16 v[132:135], a[64:67], a[40:43], v[132:135]
    buffer_load_dwordx4 v20, s[60:63], s76 offen offset:0 lds
    v_mfma_f32_16x16x32_bf16 v[132:135], a[68:71], a[44:47], v[132:135]
    ds_read_b64_tr_b16 a[82:83], v17 offset:16896
    v_mfma_f32_16x16x32_bf16 v[136:139], a[64:67], a[48:51], v[136:139]
    s_waitcnt vmcnt(23)
    v_mfma_f32_16x16x32_bf16 v[136:139], a[68:71], a[52:55], v[136:139]
    ds_read_b64_tr_b16 a[84:85], v17 offset:24576
    v_mfma_f32_16x16x32_bf16 v[140:143], a[64:67], a[56:59], v[140:143]
    ds_read_b128 a[0:3], v4 offset:0
    v_mfma_f32_16x16x32_bf16 v[140:143], a[68:71], a[60:63], v[140:143]
    s_waitcnt lgkmcnt(6)
    ds_read_b64_tr_b16 a[86:87], v17 offset:25088
    v_mfma_f32_16x16x32_bf16 v[144:147], a[72:75], a[32:35], v[144:147]
    s_waitcnt lgkmcnt(5)
    ds_read_b128 a[4:7], v5 offset:0
    v_mfma_f32_16x16x32_bf16 v[144:147], a[76:79], a[36:39], v[144:147]
    ds_read_b64_tr_b16 a[88:89], v17 offset:18432
    v_mfma_f32_16x16x32_bf16 v[148:151], a[72:75], a[40:43], v[148:151]
    buffer_load_dwordx4 v21, s[60:63], s76 offen offset:1024 lds
    v_mfma_f32_16x16x32_bf16 v[148:151], a[76:79], a[44:47], v[148:151]
    ds_read_b64_tr_b16 a[90:91], v17 offset:18944
    v_mfma_f32_16x16x32_bf16 v[152:155], a[72:75], a[48:51], v[152:155]
    ds_read_b128 a[8:11], v4 offset:2048
    v_mfma_f32_16x16x32_bf16 v[152:155], a[76:79], a[52:55], v[152:155]
    ds_read_b64_tr_b16 a[92:93], v17 offset:26624
    v_mfma_f32_16x16x32_bf16 v[156:159], a[72:75], a[56:59], v[156:159]
    ds_read_b128 a[12:15], v5 offset:2048
    v_mfma_f32_16x16x32_bf16 v[156:159], a[76:79], a[60:63], v[156:159]
    s_waitcnt lgkmcnt(9)
    ds_read_b64_tr_b16 a[94:95], v17 offset:27136
    v_mfma_f32_16x16x32_bf16 v[160:163], a[80:83], a[32:35], v[160:163]
    s_waitcnt lgkmcnt(7)
    ds_read_b128 a[16:19], v4 offset:4096
    v_mfma_f32_16x16x32_bf16 v[160:163], a[84:87], a[36:39], v[160:163]
    ds_read_b64_tr_b16 a[64:65], v18 offset:16384
    v_mfma_f32_16x16x32_bf16 v[164:167], a[80:83], a[40:43], v[164:167]
    buffer_load_dwordx4 v22, s[60:63], s76 offen offset:2048 lds
    v_mfma_f32_16x16x32_bf16 v[164:167], a[84:87], a[44:47], v[164:167]
    ds_read_b64_tr_b16 a[66:67], v18 offset:16896
    v_mfma_f32_16x16x32_bf16 v[168:171], a[80:83], a[48:51], v[168:171]
    ds_read_b128 a[20:23], v5 offset:4096
    v_mfma_f32_16x16x32_bf16 v[168:171], a[84:87], a[52:55], v[168:171]
    ds_read_b64_tr_b16 a[68:69], v18 offset:24576
    v_mfma_f32_16x16x32_bf16 v[172:175], a[80:83], a[56:59], v[172:175]
    ds_read_b128 a[24:27], v4 offset:6144
    v_mfma_f32_16x16x32_bf16 v[172:175], a[84:87], a[60:63], v[172:175]
    s_waitcnt lgkmcnt(10)
    ds_read_b64_tr_b16 a[70:71], v18 offset:25088
    v_mfma_f32_16x16x32_bf16 v[176:179], a[88:91], a[32:35], v[176:179]
    s_waitcnt lgkmcnt(7)
    ds_read_b128 a[28:31], v5 offset:6144
    v_mfma_f32_16x16x32_bf16 v[176:179], a[92:95], a[36:39], v[176:179]
    ds_read_b64_tr_b16 a[72:73], v18 offset:18432
    v_mfma_f32_16x16x32_bf16 v[180:183], a[88:91], a[40:43], v[180:183]
    buffer_load_dwordx4 v23, s[60:63], s76 offen offset:3072 lds
    v_mfma_f32_16x16x32_bf16 v[180:183], a[92:95], a[44:47], v[180:183]
    s_add_u32 s76, s76, s80
    s_add_u32 s88, s90, 0
    ds_read_b64_tr_b16 a[74:75], v18 offset:18944
    v_mfma_f32_16x16x32_bf16 v[184:187], a[88:91], a[48:51], v[184:187]
    buffer_store_dwordx4 a[236:239], v1, s[44:47], s88 offen offset:3072 sc1
    v_mfma_f32_16x16x32_bf16 v[184:187], a[92:95], a[52:55], v[184:187]
    ds_read_b64_tr_b16 a[76:77], v18 offset:26624
    v_mfma_f32_16x16x32_bf16 v[188:191], a[88:91], a[56:59], v[188:191]
    v_mfma_f32_16x16x32_bf16 v[188:191], a[92:95], a[60:63], v[188:191]
    s_waitcnt lgkmcnt(8)
    ds_read_b64_tr_b16 a[78:79], v18 offset:27136
    v_mfma_f32_16x16x32_bf16 v[192:195], a[64:67], a[32:35], v[192:195]
    s_waitcnt lgkmcnt(5)
    v_mfma_f32_16x16x32_bf16 v[192:195], a[68:71], a[36:39], v[192:195]
    ds_read_b64_tr_b16 a[80:81], v19 offset:16384
    v_mfma_f32_16x16x32_bf16 v[196:199], a[64:67], a[40:43], v[196:199]
    s_sub_u32 s87, s84, s85
    ds_read_b64_tr_b16 a[88:89], v19 offset:18432
    v_mfma_f32_16x16x32_bf16 v[196:199], a[68:71], a[44:47], v[196:199]
    ds_read_b64_tr_b16 a[82:83], v19 offset:16896
    v_mfma_f32_16x16x32_bf16 v[200:203], a[64:67], a[48:51], v[200:203]
    ds_read_b64_tr_b16 a[90:91], v19 offset:18944
    v_add_u32 v8, s87, v8
    v_mfma_f32_16x16x32_bf16 v[200:203], a[68:71], a[52:55], v[200:203]
    ds_read_b64_tr_b16 a[84:85], v19 offset:24576
    v_add_u32 v9, s87, v9
    v_mfma_f32_16x16x32_bf16 v[204:207], a[64:67], a[56:59], v[204:207]
    ds_read_b64_tr_b16 a[92:93], v19 offset:26624
    v_add_u32 v10, s87, v10
    v_mfma_f32_16x16x32_bf16 v[204:207], a[68:71], a[60:63], v[204:207]
    s_waitcnt lgkmcnt(8)
    ds_read_b64_tr_b16 a[86:87], v19 offset:25088
    v_add_u32 v11, s87, v11
    v_mfma_f32_16x16x32_bf16 v[208:211], a[72:75], a[32:35], v[208:211]
    s_waitcnt lgkmcnt(7)
    s_add_u32 m0, s83, 16384
    ds_read_b64_tr_b16 a[94:95], v19 offset:27136
    v_add_u32 v12, s87, v12
    v_mfma_f32_16x16x32_bf16 v[208:211], a[76:79], a[36:39], v[208:211]
    s_mov_b32 s58, s85
    buffer_load_dwordx4 v24, s[64:67], s77 offen offset:0 lds
    v_add_u32 v13, s87, v13
    v_mfma_f32_16x16x32_bf16 v[212:215], a[72:75], a[40:43], v[212:215]
    s_mov_b32 s85, s84
    v_add_u32 v14, s87, v14
    v_mfma_f32_16x16x32_bf16 v[212:215], a[76:79], a[44:47], v[212:215]
    s_mov_b32 s84, s83
    buffer_load_dwordx4 v25, s[64:67], s77 offen offset:1024 lds
    v_add_u32 v15, s87, v15
    v_mfma_f32_16x16x32_bf16 v[216:219], a[72:75], a[48:51], v[216:219]
    s_mov_b32 s83, s58
    v_add_u32 v16, s87, v16
    v_mfma_f32_16x16x32_bf16 v[216:219], a[76:79], a[52:55], v[216:219]
    v_add_u32 v17, s87, v17
    v_mfma_f32_16x16x32_bf16 v[220:223], a[72:75], a[56:59], v[220:223]
    v_add_u32 v18, s87, v18
    v_mfma_f32_16x16x32_bf16 v[220:223], a[76:79], a[60:63], v[220:223]
    s_waitcnt lgkmcnt(5)
    v_add_u32 v19, s87, v19
    v_mfma_f32_16x16x32_bf16 v[224:227], a[80:83], a[32:35], v[224:227]
    s_waitcnt vmcnt(18) lgkmcnt(0)
    s_barrier
    v_mfma_f32_16x16x32_bf16 v[224:227], a[84:87], a[36:39], v[224:227]
    ds_read_b64_tr_b16 a[64:65], v8 offset:0
    v_mfma_f32_16x16x32_bf16 v[228:231], a[80:83], a[40:43], v[228:231]
    buffer_load_dwordx4 v26, s[68:71], s77 offen offset:2048 lds
    v_mfma_f32_16x16x32_bf16 v[228:231], a[84:87], a[44:47], v[228:231]
    s_add_u32 s59, s90, 4096
    ds_read_b64_tr_b16 a[66:67], v8 offset:1024
    v_mfma_f32_16x16x32_bf16 v[232:235], a[80:83], a[48:51], v[232:235]
    buffer_store_dwordx4 a[232:235], v1, s[44:47], s59 offen offset:3072 sc1
    v_mfma_f32_16x16x32_bf16 v[232:235], a[84:87], a[52:55], v[232:235]
    ds_read_b64_tr_b16 a[68:69], v8 offset:8192
    v_mfma_f32_16x16x32_bf16 v[236:239], a[80:83], a[56:59], v[236:239]
    v_mfma_f32_16x16x32_bf16 v[236:239], a[84:87], a[60:63], v[236:239]
    ds_read_b64_tr_b16 a[70:71], v8 offset:9216
    v_mfma_f32_16x16x32_bf16 v[240:243], a[88:91], a[32:35], v[240:243]
    ds_read_b64_tr_b16 a[72:73], v9 offset:0
    v_mfma_f32_16x16x32_bf16 v[240:243], a[92:95], a[36:39], v[240:243]
    v_mfma_f32_16x16x32_bf16 v[244:247], a[88:91], a[40:43], v[244:247]
    ds_read_b64_tr_b16 a[74:75], v9 offset:1024
    v_mfma_f32_16x16x32_bf16 v[244:247], a[92:95], a[44:47], v[244:247]
    buffer_load_dwordx4 v27, s[68:71], s77 offen offset:3072 lds
    v_mfma_f32_16x16x32_bf16 v[248:251], a[88:91], a[48:51], v[248:251]
    s_add_u32 s77, s77, s81
    ds_read_b64_tr_b16 a[76:77], v9 offset:8192
    v_mfma_f32_16x16x32_bf16 v[248:251], a[92:95], a[52:55], v[248:251]
    v_mfma_f32_16x16x32_bf16 v[252:255], a[88:91], a[56:59], v[252:255]
    ds_read_b64_tr_b16 a[78:79], v9 offset:9216
    v_mfma_f32_16x16x32_bf16 v[252:255], a[92:95], a[60:63], v[252:255]
    s_waitcnt lgkmcnt(6)
    v_mfma_f32_16x16x32_bf16 a[128:131], a[64:67], a[0:3], a[128:131]
    s_waitcnt lgkmcnt(4)
    v_mfma_f32_16x16x32_bf16 a[128:131], a[68:71], a[4:7], a[128:131]
    s_add_u32 m0, s86, 0
    ds_read_b64_tr_b16 a[80:81], v10 offset:0
    v_mfma_f32_16x16x32_bf16 a[132:135], a[64:67], a[8:11], a[132:135]
    buffer_load_dwordx4 v28, s[72:75], s78 offen offset:0 sc1 lds
    v_mfma_f32_16x16x32_bf16 a[132:135], a[68:71], a[12:15], a[132:135]
    ds_read_b64_tr_b16 a[82:83], v10 offset:1024
    v_mfma_f32_16x16x32_bf16 a[136:139], a[64:67], a[16:19], a[136:139]
    v_mfma_f32_16x16x32_bf16 a[136:139], a[68:71], a[20:23], a[136:139]
    ds_read_b64_tr_b16 a[84:85], v10 offset:8192
    v_mfma_f32_16x16x32_bf16 a[140:143], a[64:67], a[24:27], a[140:143]
    v_mfma_f32_16x16x32_bf16 a[140:143], a[68:71], a[28:31], a[140:143]
    s_waitcnt lgkmcnt(5)
    ds_read_b64_tr_b16 a[86:87], v10 offset:9216
    v_mfma_f32_16x16x32_bf16 a[144:147], a[72:75], a[0:3], a[144:147]
    s_waitcnt lgkmcnt(4)
    v_mfma_f32_16x16x32_bf16 a[144:147], a[76:79], a[4:7], a[144:147]
    ds_read_b64_tr_b16 a[88:89], v11 offset:0
    v_mfma_f32_16x16x32_bf16 a[148:151], a[72:75], a[8:11], a[148:151]
    buffer_load_dwordx4 v29, s[72:75], s78 offen offset:1024 sc1 lds
    v_mfma_f32_16x16x32_bf16 a[148:151], a[76:79], a[12:15], a[148:151]
    s_add_u32 s88, s90, 16384
    ds_read_b64_tr_b16 a[90:91], v11 offset:1024
    v_mfma_f32_16x16x32_bf16 a[152:155], a[72:75], a[16:19], a[152:155]
    buffer_store_dwordx4 a[228:231], v1, s[44:47], s88 offen offset:3072 sc1
    v_mfma_f32_16x16x32_bf16 a[152:155], a[76:79], a[20:23], a[152:155]
    ds_read_b64_tr_b16 a[92:93], v11 offset:8192
    v_mfma_f32_16x16x32_bf16 a[156:159], a[72:75], a[24:27], a[156:159]
    v_mfma_f32_16x16x32_bf16 a[156:159], a[76:79], a[28:31], a[156:159]
    s_waitcnt lgkmcnt(5)
    ds_read_b64_tr_b16 a[94:95], v11 offset:9216
    v_mfma_f32_16x16x32_bf16 a[160:163], a[80:83], a[0:3], a[160:163]
    s_waitcnt lgkmcnt(4)
    v_mfma_f32_16x16x32_bf16 a[160:163], a[84:87], a[4:7], a[160:163]
    ds_read_b64_tr_b16 a[64:65], v12 offset:0
    v_mfma_f32_16x16x32_bf16 a[164:167], a[80:83], a[8:11], a[164:167]
    buffer_load_dwordx4 v30, s[72:75], s78 offen offset:2048 sc1 lds
    v_mfma_f32_16x16x32_bf16 a[164:167], a[84:87], a[12:15], a[164:167]
    ds_read_b64_tr_b16 a[66:67], v12 offset:1024
    v_mfma_f32_16x16x32_bf16 a[168:171], a[80:83], a[16:19], a[168:171]
    s_branch L_pado6
L_pad6:
    s_branch L_tour_ret1
L_pado6:
    v_mfma_f32_16x16x32_bf16 a[168:171], a[84:87], a[20:23], a[168:171]
    ds_read_b64_tr_b16 a[68:69], v12 offset:8192
    v_mfma_f32_16x16x32_bf16 a[172:175], a[80:83], a[24:27], a[172:175]
    v_mfma_f32_16x16x32_bf16 a[172:175], a[84:87], a[28:31], a[172:175]
    s_waitcnt lgkmcnt(5)
    ds_read_b64_tr_b16 a[70:71], v12 offset:9216
    v_mfma_f32_16x16x32_bf16 a[176:179], a[88:91], a[0:3], a[176:179]
    s_waitcnt lgkmcnt(4)
    v_mfma_f32_16x16x32_bf16 a[176:179], a[92:95], a[4:7], a[176:179]
    ds_read_b64_tr_b16 a[72:73], v13 offset:0
    v_mfma_f32_16x16x32_bf16 a[180:183], a[88:91], a[8:11], a[180:183]
    buffer_load_dwordx4 v31, s[72:75], s78 offen offset:3072 sc1 lds
    v_mfma_f32_16x16x32_bf16 a[180:183], a[92:95], a[12:15], a[180:183]
    ds_read_b64_tr_b16 a[74:75], v13 offset:1024
    v_mfma_f32_16x16x32_bf16 a[184:187], a[88:91], a[16:19], a[184:187]
    v_mfma_f32_16x16x32_bf16 a[184:187], a[92:95], a[20:23], a[184:187]
    ds_read_b64_tr_b16 a[76:77], v13 offset:8192
    v_mfma_f32_16x16x32_bf16 a[188:191], a[88:91], a[24:27], a[188:191]
    v_mfma_f32_16x16x32_bf16 a[188:191], a[92:95], a[28:31], a[188:191]
    s_waitcnt lgkmcnt(5)
    ds_read_b64_tr_b16 a[78:79], v13 offset:9216
    v_mfma_f32_16x16x32_bf16 v[64:67], a[64:67], a[0:3], v[64:67]
    s_waitcnt lgkmcnt(4)
    v_mfma_f32_16x16x32_bf16 v[64:67], a[68:71], a[4:7], v[64:67]
    s_add_u32 m0, s86, 4096
    ds_read_b64_tr_b16 a[80:81], v14 offset:0
    v_mfma_f32_16x16x32_bf16 v[68:71], a[64:67], a[8:11], v[68:71]
    buffer_load_dwordx4 v28, s[72:75], s79 offen offset:0 sc1 lds
    v_mfma_f32_16x16x32_bf16 v[68:71], a[68:71], a[12:15], v[68:71]
    s_add_u32 s59, s90, 20480
    ds_read_b64_tr_b16 a[82:83], v14 offset:1024
    v_mfma_f32_16x16x32_bf16 v[72:75], a[64:67], a[16:19], v[72:75]
    buffer_store_dwordx4 a[224:227], v1, s[44:47], s59 offen offset:3072 sc1
    v_mfma_f32_16x16x32_bf16 v[72:75], a[68:71], a[20:23], v[72:75]
    ds_read_b64_tr_b16 a[84:85], v14 offset:8192
    v_mfma_f32_16x16x32_bf16 v[76:79], a[64:67], a[24:27], v[76:79]
    v_mfma_f32_16x16x32_bf16 v[76:79], a[68:71], a[28:31], v[76:79]
    s_waitcnt lgkmcnt(5)
    ds_read_b64_tr_b16 a[86:87], v14 offset:9216
    v_mfma_f32_16x16x32_bf16 v[80:83], a[72:75], a[0:3], v[80:83]
    s_waitcnt lgkmcnt(4)
    v_mfma_f32_16x16x32_bf16 v[80:83], a[76:79], a[4:7], v[80:83]
    ds_read_b64_tr_b16 a[88:89], v15 offset:0
    v_mfma_f32_16x16x32_bf16 v[84:87], a[72:75], a[8:11], v[84:87]
    buffer_load_dwordx4 v29, s[72:75], s79 offen offset:1024 sc1 lds
    v_mfma_f32_16x16x32_bf16 v[84:87], a[76:79], a[12:15], v[84:87]
    ds_read_b64_tr_b16 a[90:91], v15 offset:1024
    v_mfma_f32_16x16x32_bf16 v[88:91], a[72:75], a[16:19], v[88:91]
    v_mfma_f32_16x16x32_bf16 v[88:91], a[76:79], a[20:23], v[88:91]
    ds_read_b64_tr_b16 a[92:93], v15 offset:8192
    v_mfma_f32_16x16x32_bf16 v[92:95], a[72:75], a[24:27], v[92:95]
    v_mfma_f32_16x16x32_bf16 v[92:95], a[76:79], a[28:31], v[92:95]
    s_waitcnt lgkmcnt(5)
    ds_read_b64_tr_b16 a[94:95], v15 offset:9216
    v_mfma_f32_16x16x32_bf16 v[96:99], a[80:83], a[0:3], v[96:99]
    s_waitcnt lgkmcnt(4)
    v_mfma_f32_16x16x32_bf16 v[96:99], a[84:87], a[4:7], v[96:99]
    ds_read_b64_tr_b16 a[64:65], v16 offset:16384
    v_mfma_f32_16x16x32_bf16 v[100:103], a[80:83], a[8:11], v[100:103]
    buffer_load_dwordx4 v30, s[72:75], s79 offen offset:2048 sc1 lds
    v_mfma_f32_16x16x32_bf16 v[100:103], a[84:87], a[12:15], v[100:103]
    ds_read_b64_tr_b16 a[66:67], v16 offset:16896
    v_mfma_f32_16x16x32_bf16 v[104:107], a[80:83], a[16:19], v[104:107]
    v_mfma_f32_16x16x32_bf16 v[104:107], a[84:87], a[20:23], v[104:107]
    ds_read_b64_tr_b16 a[68:69], v16 offset:24576
    v_mfma_f32_16x16x32_bf16 v[108:111], a[80:83], a[24:27], v[108:111]
    v_mfma_f32_16x16x32_bf16 v[108:111], a[84:87], a[28:31], v[108:111]
    s_waitcnt lgkmcnt(5)
    ds_read_b64_tr_b16 a[70:71], v16 offset:25088
    v_mfma_f32_16x16x32_bf16 v[112:115], a[88:91], a[0:3], v[112:115]
    s_waitcnt lgkmcnt(4)
    v_mfma_f32_16x16x32_bf16 v[112:115], a[92:95], a[4:7], v[112:115]
    ds_read_b64_tr_b16 a[72:73], v16 offset:18432
    v_mfma_f32_16x16x32_bf16 v[116:119], a[88:91], a[8:11], v[116:119]
    buffer_load_dwordx4 v31, s[72:75], s79 offen offset:3072 sc1 lds
    v_mfma_f32_16x16x32_bf16 v[116:119], a[92:95], a[12:15], v[116:119]
    s_add_u32 s78, s78, s82
    ds_read_b64_tr_b16 a[74:75], v16 offset:18944
    v_mfma_f32_16x16x32_bf16 v[120:123], a[88:91], a[16:19], v[120:123]
    s_add_u32 s79, s79, s82
    v_mfma_f32_16x16x32_bf16 v[120:123], a[92:95], a[20:23], v[120:123]
    s_add_u32 s88, s90, 8192
    ds_read_b64_tr_b16 a[76:77], v16 offset:26624
    v_mfma_f32_16x16x32_bf16 v[124:127], a[88:91], a[24:27], v[124:127]
    buffer_store_dwordx4 a[220:223], v1, s[44:47], s88 offen offset:0 sc1
    v_mfma_f32_16x16x32_bf16 v[124:127], a[92:95], a[28:31], v[124:127]
    s_waitcnt lgkmcnt(5)
    ds_read_b64_tr_b16 a[78:79], v16 offset:27136
    v_mfma_f32_16x16x32_bf16 v[128:131], a[64:67], a[0:3], v[128:131]
    s_waitcnt lgkmcnt(4)
    v_mfma_f32_16x16x32_bf16 v[128:131], a[68:71], a[4:7], v[128:131]
    s_mov_b32 m0, s83
    ds_read_b64_tr_b16 a[80:81], v17 offset:16384
    v_mfma_f32_16x16x32_bf16 v[132:135], a[64:67], a[8:11], v[132:135]
    buffer_load_dwordx4 v20, s[60:63], s76 offen offset:0 lds
    v_mfma_f32_16x16x32_bf16 v[132:135], a[68:71], a[12:15], v[132:135]
    ds_read_b64_tr_b16 a[82:83], v17 offset:16896
    v_mfma_f32_16x16x32_bf16 v[136:139], a[64:67], a[16:19], v[136:139]
    s_waitcnt vmcnt(23)
    v_mfma_f32_16x16x32_bf16 v[136:139], a[68:71], a[20:23], v[136:139]
    ds_read_b64_tr_b16 a[84:85], v17 offset:24576
    v_mfma_f32_16x16x32_bf16 v[140:143], a[64:67], a[24:27], v[140:143]
    ds_read_b128 a[32:35], v4 offset:32768
    v_mfma_f32_16x16x32_bf16 v[140:143], a[68:71], a[28:31], v[140:143]
    s_waitcnt lgkmcnt(6)
    ds_read_b64_tr_b16 a[86:87], v17 offset:25088
    v_mfma_f32_16x16x32_bf16 v[144:147], a[72:75], a[0:3], v[144:147]
    s_waitcnt lgkmcnt(5)
    ds_read_b128 a[36:39], v5 offset:32768
    v_mfma_f32_16x16x32_bf16 v[144:147], a[76:79], a[4:7], v[144:147]
    ds_read_b64_tr_b16 a[88:89], v17 offset:18432
    v_mfma_f32_16x16x32_bf16 v[148:151], a[72:75], a[8:11], v[148:151]
    buffer_load_dwordx4 v21, s[60:63], s76 offen offset:1024 lds
    v_mfma_f32_16x16x32_bf16 v[148:151], a[76:79], a[12:15], v[148:151]
    ds_read_b64_tr_b16 a[90:91], v17 offset:18944
    v_mfma_f32_16x16x32_bf16 v[152:155], a[72:75], a[16:19], v[152:155]
    ds_read_b128 a[40:43], v4 offset:34816
    v_mfma_f32_16x16x32_bf16 v[152:155], a[76:79], a[20:23], v[152:155]
    ds_read_b64_tr_b16 a[92:93], v17 offset:26624
    v_mfma_f32_16x16x32_bf16 v[156:159], a[72:75], a[24:27], v[156:159]
    ds_read_b128 a[44:47], v5 offset:34816
    v_mfma_f32_16x16x32_bf16 v[156:159], a[76:79], a[28:31], v[156:159]
    s_waitcnt lgkmcnt(9)
    ds_read_b64_tr_b16 a[94:95], v17 offset:27136
    v_mfma_f32_16x16x32_bf16 v[160:163], a[80:83], a[0:3], v[160:163]
    s_waitcnt lgkmcnt(7)
    ds_read_b128 a[48:51], v4 offset:36864
    v_mfma_f32_16x16x32_bf16 v[160:163], a[84:87], a[4:7], v[160:163]
    ds_read_b64_tr_b16 a[64:65], v18 offset:16384
    v_mfma_f32_16x16x32_bf16 v[164:167], a[80:83], a[8:11], v[164:167]
    buffer_load_dwordx4 v22, s[60:63], s76 offen offset:2048 lds
    v_mfma_f32_16x16x32_bf16 v[164:167], a[84:87], a[12:15], v[164:167]
    ds_read_b64_tr_b16 a[66:67], v18 offset:16896
    v_mfma_f32_16x16x32_bf16 v[168:171], a[80:83], a[16:19], v[168:171]
    ds_read_b128 a[52:55], v5 offset:36864
    v_mfma_f32_16x16x32_bf16 v[168:171], a[84:87], a[20:23], v[168:171]
    ds_read_b64_tr_b16 a[68:69], v18 offset:24576
    v_mfma_f32_16x16x32_bf16 v[172:175], a[80:83], a[24:27], v[172:175]
    ds_read_b128 a[56:59], v4 offset:38912
    v_mfma_f32_16x16x32_bf16 v[172:175], a[84:87], a[28:31], v[172:175]
    s_waitcnt lgkmcnt(10)
    ds_read_b64_tr_b16 a[70:71], v18 offset:25088
    v_mfma_f32_16x16x32_bf16 v[176:179], a[88:91], a[0:3], v[176:179]
    s_waitcnt lgkmcnt(7)
    ds_read_b128 a[60:63], v5 offset:38912
    v_mfma_f32_16x16x32_bf16 v[176:179], a[92:95], a[4:7], v[176:179]
    ds_read_b64_tr_b16 a[72:73], v18 offset:18432
    v_mfma_f32_16x16x32_bf16 v[180:183], a[88:91], a[8:11], v[180:183]
    buffer_load_dwordx4 v23, s[60:63], s76 offen offset:3072 lds
    v_mfma_f32_16x16x32_bf16 v[180:183], a[92:95], a[12:15], v[180:183]
    s_add_u32 s76, s76, s80
    s_add_u32 s59, s90, 24576
    ds_read_b64_tr_b16 a[74:75], v18 offset:18944
    v_mfma_f32_16x16x32_bf16 v[184:187], a[88:91], a[16:19], v[184:187]
    buffer_store_dwordx4 a[216:219], v1, s[44:47], s59 offen offset:0 sc1
    v_mfma_f32_16x16x32_bf16 v[184:187], a[92:95], a[20:23], v[184:187]
    ds_read_b64_tr_b16 a[76:77], v18 offset:26624
    v_mfma_f32_16x16x32_bf16 v[188:191], a[88:91], a[24:27], v[188:191]
    v_mfma_f32_16x16x32_bf16 v[188:191], a[92:95], a[28:31], v[188:191]
    s_waitcnt lgkmcnt(8)
    ds_read_b64_tr_b16 a[78:79], v18 offset:27136
    v_mfma_f32_16x16x32_bf16 v[192:195], a[64:67], a[0:3], v[192:195]
    s_waitcnt lgkmcnt(5)
    v_mfma_f32_16x16x32_bf16 v[192:195], a[68:71], a[4:7], v[192:195]
    ds_read_b64_tr_b16 a[80:81], v19 offset:16384
    v_mfma_f32_16x16x32_bf16 v[196:199], a[64:67], a[8:11], v[196:199]
    s_sub_u32 s87, s84, s85
    ds_read_b64_tr_b16 a[88:89], v19 offset:18432
    v_mfma_f32_16x16x32_bf16 v[196:199], a[68:71], a[12:15], v[196:199]
    ds_read_b64_tr_b16 a[82:83], v19 offset:16896
    v_mfma_f32_16x16x32_bf16 v[200:203], a[64:67], a[16:19], v[200:203]
    ds_read_b64_tr_b16 a[90:91], v19 offset:18944
    v_add_u32 v8, s87, v8
    v_mfma_f32_16x16x32_bf16 v[200:203], a[68:71], a[20:23], v[200:203]
    ds_read_b64_tr_b16 a[84:85], v19 offset:24576
    v_add_u32 v9, s87, v9
    v_mfma_f32_16x16x32_bf16 v[204:207], a[64:67], a[24:27], v[204:207]
    ds_read_b64_tr_b16 a[92:93], v19 offset:26624
    v_add_u32 v10, s87, v10
    v_mfma_f32_16x16x32_bf16 v[204:207], a[68:71], a[28:31], v[204:207]
    s_waitcnt lgkmcnt(8)
    ds_read_b64_tr_b16 a[86:87], v19 offset:25088
    v_add_u32 v11, s87, v11
    v_mfma_f32_16x16x32_bf16 v[208:211], a[72:75], a[0:3], v[208:211]
    s_waitcnt lgkmcnt(7)
    s_add_u32 m0, s83, 16384
    ds_read_b64_tr_b16 a[94:95], v19 offset:27136
    v_add_u32 v12, s87, v12
    v_mfma_f32_16x16x32_bf16 v[208:211], a[76:79], a[4:7], v[208:211]
    s_mov_b32 s58, s85
    buffer_load_dwordx4 v24, s[64:67], s77 offen offset:0 lds
    v_add_u32 v13, s87, v13
    v_mfma_f32_16x16x32_bf16 v[212:215], a[72:75], a[8:11], v[212:215]
    s_mov_b32 s85, s84
    v_add_u32 v14, s87, v14
    v_mfma_f32_16x16x32_bf16 v[212:215], a[76:79], a[12:15], v[212:215]
    s_mov_b32 s84, s83
    buffer_load_dwordx4 v25, s[64:67], s77 offen offset:1024 lds
    v_add_u32 v15, s87, v15
    v_mfma_f32_16x16x32_bf16 v[216:219], a[72:75], a[16:19], v[216:219]
    s_mov_b32 s83, s58
    v_add_u32 v16, s87, v16
    v_mfma_f32_16x16x32_bf16 v[216:219], a[76:79], a[20:23], v[216:219]
    v_add_u32 v17, s87, v17
    v_mfma_f32_16x16x32_bf16 v[220:223], a[72:75], a[24:27], v[220:223]
    v_add_u32 v18, s87, v18
    v_mfma_f32_16x16x32_bf16 v[220:223], a[76:79], a[28:31], v[220:223]
    s_waitcnt lgkmcnt(5)
    v_add_u32 v19, s87, v19
    v_mfma_f32_16x16x32_bf16 v[224:227], a[80:83], a[0:3], v[224:227]
    s_waitcnt vmcnt(18) lgkmcnt(0)
    s_barrier
    v_mfma_f32_16x16x32_bf16 v[224:227], a[84:87], a[4:7], v[224:227]
    ds_read_b64_tr_b16 a[64:65], v8 offset:0
    v_mfma_f32_16x16x32_bf16 v[228:231], a[80:83], a[8:11], v[228:231]
    buffer_load_dwordx4 v26, s[68:71], s77 offen offset:2048 lds
    v_mfma_f32_16x16x32_bf16 v[228:231], a[84:87], a[12:15], v[228:231]
    s_add_u32 s88, s90, 8192
    ds_read_b64_tr_b16 a[66:67], v8 offset:1024
    v_mfma_f32_16x16x32_bf16 v[232:235], a[80:83], a[16:19], v[232:235]
    buffer_store_dwordx4 a[212:215], v1, s[44:47], s88 offen offset:1024 sc1
    v_mfma_f32_16x16x32_bf16 v[232:235], a[84:87], a[20:23], v[232:235]
    ds_read_b64_tr_b16 a[68:69], v8 offset:8192
    v_mfma_f32_16x16x32_bf16 v[236:239], a[80:83], a[24:27], v[236:239]
    v_mfma_f32_16x16x32_bf16 v[236:239], a[84:87], a[28:31], v[236:239]
    ds_read_b64_tr_b16 a[70:71], v8 offset:9216
    v_mfma_f32_16x16x32_bf16 v[240:243], a[88:91], a[0:3], v[240:243]
    ds_read_b64_tr_b16 a[72:73], v9 offset:0
    v_mfma_f32_16x16x32_bf16 v[240:243], a[92:95], a[4:7], v[240:243]
    v_mfma_f32_16x16x32_bf16 v[244:247], a[88:91], a[8:11], v[244:247]
    ds_read_b64_tr_b16 a[74:75], v9 offset:1024
    v_mfma_f32_16x16x32_bf16 v[244:247], a[92:95], a[12:15], v[244:247]
    buffer_load_dwordx4 v27, s[68:71], s77 offen offset:3072 lds
    v_mfma_f32_16x16x32_bf16 v[248:251], a[88:91], a[16:19], v[248:251]
    s_add_u32 s77, s77, s81
    ds_read_b64_tr_b16 a[76:77], v9 offset:8192
    v_mfma_f32_16x16x32_bf16 v[248:251], a[92:95], a[20:23], v[248:251]
    v_mfma_f32_16x16x32_bf16 v[252:255], a[88:91], a[24:27], v[252:255]
    ds_read_b64_tr_b16 a[78:79], v9 offset:9216
    v_mfma_f32_16x16x32_bf16 v[252:255], a[92:95], a[28:31], v[252:255]
    s_waitcnt lgkmcnt(6)
    v_mfma_f32_16x16x32_bf16 a[128:131], a[64:67], a[32:35], a[128:131]
    s_waitcnt lgkmcnt(4)
    v_mfma_f32_16x16x32_bf16 a[128:131], a[68:71], a[36:39], a[128:131]
    s_add_u32 m0, s86, 32768
    ds_read_b64_tr_b16 a[80:81], v10 offset:0
    v_mfma_f32_16x16x32_bf16 a[132:135], a[64:67], a[40:43], a[132:135]
    buffer_load_dwordx4 v28, s[72:75], s78 offen offset:0 sc1 lds
    v_mfma_f32_16x16x32_bf16 a[132:135], a[68:71], a[44:47], a[132:135]
    ds_read_b64_tr_b16 a[82:83], v10 offset:1024
    v_mfma_f32_16x16x32_bf16 a[136:139], a[64:67], a[48:51], a[136:139]
    v_mfma_f32_16x16x32_bf16 a[136:139], a[68:71], a[52:55], a[136:139]
    ds_read_b64_tr_b16 a[84:85], v10 offset:8192
    v_mfma_f32_16x16x32_bf16 a[140:143], a[64:67], a[56:59], a[140:143]
    v_mfma_f32_16x16x32_bf16 a[140:143], a[68:71], a[60:63], a[140:143]
    s_waitcnt lgkmcnt(5)
    ds_read_b64_tr_b16 a[86:87], v10 offset:9216
    v_mfma_f32_16x16x32_bf16 a[144:147], a[72:75], a[32:35], a[144:147]
    s_waitcnt lgkmcnt(4)
    v_cmp_gt_u32 vcc, 16, v2
    v_lshrrev_b32 v48, 1, v2
    v_mfma_f32_16x16x32_bf16 a[144:147], a[76:79], a[36:39], a[144:147]
    ds_read_b64_tr_b16 a[88:89], v11 offset:0
    v_mul_u32_u24 v48, 1280, v48
    v_mfma_f32_16x16x32_bf16 a[148:151], a[72:75], a[40:43], a[148:151]
    buffer_load_dwordx4 v29, s[72:75], s78 offen offset:1024 sc1 lds
    v_mfma_f32_16x16x32_bf16 a[148:151], a[76:79], a[44:47], a[148:151]
    s_add_u32 s59, s90, 24576
    ds_read_b64_tr_b16 a[90:91], v11 offset:1024
    v_and_b32 v49, 1, v2
    v_mfma_f32_16x16x32_bf16 a[152:155], a[72:75], a[48:51], a[152:155]
    buffer_store_dwordx4 a[208:211], v1, s[44:47], s59 offen offset:1024 sc1
    v_mfma_f32_16x16x32_bf16 a[152:155], a[76:79], a[52:55], a[152:155]
    ds_read_b64_tr_b16 a[92:93], v11 offset:8192
    v_lshl_add_u32 v48, v49, 7, v48
    v_mfma_f32_16x16x32_bf16 a[156:159], a[72:75], a[56:59], a[156:159]
    v_mov_b32 v49, 0x7fff0000
    v_cndmask_b32 v48, v49, v48, vcc
    v_mfma_f32_16x16x32_bf16 a[156:159], a[76:79], a[60:63], a[156:159]
    s_waitcnt lgkmcnt(5)
    ds_read_b64_tr_b16 a[94:95], v11 offset:9216
    v_mfma_f32_16x16x32_bf16 a[160:163], a[80:83], a[32:35], a[160:163]
    s_waitcnt lgkmcnt(4)
    v_mfma_f32_16x16x32_bf16 a[160:163], a[84:87], a[36:39], a[160:163]
    ds_read_b64_tr_b16 a[64:65], v12 offset:0
    v_mfma_f32_16x16x32_bf16 a[164:167], a[80:83], a[40:43], a[164:167]
    buffer_load_dwordx4 v30, s[72:75], s78 offen offset:2048 sc1 lds
    v_mfma_f32_16x16x32_bf16 a[164:167], a[84:87], a[44:47], a[164:167]
    ds_read_b64_tr_b16 a[66:67], v12 offset:1024
    v_mfma_f32_16x16x32_bf16 a[168:171], a[80:83], a[48:51], a[168:171]
    v_mfma_f32_16x16x32_bf16 a[168:171], a[84:87], a[52:55], a[168:171]
    ds_read_b64_tr_b16 a[68:69], v12 offset:8192
    v_mfma_f32_16x16x32_bf16 a[172:175], a[80:83], a[56:59], a[172:175]
    v_mfma_f32_16x16x32_bf16 a[172:175], a[84:87], a[60:63], a[172:175]
    s_waitcnt lgkmcnt(5)
    ds_read_b64_tr_b16 a[70:71], v12 offset:9216
    v_mfma_f32_16x16x32_bf16 a[176:179], a[88:91], a[32:35], a[176:179]
    s_waitcnt lgkmcnt(4)
    v_mfma_f32_16x16x32_bf16 a[176:179], a[92:95], a[36:39], a[176:179]
    ds_read_b64_tr_b16 a[72:73], v13 offset:0
    v_mfma_f32_16x16x32_bf16 a[180:183], a[88:91], a[40:43], a[180:183]
    buffer_load_dwordx4 v31, s[72:75], s78 offen offset:3072 sc1 lds
    v_mfma_f32_16x16x32_bf16 a[180:183], a[92:95], a[44:47], a[180:183]
    ds_read_b64_tr_b16 a[74:75], v13 offset:1024
    v_mfma_f32_16x16x32_bf16 a[184:187], a[88:91], a[48:51], a[184:187]
    v_mfma_f32_16x16x32_bf16 a[184:187], a[92:95], a[52:55], a[184:187]
    ds_read_b64_tr_b16 a[76:77], v13 offset:8192
    v_mfma_f32_16x16x32_bf16 a[188:191], a[88:91], a[56:59], a[188:191]
    v_mfma_f32_16x16x32_bf16 a[188:191], a[92:95], a[60:63], a[188:191]
    s_waitcnt lgkmcnt(5)
    ds_read_b64_tr_b16 a[78:79], v13 offset:9216
    v_mfma_f32_16x16x32_bf16 v[64:67], a[64:67], a[32:35], v[64:67]
    s_waitcnt lgkmcnt(4)
    v_mfma_f32_16x16x32_bf16 v[64:67], a[68:71], a[36:39], v[64:67]
    s_add_u32 m0, s86, 36864
    ds_read_b64_tr_b16 a[80:81], v14 offset:0
    v_mfma_f32_16x16x32_bf16 v[68:71], a[64:67], a[40:43], v[68:71]
    buffer_load_dwordx4 v28, s[72:75], s79 offen offset:0 sc1 lds
    v_mfma_f32_16x16x32_bf16 v[68:71], a[68:71], a[44:47], v[68:71]
    ds_read_b64_tr_b16 a[82:83], v14 offset:1024
    v_mfma_f32_16x16x32_bf16 v[72:75], a[64:67], a[48:51], v[72:75]
    v_mfma_f32_16x16x32_bf16 v[72:75], a[68:71], a[52:55], v[72:75]
    s_add_u32 s88, s90, 8192
    ds_read_b64_tr_b16 a[84:85], v14 offset:8192
    v_mfma_f32_16x16x32_bf16 v[76:79], a[64:67], a[56:59], v[76:79]
    buffer_store_dwordx4 a[204:207], v1, s[44:47], s88 offen offset:2048 sc1
    v_mfma_f32_16x16x32_bf16 v[76:79], a[68:71], a[60:63], v[76:79]
    s_waitcnt lgkmcnt(5)
    ds_read_b64_tr_b16 a[86:87], v14 offset:9216
    v_mfma_f32_16x16x32_bf16 v[80:83], a[72:75], a[32:35], v[80:83]
    s_waitcnt lgkmcnt(4)
    v_mfma_f32_16x16x32_bf16 v[80:83], a[76:79], a[36:39], v[80:83]
    ds_read_b64_tr_b16 a[88:89], v15 offset:0
    v_mfma_f32_16x16x32_bf16 v[84:87], a[72:75], a[40:43], v[84:87]
    buffer_load_dwordx4 v29, s[72:75], s79 offen offset:1024 sc1 lds
    v_mfma_f32_16x16x32_bf16 v[84:87], a[76:79], a[44:47], v[84:87]
    ds_read_b64_tr_b16 a[90:91], v15 offset:1024
    v_mfma_f32_16x16x32_bf16 v[88:91], a[72:75], a[48:51], v[88:91]
    v_mfma_f32_16x16x32_bf16 v[88:91], a[76:79], a[52:55], v[88:91]
    ds_read_b64_tr_b16 a[92:93], v15 offset:8192
    v_mfma_f32_16x16x32_bf16 v[92:95], a[72:75], a[56:59], v[92:95]
    v_mfma_f32_16x16x32_bf16 v[92:95], a[76:79], a[60:63], v[92:95]
    s_waitcnt lgkmcnt(5)
    ds_read_b64_tr_b16 a[94:95], v15 offset:9216
    v_mfma_f32_16x16x32_bf16 v[96:99], a[80:83], a[32:35], v[96:99]
    s_waitcnt lgkmcnt(4)
    v_mfma_f32_16x16x32_bf16 v[96:99], a[84:87], a[36:39], v[96:99]
    ds_read_b64_tr_b16 a[64:65], v16 offset:16384
    v_mfma_f32_16x16x32_bf16 v[100:103], a[80:83], a[40:43], v[100:103]
    buffer_load_dwordx4 v30, s[72:75], s79 offen offset:2048 sc1 lds
    v_mfma_f32_16x16x32_bf16 v[100:103], a[84:87], a[44:47], v[100:103]
    ds_read_b64_tr_b16 a[66:67], v16 offset:16896
    v_mfma_f32_16x16x32_bf16 v[104:107], a[80:83], a[48:51], v[104:107]
    v_mfma_f32_16x16x32_bf16 v[104:107], a[84:87], a[52:55], v[104:107]
    ds_read_b64_tr_b16 a[68:69], v16 offset:24576
    v_mfma_f32_16x16x32_bf16 v[108:111], a[80:83], a[56:59], v[108:111]
    v_mfma_f32_16x16x32_bf16 v[108:111], a[84:87], a[60:63], v[108:111]
    s_waitcnt lgkmcnt(5)
    ds_read_b64_tr_b16 a[70:71], v16 offset:25088
    v_mfma_f32_16x16x32_bf16 v[112:115], a[88:91], a[32:35], v[112:115]
    s_waitcnt lgkmcnt(4)
    v_mfma_f32_16x16x32_bf16 v[112:115], a[92:95], a[36:39], v[112:115]
    ds_read_b64_tr_b16 a[72:73], v16 offset:18432
    v_mfma_f32_16x16x32_bf16 v[116:119], a[88:91], a[40:43], v[116:119]
    buffer_load_dwordx4 v31, s[72:75], s79 offen offset:3072 sc1 lds
    v_mfma_f32_16x16x32_bf16 v[116:119], a[92:95], a[44:47], v[116:119]
    s_add_u32 s78, s78, s82
    ds_read_b64_tr_b16 a[74:75], v16 offset:18944
    v_mfma_f32_16x16x32_bf16 v[120:123], a[88:91], a[48:51], v[120:123]
    s_add_u32 s79, s79, s82
    v_mfma_f32_16x16x32_bf16 v[120:123], a[92:95], a[52:55], v[120:123]
    ds_read_b64_tr_b16 a[76:77], v16 offset:26624
    v_mfma_f32_16x16x32_bf16 v[124:127], a[88:91], a[56:59], v[124:127]
    v_mfma_f32_16x16x32_bf16 v[124:127], a[92:95], a[60:63], v[124:127]
    s_waitcnt lgkmcnt(5)
    s_add_u32 s59, s90, 24576
    ds_read_b64_tr_b16 a[78:79], v16 offset:27136
    v_mfma_f32_16x16x32_bf16 v[128:131], a[64:67], a[32:35], v[128:131]
    s_waitcnt lgkmcnt(4)
    buffer_store_dwordx4 a[200:203], v1, s[44:47], s59 offen offset:2048 sc1
    v_mfma_f32_16x16x32_bf16 v[128:131], a[68:71], a[36:39], v[128:131]
    s_mov_b32 m0, s83
    ds_read_b64_tr_b16 a[80:81], v17 offset:16384
    v_mfma_f32_16x16x32_bf16 v[132:135], a[64:67], a[40:43], v[132:135]
    buffer_load_dwordx4 v20, s[60:63], s76 offen offset:0 lds
    v_mfma_f32_16x16x32_bf16 v[132:135], a[68:71], a[44:47], v[132:135]
    ds_read_b64_tr_b16 a[82:83], v17 offset:16896
    v_mfma_f32_16x16x32_bf16 v[136:139], a[64:67], a[48:51], v[136:139]
    s_waitcnt vmcnt(23)
    v_mfma_f32_16x16x32_bf16 v[136:139], a[68:71], a[52:55], v[136:139]
    ds_read_b64_tr_b16 a[84:85], v17 offset:24576
    v_mfma_f32_16x16x32_bf16 v[140:143], a[64:67], a[56:59], v[140:143]
    ds_read_b128 a[0:3], v4 offset:0
    v_mfma_f32_16x16x32_bf16 v[140:143], a[68:71], a[60:63], v[140:143]
    s_waitcnt lgkmcnt(6)
    ds_read_b64_tr_b16 a[86:87], v17 offset:25088
    v_mfma_f32_16x16x32_bf16 v[144:147], a[72:75], a[32:35], v[144:147]
    s_waitcnt lgkmcnt(5)
    ds_read_b128 a[4:7], v5 offset:0
    v_mfma_f32_16x16x32_bf16 v[144:147], a[76:79], a[36:39], v[144:147]
    ds_read_b64_tr_b16 a[88:89], v17 offset:18432
    v_mfma_f32_16x16x32_bf16 v[148:151], a[72:75], a[40:43], v[148:151]
    buffer_load_dwordx4 v21, s[60:63], s76 offen offset:1024 lds
    v_mfma_f32_16x16x32_bf16 v[148:151], a[76:79], a[44:47], v[148:151]
    ds_read_b64_tr_b16 a[90:91], v17 offset:18944
    v_mfma_f32_16x16x32_bf16 v[152:155], a[72:75], a[48:51], v[152:155]
    ds_read_b128 a[8:11], v4 offset:2048
    v_mfma_f32_16x16x32_bf16 v[152:155], a[76:79], a[52:55], v[152:155]
    ds_read_b64_tr_b16 a[92:93], v17 offset:26624
    v_mfma_f32_16x16x32_bf16 v[156:159], a[72:75], a[56:59], v[156:159]
    ds_read_b128 a[12:15], v5 offset:2048
    v_mfma_f32_16x16x32_bf16 v[156:159], a[76:79], a[60:63], v[156:159]
    s_waitcnt lgkmcnt(9)
    ds_read_b64_tr_b16 a[94:95], v17 offset:27136
    v_mfma_f32_16x16x32_bf16 v[160:163], a[80:83], a[32:35], v[160:163]
    s_waitcnt lgkmcnt(7)
    ds_read_b128 a[16:19], v4 offset:4096
    v_mfma_f32_16x16x32_bf16 v[160:163], a[84:87], a[36:39], v[160:163]
    ds_read_b64_tr_b16 a[64:65], v18 offset:16384
    v_mfma_f32_16x16x32_bf16 v[164:167], a[80:83], a[40:43], v[164:167]
    buffer_load_dwordx4 v22, s[60:63], s76 offen offset:2048 lds
    v_mfma_f32_16x16x32_bf16 v[164:167], a[84:87], a[44:47], v[164:167]
    ds_read_b64_tr_b16 a[66:67], v18 offset:16896
    v_mfma_f32_16x16x32_bf16 v[168:171], a[80:83], a[48:51], v[168:171]
    ds_read_b128 a[20:23], v5 offset:4096
    v_mfma_f32_16x16x32_bf16 v[168:171], a[84:87], a[52:55], v[168:171]
    ds_read_b64_tr_b16 a[68:69], v18 offset:24576
    v_mfma_f32_16x16x32_bf16 v[172:175], a[80:83], a[56:59], v[172:175]
    ds_read_b128 a[24:27], v4 offset:6144
    v_mfma_f32_16x16x32_bf16 v[172:175], a[84:87], a[60:63], v[172:175]
    s_waitcnt lgkmcnt(10)
    ds_read_b64_tr_b16 a[70:71], v18 offset:25088
    v_mfma_f32_16x16x32_bf16 v[176:179], a[88:91], a[32:35], v[176:179]
    s_waitcnt lgkmcnt(7)
    ds_read_b128 a[28:31], v5 offset:6144
    v_mfma_f32_16x16x32_bf16 v[176:179], a[92:95], a[36:39], v[176:179]
    ds_read_b64_tr_b16 a[72:73], v18 offset:18432
    v_mfma_f32_16x16x32_bf16 v[180:183], a[88:91], a[40:43], v[180:183]
    buffer_load_dwordx4 v23, s[60:63], s76 offen offset:3072 lds
    v_mfma_f32_16x16x32_bf16 v[180:183], a[92:95], a[44:47], v[180:183]
    s_add_u32 s76, s76, s80
    s_add_u32 s88, s90, 8192
    ds_read_b64_tr_b16 a[74:75], v18 offset:18944
    v_mfma_f32_16x16x32_bf16 v[184:187], a[88:91], a[48:51], v[184:187]
    buffer_store_dwordx4 a[196:199], v1, s[44:47], s88 offen offset:3072 sc1
    v_mfma_f32_16x16x32_bf16 v[184:187], a[92:95], a[52:55], v[184:187]
    ds_read_b64_tr_b16 a[76:77], v18 offset:26624
    v_mfma_f32_16x16x32_bf16 v[188:191], a[88:91], a[56:59], v[188:191]
    v_mfma_f32_16x16x32_bf16 v[188:191], a[92:95], a[60:63], v[188:191]
    s_waitcnt lgkmcnt(8)
    ds_read_b64_tr_b16 a[78:79], v18 offset:27136
    v_mfma_f32_16x16x32_bf16 v[192:195], a[64:67], a[32:35], v[192:195]
    s_waitcnt lgkmcnt(5)
    v_mfma_f32_16x16x32_bf16 v[192:195], a[68:71], a[36:39], v[192:195]
    ds_read_b64_tr_b16 a[80:81], v19 offset:16384
    v_mfma_f32_16x16x32_bf16 v[196:199], a[64:67], a[40:43], v[196:199]
    s_sub_u32 s87, s84, s85
    ds_read_b64_tr_b16 a[88:89], v19 offset:18432
    v_mfma_f32_16x16x32_bf16 v[196:199], a[68:71], a[44:47], v[196:199]
    ds_read_b64_tr_b16 a[82:83], v19 offset:16896
    v_mfma_f32_16x16x32_bf16 v[200:203], a[64:67], a[48:51], v[200:203]
    ds_read_b64_tr_b16 a[90:91], v19 offset:18944
    v_add_u32 v8, s87, v8
    v_mfma_f32_16x16x32_bf16 v[200:203], a[68:71], a[52:55], v[200:203]
    ds_read_b64_tr_b16 a[84:85], v19 offset:24576
    v_add_u32 v9, s87, v9
    v_mfma_f32_16x16x32_bf16 v[204:207], a[64:67], a[56:59], v[204:207]
    ds_read_b64_tr_b16 a[92:93], v19 offset:26624
    v_add_u32 v10, s87, v10
    v_mfma_f32_16x16x32_bf16 v[204:207], a[68:71], a[60:63], v[204:207]
    s_waitcnt lgkmcnt(8)
    ds_read_b64_tr_b16 a[86:87], v19 offset:25088
    v_add_u32 v11, s87, v11
    v_mfma_f32_16x16x32_bf16 v[208:211], a[72:75], a[32:35], v[208:211]
    s_waitcnt lgkmcnt(7)
    s_add_u32 m0, s83, 16384
    ds_read_b64_tr_b16 a[94:95], v19 offset:27136
    v_add_u32 v12, s87, v12
    v_mfma_f32_16x16x32_bf16 v[208:211], a[76:79], a[36:39], v[208:211]
    s_mov_b32 s58, s85
    buffer_load_dwordx4 v24, s[64:67], s77 offen offset:0 lds
    v_add_u32 v13, s87, v13
    v_mfma_f32_16x16x32_bf16 v[212:215], a[72:75], a[40:43], v[212:215]
    s_mov_b32 s85, s84
    v_add_u32 v14, s87, v14
    v_mfma_f32_16x16x32_bf16 v[212:215], a[76:79], a[44:47], v[212:215]
    s_mov_b32 s84, s83
    buffer_load_dwordx4 v25, s[64:67], s77 offen offset:1024 lds
    v_add_u32 v15, s87, v15
    v_mfma_f32_16x16x32_bf16 v[216:219], a[72:75], a[48:51], v[216:219]
    s_mov_b32 s83, s58
    v_add_u32 v16, s87, v16
    v_mfma_f32_16x16x32_bf16 v[216:219], a[76:79], a[52:55], v[216:219]
    v_add_u32 v17, s87, v17
    v_mfma_f32_16x16x32_bf16 v[220:223], a[72:75], a[56:59], v[220:223]
    v_add_u32 v18, s87, v18
    v_mfma_f32_16x16x32_bf16 v[220:223], a[76:79], a[60:63], v[220:223]
    s_waitcnt lgkmcnt(5)
    v_add_u32 v19, s87, v19
    v_mfma_f32_16x16x32_bf16 v[224:227], a[80:83], a[32:35], v[224:227]
    s_waitcnt vmcnt(18) lgkmcnt(0)
    s_barrier
    v_mfma_f32_16x16x32_bf16 v[224:227], a[84:87], a[36:39], v[224:227]
    ds_read_b64_tr_b16 a[64:65], v8 offset:0
    v_mfma_f32_16x16x32_bf16 v[228:231], a[80:83], a[40:43], v[228:231]
    buffer_load_dwordx4 v26, s[68:71], s77 offen offset:2048 lds
    v_mfma_f32_16x16x32_bf16 v[228:231], a[84:87], a[44:47], v[228:231]
    s_add_u32 s59, s90, 24576
    ds_read_b64_tr_b16 a[66:67], v8 offset:1024
    v_mfma_f32_16x16x32_bf16 v[232:235], a[80:83], a[48:51], v[232:235]
    buffer_store_dwordx4 a[192:195], v1, s[44:47], s59 offen offset:3072 sc1
    v_mfma_f32_16x16x32_bf16 v[232:235], a[84:87], a[52:55], v[232:235]
    ds_read_b64_tr_b16 a[68:69], v8 offset:8192
    v_mfma_f32_16x16x32_bf16 v[236:239], a[80:83], a[56:59], v[236:239]
    v_mfma_f32_16x16x32_bf16 v[236:239], a[84:87], a[60:63], v[236:239]
    ds_read_b64_tr_b16 a[70:71], v8 offset:9216
    v_mfma_f32_16x16x32_bf16 v[240:243], a[88:91], a[32:35], v[240:243]
    ds_read_b64_tr_b16 a[72:73], v9 offset:0
    v_mfma_f32_16x16x32_bf16 v[240:243], a[92:95], a[36:39], v[240:243]
    v_mfma_f32_16x16x32_bf16 v[244:247], a[88:91], a[40:43], v[244:247]
    ds_read_b64_tr_b16 a[74:75], v9 offset:1024
    v_mfma_f32_16x16x32_bf16 v[244:247], a[92:95], a[44:47], v[244:247]
    buffer_load_dwordx4 v27, s[68:71], s77 offen offset:3072 lds
    v_mfma_f32_16x16x32_bf16 v[248:251], a[88:91], a[48:51], v[248:251]
    s_add_u32 s77, s77, s81
    ds_read_b64_tr_b16 a[76:77], v9 offset:8192
    v_mfma_f32_16x16x32_bf16 v[248:251], a[92:95], a[52:55], v[248:251]
    v_mfma_f32_16x16x32_bf16 v[252:255], a[88:91], a[56:59], v[252:255]
    ds_read_b64_tr_b16 a[78:79], v9 offset:9216
    v_mfma_f32_16x16x32_bf16 v[252:255], a[92:95], a[60:63], v[252:255]
    s_waitcnt lgkmcnt(6)
    v_mfma_f32_16x16x32_bf16 a[128:131], a[64:67], a[0:3], a[128:131]
    s_waitcnt lgkmcnt(4)
    v_mfma_f32_16x16x32_bf16 a[128:131], a[68:71], a[4:7], a[128:131]
    s_add_u32 m0, s86, 0
    ds_read_b64_tr_b16 a[80:81], v10 offset:0
    v_mfma_f32_16x16x32_bf16 a[132:135], a[64:67], a[8:11], a[132:135]
    buffer_load_dwordx4 v28, s[72:75], s78 offen offset:0 sc1 lds
    v_mfma_f32_16x16x32_bf16 a[132:135], a[68:71], a[12:15], a[132:135]
    ds_read_b64_tr_b16 a[82:83], v10 offset:1024
    v_mfma_f32_16x16x32_bf16 a[136:139], a[64:67], a[16:19], a[136:139]
    v_mfma_f32_16x16x32_bf16 a[136:139], a[68:71], a[20:23], a[136:139]
    ds_read_b64_tr_b16 a[84:85], v10 offset:8192
    v_mfma_f32_16x16x32_bf16 a[140:143], a[64:67], a[24:27], a[140:143]
    v_mfma_f32_16x16x32_bf16 a[140:143], a[68:71], a[28:31], a[140:143]
    s_waitcnt lgkmcnt(5)
    ds_read_b64_tr_b16 a[86:87], v10 offset:9216
    v_mfma_f32_16x16x32_bf16 a[144:147], a[72:75], a[0:3], a[144:147]
    s_waitcnt lgkmcnt(4)
    v_mfma_f32_16x16x32_bf16 a[144:147], a[76:79], a[4:7], a[144:147]
    ds_read_b64_tr_b16 a[88:89], v11 offset:0
    v_mfma_f32_16x16x32_bf16 a[148:151], a[72:75], a[8:11], a[148:151]
    buffer_load_dwordx4 v29, s[72:75], s78 offen offset:1024 sc1 lds
    v_mfma_f32_16x16x32_bf16 a[148:151], a[76:79], a[12:15], a[148:151]
    ds_read_b64_tr_b16 a[90:91], v11 offset:1024
    v_mfma_f32_16x16x32_bf16 a[152:155], a[72:75], a[16:19], a[152:155]
    v_mfma_f32_16x16x32_bf16 a[152:155], a[76:79], a[20:23], a[152:155]
    s_add_u32 s88, s90, 12288
    ds_read_b64_tr_b16 a[92:93], v11 offset:8192
    v_mfma_f32_16x16x32_bf16 a[156:159], a[72:75], a[24:27], a[156:159]
    buffer_store_dwordx4 a[96:99], v1, s[44:47], s88 offen offset:0 sc1
    v_mfma_f32_16x16x32_bf16 a[156:159], a[76:79], a[28:31], a[156:159]
    s_waitcnt lgkmcnt(5)
    ds_read_b64_tr_b16 a[94:95], v11 offset:9216
    v_mfma_f32_16x16x32_bf16 a[160:163], a[80:83], a[0:3], a[160:163]
    s_branch L_pado7
L_pad7:
    s_branch L_tour_ret1
L_pado7:
    s_waitcnt lgkmcnt(4)
    v_mfma_f32_16x16x32_bf16 a[160:163], a[84:87], a[4:7], a[160:163]
    ds_read_b64_tr_b16 a[64:65], v12 offset:0
    v_mfma_f32_16x16x32_bf16 a[164:167], a[80:83], a[8:11], a[164:167]
    buffer_load_dwordx4 v30, s[72:75], s78 offen offset:2048 sc1 lds
    v_mfma_f32_16x16x32_bf16 a[164:167], a[84:87], a[12:15], a[164:167]
    ds_read_b64_tr_b16 a[66:67], v12 offset:1024
    v_mfma_f32_16x16x32_bf16 a[168:171], a[80:83], a[16:19], a[168:171]
    v_mfma_f32_16x16x32_bf16 a[168:171], a[84:87], a[20:23], a[168:171]
    ds_read_b64_tr_b16 a[68:69], v12 offset:8192
    v_mfma_f32_16x16x32_bf16 a[172:175], a[80:83], a[24:27], a[172:175]
    v_mfma_f32_16x16x32_bf16 a[172:175], a[84:87], a[28:31], a[172:175]
    s_waitcnt lgkmcnt(5)
    ds_read_b64_tr_b16 a[70:71], v12 offset:9216
    v_mfma_f32_16x16x32_bf16 a[176:179], a[88:91], a[0:3], a[176:179]
    s_waitcnt lgkmcnt(4)
    v_mfma_f32_16x16x32_bf16 a[176:179], a[92:95], a[4:7], a[176:179]
    ds_read_b64_tr_b16 a[72:73], v13 offset:0
    v_mfma_f32_16x16x32_bf16 a[180:183], a[88:91], a[8:11], a[180:183]
    buffer_load_dwordx4 v31, s[72:75], s78 offen offset:3072 sc1 lds
    v_mfma_f32_16x16x32_bf16 a[180:183], a[92:95], a[12:15], a[180:183]
    ds_read_b64_tr_b16 a[74:75], v13 offset:1024
    v_mfma_f32_16x16x32_bf16 a[184:187], a[88:91], a[16:19], a[184:187]
    v_mfma_f32_16x16x32_bf16 a[184:187], a[92:95], a[20:23], a[184:187]
    ds_read_b64_tr_b16 a[76:77], v13 offset:8192
    v_mfma_f32_16x16x32_bf16 a[188:191], a[88:91], a[24:27], a[188:191]
    v_mfma_f32_16x16x32_bf16 a[188:191], a[92:95], a[28:31], a[188:191]
    s_waitcnt lgkmcnt(5)
    ds_read_b64_tr_b16 a[78:79], v13 offset:9216
    v_mfma_f32_16x16x32_bf16 v[64:67], a[64:67], a[0:3], v[64:67]
    s_waitcnt lgkmcnt(4)
    v_mfma_f32_16x16x32_bf16 v[64:67], a[68:71], a[4:7], v[64:67]
    s_add_u32 m0, s86, 4096
    ds_read_b64_tr_b16 a[80:81], v14 offset:0
    v_mfma_f32_16x16x32_bf16 v[68:71], a[64:67], a[8:11], v[68:71]
    buffer_load_dwordx4 v28, s[72:75], s79 offen offset:0 sc1 lds
    v_mfma_f32_16x16x32_bf16 v[68:71], a[68:71], a[12:15], v[68:71]
    ds_read_b64_tr_b16 a[82:83], v14 offset:1024
    v_mfma_f32_16x16x32_bf16 v[72:75], a[64:67], a[16:19], v[72:75]
    v_mfma_f32_16x16x32_bf16 v[72:75], a[68:71], a[20:23], v[72:75]
    ds_read_b64_tr_b16 a[84:85], v14 offset:8192
    v_mfma_f32_16x16x32_bf16 v[76:79], a[64:67], a[24:27], v[76:79]
    v_mfma_f32_16x16x32_bf16 v[76:79], a[68:71], a[28:31], v[76:79]
    s_waitcnt lgkmcnt(5)
    s_add_u32 s59, s90, 28672
    ds_read_b64_tr_b16 a[86:87], v14 offset:9216
    v_mfma_f32_16x16x32_bf16 v[80:83], a[72:75], a[0:3], v[80:83]
    s_waitcnt lgkmcnt(4)
    buffer_store_dwordx4 a[100:103], v1, s[44:47], s59 offen offset:0 sc1
    v_mfma_f32_16x16x32_bf16 v[80:83], a[76:79], a[4:7], v[80:83]
    ds_read_b64_tr_b16 a[88:89], v15 offset:0
    v_mfma_f32_16x16x32_bf16 v[84:87], a[72:75], a[8:11], v[84:87]
    buffer_load_dwordx4 v29, s[72:75], s79 offen offset:1024 sc1 lds
    v_mfma_f32_16x16x32_bf16 v[84:87], a[76:79], a[12:15], v[84:87]
    ds_read_b64_tr_b16 a[90:91], v15 offset:1024
    v_mfma_f32_16x16x32_bf16 v[88:91], a[72:75], a[16:19], v[88:91]
    v_mfma_f32_16x16x32_bf16 v[88:91], a[76:79], a[20:23], v[88:91]
    ds_read_b64_tr_b16 a[92:93], v15 offset:8192
    v_mfma_f32_16x16x32_bf16 v[92:95], a[72:75], a[24:27], v[92:95]
    v_mfma_f32_16x16x32_bf16 v[92:95], a[76:79], a[28:31], v[92:95]
    s_waitcnt lgkmcnt(5)
    ds_read_b64_tr_b16 a[94:95], v15 offset:9216
    v_mfma_f32_16x16x32_bf16 v[96:99], a[80:83], a[0:3], v[96:99]
    s_waitcnt lgkmcnt(4)
    v_mfma_f32_16x16x32_bf16 v[96:99], a[84:87], a[4:7], v[96:99]
    ds_read_b64_tr_b16 a[64:65], v16 offset:16384
    v_mfma_f32_16x16x32_bf16 v[100:103], a[80:83], a[8:11], v[100:103]
    buffer_load_dwordx4 v30, s[72:75], s79 offen offset:2048 sc1 lds
    v_mfma_f32_16x16x32_bf16 v[100:103], a[84:87], a[12:15], v[100:103]
    ds_read_b64_tr_b16 a[66:67], v16 offset:16896
    v_mfma_f32_16x16x32_bf16 v[104:107], a[80:83], a[16:19], v[104:107]
    v_mfma_f32_16x16x32_bf16 v[104:107], a[84:87], a[20:23], v[104:107]
    ds_read_b64_tr_b16 a[68:69], v16 offset:24576
    v_mfma_f32_16x16x32_bf16 v[108:111], a[80:83], a[24:27], v[108:111]
    v_mfma_f32_16x16x32_bf16 v[108:111], a[84:87], a[28:31], v[108:111]
    s_waitcnt lgkmcnt(5)
    ds_read_b64_tr_b16 a[70:71], v16 offset:25088
    v_mfma_f32_16x16x32_bf16 v[112:115], a[88:91], a[0:3], v[112:115]
    s_waitcnt lgkmcnt(4)
    v_mfma_f32_16x16x32_bf16 v[112:115], a[92:95], a[4:7], v[112:115]
    ds_read_b64_tr_b16 a[72:73], v16 offset:18432
    v_mfma_f32_16x16x32_bf16 v[116:119], a[88:91], a[8:11], v[116:119]
    buffer_load_dwordx4 v31, s[72:75], s79 offen offset:3072 sc1 lds
    v_mfma_f32_16x16x32_bf16 v[116:119], a[92:95], a[12:15], v[116:119]
    s_add_u32 s78, s78, s82
    ds_read_b64_tr_b16 a[74:75], v16 offset:18944
    v_mfma_f32_16x16x32_bf16 v[120:123], a[88:91], a[16:19], v[120:123]
    s_add_u32 s79, s79, s82
    v_mfma_f32_16x16x32_bf16 v[120:123], a[92:95], a[20:23], v[120:123]
    ds_read_b64_tr_b16 a[76:77], v16 offset:26624
    v_mfma_f32_16x16x32_bf16 v[124:127], a[88:91], a[24:27], v[124:127]
    v_mfma_f32_16x16x32_bf16 v[124:127], a[92:95], a[28:31], v[124:127]
    s_waitcnt lgkmcnt(5)
    ds_read_b64_tr_b16 a[78:79], v16 offset:27136
    v_mfma_f32_16x16x32_bf16 v[128:131], a[64:67], a[0:3], v[128:131]
    s_waitcnt lgkmcnt(4)
    v_mfma_f32_16x16x32_bf16 v[128:131], a[68:71], a[4:7], v[128:131]
    s_mov_b32 m0, s83
    ds_read_b64_tr_b16 a[80:81], v17 offset:16384
    v_mfma_f32_16x16x32_bf16 v[132:135], a[64:67], a[8:11], v[132:135]
    buffer_load_dwordx4 v20, s[60:63], s76 offen offset:0 lds
    v_mfma_f32_16x16x32_bf16 v[132:135], a[68:71], a[12:15], v[132:135]
    s_add_u32 s88, s90, 12288
    ds_read_b64_tr_b16 a[82:83], v17 offset:16896
    v_mfma_f32_16x16x32_bf16 v[136:139], a[64:67], a[16:19], v[136:139]
    s_waitcnt vmcnt(22)
    buffer_store_dwordx4 a[104:107], v1, s[44:47], s88 offen offset:1024 sc1
    v_mfma_f32_16x16x32_bf16 v[136:139], a[68:71], a[20:23], v[136:139]
    ds_read_b64_tr_b16 a[84:85], v17 offset:24576
    v_mfma_f32_16x16x32_bf16 v[140:143], a[64:67], a[24:27], v[140:143]
    ds_read_b128 a[32:35], v4 offset:32768
    v_mfma_f32_16x16x32_bf16 v[140:143], a[68:71], a[28:31], v[140:143]
    s_waitcnt lgkmcnt(6)
    ds_read_b64_tr_b16 a[86:87], v17 offset:25088
    v_mfma_f32_16x16x32_bf16 v[144:147], a[72:75], a[0:3], v[144:147]
    s_waitcnt lgkmcnt(5)
    ds_read_b128 a[36:39], v5 offset:32768
    v_mfma_f32_16x16x32_bf16 v[144:147], a[76:79], a[4:7], v[144:147]
    ds_read_b64_tr_b16 a[88:89], v17 offset:18432
    v_mfma_f32_16x16x32_bf16 v[148:151], a[72:75], a[8:11], v[148:151]
    buffer_load_dwordx4 v21, s[60:63], s76 offen offset:1024 lds
    v_mfma_f32_16x16x32_bf16 v[148:151], a[76:79], a[12:15], v[148:151]
    ds_read_b64_tr_b16 a[90:91], v17 offset:18944
    v_mfma_f32_16x16x32_bf16 v[152:155], a[72:75], a[16:19], v[152:155]
    ds_read_b128 a[40:43], v4 offset:34816
    v_mfma_f32_16x16x32_bf16 v[152:155], a[76:79], a[20:23], v[152:155]
    ds_read_b64_tr_b16 a[92:93], v17 offset:26624
    v_mfma_f32_16x16x32_bf16 v[156:159], a[72:75], a[24:27], v[156:159]
    ds_read_b128 a[44:47], v5 offset:34816
    v_mfma_f32_16x16x32_bf16 v[156:159], a[76:79], a[28:31], v[156:159]
    s_waitcnt lgkmcnt(9)
    ds_read_b64_tr_b16 a[94:95], v17 offset:27136
    v_mfma_f32_16x16x32_bf16 v[160:163], a[80:83], a[0:3], v[160:163]
    s_waitcnt lgkmcnt(7)
    ds_read_b128 a[48:51], v4 offset:36864
    v_mfma_f32_16x16x32_bf16 v[160:163], a[84:87], a[4:7], v[160:163]
    ds_read_b64_tr_b16 a[64:65], v18 offset:16384
    v_mfma_f32_16x16x32_bf16 v[164:167], a[80:83], a[8:11], v[164:167]
    buffer_load_dwordx4 v22, s[60:63], s76 offen offset:2048 lds
    v_mfma_f32_16x16x32_bf16 v[164:167], a[84:87], a[12:15], v[164:167]
    ds_read_b64_tr_b16 a[66:67], v18 offset:16896
    v_mfma_f32_16x16x32_bf16 v[168:171], a[80:83], a[16:19], v[168:171]
    ds_read_b128 a[52:55], v5 offset:36864
    v_mfma_f32_16x16x32_bf16 v[168:171], a[84:87], a[20:23], v[168:171]
    ds_read_b64_tr_b16 a[68:69], v18 offset:24576
    v_mfma_f32_16x16x32_bf16 v[172:175], a[80:83], a[24:27], v[172:175]
    ds_read_b128 a[56:59], v4 offset:38912
    v_mfma_f32_16x16x32_bf16 v[172:175], a[84:87], a[28:31], v[172:175]
    s_waitcnt lgkmcnt(10)
    ds_read_b64_tr_b16 a[70:71], v18 offset:25088
    v_mfma_f32_16x16x32_bf16 v[176:179], a[88:91], a[0:3], v[176:179]
    s_waitcnt lgkmcnt(7)
    ds_read_b128 a[60:63], v5 offset:38912
    v_mfma_f32_16x16x32_bf16 v[176:179], a[92:95], a[4:7], v[176:179]
    ds_read_b64_tr_b16 a[72:73], v18 offset:18432
    v_mfma_f32_16x16x32_bf16 v[180:183], a[88:91], a[8:11], v[180:183]
    buffer_load_dwordx4 v23, s[60:63], s76 offen offset:3072 lds
    v_mfma_f32_16x16x32_bf16 v[180:183], a[92:95], a[12:15], v[180:183]
    s_add_u32 s76, s76, s80
    s_add_u32 s59, s90, 28672
    ds_read_b64_tr_b16 a[74:75], v18 offset:18944
    v_mfma_f32_16x16x32_bf16 v[184:187], a[88:91], a[16:19], v[184:187]
    buffer_store_dwordx4 a[108:111], v1, s[44:47], s59 offen offset:1024 sc1
    v_mfma_f32_16x16x32_bf16 v[184:187], a[92:95], a[20:23], v[184:187]
    ds_read_b64_tr_b16 a[76:77], v18 offset:26624
    v_mfma_f32_16x16x32_bf16 v[188:191], a[88:91], a[24:27], v[188:191]
    v_mfma_f32_16x16x32_bf16 v[188:191], a[92:95], a[28:31], v[188:191]
    s_waitcnt lgkmcnt(8)
    ds_read_b64_tr_b16 a[78:79], v18 offset:27136
    v_mfma_f32_16x16x32_bf16 v[192:195], a[64:67], a[0:3], v[192:195]
    s_waitcnt lgkmcnt(5)
    v_mfma_f32_16x16x32_bf16 v[192:195], a[68:71], a[4:7], v[192:195]
    ds_read_b64_tr_b16 a[80:81], v19 offset:16384
    v_mfma_f32_16x16x32_bf16 v[196:199], a[64:67], a[8:11], v[196:199]
    s_sub_u32 s87, s84, s85
    ds_read_b64_tr_b16 a[88:89], v19 offset:18432
    v_mfma_f32_16x16x32_bf16 v[196:199], a[68:71], a[12:15], v[196:199]
    ds_read_b64_tr_b16 a[82:83], v19 offset:16896
    v_mfma_f32_16x16x32_bf16 v[200:203], a[64:67], a[16:19], v[200:203]
    ds_read_b64_tr_b16 a[90:91], v19 offset:18944
    v_add_u32 v8, s87, v8
    v_mfma_f32_16x16x32_bf16 v[200:203], a[68:71], a[20:23], v[200:203]
    ds_read_b64_tr_b16 a[84:85], v19 offset:24576
    v_add_u32 v9, s87, v9
    v_mfma_f32_16x16x32_bf16 v[204:207], a[64:67], a[24:27], v[204:207]
    ds_read_b64_tr_b16 a[92:93], v19 offset:26624
    v_add_u32 v10, s87, v10
    v_mfma_f32_16x16x32_bf16 v[204:207], a[68:71], a[28:31], v[204:207]
    s_waitcnt lgkmcnt(8)
    ds_read_b64_tr_b16 a[86:87], v19 offset:25088
    v_add_u32 v11, s87, v11
    v_mfma_f32_16x16x32_bf16 v[208:211], a[72:75], a[0:3], v[208:211]
    s_waitcnt lgkmcnt(7)
    s_add_u32 m0, s83, 16384
    ds_read_b64_tr_b16 a[94:95], v19 offset:27136
    v_add_u32 v12, s87, v12
    v_mfma_f32_16x16x32_bf16 v[208:211], a[76:79], a[4:7], v[208:211]
    s_mov_b32 s58, s85
    buffer_load_dwordx4 v24, s[64:67], s77 offen offset:0 lds
    v_add_u32 v13, s87, v13
    v_mfma_f32_16x16x32_bf16 v[212:215], a[72:75], a[8:11], v[212:215]
    s_mov_b32 s85, s84
    v_add_u32 v14, s87, v14
    v_mfma_f32_16x16x32_bf16 v[212:215], a[76:79], a[12:15], v[212:215]
    s_mov_b32 s84, s83
    buffer_load_dwordx4 v25, s[64:67], s77 offen offset:1024 lds
    v_add_u32 v15, s87, v15
    v_mfma_f32_16x16x32_bf16 v[216:219], a[72:75], a[16:19], v[216:219]
    s_mov_b32 s83, s58
    v_add_u32 v16, s87, v16
    v_mfma_f32_16x16x32_bf16 v[216:219], a[76:79], a[20:23], v[216:219]
    v_add_u32 v17, s87, v17
    v_mfma_f32_16x16x32_bf16 v[220:223], a[72:75], a[24:27], v[220:223]
    v_add_u32 v18, s87, v18
    v_mfma_f32_16x16x32_bf16 v[220:223], a[76:79], a[28:31], v[220:223]
    s_waitcnt lgkmcnt(5)
    v_add_u32 v19, s87, v19
    v_mfma_f32_16x16x32_bf16 v[224:227], a[80:83], a[0:3], v[224:227]
    s_waitcnt vmcnt(18) lgkmcnt(0)
    s_barrier
    v_mfma_f32_16x16x32_bf16 v[224:227], a[84:87], a[4:7], v[224:227]
    ds_read_b64_tr_b16 a[64:65], v8 offset:0
    v_mfma_f32_16x16x32_bf16 v[228:231], a[80:83], a[8:11], v[228:231]
    buffer_load_dwordx4 v26, s[68:71], s77 offen offset:2048 lds
    v_mfma_f32_16x16x32_bf16 v[228:231], a[84:87], a[12:15], v[228:231]
    ds_read_b64_tr_b16 a[66:67], v8 offset:1024
    v_mfma_f32_16x16x32_bf16 v[232:235], a[80:83], a[16:19], v[232:235]
    v_mfma_f32_16x16x32_bf16 v[232:235], a[84:87], a[20:23], v[232:235]
    s_add_u32 s88, s90, 12288
    ds_read_b64_tr_b16 a[68:69], v8 offset:8192
    v_mfma_f32_16x16x32_bf16 v[236:239], a[80:83], a[24:27], v[236:239]
    buffer_store_dwordx4 a[112:115], v1, s[44:47], s88 offen offset:2048 sc1
    v_mfma_f32_16x16x32_bf16 v[236:239], a[84:87], a[28:31], v[236:239]
    ds_read_b64_tr_b16 a[70:71], v8 offset:9216
    v_mfma_f32_16x16x32_bf16 v[240:243], a[88:91], a[0:3], v[240:243]
    ds_read_b64_tr_b16 a[72:73], v9 offset:0
    v_mfma_f32_16x16x32_bf16 v[240:243], a[92:95], a[4:7], v[240:243]
    v_mfma_f32_16x16x32_bf16 v[244:247], a[88:91], a[8:11], v[244:247]
    ds_read_b64_tr_b16 a[74:75], v9 offset:1024
    v_mfma_f32_16x16x32_bf16 v[244:247], a[92:95], a[12:15], v[244:247]
    buffer_load_dwordx4 v27, s[68:71], s77 offen offset:3072 lds
    v_mfma_f32_16x16x32_bf16 v[248:251], a[88:91], a[16:19], v[248:251]
    s_add_u32 s77, s77, s81
    ds_read_b64_tr_b16 a[76:77], v9 offset:8192
    v_mfma_f32_16x16x32_bf16 v[248:251], a[92:95], a[20:23], v[248:251]
    v_mfma_f32_16x16x32_bf16 v[252:255], a[88:91], a[24:27], v[252:255]
    ds_read_b64_tr_b16 a[78:79], v9 offset:9216
    v_mfma_f32_16x16x32_bf16 v[252:255], a[92:95], a[28:31], v[252:255]
    s_waitcnt lgkmcnt(6)
    v_mfma_f32_16x16x32_bf16 a[128:131], a[64:67], a[32:35], a[128:131]
    s_waitcnt lgkmcnt(4)
    v_mfma_f32_16x16x32_bf16 a[128:131], a[68:71], a[36:39], a[128:131]
    s_add_u32 m0, s86, 32768
    ds_read_b64_tr_b16 a[80:81], v10 offset:0
    v_mfma_f32_16x16x32_bf16 a[132:135], a[64:67], a[40:43], a[132:135]
    buffer_load_dwordx4 v28, s[72:75], s78 offen offset:0 sc1 lds
    v_mfma_f32_16x16x32_bf16 a[132:135], a[68:71], a[44:47], a[132:135]
    ds_read_b64_tr_b16 a[82:83], v10 offset:1024
    v_mfma_f32_16x16x32_bf16 a[136:139], a[64:67], a[48:51], a[136:139]
    v_mfma_f32_16x16x32_bf16 a[136:139], a[68:71], a[52:55], a[136:139]
    ds_read_b64_tr_b16 a[84:85], v10 offset:8192
    v_mfma_f32_16x16x32_bf16 a[140:143], a[64:67], a[56:59], a[140:143]
    v_mfma_f32_16x16x32_bf16 a[140:143], a[68:71], a[60:63], a[140:143]
    s_waitcnt lgkmcnt(5)
    ds_read_b64_tr_b16 a[86:87], v10 offset:9216
    v_mfma_f32_16x16x32_bf16 a[144:147], a[72:75], a[32:35], a[144:147]
    s_waitcnt lgkmcnt(4)
    v_mfma_f32_16x16x32_bf16 a[144:147], a[76:79], a[36:39], a[144:147]
    ds_read_b64_tr_b16 a[88:89], v11 offset:0
    v_mfma_f32_16x16x32_bf16 a[148:151], a[72:75], a[40:43], a[148:151]
    buffer_load_dwordx4 v29, s[72:75], s78 offen offset:1024 sc1 lds
    v_mfma_f32_16x16x32_bf16 a[148:151], a[76:79], a[44:47], a[148:151]
    ds_read_b64_tr_b16 a[90:91], v11 offset:1024
    v_mfma_f32_16x16x32_bf16 a[152:155], a[72:75], a[48:51], a[152:155]
    v_mfma_f32_16x16x32_bf16 a[152:155], a[76:79], a[52:55], a[152:155]
    ds_read_b64_tr_b16 a[92:93], v11 offset:8192
    v_mfma_f32_16x16x32_bf16 a[156:159], a[72:75], a[56:59], a[156:159]
    v_mfma_f32_16x16x32_bf16 a[156:159], a[76:79], a[60:63], a[156:159]
    s_waitcnt lgkmcnt(5)
    s_add_u32 s59, s90, 28672
    ds_read_b64_tr_b16 a[94:95], v11 offset:9216
    v_mfma_f32_16x16x32_bf16 a[160:163], a[80:83], a[32:35], a[160:163]
    s_waitcnt lgkmcnt(4)
    buffer_store_dwordx4 a[116:119], v1, s[44:47], s59 offen offset:2048 sc1
    v_mfma_f32_16x16x32_bf16 a[160:163], a[84:87], a[36:39], a[160:163]
    ds_read_b64_tr_b16 a[64:65], v12 offset:0
    v_mfma_f32_16x16x32_bf16 a[164:167], a[80:83], a[40:43], a[164:167]
    buffer_load_dwordx4 v30, s[72:75], s78 offen offset:2048 sc1 lds
    v_mfma_f32_16x16x32_bf16 a[164:167], a[84:87], a[44:47], a[164:167]
    ds_read_b64_tr_b16 a[66:67], v12 offset:1024
    v_mfma_f32_16x16x32_bf16 a[168:171], a[80:83], a[48:51], a[168:171]
    v_mfma_f32_16x16x32_bf16 a[168:171], a[84:87], a[52:55], a[168:171]
    ds_read_b64_tr_b16 a[68:69], v12 offset:8192
    v_mfma_f32_16x16x32_bf16 a[172:175], a[80:83], a[56:59], a[172:175]
    v_mfma_f32_16x16x32_bf16 a[172:175], a[84:87], a[60:63], a[172:175]
    s_waitcnt lgkmcnt(5)
    ds_read_b64_tr_b16 a[70:71], v12 offset:9216
    v_mfma_f32_16x16x32_bf16 a[176:179], a[88:91], a[32:35], a[176:179]
    s_waitcnt lgkmcnt(4)
    v_mfma_f32_16x16x32_bf16 a[176:179], a[92:95], a[36:39], a[176:179]
    ds_read_b64_tr_b16 a[72:73], v13 offset:0
    v_mfma_f32_16x16x32_bf16 a[180:183], a[88:91], a[40:43], a[180:183]
    buffer_load_dwordx4 v31, s[72:75], s78 offen offset:3072 sc1 lds
    v_mfma_f32_16x16x32_bf16 a[180:183], a[92:95], a[44:47], a[180:183]
    ds_read_b64_tr_b16 a[74:75], v13 offset:1024
    v_mfma_f32_16x16x32_bf16 a[184:187], a[88:91], a[48:51], a[184:187]
    v_mfma_f32_16x16x32_bf16 a[184:187], a[92:95], a[52:55], a[184:187]
    ds_read_b64_tr_b16 a[76:77], v13 offset:8192
    v_mfma_f32_16x16x32_bf16 a[188:191], a[88:91], a[56:59], a[188:191]
    v_mfma_f32_16x16x32_bf16 a[188:191], a[92:95], a[60:63], a[188:191]
    s_waitcnt lgkmcnt(5)
    ds_read_b64_tr_b16 a[78:79], v13 offset:9216
    v_mfma_f32_16x16x32_bf16 v[64:67], a[64:67], a[32:35], v[64:67]
    s_waitcnt lgkmcnt(4)
    v_mfma_f32_16x16x32_bf16 v[64:67], a[68:71], a[36:39], v[64:67]
    s_add_u32 m0, s86, 36864
    ds_read_b64_tr_b16 a[80:81], v14 offset:0
    v_mfma_f32_16x16x32_bf16 v[68:71], a[64:67], a[40:43], v[68:71]
    buffer_load_dwordx4 v28, s[72:75], s79 offen offset:0 sc1 lds
    v_mfma_f32_16x16x32_bf16 v[68:71], a[68:71], a[44:47], v[68:71]
    ds_read_b64_tr_b16 a[82:83], v14 offset:1024
    v_mfma_f32_16x16x32_bf16 v[72:75], a[64:67], a[48:51], v[72:75]
    v_mfma_f32_16x16x32_bf16 v[72:75], a[68:71], a[52:55], v[72:75]
    ds_read_b64_tr_b16 a[84:85], v14 offset:8192
    v_mfma_f32_16x16x32_bf16 v[76:79], a[64:67], a[56:59], v[76:79]
    v_mfma_f32_16x16x32_bf16 v[76:79], a[68:71], a[60:63], v[76:79]
    s_waitcnt lgkmcnt(5)
    ds_read_b64_tr_b16 a[86:87], v14 offset:9216
    v_mfma_f32_16x16x32_bf16 v[80:83], a[72:75], a[32:35], v[80:83]
    s_waitcnt lgkmcnt(4)
    v_mfma_f32_16x16x32_bf16 v[80:83], a[76:79], a[36:39], v[80:83]
    ds_read_b64_tr_b16 a[88:89], v15 offset:0
    v_mfma_f32_16x16x32_bf16 v[84:87], a[72:75], a[40:43], v[84:87]
    buffer_load_dwordx4 v29, s[72:75], s79 offen offset:1024 sc1 lds
    v_mfma_f32_16x16x32_bf16 v[84:87], a[76:79], a[44:47], v[84:87]
    s_add_u32 s88, s90, 12288
    ds_read_b64_tr_b16 a[90:91], v15 offset:1024
    v_mfma_f32_16x16x32_bf16 v[88:91], a[72:75], a[48:51], v[88:91]
    buffer_store_dwordx4 a[120:123], v1, s[44:47], s88 offen offset:3072 sc1
    v_mfma_f32_16x16x32_bf16 v[88:91], a[76:79], a[52:55], v[88:91]
    ds_read_b64_tr_b16 a[92:93], v15 offset:8192
    v_mfma_f32_16x16x32_bf16 v[92:95], a[72:75], a[56:59], v[92:95]
    v_mfma_f32_16x16x32_bf16 v[92:95], a[76:79], a[60:63], v[92:95]
    s_waitcnt lgkmcnt(5)
    ds_read_b64_tr_b16 a[94:95], v15 offset:9216
    v_mfma_f32_16x16x32_bf16 v[96:99], a[80:83], a[32:35], v[96:99]
    s_waitcnt lgkmcnt(4)
    v_mfma_f32_16x16x32_bf16 v[96:99], a[84:87], a[36:39], v[96:99]
    ds_read_b64_tr_b16 a[64:65], v16 offset:16384
    v_mfma_f32_16x16x32_bf16 v[100:103], a[80:83], a[40:43], v[100:103]
    buffer_load_dwordx4 v30, s[72:75], s79 offen offset:2048 sc1 lds
    v_mfma_f32_16x16x32_bf16 v[100:103], a[84:87], a[44:47], v[100:103]
    ds_read_b64_tr_b16 a[66:67], v16 offset:16896
    v_mfma_f32_16x16x32_bf16 v[104:107], a[80:83], a[48:51], v[104:107]
    v_mfma_f32_16x16x32_bf16 v[104:107], a[84:87], a[52:55], v[104:107]
    ds_read_b64_tr_b16 a[68:69], v16 offset:24576
    v_mfma_f32_16x16x32_bf16 v[108:111], a[80:83], a[56:59], v[108:111]
    v_mfma_f32_16x16x32_bf16 v[108:111], a[84:87], a[60:63], v[108:111]
    s_waitcnt lgkmcnt(5)
    ds_read_b64_tr_b16 a[70:71], v16 offset:25088
    v_mfma_f32_16x16x32_bf16 v[112:115], a[88:91], a[32:35], v[112:115]
    s_waitcnt lgkmcnt(4)
    v_mfma_f32_16x16x32_bf16 v[112:115], a[92:95], a[36:39], v[112:115]
    ds_read_b64_tr_b16 a[72:73], v16 offset:18432
    v_mfma_f32_16x16x32_bf16 v[116:119], a[88:91], a[40:43], v[116:119]
    buffer_load_dwordx4 v31, s[72:75], s79 offen offset:3072 sc1 lds
    v_mfma_f32_16x16x32_bf16 v[116:119], a[92:95], a[44:47], v[116:119]
    s_add_u32 s78, s78, s82
    ds_read_b64_tr_b16 a[74:75], v16 offset:18944
    v_mfma_f32_16x16x32_bf16 v[120:123], a[88:91], a[48:51], v[120:123]
    s_add_u32 s79, s79, s82
    v_mfma_f32_16x16x32_bf16 v[120:123], a[92:95], a[52:55], v[120:123]
    ds_read_b64_tr_b16 a[76:77], v16 offset:26624
    v_mfma_f32_16x16x32_bf16 v[124:127], a[88:91], a[56:59], v[124:127]
    v_mfma_f32_16x16x32_bf16 v[124:127], a[92:95], a[60:63], v[124:127]
    s_waitcnt lgkmcnt(5)
    ds_read_b64_tr_b16 a[78:79], v16 offset:27136
    v_mfma_f32_16x16x32_bf16 v[128:131], a[64:67], a[32:35], v[128:131]
    s_waitcnt lgkmcnt(4)
    v_mfma_f32_16x16x32_bf16 v[128:131], a[68:71], a[36:39], v[128:131]
    s_mov_b32 m0, s83
    ds_read_b64_tr_b16 a[80:81], v17 offset:16384
    v_mfma_f32_16x16x32_bf16 v[132:135], a[64:67], a[40:43], v[132:135]
    buffer_load_dwordx4 v20, s[60:63], s76 offen offset:0 lds
    v_mfma_f32_16x16x32_bf16 v[132:135], a[68:71], a[44:47], v[132:135]
    s_add_u32 s59, s90, 28672
    ds_read_b64_tr_b16 a[82:83], v17 offset:16896
    v_mfma_f32_16x16x32_bf16 v[136:139], a[64:67], a[48:51], v[136:139]
    s_waitcnt vmcnt(22)
    buffer_store_dwordx4 a[124:127], v1, s[44:47], s59 offen offset:3072 sc1
    v_mfma_f32_16x16x32_bf16 v[136:139], a[68:71], a[52:55], v[136:139]
    ds_read_b64_tr_b16 a[84:85], v17 offset:24576
    v_mfma_f32_16x16x32_bf16 v[140:143], a[64:67], a[56:59], v[140:143]
    ds_read_b128 a[0:3], v4 offset:0
    v_mfma_f32_16x16x32_bf16 v[140:143], a[68:71], a[60:63], v[140:143]
    s_waitcnt lgkmcnt(6)
    ds_read_b64_tr_b16 a[86:87], v17 offset:25088
    v_mfma_f32_16x16x32_bf16 v[144:147], a[72:75], a[32:35], v[144:147]
    s_waitcnt lgkmcnt(5)
    ds_read_b128 a[4:7], v5 offset:0
    v_mfma_f32_16x16x32_bf16 v[144:147], a[76:79], a[36:39], v[144:147]
    ds_read_b64_tr_b16 a[88:89], v17 offset:18432
    v_mfma_f32_16x16x32_bf16 v[148:151], a[72:75], a[40:43], v[148:151]
    buffer_load_dwordx4 v21, s[60:63], s76 offen offset:1024 lds
    v_mfma_f32_16x16x32_bf16 v[148:151], a[76:79], a[44:47], v[148:151]
    ds_read_b64_tr_b16 a[90:91], v17 offset:18944
    v_mfma_f32_16x16x32_bf16 v[152:155], a[72:75], a[48:51], v[152:155]
    ds_read_b128 a[8:11], v4 offset:2048
    v_mfma_f32_16x16x32_bf16 v[152:155], a[76:79], a[52:55], v[152:155]
    ds_read_b64_tr_b16 a[92:93], v17 offset:26624
    v_mfma_f32_16x16x32_bf16 v[156:159], a[72:75], a[56:59], v[156:159]
    ds_read_b128 a[12:15], v5 offset:2048
    v_mfma_f32_16x16x32_bf16 v[156:159], a[76:79], a[60:63], v[156:159]
    s_waitcnt lgkmcnt(9)
    ds_read_b64_tr_b16 a[94:95], v17 offset:27136
    v_mfma_f32_16x16x32_bf16 v[160:163], a[80:83], a[32:35], v[160:163]
    s_waitcnt lgkmcnt(7)
    ds_read_b128 a[16:19], v4 offset:4096
    v_mfma_f32_16x16x32_bf16 v[160:163], a[84:87], a[36:39], v[160:163]
    ds_read_b64_tr_b16 a[64:65], v18 offset:16384
    v_mfma_f32_16x16x32_bf16 v[164:167], a[80:83], a[40:43], v[164:167]
    buffer_load_dwordx4 v22, s[60:63], s76 offen offset:2048 lds
    v_mfma_f32_16x16x32_bf16 v[164:167], a[84:87], a[44:47], v[164:167]
    ds_read_b64_tr_b16 a[66:67], v18 offset:16896
    v_mfma_f32_16x16x32_bf16 v[168:171], a[80:83], a[48:51], v[168:171]
    ds_read_b128 a[20:23], v5 offset:4096
    v_mfma_f32_16x16x32_bf16 v[168:171], a[84:87], a[52:55], v[168:171]
    ds_read_b64_tr_b16 a[68:69], v18 offset:24576
    v_mfma_f32_16x16x32_bf16 v[172:175], a[80:83], a[56:59], v[172:175]
    ds_read_b128 a[24:27], v4 offset:6144
    v_mfma_f32_16x16x32_bf16 v[172:175], a[84:87], a[60:63], v[172:175]
    s_waitcnt lgkmcnt(10)
    ds_read_b64_tr_b16 a[70:71], v18 offset:25088
    v_mfma_f32_16x16x32_bf16 v[176:179], a[88:91], a[32:35], v[176:179]
    s_waitcnt lgkmcnt(7)
    ds_read_b128 a[28:31], v5 offset:6144
    v_mfma_f32_16x16x32_bf16 v[176:179], a[92:95], a[36:39], v[176:179]
    ds_read_b64_tr_b16 a[72:73], v18 offset:18432
    v_mfma_f32_16x16x32_bf16 v[180:183], a[88:91], a[40:43], v[180:183]
    buffer_load_dwordx4 v23, s[60:63], s76 offen offset:3072 lds
    v_mfma_f32_16x16x32_bf16 v[180:183], a[92:95], a[44:47], v[180:183]
    s_add_u32 s76, s76, s80
    ds_read_b64_tr_b16 a[74:75], v18 offset:18944
    v_mfma_f32_16x16x32_bf16 v[184:187], a[88:91], a[48:51], v[184:187]
    v_mfma_f32_16x16x32_bf16 v[184:187], a[92:95], a[52:55], v[184:187]
    ds_read_b64_tr_b16 a[76:77], v18 offset:26624
    v_mfma_f32_16x16x32_bf16 v[188:191], a[88:91], a[56:59], v[188:191]
    v_mfma_f32_16x16x32_bf16 v[188:191], a[92:95], a[60:63], v[188:191]
    s_waitcnt lgkmcnt(8)
    ds_read_b64_tr_b16 a[78:79], v18 offset:27136
    v_mfma_f32_16x16x32_bf16 v[192:195], a[64:67], a[32:35], v[192:195]
    s_waitcnt lgkmcnt(5)
    v_mfma_f32_16x16x32_bf16 v[192:195], a[68:71], a[36:39], v[192:195]
    ds_read_b64_tr_b16 a[80:81], v19 offset:16384
    v_mfma_f32_16x16x32_bf16 v[196:199], a[64:67], a[40:43], v[196:199]
    s_sub_u32 s87, s84, s85
    ds_read_b64_tr_b16 a[88:89], v19 offset:18432
    v_mfma_f32_16x16x32_bf16 v[196:199], a[68:71], a[44:47], v[196:199]
    ds_read_b64_tr_b16 a[82:83], v19 offset:16896
    v_mfma_f32_16x16x32_bf16 v[200:203], a[64:67], a[48:51], v[200:203]
    ds_read_b64_tr_b16 a[90:91], v19 offset:18944
    v_add_u32 v8, s87, v8
    v_mfma_f32_16x16x32_bf16 v[200:203], a[68:71], a[52:55], v[200:203]
    ds_read_b64_tr_b16 a[84:85], v19 offset:24576
    v_add_u32 v9, s87, v9
    v_mfma_f32_16x16x32_bf16 v[204:207], a[64:67], a[56:59], v[204:207]
    ds_read_b64_tr_b16 a[92:93], v19 offset:26624
    v_add_u32 v10, s87, v10
    v_mfma_f32_16x16x32_bf16 v[204:207], a[68:71], a[60:63], v[204:207]
    s_waitcnt lgkmcnt(8)
    ds_read_b64_tr_b16 a[86:87], v19 offset:25088
    v_add_u32 v11, s87, v11
    v_mfma_f32_16x16x32_bf16 v[208:211], a[72:75], a[32:35], v[208:211]
    s_waitcnt lgkmcnt(7)
    s_add_u32 m0, s83, 16384
    ds_read_b64_tr_b16 a[94:95], v19 offset:27136
    v_add_u32 v12, s87, v12
    v_mfma_f32_16x16x32_bf16 v[208:211], a[76:79], a[36:39], v[208:211]
    s_mov_b32 s58, s85
    buffer_load_dwordx4 v24, s[64:67], s77 offen offset:0 lds
    v_add_u32 v13, s87, v13
    v_mfma_f32_16x16x32_bf16 v[212:215], a[72:75], a[40:43], v[212:215]
    s_mov_b32 s85, s84
    v_add_u32 v14, s87, v14
    v_mfma_f32_16x16x32_bf16 v[212:215], a[76:79], a[44:47], v[212:215]
    s_mov_b32 s84, s83
    buffer_load_dwordx4 v25, s[64:67], s77 offen offset:1024 lds
    v_add_u32 v15, s87, v15
    v_mfma_f32_16x16x32_bf16 v[216:219], a[72:75], a[48:51], v[216:219]
    s_mov_b32 s83, s58
    v_add_u32 v16, s87, v16
    v_mfma_f32_16x16x32_bf16 v[216:219], a[76:79], a[52:55], v[216:219]
    v_add_u32 v17, s87, v17
    v_mfma_f32_16x16x32_bf16 v[220:223], a[72:75], a[56:59], v[220:223]
    v_add_u32 v18, s87, v18
    v_mfma_f32_16x16x32_bf16 v[220:223], a[76:79], a[60:63], v[220:223]
    s_waitcnt lgkmcnt(5)
    v_add_u32 v19, s87, v19
    v_mfma_f32_16x16x32_bf16 v[224:227], a[80:83], a[32:35], v[224:227]
    s_waitcnt vmcnt(17) lgkmcnt(0)
    s_barrier
    v_mfma_f32_16x16x32_bf16 v[224:227], a[84:87], a[36:39], v[224:227]
    ds_read_b64_tr_b16 a[64:65], v8 offset:0
    v_mfma_f32_16x16x32_bf16 v[228:231], a[80:83], a[40:43], v[228:231]
    buffer_load_dwordx4 v26, s[68:71], s77 offen offset:2048 lds
    v_mfma_f32_16x16x32_bf16 v[228:231], a[84:87], a[44:47], v[228:231]
    ds_read_b64_tr_b16 a[66:67], v8 offset:1024
    v_mfma_f32_16x16x32_bf16 v[232:235], a[80:83], a[48:51], v[232:235]
    v_mfma_f32_16x16x32_bf16 v[232:235], a[84:87], a[52:55], v[232:235]
    ds_read_b64_tr_b16 a[68:69], v8 offset:8192
    v_mfma_f32_16x16x32_bf16 v[236:239], a[80:83], a[56:59], v[236:239]
    v_mfma_f32_16x16x32_bf16 v[236:239], a[84:87], a[60:63], v[236:239]
    ds_read_b64_tr_b16 a[70:71], v8 offset:9216
    v_mfma_f32_16x16x32_bf16 v[240:243], a[88:91], a[32:35], v[240:243]
    ds_read_b64_tr_b16 a[72:73], v9 offset:0
    v_mfma_f32_16x16x32_bf16 v[240:243], a[92:95], a[36:39], v[240:243]
    v_mfma_f32_16x16x32_bf16 v[244:247], a[88:91], a[40:43], v[244:247]
    ds_read_b64_tr_b16 a[74:75], v9 offset:1024
    v_mfma_f32_16x16x32_bf16 v[244:247], a[92:95], a[44:47], v[244:247]
    buffer_load_dwordx4 v27, s[68:71], s77 offen offset:3072 lds
    v_mfma_f32_16x16x32_bf16 v[248:251], a[88:91], a[48:51], v[248:251]
    s_add_u32 s77, s77, s81
    ds_read_b64_tr_b16 a[76:77], v9 offset:8192
    v_mfma_f32_16x16x32_bf16 v[248:251], a[92:95], a[52:55], v[248:251]
    v_mfma_f32_16x16x32_bf16 v[252:255], a[88:91], a[56:59], v[252:255]
    ds_read_b64_tr_b16 a[78:79], v9 offset:9216
    v_mfma_f32_16x16x32_bf16 v[252:255], a[92:95], a[60:63], v[252:255]
    s_waitcnt lgkmcnt(6)
    v_mfma_f32_16x16x32_bf16 a[128:131], a[64:67], a[0:3], a[128:131]
    s_waitcnt lgkmcnt(4)
    v_mfma_f32_16x16x32_bf16 a[128:131], a[68:71], a[4:7], a[128:131]
    s_add_u32 m0, s86, 0
    ds_read_b64_tr_b16 a[80:81], v10 offset:0
    v_mfma_f32_16x16x32_bf16 a[132:135], a[64:67], a[8:11], a[132:135]
    buffer_load_dwordx4 v28, s[72:75], s78 offen offset:0 sc1 lds
    v_mfma_f32_16x16x32_bf16 a[132:135], a[68:71], a[12:15], a[132:135]
    ds_read_b64_tr_b16 a[82:83], v10 offset:1024
    v_mfma_f32_16x16x32_bf16 a[136:139], a[64:67], a[16:19], a[136:139]
    v_mfma_f32_16x16x32_bf16 a[136:139], a[68:71], a[20:23], a[136:139]
    ds_read_b64_tr_b16 a[84:85], v10 offset:8192
    v_mfma_f32_16x16x32_bf16 a[140:143], a[64:67], a[24:27], a[140:143]
    v_mfma_f32_16x16x32_bf16 a[140:143], a[68:71], a[28:31], a[140:143]
    s_waitcnt lgkmcnt(5)
    ds_read_b64_tr_b16 a[86:87], v10 offset:9216
    v_mfma_f32_16x16x32_bf16 a[144:147], a[72:75], a[0:3], a[144:147]
    s_waitcnt lgkmcnt(4)
    v_mfma_f32_16x16x32_bf16 a[144:147], a[76:79], a[4:7], a[144:147]
    ds_read_b64_tr_b16 a[88:89], v11 offset:0
    v_mfma_f32_16x16x32_bf16 a[148:151], a[72:75], a[8:11], a[148:151]
    buffer_load_dwordx4 v29, s[72:75], s78 offen offset:1024 sc1 lds
    v_mfma_f32_16x16x32_bf16 a[148:151], a[76:79], a[12:15], a[148:151]
    ds_read_b64_tr_b16 a[90:91], v11 offset:1024
    v_mfma_f32_16x16x32_bf16 a[152:155], a[72:75], a[16:19], a[152:155]
    v_mfma_f32_16x16x32_bf16 a[152:155], a[76:79], a[20:23], a[152:155]
    ds_read_b64_tr_b16 a[92:93], v11 offset:8192
    v_mfma_f32_16x16x32_bf16 a[156:159], a[72:75], a[24:27], a[156:159]
    v_mfma_f32_16x16x32_bf16 a[156:159], a[76:79], a[28:31], a[156:159]
    s_waitcnt lgkmcnt(5)
    ds_read_b64_tr_b16 a[94:95], v11 offset:9216
    v_mfma_f32_16x16x32_bf16 a[160:163], a[80:83], a[0:3], a[160:163]
    s_waitcnt lgkmcnt(4)
    v_mfma_f32_16x16x32_bf16 a[160:163], a[84:87], a[4:7], a[160:163]
    ds_read_b64_tr_b16 a[64:65], v12 offset:0
    v_mfma_f32_16x16x32_bf16 a[164:167], a[80:83], a[8:11], a[164:167]
    buffer_load_dwordx4 v30, s[72:75], s78 offen offset:2048 sc1 lds
    v_mfma_f32_16x16x32_bf16 a[164:167], a[84:87], a[12:15], a[164:167]
    ds_read_b64_tr_b16 a[66:67], v12 offset:1024
    v_mfma_f32_16x16x32_bf16 a[168:171], a[80:83], a[16:19], a[168:171]
    s_branch L_pado8
L_pad8:
    s_branch L_tour_ret2
L_pado8:
    v_mfma_f32_16x16x32_bf16 a[168:171], a[84:87], a[20:23], a[168:171]
    ds_read_b64_tr_b16 a[68:69], v12 offset:8192
    v_mfma_f32_16x16x32_bf16 a[172:175], a[80:83], a[24:27], a[172:175]
    v_mfma_f32_16x16x32_bf16 a[172:175], a[84:87], a[28:31], a[172:175]
    s_waitcnt lgkmcnt(5)
    ds_read_b64_tr_b16 a[70:71], v12 offset:9216
    v_mfma_f32_16x16x32_bf16 a[176:179], a[88:91], a[0:3], a[176:179]
    s_waitcnt lgkmcnt(4)
    v_mfma_f32_16x16x32_bf16 a[176:179], a[92:95], a[4:7], a[176:179]
    ds_read_b64_tr_b16 a[72:73], v13 offset:0
    v_mfma_f32_16x16x32_bf16 a[180:183], a[88:91], a[8:11], a[180:183]
    buffer_load_dwordx4 v31, s[72:75], s78 offen offset:3072 sc1 lds
    v_mfma_f32_16x16x32_bf16 a[180:183], a[92:95], a[12:15], a[180:183]
    ds_read_b64_tr_b16 a[74:75], v13 offset:1024
    v_mfma_f32_16x16x32_bf16 a[184:187], a[88:91], a[16:19], a[184:187]
    v_mfma_f32_16x16x32_bf16 a[184:187], a[92:95], a[20:23], a[184:187]
    ds_read_b64_tr_b16 a[76:77], v13 offset:8192
    v_mfma_f32_16x16x32_bf16 a[188:191], a[88:91], a[24:27], a[188:191]
    v_mfma_f32_16x16x32_bf16 a[188:191], a[92:95], a[28:31], a[188:191]
    s_waitcnt lgkmcnt(5)
    ds_read_b64_tr_b16 a[78:79], v13 offset:9216
    v_mfma_f32_16x16x32_bf16 v[64:67], a[64:67], a[0:3], v[64:67]
    s_waitcnt lgkmcnt(4)
    v_mfma_f32_16x16x32_bf16 v[64:67], a[68:71], a[4:7], v[64:67]
    s_add_u32 m0, s86, 4096
    ds_read_b64_tr_b16 a[80:81], v14 offset:0
    v_mfma_f32_16x16x32_bf16 v[68:71], a[64:67], a[8:11], v[68:71]
    buffer_load_dwordx4 v28, s[72:75], s79 offen offset:0 sc1 lds
    v_mfma_f32_16x16x32_bf16 v[68:71], a[68:71], a[12:15], v[68:71]
    ds_read_b64_tr_b16 a[82:83], v14 offset:1024
    v_mfma_f32_16x16x32_bf16 v[72:75], a[64:67], a[16:19], v[72:75]
    v_mfma_f32_16x16x32_bf16 v[72:75], a[68:71], a[20:23], v[72:75]
    ds_read_b64_tr_b16 a[84:85], v14 offset:8192
    v_mfma_f32_16x16x32_bf16 v[76:79], a[64:67], a[24:27], v[76:79]
    v_mfma_f32_16x16x32_bf16 v[76:79], a[68:71], a[28:31], v[76:79]
    s_waitcnt lgkmcnt(5)
    ds_read_b64_tr_b16 a[86:87], v14 offset:9216
    v_mfma_f32_16x16x32_bf16 v[80:83], a[72:75], a[0:3], v[80:83]
    s_waitcnt lgkmcnt(4)
    v_mfma_f32_16x16x32_bf16 v[80:83], a[76:79], a[4:7], v[80:83]
    ds_read_b64_tr_b16 a[88:89], v15 offset:0
    v_mfma_f32_16x16x32_bf16 v[84:87], a[72:75], a[8:11], v[84:87]
    buffer_load_dwordx4 v29, s[72:75], s79 offen offset:1024 sc1 lds
    v_mfma_f32_16x16x32_bf16 v[84:87], a[76:79], a[12:15], v[84:87]
    ds_read_b64_tr_b16 a[90:91], v15 offset:1024
    v_mfma_f32_16x16x32_bf16 v[88:91], a[72:75], a[16:19], v[88:91]
    v_mfma_f32_16x16x32_bf16 v[88:91], a[76:79], a[20:23], v[88:91]
    ds_read_b64_tr_b16 a[92:93], v15 offset:8192
    v_mfma_f32_16x16x32_bf16 v[92:95], a[72:75], a[24:27], v[92:95]
    v_mfma_f32_16x16x32_bf16 v[92:95], a[76:79], a[28:31], v[92:95]
    s_waitcnt lgkmcnt(5)
    ds_read_b64_tr_b16 a[94:95], v15 offset:9216
    v_mfma_f32_16x16x32_bf16 v[96:99], a[80:83], a[0:3], v[96:99]
    s_waitcnt lgkmcnt(4)
    v_mfma_f32_16x16x32_bf16 v[96:99], a[84:87], a[4:7], v[96:99]
    ds_read_b64_tr_b16 a[64:65], v16 offset:16384
    v_mfma_f32_16x16x32_bf16 v[100:103], a[80:83], a[8:11], v[100:103]
    buffer_load_dwordx4 v30, s[72:75], s79 offen offset:2048 sc1 lds
    v_mfma_f32_16x16x32_bf16 v[100:103], a[84:87], a[12:15], v[100:103]
    ds_read_b64_tr_b16 a[66:67], v16 offset:16896
    v_mfma_f32_16x16x32_bf16 v[104:107], a[80:83], a[16:19], v[104:107]
    v_mfma_f32_16x16x32_bf16 v[104:107], a[84:87], a[20:23], v[104:107]
    ds_read_b64_tr_b16 a[68:69], v16 offset:24576
    v_mfma_f32_16x16x32_bf16 v[108:111], a[80:83], a[24:27], v[108:111]
    v_mfma_f32_16x16x32_bf16 v[108:111], a[84:87], a[28:31], v[108:111]
    s_waitcnt lgkmcnt(5)
    ds_read_b64_tr_b16 a[70:71], v16 offset:25088
    v_mfma_f32_16x16x32_bf16 v[112:115], a[88:91], a[0:3], v[112:115]
    s_waitcnt lgkmcnt(4)
    v_mfma_f32_16x16x32_bf16 v[112:115], a[92:95], a[4:7], v[112:115]
    ds_read_b64_tr_b16 a[72:73], v16 offset:18432
    v_mfma_f32_16x16x32_bf16 v[116:119], a[88:91], a[8:11], v[116:119]
    buffer_load_dwordx4 v31, s[72:75], s79 offen offset:3072 sc1 lds
    v_mfma_f32_16x16x32_bf16 v[116:119], a[92:95], a[12:15], v[116:119]
    s_add_u32 s78, s78, s82
    ds_read_b64_tr_b16 a[74:75], v16 offset:18944
    v_mfma_f32_16x16x32_bf16 v[120:123], a[88:91], a[16:19], v[120:123]
    s_add_u32 s79, s79, s82
    v_mfma_f32_16x16x32_bf16 v[120:123], a[92:95], a[20:23], v[120:123]
    ds_read_b64_tr_b16 a[76:77], v16 offset:26624
    v_mfma_f32_16x16x32_bf16 v[124:127], a[88:91], a[24:27], v[124:127]
    v_mfma_f32_16x16x32_bf16 v[124:127], a[92:95], a[28:31], v[124:127]
    s_waitcnt lgkmcnt(5)
    ds_read_b64_tr_b16 a[78:79], v16 offset:27136
    v_mfma_f32_16x16x32_bf16 v[128:131], a[64:67], a[0:3], v[128:131]
    s_waitcnt lgkmcnt(4)
    v_mfma_f32_16x16x32_bf16 v[128:131], a[68:71], a[4:7], v[128:131]
    s_mov_b32 m0, s83
    ds_read_b64_tr_b16 a[80:81], v17 offset:16384
    v_mfma_f32_16x16x32_bf16 v[132:135], a[64:67], a[8:11], v[132:135]
    buffer_load_dwordx4 v20, s[60:63], s76 offen offset:0 lds
    v_mfma_f32_16x16x32_bf16 v[132:135], a[68:71], a[12:15], v[132:135]
    s_add_u32 s3, s36, 0
    ds_read_b64_tr_b16 a[82:83], v17 offset:16896
    v_mfma_f32_16x16x32_bf16 v[136:139], a[64:67], a[16:19], v[136:139]
    s_waitcnt vmcnt(18)
    buffer_load_dword v50, v48, s[24:27], s3 offen
    v_mfma_f32_16x16x32_bf16 v[136:139], a[68:71], a[20:23], v[136:139]
    ds_read_b64_tr_b16 a[84:85], v17 offset:24576
    v_mfma_f32_16x16x32_bf16 v[140:143], a[64:67], a[24:27], v[140:143]
    ds_read_b128 a[32:35], v4 offset:32768
    v_mfma_f32_16x16x32_bf16 v[140:143], a[68:71], a[28:31], v[140:143]
    s_waitcnt lgkmcnt(6)
    ds_read_b64_tr_b16 a[86:87], v17 offset:25088
    v_mfma_f32_16x16x32_bf16 v[144:147], a[72:75], a[0:3], v[144:147]
    s_waitcnt lgkmcnt(5)
    ds_read_b128 a[36:39], v5 offset:32768
    v_mfma_f32_16x16x32_bf16 v[144:147], a[76:79], a[4:7], v[144:147]
    ds_read_b64_tr_b16 a[88:89], v17 offset:18432
    v_mfma_f32_16x16x32_bf16 v[148:151], a[72:75], a[8:11], v[148:151]
    buffer_load_dwordx4 v21, s[60:63], s76 offen offset:1024 lds
    v_mfma_f32_16x16x32_bf16 v[148:151], a[76:79], a[12:15], v[148:151]
    ds_read_b64_tr_b16 a[90:91], v17 offset:18944
    v_mfma_f32_16x16x32_bf16 v[152:155], a[72:75], a[16:19], v[152:155]
    ds_read_b128 a[40:43], v4 offset:34816
    v_mfma_f32_16x16x32_bf16 v[152:155], a[76:79], a[20:23], v[152:155]
    ds_read_b64_tr_b16 a[92:93], v17 offset:26624
    v_mfma_f32_16x16x32_bf16 v[156:159], a[72:75], a[24:27], v[156:159]
    ds_read_b128 a[44:47], v5 offset:34816
    v_mfma_f32_16x16x32_bf16 v[156:159], a[76:79], a[28:31], v[156:159]
    s_waitcnt lgkmcnt(9)
    ds_read_b64_tr_b16 a[94:95], v17 offset:27136
    v_mfma_f32_16x16x32_bf16 v[160:163], a[80:83], a[0:3], v[160:163]
    s_waitcnt lgkmcnt(7)
    ds_read_b128 a[48:51], v4 offset:36864
    v_mfma_f32_16x16x32_bf16 v[160:163], a[84:87], a[4:7], v[160:163]
    ds_read_b64_tr_b16 a[64:65], v18 offset:16384
    v_mfma_f32_16x16x32_bf16 v[164:167], a[80:83], a[8:11], v[164:167]
    buffer_load_dwordx4 v22, s[60:63], s76 offen offset:2048 lds
    v_mfma_f32_16x16x32_bf16 v[164:167], a[84:87], a[12:15], v[164:167]
    ds_read_b64_tr_b16 a[66:67], v18 offset:16896
    v_mfma_f32_16x16x32_bf16 v[168:171], a[80:83], a[16:19], v[168:171]
    ds_read_b128 a[52:55], v5 offset:36864
    v_mfma_f32_16x16x32_bf16 v[168:171], a[84:87], a[20:23], v[168:171]
    ds_read_b64_tr_b16 a[68:69], v18 offset:24576
    v_mfma_f32_16x16x32_bf16 v[172:175], a[80:83], a[24:27], v[172:175]
    ds_read_b128 a[56:59], v4 offset:38912
    v_mfma_f32_16x16x32_bf16 v[172:175], a[84:87], a[28:31], v[172:175]
    s_waitcnt lgkmcnt(10)
    ds_read_b64_tr_b16 a[70:71], v18 offset:25088
    v_mfma_f32_16x16x32_bf16 v[176:179], a[88:91], a[0:3], v[176:179]
    s_waitcnt lgkmcnt(7)
    ds_read_b128 a[60:63], v5 offset:38912
    v_mfma_f32_16x16x32_bf16 v[176:179], a[92:95], a[4:7], v[176:179]
    ds_read_b64_tr_b16 a[72:73], v18 offset:18432
    v_mfma_f32_16x16x32_bf16 v[180:183], a[88:91], a[8:11], v[180:183]
    buffer_load_dwordx4 v23, s[60:63], s76 offen offset:3072 lds
    v_mfma_f32_16x16x32_bf16 v[180:183], a[92:95], a[12:15], v[180:183]
    s_add_u32 s76, s76, s80
    s_add_u32 s3, s36, 10240
    ds_read_b64_tr_b16 a[74:75], v18 offset:18944
    v_mfma_f32_16x16x32_bf16 v[184:187], a[88:91], a[16:19], v[184:187]
    buffer_load_dword v51, v48, s[24:27], s3 offen
    v_mfma_f32_16x16x32_bf16 v[184:187], a[92:95], a[20:23], v[184:187]
    ds_read_b64_tr_b16 a[76:77], v18 offset:26624
    v_mfma_f32_16x16x32_bf16 v[188:191], a[88:91], a[24:27], v[188:191]
    v_mfma_f32_16x16x32_bf16 v[188:191], a[92:95], a[28:31], v[188:191]
    s_waitcnt lgkmcnt(8)
    ds_read_b64_tr_b16 a[78:79], v18 offset:27136
    v_mfma_f32_16x16x32_bf16 v[192:195], a[64:67], a[0:3], v[192:195]
    s_waitcnt lgkmcnt(5)
    v_mfma_f32_16x16x32_bf16 v[192:195], a[68:71], a[4:7], v[192:195]
    ds_read_b64_tr_b16 a[80:81], v19 offset:16384
    v_mfma_f32_16x16x32_bf16 v[196:199], a[64:67], a[8:11], v[196:199]
    s_sub_u32 s87, s84, s85
    ds_read_b64_tr_b16 a[88:89], v19 offset:18432
    v_mfma_f32_16x16x32_bf16 v[196:199], a[68:71], a[12:15], v[196:199]
    ds_read_b64_tr_b16 a[82:83], v19 offset:16896
    v_mfma_f32_16x16x32_bf16 v[200:203], a[64:67], a[16:19], v[200:203]
    ds_read_b64_tr_b16 a[90:91], v19 offset:18944
    v_add_u32 v8, s87, v8
    v_mfma_f32_16x16x32_bf16 v[200:203], a[68:71], a[20:23], v[200:203]
    ds_read_b64_tr_b16 a[84:85], v19 offset:24576
    v_add_u32 v9, s87, v9
    v_mfma_f32_16x16x32_bf16 v[204:207], a[64:67], a[24:27], v[204:207]
    ds_read_b64_tr_b16 a[92:93], v19 offset:26624
    v_add_u32 v10, s87, v10
    v_mfma_f32_16x16x32_bf16 v[204:207], a[68:71], a[28:31], v[204:207]
    s_waitcnt lgkmcnt(8)
    ds_read_b64_tr_b16 a[86:87], v19 offset:25088
    v_add_u32 v11, s87, v11
    v_mfma_f32_16x16x32_bf16 v[208:211], a[72:75], a[0:3], v[208:211]
    s_waitcnt lgkmcnt(7)
    s_add_u32 m0, s83, 16384
    ds_read_b64_tr_b16 a[94:95], v19 offset:27136
    v_add_u32 v12, s87, v12
    v_mfma_f32_16x16x32_bf16 v[208:211], a[76:79], a[4:7], v[208:211]
    s_mov_b32 s58, s85
    buffer_load_dwordx4 v24, s[64:67], s77 offen offset:0 lds
    v_add_u32 v13, s87, v13
    v_mfma_f32_16x16x32_bf16 v[212:215], a[72:75], a[8:11], v[212:215]
    s_mov_b32 s85, s84
    v_add_u32 v14, s87, v14
    v_mfma_f32_16x16x32_bf16 v[212:215], a[76:79], a[12:15], v[212:215]
    s_mov_b32 s84, s83
    buffer_load_dwordx4 v25, s[64:67], s77 offen offset:1024 lds
    v_add_u32 v15, s87, v15
    v_mfma_f32_16x16x32_bf16 v[216:219], a[72:75], a[16:19], v[216:219]
    s_mov_b32 s83, s58
    v_add_u32 v16, s87, v16
    v_mfma_f32_16x16x32_bf16 v[216:219], a[76:79], a[20:23], v[216:219]
    v_add_u32 v17, s87, v17
    v_mfma_f32_16x16x32_bf16 v[220:223], a[72:75], a[24:27], v[220:223]
    v_add_u32 v18, s87, v18
    v_mfma_f32_16x16x32_bf16 v[220:223], a[76:79], a[28:31], v[220:223]
    s_waitcnt lgkmcnt(5)
    v_add_u32 v19, s87, v19
    v_mfma_f32_16x16x32_bf16 v[224:227], a[80:83], a[0:3], v[224:227]
    s_waitcnt vmcnt(16) lgkmcnt(0)
    s_barrier
    v_mfma_f32_16x16x32_bf16 v[224:227], a[84:87], a[4:7], v[224:227]
    ds_read_b64_tr_b16 a[64:65], v8 offset:0
    v_mfma_f32_16x16x32_bf16 v[228:231], a[80:83], a[8:11], v[228:231]
    buffer_load_dwordx4 v26, s[68:71], s77 offen offset:2048 lds
    v_mfma_f32_16x16x32_bf16 v[228:231], a[84:87], a[12:15], v[228:231]
    s_add_u32 s3, s36, 20480
    ds_read_b64_tr_b16 a[66:67], v8 offset:1024
    v_mfma_f32_16x16x32_bf16 v[232:235], a[80:83], a[16:19], v[232:235]
    buffer_load_dword v52, v48, s[24:27], s3 offen
    v_mfma_f32_16x16x32_bf16 v[232:235], a[84:87], a[20:23], v[232:235]
    ds_read_b64_tr_b16 a[68:69], v8 offset:8192
    v_mfma_f32_16x16x32_bf16 v[236:239], a[80:83], a[24:27], v[236:239]
    v_mfma_f32_16x16x32_bf16 v[236:239], a[84:87], a[28:31], v[236:239]
    ds_read_b64_tr_b16 a[70:71], v8 offset:9216
    v_mfma_f32_16x16x32_bf16 v[240:243], a[88:91], a[0:3], v[240:243]
    ds_read_b64_tr_b16 a[72:73], v9 offset:0
    v_mfma_f32_16x16x32_bf16 v[240:243], a[92:95], a[4:7], v[240:243]
    v_mfma_f32_16x16x32_bf16 v[244:247], a[88:91], a[8:11], v[244:247]
    ds_read_b64_tr_b16 a[74:75], v9 offset:1024
    v_mfma_f32_16x16x32_bf16 v[244:247], a[92:95], a[12:15], v[244:247]
    buffer_load_dwordx4 v27, s[68:71], s77 offen offset:3072 lds
    v_mfma_f32_16x16x32_bf16 v[248:251], a[88:91], a[16:19], v[248:251]
    s_add_u32 s77, s77, s81
    ds_read_b64_tr_b16 a[76:77], v9 offset:8192
    v_mfma_f32_16x16x32_bf16 v[248:251], a[92:95], a[20:23], v[248:251]
    v_mfma_f32_16x16x32_bf16 v[252:255], a[88:91], a[24:27], v[252:255]
    ds_read_b64_tr_b16 a[78:79], v9 offset:9216
    v_mfma_f32_16x16x32_bf16 v[252:255], a[92:95], a[28:31], v[252:255]
    s_waitcnt lgkmcnt(6)
    v_mfma_f32_16x16x32_bf16 a[128:131], a[64:67], a[32:35], a[128:131]
    s_waitcnt lgkmcnt(4)
    v_mfma_f32_16x16x32_bf16 a[128:131], a[68:71], a[36:39], a[128:131]
    s_add_u32 m0, s86, 32768
    ds_read_b64_tr_b16 a[80:81], v10 offset:0
    v_mfma_f32_16x16x32_bf16 a[132:135], a[64:67], a[40:43], a[132:135]
    buffer_load_dwordx4 v28, s[72:75], s78 offen offset:0 sc1 lds
    v_mfma_f32_16x16x32_bf16 a[132:135], a[68:71], a[44:47], a[132:135]
    ds_read_b64_tr_b16 a[82:83], v10 offset:1024
    v_mfma_f32_16x16x32_bf16 a[136:139], a[64:67], a[48:51], a[136:139]
    v_mov_b32 v63, -1
    v_mfma_f32_16x16x32_bf16 a[136:139], a[68:71], a[52:55], a[136:139]
    ds_read_b64_tr_b16 a[84:85], v10 offset:8192
    v_mfma_f32_16x16x32_bf16 a[140:143], a[64:67], a[56:59], a[140:143]
    v_mfma_f32_16x16x32_bf16 a[140:143], a[68:71], a[60:63], a[140:143]
    s_waitcnt lgkmcnt(5)
    ds_read_b64_tr_b16 a[86:87], v10 offset:9216
    v_mfma_f32_16x16x32_bf16 a[144:147], a[72:75], a[32:35], a[144:147]
    s_waitcnt lgkmcnt(4)
    v_mfma_f32_16x16x32_bf16 a[144:147], a[76:79], a[36:39], a[144:147]
    ds_read_b64_tr_b16 a[88:89], v11 offset:0
    v_mfma_f32_16x16x32_bf16 a[148:151], a[72:75], a[40:43], a[148:151]
    buffer_load_dwordx4 v29, s[72:75], s78 offen offset:1024 sc1 lds
    v_mfma_f32_16x16x32_bf16 a[148:151], a[76:79], a[44:47], a[148:151]
    s_add_u32 s3, s36, 30720
    ds_read_b64_tr_b16 a[90:91], v11 offset:1024
    v_mfma_f32_16x16x32_bf16 a[152:155], a[72:75], a[48:51], a[152:155]
    buffer_load_dword v53, v48, s[24:27], s3 offen
    v_mfma_f32_16x16x32_bf16 a[152:155], a[76:79], a[52:55], a[152:155]
    ds_read_b64_tr_b16 a[92:93], v11 offset:8192
    v_mfma_f32_16x16x32_bf16 a[156:159], a[72:75], a[56:59], a[156:159]
    v_mfma_f32_16x16x32_bf16 a[156:159], a[76:79], a[60:63], a[156:159]
    s_waitcnt lgkmcnt(5)
    ds_read_b64_tr_b16 a[94:95], v11 offset:9216
    v_mfma_f32_16x16x32_bf16 a[160:163], a[80:83], a[32:35], a[160:163]
    s_waitcnt lgkmcnt(4)
    v_mfma_f32_16x16x32_bf16 a[160:163], a[84:87], a[36:39], a[160:163]
    ds_read_b64_tr_b16 a[64:65], v12 offset:0
    v_mfma_f32_16x16x32_bf16 a[164:167], a[80:83], a[40:43], a[164:167]
    buffer_load_dwordx4 v30, s[72:75], s78 offen offset:2048 sc1 lds
    v_mfma_f32_16x16x32_bf16 a[164:167], a[84:87], a[44:47], a[164:167]
    ds_read_b64_tr_b16 a[66:67], v12 offset:1024
    v_mfma_f32_16x16x32_bf16 a[168:171], a[80:83], a[48:51], a[168:171]
    s_waitcnt vmcnt(30)
    buffer_store_dword v63, off, s[44:47], s100 offset:0 sc1
    v_mfma_f32_16x16x32_bf16 a[168:171], a[84:87], a[52:55], a[168:171]
    ds_read_b64_tr_b16 a[68:69], v12 offset:8192
    v_mfma_f32_16x16x32_bf16 a[172:175], a[80:83], a[56:59], a[172:175]
    v_mfma_f32_16x16x32_bf16 a[172:175], a[84:87], a[60:63], a[172:175]
    s_waitcnt lgkmcnt(5)
    ds_read_b64_tr_b16 a[70:71], v12 offset:9216
    v_mfma_f32_16x16x32_bf16 a[176:179], a[88:91], a[32:35], a[176:179]
    s_waitcnt lgkmcnt(4)
    v_mfma_f32_16x16x32_bf16 a[176:179], a[92:95], a[36:39], a[176:179]
    ds_read_b64_tr_b16 a[72:73], v13 offset:0
    v_mfma_f32_16x16x32_bf16 a[180:183], a[88:91], a[40:43], a[180:183]
    buffer_load_dwordx4 v31, s[72:75], s78 offen offset:3072 sc1 lds
    v_mfma_f32_16x16x32_bf16 a[180:183], a[92:95], a[44:47], a[180:183]
    ds_read_b64_tr_b16 a[74:75], v13 offset:1024
    v_mfma_f32_16x16x32_bf16 a[184:187], a[88:91], a[48:51], a[184:187]
    v_mfma_f32_16x16x32_bf16 a[184:187], a[92:95], a[52:55], a[184:187]
    ds_read_b64_tr_b16 a[76:77], v13 offset:8192
    v_mfma_f32_16x16x32_bf16 a[188:191], a[88:91], a[56:59], a[188:191]
    v_mfma_f32_16x16x32_bf16 a[188:191], a[92:95], a[60:63], a[188:191]
    s_waitcnt lgkmcnt(5)
    ds_read_b64_tr_b16 a[78:79], v13 offset:9216
    v_mfma_f32_16x16x32_bf16 v[64:67], a[64:67], a[32:35], v[64:67]
    s_waitcnt lgkmcnt(4)
    v_mfma_f32_16x16x32_bf16 v[64:67], a[68:71], a[36:39], v[64:67]
    s_add_u32 m0, s86, 36864
    ds_read_b64_tr_b16 a[80:81], v14 offset:0
    v_mfma_f32_16x16x32_bf16 v[68:71], a[64:67], a[40:43], v[68:71]
    buffer_load_dwordx4 v28, s[72:75], s79 offen offset:0 sc1 lds
    v_mfma_f32_16x16x32_bf16 v[68:71], a[68:71], a[44:47], v[68:71]
    ds_read_b64_tr_b16 a[82:83], v14 offset:1024
    v_mfma_f32_16x16x32_bf16 v[72:75], a[64:67], a[48:51], v[72:75]
    v_mfma_f32_16x16x32_bf16 v[72:75], a[68:71], a[52:55], v[72:75]
    ds_read_b64_tr_b16 a[84:85], v14 offset:8192
    v_mfma_f32_16x16x32_bf16 v[76:79], a[64:67], a[56:59], v[76:79]
    v_mfma_f32_16x16x32_bf16 v[76:79], a[68:71], a[60:63], v[76:79]
    s_waitcnt lgkmcnt(5)
    ds_read_b64_tr_b16 a[86:87], v14 offset:9216
    v_mfma_f32_16x16x32_bf16 v[80:83], a[72:75], a[32:35], v[80:83]
    s_waitcnt lgkmcnt(4)
    v_mfma_f32_16x16x32_bf16 v[80:83], a[76:79], a[36:39], v[80:83]
    ds_read_b64_tr_b16 a[88:89], v15 offset:0
    v_mfma_f32_16x16x32_bf16 v[84:87], a[72:75], a[40:43], v[84:87]
    buffer_load_dwordx4 v29, s[72:75], s79 offen offset:1024 sc1 lds
    v_mfma_f32_16x16x32_bf16 v[84:87], a[76:79], a[44:47], v[84:87]
    ds_read_b64_tr_b16 a[90:91], v15 offset:1024
    v_mfma_f32_16x16x32_bf16 v[88:91], a[72:75], a[48:51], v[88:91]
    v_mfma_f32_16x16x32_bf16 v[88:91], a[76:79], a[52:55], v[88:91]
    ds_read_b64_tr_b16 a[92:93], v15 offset:8192
    v_mfma_f32_16x16x32_bf16 v[92:95], a[72:75], a[56:59], v[92:95]
    v_mfma_f32_16x16x32_bf16 v[92:95], a[76:79], a[60:63], v[92:95]
    s_waitcnt lgkmcnt(5)
    ds_read_b64_tr_b16 a[94:95], v15 offset:9216
    v_mfma_f32_16x16x32_bf16 v[96:99], a[80:83], a[32:35], v[96:99]
    s_waitcnt lgkmcnt(4)
    v_mfma_f32_16x16x32_bf16 v[96:99], a[84:87], a[36:39], v[96:99]
    ds_read_b64_tr_b16 a[64:65], v16 offset:16384
    v_mfma_f32_16x16x32_bf16 v[100:103], a[80:83], a[40:43], v[100:103]
    buffer_load_dwordx4 v30, s[72:75], s79 offen offset:2048 sc1 lds
    v_mfma_f32_16x16x32_bf16 v[100:103], a[84:87], a[44:47], v[100:103]
    ds_read_b64_tr_b16 a[66:67], v16 offset:16896
    v_mfma_f32_16x16x32_bf16 v[104:107], a[80:83], a[48:51], v[104:107]
    v_mfma_f32_16x16x32_bf16 v[104:107], a[84:87], a[52:55], v[104:107]
    ds_read_b64_tr_b16 a[68:69], v16 offset:24576
    v_mfma_f32_16x16x32_bf16 v[108:111], a[80:83], a[56:59], v[108:111]
    v_mfma_f32_16x16x32_bf16 v[108:111], a[84:87], a[60:63], v[108:111]
    s_waitcnt lgkmcnt(5)
    ds_read_b64_tr_b16 a[70:71], v16 offset:25088
    v_mfma_f32_16x16x32_bf16 v[112:115], a[88:91], a[32:35], v[112:115]
    s_waitcnt lgkmcnt(4)
    v_mfma_f32_16x16x32_bf16 v[112:115], a[92:95], a[36:39], v[112:115]
    ds_read_b64_tr_b16 a[72:73], v16 offset:18432
    v_mfma_f32_16x16x32_bf16 v[116:119], a[88:91], a[40:43], v[116:119]
    buffer_load_dwordx4 v31, s[72:75], s79 offen offset:3072 sc1 lds
    v_mfma_f32_16x16x32_bf16 v[116:119], a[92:95], a[44:47], v[116:119]
    s_add_u32 s78, s78, s82
    ds_read_b64_tr_b16 a[74:75], v16 offset:18944
    v_mfma_f32_16x16x32_bf16 v[120:123], a[88:91], a[48:51], v[120:123]
    s_add_u32 s79, s79, s82
    v_mfma_f32_16x16x32_bf16 v[120:123], a[92:95], a[52:55], v[120:123]
    ds_read_b64_tr_b16 a[76:77], v16 offset:26624
    v_mfma_f32_16x16x32_bf16 v[124:127], a[88:91], a[56:59], v[124:127]
    v_lshrrev_b32 v6, 4, v2
    v_mul_u32_u24 v6, 1280, v6
    v_mfma_f32_16x16x32_bf16 v[124:127], a[92:95], a[60:63], v[124:127]
    s_waitcnt lgkmcnt(5)
    ds_read_b64_tr_b16 a[78:79], v16 offset:27136
    v_and_b32 v28, 0xff, v20
    v_mfma_f32_16x16x32_bf16 v[128:131], a[64:67], a[32:35], v[128:131]
    s_waitcnt lgkmcnt(4)
    s_mov_b64 s[72:73], s[24:25]
    s_mov_b32 s74, s26
    v_add_u32 v28, v28, v6
    v_and_b32 v29, 0xff, v21
    v_mfma_f32_16x16x32_bf16 v[128:131], a[68:71], a[36:39], v[128:131]
    s_mov_b32 m0, s83
    s_mov_b32 s78, s36
    ds_read_b64_tr_b16 a[80:81], v17 offset:16384
    v_add_u32 v29, v29, v6
    v_mfma_f32_16x16x32_bf16 v[132:135], a[64:67], a[40:43], v[132:135]
    s_add_u32 s79, s36, 10240
    buffer_load_dwordx4 v20, s[60:63], s76 offen offset:0 lds
    v_mfma_f32_16x16x32_bf16 v[132:135], a[68:71], a[44:47], v[132:135]
    ds_read_b64_tr_b16 a[82:83], v17 offset:16896
    v_add_u32 v29, 19456, v29
    v_mfma_f32_16x16x32_bf16 v[136:139], a[64:67], a[48:51], v[136:139]
    s_waitcnt vmcnt(22)
    v_and_b32 v30, 0xff, v22
    v_add_u32 v30, v30, v6
    v_mfma_f32_16x16x32_bf16 v[136:139], a[68:71], a[52:55], v[136:139]
    ds_read_b64_tr_b16 a[84:85], v17 offset:24576
    v_add_u32 v30, 3072, v30
    v_mfma_f32_16x16x32_bf16 v[140:143], a[64:67], a[56:59], v[140:143]
    ds_read_b128 a[0:3], v4 offset:0
    v_and_b32 v31, 0xff, v23
    v_mfma_f32_16x16x32_bf16 v[140:143], a[68:71], a[60:63], v[140:143]
    s_waitcnt lgkmcnt(6)
    ds_read_b64_tr_b16 a[86:87], v17 offset:25088
    v_add_u32 v31, v31, v6
    v_mfma_f32_16x16x32_bf16 v[144:147], a[72:75], a[32:35], v[144:147]
    s_waitcnt lgkmcnt(5)
    ds_read_b128 a[4:7], v5 offset:0
    v_add_u32 v31, 22528, v31
    v_mfma_f32_16x16x32_bf16 v[144:147], a[76:79], a[36:39], v[144:147]
    ds_read_b64_tr_b16 a[88:89], v17 offset:18432
    v_mfma_f32_16x16x32_bf16 v[148:151], a[72:75], a[40:43], v[148:151]
    buffer_load_dwordx4 v21, s[60:63], s76 offen offset:1024 lds
    v_mfma_f32_16x16x32_bf16 v[148:151], a[76:79], a[44:47], v[148:151]
    ds_read_b64_tr_b16 a[90:91], v17 offset:18944
    v_mfma_f32_16x16x32_bf16 v[152:155], a[72:75], a[48:51], v[152:155]
    ds_read_b128 a[8:11], v4 offset:2048
    v_mfma_f32_16x16x32_bf16 v[152:155], a[76:79], a[52:55], v[152:155]
    ds_read_b64_tr_b16 a[92:93], v17 offset:26624
    v_mfma_f32_16x16x32_bf16 v[156:159], a[72:75], a[56:59], v[156:159]
    ds_read_b128 a[12:15], v5 offset:2048
    v_mfma_f32_16x16x32_bf16 v[156:159], a[76:79], a[60:63], v[156:159]
    s_waitcnt lgkmcnt(9)
    ds_read_b64_tr_b16 a[94:95], v17 offset:27136
    v_mfma_f32_16x16x32_bf16 v[160:163], a[80:83], a[32:35], v[160:163]
    s_waitcnt lgkmcnt(7)
    ds_read_b128 a[16:19], v4 offset:4096
    v_mfma_f32_16x16x32_bf16 v[160:163], a[84:87], a[36:39], v[160:163]
    ds_read_b64_tr_b16 a[64:65], v18 offset:16384
    v_mfma_f32_16x16x32_bf16 v[164:167], a[80:83], a[40:43], v[164:167]
    buffer_load_dwordx4 v22, s[60:63], s76 offen offset:2048 lds
    v_mfma_f32_16x16x32_bf16 v[164:167], a[84:87], a[44:47], v[164:167]
    ds_read_b64_tr_b16 a[66:67], v18 offset:16896
    v_mfma_f32_16x16x32_bf16 v[168:171], a[80:83], a[48:51], v[168:171]
    ds_read_b128 a[20:23], v5 offset:4096
    v_mfma_f32_16x16x32_bf16 v[168:171], a[84:87], a[52:55], v[168:171]
    ds_read_b64_tr_b16 a[68:69], v18 offset:24576
    v_mfma_f32_16x16x32_bf16 v[172:175], a[80:83], a[56:59], v[172:175]
    ds_read_b128 a[24:27], v4 offset:6144
    v_mfma_f32_16x16x32_bf16 v[172:175], a[84:87], a[60:63], v[172:175]
    s_waitcnt lgkmcnt(10)
    ds_read_b64_tr_b16 a[70:71], v18 offset:25088
    v_mfma_f32_16x16x32_bf16 v[176:179], a[88:91], a[32:35], v[176:179]
    s_waitcnt lgkmcnt(7)
    ds_read_b128 a[28:31], v5 offset:6144
    v_mfma_f32_16x16x32_bf16 v[176:179], a[92:95], a[36:39], v[176:179]
    ds_read_b64_tr_b16 a[72:73], v18 offset:18432
    v_mfma_f32_16x16x32_bf16 v[180:183], a[88:91], a[40:43], v[180:183]
    buffer_load_dwordx4 v23, s[60:63], s76 offen offset:3072 lds
    v_mfma_f32_16x16x32_bf16 v[180:183], a[92:95], a[44:47], v[180:183]
    s_add_u32 s76, s76, s80
    ds_read_b64_tr_b16 a[74:75], v18 offset:18944
    v_mfma_f32_16x16x32_bf16 v[184:187], a[88:91], a[48:51], v[184:187]
    v_mfma_f32_16x16x32_bf16 v[184:187], a[92:95], a[52:55], v[184:187]
    ds_read_b64_tr_b16 a[76:77], v18 offset:26624
    v_mfma_f32_16x16x32_bf16 v[188:191], a[88:91], a[56:59], v[188:191]
    v_mfma_f32_16x16x32_bf16 v[188:191], a[92:95], a[60:63], v[188:191]
    s_waitcnt lgkmcnt(8)
    ds_read_b64_tr_b16 a[78:79], v18 offset:27136
    v_mfma_f32_16x16x32_bf16 v[192:195], a[64:67], a[32:35], v[192:195]
    s_waitcnt lgkmcnt(5)
    v_mfma_f32_16x16x32_bf16 v[192:195], a[68:71], a[36:39], v[192:195]
    ds_read_b64_tr_b16 a[80:81], v19 offset:16384
    v_mfma_f32_16x16x32_bf16 v[196:199], a[64:67], a[40:43], v[196:199]
    s_sub_u32 s87, s84, s85
    ds_read_b64_tr_b16 a[88:89], v19 offset:18432
    v_mfma_f32_16x16x32_bf16 v[196:199], a[68:71], a[44:47], v[196:199]
    ds_read_b64_tr_b16 a[82:83], v19 offset:16896
    v_mfma_f32_16x16x32_bf16 v[200:203], a[64:67], a[48:51], v[200:203]
    ds_read_b64_tr_b16 a[90:91], v19 offset:18944
    v_add_u32 v8, s87, v8
    v_mfma_f32_16x16x32_bf16 v[200:203], a[68:71], a[52:55], v[200:203]
    ds_read_b64_tr_b16 a[84:85], v19 offset:24576
    v_add_u32 v9, s87, v9
    v_mfma_f32_16x16x32_bf16 v[204:207], a[64:67], a[56:59], v[204:207]
    ds_read_b64_tr_b16 a[92:93], v19 offset:26624
    v_add_u32 v10, s87, v10
    v_mfma_f32_16x16x32_bf16 v[204:207], a[68:71], a[60:63], v[204:207]
    s_waitcnt lgkmcnt(8)
    ds_read_b64_tr_b16 a[86:87], v19 offset:25088
    v_add_u32 v11, s87, v11
    v_mfma_f32_16x16x32_bf16 v[208:211], a[72:75], a[32:35], v[208:211]
    s_waitcnt lgkmcnt(7)
    s_add_u32 m0, s83, 16384
    ds_read_b64_tr_b16 a[94:95], v19 offset:27136
    v_add_u32 v12, s87, v12
    v_mfma_f32_16x16x32_bf16 v[208:211], a[76:79], a[36:39], v[208:211]
    s_mov_b32 s58, s85
    buffer_load_dwordx4 v24, s[64:67], s77 offen offset:0 lds
    v_add_u32 v13, s87, v13
    v_mfma_f32_16x16x32_bf16 v[212:215], a[72:75], a[40:43], v[212:215]
    s_mov_b32 s85, s84
    v_add_u32 v14, s87, v14
    v_mfma_f32_16x16x32_bf16 v[212:215], a[76:79], a[44:47], v[212:215]
    s_mov_b32 s84, s83
    buffer_load_dwordx4 v25, s[64:67], s77 offen offset:1024 lds
    v_add_u32 v15, s87, v15
    v_mfma_f32_16x16x32_bf16 v[216:219], a[72:75], a[48:51], v[216:219]
    s_mov_b32 s83, s58
    v_add_u32 v16, s87, v16
    v_mfma_f32_16x16x32_bf16 v[216:219], a[76:79], a[52:55], v[216:219]
    v_add_u32 v17, s87, v17
    v_mfma_f32_16x16x32_bf16 v[220:223], a[72:75], a[56:59], v[220:223]
    v_add_u32 v18, s87, v18
    v_mfma_f32_16x16x32_bf16 v[220:223], a[76:79], a[60:63], v[220:223]
    s_waitcnt lgkmcnt(5)
    v_add_u32 v19, s87, v19
    v_mfma_f32_16x16x32_bf16 v[224:227], a[80:83], a[32:35], v[224:227]
    s_waitcnt vmcnt(16) lgkmcnt(0)
    s_barrier
    v_mfma_f32_16x16x32_bf16 v[224:227], a[84:87], a[36:39], v[224:227]
    ds_read_b64_tr_b16 a[64:65], v8 offset:0
    v_mfma_f32_16x16x32_bf16 v[228:231], a[80:83], a[40:43], v[228:231]
    buffer_load_dwordx4 v26, s[68:71], s77 offen offset:2048 lds
    v_mfma_f32_16x16x32_bf16 v[228:231], a[84:87], a[44:47], v[228:231]
    ds_read_b64_tr_b16 a[66:67], v8 offset:1024
    v_mfma_f32_16x16x32_bf16 v[232:235], a[80:83], a[48:51], v[232:235]
    v_mfma_f32_16x16x32_bf16 v[232:235], a[84:87], a[52:55], v[232:235]
    ds_read_b64_tr_b16 a[68:69], v8 offset:8192
    v_mfma_f32_16x16x32_bf16 v[236:239], a[80:83], a[56:59], v[236:239]
    v_mfma_f32_16x16x32_bf16 v[236:239], a[84:87], a[60:63], v[236:239]
    ds_read_b64_tr_b16 a[70:71], v8 offset:9216
    v_mfma_f32_16x16x32_bf16 v[240:243], a[88:91], a[32:35], v[240:243]
    ds_read_b64_tr_b16 a[72:73], v9 offset:0
    v_mfma_f32_16x16x32_bf16 v[240:243], a[92:95], a[36:39], v[240:243]
    v_mfma_f32_16x16x32_bf16 v[244:247], a[88:91], a[40:43], v[244:247]
    ds_read_b64_tr_b16 a[74:75], v9 offset:1024
    v_mfma_f32_16x16x32_bf16 v[244:247], a[92:95], a[44:47], v[244:247]
    buffer_load_dwordx4 v27, s[68:71], s77 offen offset:3072 lds
    v_mfma_f32_16x16x32_bf16 v[248:251], a[88:91], a[48:51], v[248:251]
    s_add_u32 s77, s77, s81
    ds_read_b64_tr_b16 a[76:77], v9 offset:8192
    v_mfma_f32_16x16x32_bf16 v[248:251], a[92:95], a[52:55], v[248:251]
    v_mfma_f32_16x16x32_bf16 v[252:255], a[88:91], a[56:59], v[252:255]
    ds_read_b64_tr_b16 a[78:79], v9 offset:9216
    v_mfma_f32_16x16x32_bf16 v[252:255], a[92:95], a[60:63], v[252:255]
    s_waitcnt lgkmcnt(6)
    v_mfma_f32_16x16x32_bf16 a[128:131], a[64:67], a[0:3], a[128:131]
    s_waitcnt lgkmcnt(4)
    v_mfma_f32_16x16x32_bf16 a[128:131], a[68:71], a[4:7], a[128:131]
    s_add_u32 m0, s86, 0
    ds_read_b64_tr_b16 a[80:81], v10 offset:0
    v_mfma_f32_16x16x32_bf16 a[132:135], a[64:67], a[8:11], a[132:135]
    buffer_load_dwordx4 v28, s[72:75], s78 offen offset:0 sc1 lds
    v_mfma_f32_16x16x32_bf16 a[132:135], a[68:71], a[12:15], a[132:135]
    s_mov_b64 s[60:61], s[44:45]
    ds_read_b64_tr_b16 a[82:83], v10 offset:1024
    v_mfma_f32_16x16x32_bf16 a[136:139], a[64:67], a[16:19], a[136:139]
    buffer_load_dwordx4 v29, s[72:75], s78 offen offset:1024 sc1 lds
    v_mfma_f32_16x16x32_bf16 a[136:139], a[68:71], a[20:23], a[136:139]
    s_cmp_lt_u32 s101, 910
    s_cselect_b32 s62, 268435456, 0
    ds_read_b64_tr_b16 a[84:85], v10 offset:8192
    v_mfma_f32_16x16x32_bf16 a[140:143], a[64:67], a[24:27], a[140:143]
    s_lshl_b32 s98, s101, 13
    s_add_u32 s98, s98, 62914560
    s_add_u32 s99, s98, 4096
    v_mfma_f32_16x16x32_bf16 a[140:143], a[68:71], a[28:31], a[140:143]
    s_waitcnt lgkmcnt(5)
    s_lshr_b32 s12, s53, 3
    ds_read_b64_tr_b16 a[86:87], v10 offset:9216
    v_mfma_f32_16x16x32_bf16 a[144:147], a[72:75], a[0:3], a[144:147]
    s_waitcnt lgkmcnt(4)
    buffer_load_dwordx4 v30, s[72:75], s78 offen offset:2048 sc1 lds
    v_mfma_f32_16x16x32_bf16 a[144:147], a[76:79], a[4:7], a[144:147]
    s_and_b32 s14, s53, 3
    s_sub_u32 s13, 15, s54
    ds_read_b64_tr_b16 a[88:89], v11 offset:0
    v_mfma_f32_16x16x32_bf16 a[148:151], a[72:75], a[8:11], a[148:151]
    buffer_load_dwordx4 v31, s[72:75], s78 offen offset:3072 sc1 lds
    v_mfma_f32_16x16x32_bf16 a[148:151], a[76:79], a[12:15], a[148:151]
    s_add_u32 m0, s86, 4096
    ds_read_b64_tr_b16 a[90:91], v11 offset:1024
    v_mfma_f32_16x16x32_bf16 a[152:155], a[72:75], a[16:19], a[152:155]
    s_branch L_pado9
L_pad9:
    s_branch L_tour_ret2
L_pado9:
    buffer_load_dwordx4 v28, s[72:75], s79 offen offset:0 sc1 lds
    v_mfma_f32_16x16x32_bf16 a[152:155], a[76:79], a[20:23], a[152:155]
    s_bitcmp1_b32 s53, 2
    s_cselect_b32 s13, s13, s54
    ds_read_b64_tr_b16 a[92:93], v11 offset:8192
    v_mfma_f32_16x16x32_bf16 a[156:159], a[72:75], a[24:27], a[156:159]
    s_mul_i32 s55, s13, 1490944
    s_lshl_b32 s56, s52, 12
    s_add_u32 s55, s55, s56
    v_mfma_f32_16x16x32_bf16 a[156:159], a[76:79], a[28:31], a[156:159]
    s_waitcnt lgkmcnt(5)
    s_add_u32 s55, s55, 37748736
    ds_read_b64_tr_b16 a[94:95], v11 offset:9216
    v_mfma_f32_16x16x32_bf16 a[160:163], a[80:83], a[0:3], a[160:163]
    s_waitcnt lgkmcnt(4)
    buffer_load_dwordx4 v29, s[72:75], s79 offen offset:1024 sc1 lds
    v_mfma_f32_16x16x32_bf16 a[160:163], a[84:87], a[4:7], a[160:163]
    s_lshl_b32 s18, s53, 15
    s_add_u32 s18, s18, s55
    ds_read_b64_tr_b16 a[64:65], v12 offset:0
    v_mfma_f32_16x16x32_bf16 a[164:167], a[80:83], a[8:11], a[164:167]
    s_and_b32 s28, s53, 7
    buffer_load_dwordx4 v30, s[72:75], s79 offen offset:2048 sc1 lds
    v_mfma_f32_16x16x32_bf16 a[164:167], a[84:87], a[12:15], a[164:167]
    s_mul_i32 s15, s12, 114688
    s_add_u32 s15, s15, s55
    ds_read_b64_tr_b16 a[66:67], v12 offset:1024
    v_mfma_f32_16x16x32_bf16 a[168:171], a[80:83], a[16:19], a[168:171]
    s_add_u32 s15, s15, 1048576
    buffer_load_dwordx4 v31, s[72:75], s79 offen offset:3072 sc1 lds
    v_mfma_f32_16x16x32_bf16 a[168:171], a[84:87], a[20:23], a[168:171]
    s_add_u32 s78, s78, s82
    s_mul_i32 s55, s14, 10240
    ds_read_b64_tr_b16 a[68:69], v12 offset:8192
    v_mfma_f32_16x16x32_bf16 a[172:175], a[80:83], a[24:27], a[172:175]
    s_add_u32 s79, s79, s82
    s_lshr_b32 s57, s52, 1
    s_mul_i32 s56, s57, 40960
    v_mfma_f32_16x16x32_bf16 a[172:175], a[84:87], a[28:31], a[172:175]
    s_waitcnt lgkmcnt(5)
    s_add_u32 s55, s55, s56
    ds_read_b64_tr_b16 a[70:71], v12 offset:9216
    v_mfma_f32_16x16x32_bf16 a[176:179], a[88:91], a[0:3], a[176:179]
    s_waitcnt lgkmcnt(4)
    s_and_b32 s34, s52, 1
    s_mul_i32 s56, s34, 5120
    v_mfma_f32_16x16x32_bf16 a[176:179], a[92:95], a[4:7], a[176:179]
    s_add_u32 s55, s55, s56
    s_add_u32 s55, s55, 62914560
    ds_read_b64_tr_b16 a[72:73], v13 offset:0
    v_mfma_f32_16x16x32_bf16 a[180:183], a[88:91], a[8:11], a[180:183]
    s_mul_i32 s19, s53, 163840
    s_add_u32 s19, s19, s55
    s_mul_i32 s16, s12, 573440
    v_mfma_f32_16x16x32_bf16 a[180:183], a[92:95], a[12:15], a[180:183]
    s_add_u32 s16, s16, s55
    s_add_u32 s16, s16, 5242880
    ds_read_b64_tr_b16 a[74:75], v13 offset:1024
    v_mfma_f32_16x16x32_bf16 a[184:187], a[88:91], a[16:19], a[184:187]
    s_mov_b64 s[8:9], s[44:45]
    s_mov_b32 s10, 268435456
    s_mov_b32 s11, 0x20000
    v_mfma_f32_16x16x32_bf16 a[184:187], a[92:95], a[20:23], a[184:187]
    s_lshl_b32 s26, s52, 10
    s_add_u32 s26, s26, 131072
    ds_read_b64_tr_b16 a[76:77], v13 offset:8192
    v_mfma_f32_16x16x32_bf16 a[188:191], a[88:91], a[24:27], a[188:191]
    s_sub_u32 s3, s86, 32768
    s_lshl_b32 s55, s13, 1
    s_add_u32 s55, s55, s57
    v_mfma_f32_16x16x32_bf16 a[188:191], a[92:95], a[28:31], a[188:191]
    s_waitcnt lgkmcnt(5)
    s_lshl_b32 s55, s55, 2
    ds_read_b64_tr_b16 a[78:79], v13 offset:9216
    v_mfma_f32_16x16x32_bf16 v[64:67], a[64:67], a[0:3], v[64:67]
    s_waitcnt lgkmcnt(4)
    v_add_u32 v20, s3, v8
    v_add_u32 v21, s3, v9
    v_mfma_f32_16x16x32_bf16 v[64:67], a[68:71], a[4:7], v[64:67]
    s_add_u32 s55, s55, s12
    ds_read_b64_tr_b16 a[80:81], v14 offset:0
    v_add_u32 v22, s3, v10
    v_mfma_f32_16x16x32_bf16 v[68:71], a[64:67], a[8:11], v[68:71]
    s_mul_i32 s25, s55, 20480
    v_add_u32 v23, s3, v11
    v_add_u32 v24, s3, v12
    v_mfma_f32_16x16x32_bf16 v[68:71], a[68:71], a[12:15], v[68:71]
    s_mul_i32 s55, s14, 320
    ds_read_b64_tr_b16 a[82:83], v14 offset:1024
    v_add_u32 v25, s3, v13
    v_mfma_f32_16x16x32_bf16 v[72:75], a[64:67], a[16:19], v[72:75]
    s_add_u32 s25, s25, s55
    v_add_u32 v26, s3, v14
    v_add_u32 v27, s3, v15
    v_mfma_f32_16x16x32_bf16 v[72:75], a[68:71], a[20:23], v[72:75]
    s_mul_i32 s55, s34, 160
    s_add_u32 s25, s25, s55
    ds_read_b64_tr_b16 a[84:85], v14 offset:8192
    v_mfma_f32_16x16x32_bf16 v[76:79], a[64:67], a[24:27], v[76:79]
    s_lshl_b32 s56, s57, 3
    s_add_u32 s55, s12, 0
    s_and_b32 s55, s55, 3
    v_mfma_f32_16x16x32_bf16 v[76:79], a[68:71], a[28:31], v[76:79]
    s_waitcnt lgkmcnt(5)
    s_add_u32 s55, s55, s56
    ds_read_b64_tr_b16 a[86:87], v14 offset:9216
    v_mfma_f32_16x16x32_bf16 v[80:83], a[72:75], a[0:3], v[80:83]
    s_waitcnt lgkmcnt(4)
    s_lshl_b32 s30, s55, 10
    s_add_u32 s55, s12, 1
    v_mfma_f32_16x16x32_bf16 v[80:83], a[76:79], a[4:7], v[80:83]
    s_and_b32 s55, s55, 3
    s_add_u32 s55, s55, s56
    ds_read_b64_tr_b16 a[88:89], v15 offset:0
    v_mfma_f32_16x16x32_bf16 v[84:87], a[72:75], a[8:11], v[84:87]
    s_lshl_b32 s31, s55, 10
    s_add_u32 s55, s12, 2
    s_and_b32 s55, s55, 3
    v_mfma_f32_16x16x32_bf16 v[84:87], a[76:79], a[12:15], v[84:87]
    s_add_u32 s55, s55, s56
    s_lshl_b32 s32, s55, 10
    ds_read_b64_tr_b16 a[90:91], v15 offset:1024
    v_mfma_f32_16x16x32_bf16 v[88:91], a[72:75], a[16:19], v[88:91]
    s_add_u32 s55, s12, 3
    s_and_b32 s55, s55, 3
    s_add_u32 s55, s55, s56
    v_mfma_f32_16x16x32_bf16 v[88:91], a[76:79], a[20:23], v[88:91]
    s_lshl_b32 s33, s55, 10
    s_lshl_b32 s35, s34, 10
    ds_read_b64_tr_b16 a[92:93], v15 offset:8192
    v_mfma_f32_16x16x32_bf16 v[92:95], a[72:75], a[24:27], v[92:95]
    s_add_u32 s35, s35, 131072
    s_lshl_b32 s34, s34, 13
    s_add_u32 s34, s34, 4096
    v_mfma_f32_16x16x32_bf16 v[92:95], a[76:79], a[28:31], v[92:95]
    s_waitcnt lgkmcnt(5)
    s_lshl_b32 s55, s13, 2
    ds_read_b64_tr_b16 a[94:95], v15 offset:9216
    v_mfma_f32_16x16x32_bf16 v[96:99], a[80:83], a[0:3], v[96:99]
    s_waitcnt lgkmcnt(4)
    s_add_u32 s55, s55, s14
    s_mul_i32 s23, s55, 122880
    v_mfma_f32_16x16x32_bf16 v[96:99], a[84:87], a[4:7], v[96:99]
    s_mul_i32 s56, s52, 2560
    s_add_u32 s23, s23, s56
    ds_read_b64_tr_b16 a[64:65], v16 offset:16384
    v_mfma_f32_16x16x32_bf16 v[100:103], a[80:83], a[8:11], v[100:103]
    s_add_u32 s23, s23, 71303168
    s_lshl_b32 s27, s54, 4
    s_add_u32 s27, s27, s12
    v_mfma_f32_16x16x32_bf16 v[100:103], a[84:87], a[12:15], v[100:103]
    s_lshl_b32 s27, s27, 10
    s_lshl_b32 s55, s52, 7
    ds_read_b64_tr_b16 a[66:67], v16 offset:16896
    v_mfma_f32_16x16x32_bf16 v[104:107], a[80:83], a[16:19], v[104:107]
    s_add_u32 s27, s27, s55
    s_add_u32 s27, s27, 83886092
    s_andn2_b32 s24, s100, 0xc00
    v_mfma_f32_16x16x32_bf16 v[104:107], a[84:87], a[20:23], v[104:107]
    s_lshl_b32 s39, s52, 12
    s_add_u32 s39, s39, 147456
    ds_read_b64_tr_b16 a[68:69], v16 offset:24576
    v_mfma_f32_16x16x32_bf16 v[108:111], a[80:83], a[24:27], v[108:111]
    s_sub_u32 s55, 3, s52
    s_lshl_b32 s36, s54, 2
    s_add_u32 s36, s36, s55
    v_mfma_f32_16x16x32_bf16 v[108:111], a[84:87], a[28:31], v[108:111]
    s_waitcnt lgkmcnt(5)
    s_mul_i32 s37, s54, 1490944
    ds_read_b64_tr_b16 a[70:71], v16 offset:25088
    v_mfma_f32_16x16x32_bf16 v[112:115], a[88:91], a[0:3], v[112:115]
    s_waitcnt lgkmcnt(4)
    s_lshl_b32 s57, s53, 15
    s_add_u32 s37, s37, s57
    v_mfma_f32_16x16x32_bf16 v[112:115], a[92:95], a[4:7], v[112:115]
    s_lshl_b32 s57, s55, 11
    s_add_u32 s37, s37, s57
    ds_read_b64_tr_b16 a[72:73], v16 offset:18432
    v_mfma_f32_16x16x32_bf16 v[116:119], a[88:91], a[8:11], v[116:119]
    s_add_u32 s37, s37, 37748736
    v_mfma_f32_16x16x32_bf16 v[116:119], a[92:95], a[12:15], v[116:119]
    ds_read_b64_tr_b16 a[74:75], v16 offset:18944
    v_mfma_f32_16x16x32_bf16 v[120:123], a[88:91], a[16:19], v[120:123]
    s_and_b32 s88, s100, 0xfffe3e00
    v_mfma_f32_16x16x32_bf16 v[120:123], a[92:95], a[20:23], v[120:123]
    ds_read_b64_tr_b16 a[76:77], v16 offset:26624
    v_mfma_f32_16x16x32_bf16 v[124:127], a[88:91], a[24:27], v[124:127]
    v_mfma_f32_16x16x32_bf16 v[124:127], a[92:95], a[28:31], v[124:127]
    s_waitcnt lgkmcnt(5)
    s_waitcnt vmcnt(0)
    ds_read_b64_tr_b16 a[78:79], v16 offset:27136
    v_mfma_f32_16x16x32_bf16 v[128:131], a[64:67], a[0:3], v[128:131]
    s_waitcnt lgkmcnt(4)
    ds_read_b64_tr_b16 a[96:97], v20 offset:0
    v_mfma_f32_16x16x32_bf16 v[128:131], a[68:71], a[4:7], v[128:131]
    ds_read_b64_tr_b16 a[80:81], v17 offset:16384
    ds_read_b64_tr_b16 a[98:99], v20 offset:1024
    v_mfma_f32_16x16x32_bf16 v[132:135], a[64:67], a[8:11], v[132:135]
    ds_read_b64_tr_b16 a[100:101], v21 offset:0
    v_mfma_f32_16x16x32_bf16 v[132:135], a[68:71], a[12:15], v[132:135]
    ds_read_b64_tr_b16 a[82:83], v17 offset:16896
    ds_read_b64_tr_b16 a[102:103], v21 offset:1024
    v_mfma_f32_16x16x32_bf16 v[136:139], a[64:67], a[16:19], v[136:139]
    s_waitcnt vmcnt(16)
    ds_read_b64_tr_b16 a[104:105], v22 offset:0
    v_mfma_f32_16x16x32_bf16 v[136:139], a[68:71], a[20:23], v[136:139]
    ds_read_b64_tr_b16 a[84:85], v17 offset:24576
    ds_read_b64_tr_b16 a[106:107], v22 offset:1024
    v_mfma_f32_16x16x32_bf16 v[140:143], a[64:67], a[24:27], v[140:143]
    ds_read_b128 a[32:35], v4 offset:32768
    v_bfe_u32 v29, v2, 2, 3
    v_mfma_f32_16x16x32_bf16 v[140:143], a[68:71], a[28:31], v[140:143]
    s_waitcnt lgkmcnt(12)
    ds_read_b64_tr_b16 a[86:87], v17 offset:25088
    v_and_b32 v30, 3, v2
    v_mfma_f32_16x16x32_bf16 v[144:147], a[72:75], a[0:3], v[144:147]
    s_waitcnt lgkmcnt(11)
    ds_read_b128 a[36:39], v5 offset:32768
    v_lshl_add_u32 v29, v29, 7, v30
    v_mfma_f32_16x16x32_bf16 v[144:147], a[76:79], a[4:7], v[144:147]
    ds_read_b64_tr_b16 a[88:89], v17 offset:18432
    ds_read_b64_tr_b16 a[108:109], v23 offset:0
    v_mfma_f32_16x16x32_bf16 v[148:151], a[72:75], a[8:11], v[148:151]
    ds_read_b128 a[40:43], v4 offset:34816
    ds_read_b64_tr_b16 a[110:111], v23 offset:1024
    v_mfma_f32_16x16x32_bf16 v[148:151], a[76:79], a[12:15], v[148:151]
    ds_read_b64_tr_b16 a[90:91], v17 offset:18944
    ds_read_b64_tr_b16 a[112:113], v24 offset:0
    v_mfma_f32_16x16x32_bf16 v[152:155], a[72:75], a[16:19], v[152:155]
    ds_read_b128 a[44:47], v5 offset:34816
    ds_read_b64_tr_b16 a[114:115], v24 offset:1024
    v_mfma_f32_16x16x32_bf16 v[152:155], a[76:79], a[20:23], v[152:155]
    ds_read_b64_tr_b16 a[92:93], v17 offset:26624
    ds_read_b64_tr_b16 a[116:117], v25 offset:0
    v_mfma_f32_16x16x32_bf16 v[156:159], a[72:75], a[24:27], v[156:159]
    ds_read_b128 a[48:51], v4 offset:36864
    ds_read_b64_tr_b16 a[118:119], v25 offset:1024
    v_mfma_f32_16x16x32_bf16 v[156:159], a[76:79], a[28:31], v[156:159]
    s_waitcnt lgkmcnt(15)
    ds_read_b64_tr_b16 a[94:95], v17 offset:27136
    ds_read_b64_tr_b16 a[120:121], v26 offset:0
    v_mfma_f32_16x16x32_bf16 v[160:163], a[80:83], a[0:3], v[160:163]
    s_waitcnt lgkmcnt(15)
    ds_read_b128 a[52:55], v5 offset:36864
    v_lshl_add_u32 v29, v29, 7, s88
    v_mfma_f32_16x16x32_bf16 v[160:163], a[84:87], a[4:7], v[160:163]
    ds_read_b64_tr_b16 a[64:65], v18 offset:16384
    ds_read_b64_tr_b16 a[122:123], v26 offset:1024
    v_mfma_f32_16x16x32_bf16 v[164:167], a[80:83], a[8:11], v[164:167]
    ds_read_b128 a[56:59], v4 offset:38912
    ds_read_b64_tr_b16 a[124:125], v27 offset:0
    v_mfma_f32_16x16x32_bf16 v[164:167], a[84:87], a[12:15], v[164:167]
    ds_read_b64_tr_b16 a[66:67], v18 offset:16896
    ds_read_b64_tr_b16 a[126:127], v27 offset:1024
    v_mfma_f32_16x16x32_bf16 v[168:171], a[80:83], a[16:19], v[168:171]
    ds_read_b128 a[60:63], v5 offset:38912
    v_mfma_f32_16x16x32_bf16 v[168:171], a[84:87], a[20:23], v[168:171]
    ds_read_b64_tr_b16 a[68:69], v18 offset:24576
    v_mfma_f32_16x16x32_bf16 v[172:175], a[80:83], a[24:27], v[172:175]
    v_mfma_f32_16x16x32_bf16 v[172:175], a[84:87], a[28:31], v[172:175]
    s_waitcnt lgkmcnt(15)
    ds_read_b64_tr_b16 a[70:71], v18 offset:25088
    v_mfma_f32_16x16x32_bf16 v[176:179], a[88:91], a[0:3], v[176:179]
    s_waitcnt lgkmcnt(11)
    buffer_load_dword v28, v29, s[44:47], 0 offen offset:0 sc1
    v_mfma_f32_16x16x32_bf16 v[176:179], a[92:95], a[4:7], v[176:179]
    ds_read_b64_tr_b16 a[72:73], v18 offset:18432
    v_mfma_f32_16x16x32_bf16 v[180:183], a[88:91], a[8:11], v[180:183]
    v_mfma_f32_16x16x32_bf16 v[180:183], a[92:95], a[12:15], v[180:183]
    ds_read_b64_tr_b16 a[74:75], v18 offset:18944
    v_mfma_f32_16x16x32_bf16 v[184:187], a[88:91], a[16:19], v[184:187]
    s_waitcnt lgkmcnt(4)
    buffer_store_dwordx4 a[96:99], v1, s[60:63], s98 offen offset:0 sc1
    v_mfma_f32_16x16x32_bf16 v[184:187], a[92:95], a[20:23], v[184:187]
    ds_read_b64_tr_b16 a[76:77], v18 offset:26624
    v_mfma_f32_16x16x32_bf16 v[188:191], a[88:91], a[24:27], v[188:191]
    v_mfma_f32_16x16x32_bf16 v[188:191], a[92:95], a[28:31], v[188:191]
    ds_read_b64_tr_b16 a[78:79], v18 offset:27136
    v_mfma_f32_16x16x32_bf16 v[192:195], a[64:67], a[0:3], v[192:195]
    s_waitcnt lgkmcnt(4)
    v_mfma_f32_16x16x32_bf16 v[192:195], a[68:71], a[4:7], v[192:195]
    ds_read_b64_tr_b16 a[80:81], v19 offset:16384
    v_mfma_f32_16x16x32_bf16 v[196:199], a[64:67], a[8:11], v[196:199]
    s_sub_u32 s87, s84, s85
    ds_read_b64_tr_b16 a[88:89], v19 offset:18432
    v_mfma_f32_16x16x32_bf16 v[196:199], a[68:71], a[12:15], v[196:199]
    ds_read_b64_tr_b16 a[82:83], v19 offset:16896
    v_mfma_f32_16x16x32_bf16 v[200:203], a[64:67], a[16:19], v[200:203]
    s_mov_b32 s58, s85
    ds_read_b64_tr_b16 a[90:91], v19 offset:18944
    v_add_u32 v8, s87, v8
    v_mfma_f32_16x16x32_bf16 v[200:203], a[68:71], a[20:23], v[200:203]
    s_mov_b32 s85, s84
    ds_read_b64_tr_b16 a[84:85], v19 offset:24576
    v_add_u32 v9, s87, v9
    v_mfma_f32_16x16x32_bf16 v[204:207], a[64:67], a[24:27], v[204:207]
    s_mov_b32 s84, s83
    ds_read_b64_tr_b16 a[92:93], v19 offset:26624
    v_add_u32 v10, s87, v10
    v_mfma_f32_16x16x32_bf16 v[204:207], a[68:71], a[28:31], v[204:207]
    s_waitcnt lgkmcnt(8)
    s_mov_b32 s83, s58
    ds_read_b64_tr_b16 a[86:87], v19 offset:25088
    v_add_u32 v11, s87, v11
    v_mfma_f32_16x16x32_bf16 v[208:211], a[72:75], a[0:3], v[208:211]
    s_waitcnt lgkmcnt(7)
    ds_read_b64_tr_b16 a[94:95], v19 offset:27136
    v_add_u32 v12, s87, v12
    v_mfma_f32_16x16x32_bf16 v[208:211], a[76:79], a[4:7], v[208:211]
    v_add_u32 v13, s87, v13
    v_mfma_f32_16x16x32_bf16 v[212:215], a[72:75], a[8:11], v[212:215]
    v_add_u32 v14, s87, v14
    v_mfma_f32_16x16x32_bf16 v[212:215], a[76:79], a[12:15], v[212:215]
    v_add_u32 v15, s87, v15
    v_mfma_f32_16x16x32_bf16 v[216:219], a[72:75], a[16:19], v[216:219]
    v_add_u32 v16, s87, v16
    v_mfma_f32_16x16x32_bf16 v[216:219], a[76:79], a[20:23], v[216:219]
    v_add_u32 v17, s87, v17
    v_mfma_f32_16x16x32_bf16 v[220:223], a[72:75], a[24:27], v[220:223]
    v_add_u32 v18, s87, v18
    v_mfma_f32_16x16x32_bf16 v[220:223], a[76:79], a[28:31], v[220:223]
    s_waitcnt lgkmcnt(5)
    v_add_u32 v19, s87, v19
    v_mfma_f32_16x16x32_bf16 v[224:227], a[80:83], a[0:3], v[224:227]
    s_waitcnt vmcnt(10) lgkmcnt(0)
    s_barrier
    v_mfma_f32_16x16x32_bf16 v[224:227], a[84:87], a[4:7], v[224:227]
    ds_read_b64_tr_b16 a[64:65], v8 offset:0
    v_mfma_f32_16x16x32_bf16 v[228:231], a[80:83], a[8:11], v[228:231]
    buffer_store_dwordx4 a[100:103], v1, s[60:63], s98 offen offset:1024 sc1
    v_mfma_f32_16x16x32_bf16 v[228:231], a[84:87], a[12:15], v[228:231]
    ds_read_b64_tr_b16 a[66:67], v8 offset:1024
    v_mfma_f32_16x16x32_bf16 v[232:235], a[80:83], a[16:19], v[232:235]
    v_mfma_f32_16x16x32_bf16 v[232:235], a[84:87], a[20:23], v[232:235]
    ds_read_b64_tr_b16 a[68:69], v8 offset:8192
    v_mfma_f32_16x16x32_bf16 v[236:239], a[80:83], a[24:27], v[236:239]
    v_mfma_f32_16x16x32_bf16 v[236:239], a[84:87], a[28:31], v[236:239]
    ds_read_b64_tr_b16 a[70:71], v8 offset:9216
    v_mfma_f32_16x16x32_bf16 v[240:243], a[88:91], a[0:3], v[240:243]
    ds_read_b64_tr_b16 a[72:73], v9 offset:0
    v_mfma_f32_16x16x32_bf16 v[240:243], a[92:95], a[4:7], v[240:243]
    v_mfma_f32_16x16x32_bf16 v[244:247], a[88:91], a[8:11], v[244:247]
    ds_read_b64_tr_b16 a[74:75], v9 offset:1024
    v_mfma_f32_16x16x32_bf16 v[244:247], a[92:95], a[12:15], v[244:247]
    buffer_store_dwordx4 a[104:107], v1, s[60:63], s98 offen offset:2048 sc1
    v_mfma_f32_16x16x32_bf16 v[248:251], a[88:91], a[16:19], v[248:251]
    ds_read_b64_tr_b16 a[76:77], v9 offset:8192
    v_mfma_f32_16x16x32_bf16 v[248:251], a[92:95], a[20:23], v[248:251]
    v_mfma_f32_16x16x32_bf16 v[252:255], a[88:91], a[24:27], v[252:255]
    ds_read_b64_tr_b16 a[78:79], v9 offset:9216
    v_mfma_f32_16x16x32_bf16 v[252:255], a[92:95], a[28:31], v[252:255]
    s_waitcnt lgkmcnt(6)
    v_mfma_f32_16x16x32_bf16 a[128:131], a[64:67], a[32:35], a[128:131]
    s_waitcnt lgkmcnt(4)
    s_lshl_b32 s86, s53, 20
    s_add_u32 s86, s86, 4194304
    v_mfma_f32_16x16x32_bf16 a[128:131], a[68:71], a[36:39], a[128:131]
    s_lshl_b32 s80, s52, 13
    s_add_u32 s59, s80, 4096
    ds_read_b64_tr_b16 a[80:81], v10 offset:0
    v_mfma_f32_16x16x32_bf16 a[132:135], a[64:67], a[40:43], a[132:135]
    s_and_b32 s55, s52, 1
    s_lshl_b32 s56, s55, 14
    s_add_u32 s68, s80, s56
    v_mfma_f32_16x16x32_bf16 a[132:135], a[68:71], a[44:47], a[132:135]
    s_add_u32 s68, s68, 8192
    s_add_u32 s68, s68, s86
    ds_read_b64_tr_b16 a[82:83], v10 offset:1024
    v_mfma_f32_16x16x32_bf16 a[136:139], a[64:67], a[48:51], a[136:139]
    s_lshl_b32 s56, s54, 1
    buffer_store_dwordx4 a[108:111], v1, s[60:63], s98 offen offset:3072 sc1
    v_mfma_f32_16x16x32_bf16 a[136:139], a[68:71], a[52:55], a[136:139]
    s_sub_u32 s75, 33, s56
    s_sub_u32 s74, s75, s55
    ds_read_b64_tr_b16 a[84:85], v10 offset:8192
    v_mfma_f32_16x16x32_bf16 a[140:143], a[64:67], a[56:59], a[140:143]
    s_mov_b32 s70, 32768
    s_mov_b32 s71, 4096
    s_mov_b32 s72, 0
    v_mfma_f32_16x16x32_bf16 a[140:143], a[68:71], a[60:63], a[140:143]
    s_waitcnt lgkmcnt(5)
    s_mov_b32 s73, 4
    ds_read_b64_tr_b16 a[86:87], v10 offset:9216
    v_mfma_f32_16x16x32_bf16 a[144:147], a[72:75], a[32:35], a[144:147]
    s_waitcnt lgkmcnt(4)
    s_mov_b32 s78, 0
    s_mov_b32 s79, 98304
    v_mfma_f32_16x16x32_bf16 a[144:147], a[76:79], a[36:39], a[144:147]
    s_lshr_b32 s55, s52, 1
    ds_read_b64_tr_b16 a[88:89], v11 offset:0
    v_accvgpr_read_b32 v32, a128
    v_mfma_f32_16x16x32_bf16 a[148:151], a[72:75], a[40:43], a[148:151]
    s_lshl_b32 s55, s55, 14
    v_accvgpr_read_b32 v6, a129
    v_cvt_pk_bf16_f32 v32, v32, v6
    v_mfma_f32_16x16x32_bf16 a[148:151], a[76:79], a[44:47], a[148:151]
    s_and_b32 s56, s52, 1
    ds_read_b64_tr_b16 a[90:91], v11 offset:1024
    v_accvgpr_read_b32 v33, a130
    v_mfma_f32_16x16x32_bf16 a[152:155], a[72:75], a[48:51], a[152:155]
    s_lshl_b32 s56, s56, 12
    buffer_store_dwordx4 a[112:115], v1, s[60:63], s99 offen offset:0 sc1
    v_mfma_f32_16x16x32_bf16 a[152:155], a[76:79], a[52:55], a[152:155]
    s_add_u32 s55, s55, s56
    ds_read_b64_tr_b16 a[92:93], v11 offset:8192
    v_accvgpr_read_b32 v6, a131
    v_mfma_f32_16x16x32_bf16 a[156:159], a[72:75], a[56:59], a[156:159]
    s_add_u32 m0, s80, 98304
    s_add_u32 s55, s55, s86
    v_cvt_pk_bf16_f32 v33, v33, v6
    v_mfma_f32_16x16x32_bf16 a[156:159], a[76:79], a[60:63], a[156:159]
    s_waitcnt lgkmcnt(5)
    ds_read_b64_tr_b16 a[94:95], v11 offset:9216
    v_mfma_f32_16x16x32_bf16 a[160:163], a[80:83], a[32:35], a[160:163]
    s_waitcnt lgkmcnt(4)
    v_mfma_f32_16x16x32_bf16 a[160:163], a[84:87], a[36:39], a[160:163]
    ds_read_b64_tr_b16 a[64:65], v12 offset:0
    v_accvgpr_read_b32 v34, a144
    v_mfma_f32_16x16x32_bf16 a[164:167], a[80:83], a[40:43], a[164:167]
    v_accvgpr_read_b32 v6, a145
    v_cvt_pk_bf16_f32 v34, v34, v6
    v_mfma_f32_16x16x32_bf16 a[164:167], a[84:87], a[44:47], a[164:167]
    ds_read_b64_tr_b16 a[66:67], v12 offset:1024
    v_accvgpr_read_b32 v35, a146
    v_mfma_f32_16x16x32_bf16 a[168:171], a[80:83], a[48:51], a[168:171]
    buffer_store_dwordx4 a[116:119], v1, s[60:63], s99 offen offset:1024 sc1
    v_mfma_f32_16x16x32_bf16 a[168:171], a[84:87], a[52:55], a[168:171]
    ds_read_b64_tr_b16 a[68:69], v12 offset:8192
    v_accvgpr_read_b32 v6, a147
    v_mfma_f32_16x16x32_bf16 a[172:175], a[80:83], a[56:59], a[172:175]
    v_cvt_pk_bf16_f32 v35, v35, v6
    v_accvgpr_read_b32 v36, a132
    v_mfma_f32_16x16x32_bf16 a[172:175], a[84:87], a[60:63], a[172:175]
    s_waitcnt lgkmcnt(5)
    ds_read_b64_tr_b16 a[70:71], v12 offset:9216
    v_accvgpr_read_b32 v6, a133
    v_mfma_f32_16x16x32_bf16 a[176:179], a[88:91], a[32:35], a[176:179]
    s_waitcnt lgkmcnt(4)
    v_cvt_pk_bf16_f32 v36, v36, v6
    v_accvgpr_read_b32 v37, a134
    v_mfma_f32_16x16x32_bf16 a[176:179], a[92:95], a[36:39], a[176:179]
    ds_read_b64_tr_b16 a[72:73], v13 offset:0
    v_accvgpr_read_b32 v6, a135
    v_mfma_f32_16x16x32_bf16 a[180:183], a[88:91], a[40:43], a[180:183]
    v_cvt_pk_bf16_f32 v37, v37, v6
    v_accvgpr_read_b32 v38, a148
    v_mfma_f32_16x16x32_bf16 a[180:183], a[92:95], a[44:47], a[180:183]
    ds_read_b64_tr_b16 a[74:75], v13 offset:1024
    v_accvgpr_read_b32 v6, a149
    v_mfma_f32_16x16x32_bf16 a[184:187], a[88:91], a[48:51], a[184:187]
    buffer_store_dwordx4 a[120:123], v1, s[60:63], s99 offen offset:2048 sc1
    v_mfma_f32_16x16x32_bf16 a[184:187], a[92:95], a[52:55], a[184:187]
    ds_read_b64_tr_b16 a[76:77], v13 offset:8192
    v_cvt_pk_bf16_f32 v38, v38, v6
    v_mfma_f32_16x16x32_bf16 a[188:191], a[88:91], a[56:59], a[188:191]
    v_accvgpr_read_b32 v39, a150
    v_accvgpr_read_b32 v6, a151
    v_mfma_f32_16x16x32_bf16 a[188:191], a[92:95], a[60:63], a[188:191]
    s_waitcnt lgkmcnt(5)
    ds_read_b64_tr_b16 a[78:79], v13 offset:9216
    v_cvt_pk_bf16_f32 v39, v39, v6
    v_mfma_f32_16x16x32_bf16 v[64:67], a[64:67], a[32:35], v[64:67]
    s_waitcnt lgkmcnt(4)
    v_accvgpr_read_b32 v40, a136
    v_accvgpr_read_b32 v6, a137
    v_mfma_f32_16x16x32_bf16 v[64:67], a[68:71], a[36:39], v[64:67]
    ds_read_b64_tr_b16 a[80:81], v14 offset:0
    v_cvt_pk_bf16_f32 v40, v40, v6
    v_mfma_f32_16x16x32_bf16 v[68:71], a[64:67], a[40:43], v[68:71]
    v_accvgpr_read_b32 v41, a138
    v_accvgpr_read_b32 v6, a139
    v_mfma_f32_16x16x32_bf16 v[68:71], a[68:71], a[44:47], v[68:71]
    ds_read_b64_tr_b16 a[82:83], v14 offset:1024
    v_cvt_pk_bf16_f32 v41, v41, v6
    v_mfma_f32_16x16x32_bf16 v[72:75], a[64:67], a[48:51], v[72:75]
    buffer_store_dwordx4 a[124:127], v1, s[60:63], s99 offen offset:3072 sc1
    v_mfma_f32_16x16x32_bf16 v[72:75], a[68:71], a[52:55], v[72:75]
    ds_read_b64_tr_b16 a[84:85], v14 offset:8192
    v_accvgpr_read_b32 v42, a152
    v_mfma_f32_16x16x32_bf16 v[76:79], a[64:67], a[56:59], v[76:79]
    v_accvgpr_read_b32 v6, a153
    v_cvt_pk_bf16_f32 v42, v42, v6
    v_mfma_f32_16x16x32_bf16 v[76:79], a[68:71], a[60:63], v[76:79]
    s_waitcnt lgkmcnt(5)
    ds_read_b64_tr_b16 a[86:87], v14 offset:9216
    v_accvgpr_read_b32 v43, a154
    v_mfma_f32_16x16x32_bf16 v[80:83], a[72:75], a[32:35], v[80:83]
    s_waitcnt lgkmcnt(4)
    v_accvgpr_read_b32 v6, a155
    v_cvt_pk_bf16_f32 v43, v43, v6
    v_mfma_f32_16x16x32_bf16 v[80:83], a[76:79], a[36:39], v[80:83]
    ds_read_b64_tr_b16 a[88:89], v15 offset:0
    v_accvgpr_read_b32 v44, a140
    v_mfma_f32_16x16x32_bf16 v[84:87], a[72:75], a[40:43], v[84:87]
    v_accvgpr_read_b32 v6, a141
    v_cvt_pk_bf16_f32 v44, v44, v6
    v_mfma_f32_16x16x32_bf16 v[84:87], a[76:79], a[44:47], v[84:87]
    ds_read_b64_tr_b16 a[90:91], v15 offset:1024
    v_accvgpr_read_b32 v45, a142
    v_mfma_f32_16x16x32_bf16 v[88:91], a[72:75], a[48:51], v[88:91]
    s_waitcnt vmcnt(8)
    v_cmp_ne_u32 vcc, -1, v28
    v_accvgpr_read_b32 v6, a143
    v_mfma_f32_16x16x32_bf16 v[88:91], a[76:79], a[52:55], v[88:91]
    ds_read_b64_tr_b16 a[92:93], v15 offset:8192
    v_cvt_pk_bf16_f32 v45, v45, v6
    v_mfma_f32_16x16x32_bf16 v[92:95], a[72:75], a[56:59], v[92:95]
    v_accvgpr_read_b32 v46, a156
    v_accvgpr_read_b32 v6, a157
    s_cbranch_vccnz L_spin2
L_spin2_back:
    v_mfma_f32_16x16x32_bf16 v[92:95], a[76:79], a[60:63], v[92:95]
    s_waitcnt lgkmcnt(5)
    ds_read_b64_tr_b16 a[94:95], v15 offset:9216
    v_cvt_pk_bf16_f32 v46, v46, v6
    v_mfma_f32_16x16x32_bf16 v[96:99], a[80:83], a[32:35], v[96:99]
    s_waitcnt lgkmcnt(4)
    buffer_load_dwordx4 v1, s[44:47], s55 offen offset:0 sc1 lds
    v_mfma_f32_16x16x32_bf16 v[96:99], a[84:87], a[36:39], v[96:99]
    ds_read_b64_tr_b16 a[64:65], v16 offset:16384
    v_accvgpr_read_b32 v47, a158
    v_mfma_f32_16x16x32_bf16 v[100:103], a[80:83], a[40:43], v[100:103]
    v_accvgpr_read_b32 v6, a159
    v_cvt_pk_bf16_f32 v47, v47, v6
    v_mfma_f32_16x16x32_bf16 v[100:103], a[84:87], a[44:47], v[100:103]
    ds_read_b64_tr_b16 a[66:67], v16 offset:16896
    buffer_load_dwordx4 v1, s[44:47], s55 offen offset:1024 sc1 lds
    v_mfma_f32_16x16x32_bf16 v[104:107], a[80:83], a[48:51], v[104:107]
    v_accvgpr_read_b32 v48, a160
    v_accvgpr_read_b32 v6, a161
    v_mfma_f32_16x16x32_bf16 v[104:107], a[84:87], a[52:55], v[104:107]
    ds_read_b64_tr_b16 a[68:69], v16 offset:24576
    v_cvt_pk_bf16_f32 v48, v48, v6
    v_mfma_f32_16x16x32_bf16 v[108:111], a[80:83], a[56:59], v[108:111]
    buffer_load_dwordx4 v1, s[44:47], s55 offen offset:2048 sc1 lds
    v_mfma_f32_16x16x32_bf16 v[108:111], a[84:87], a[60:63], v[108:111]
    s_waitcnt lgkmcnt(5)
    ds_read_b64_tr_b16 a[70:71], v16 offset:25088
    v_accvgpr_read_b32 v49, a162
    v_mfma_f32_16x16x32_bf16 v[112:115], a[88:91], a[32:35], v[112:115]
    s_waitcnt lgkmcnt(4)
    v_accvgpr_read_b32 v6, a163
    v_cvt_pk_bf16_f32 v49, v49, v6
    v_mfma_f32_16x16x32_bf16 v[112:115], a[92:95], a[36:39], v[112:115]
    ds_read_b64_tr_b16 a[72:73], v16 offset:18432
    buffer_load_dwordx4 v1, s[44:47], s55 offen offset:3072 sc1 lds
    v_mfma_f32_16x16x32_bf16 v[116:119], a[88:91], a[40:43], v[116:119]
    s_mov_b32 s76, s15
    v_accvgpr_read_b32 v50, a176
    v_accvgpr_read_b32 v6, a177
    v_mfma_f32_16x16x32_bf16 v[116:119], a[92:95], a[44:47], v[116:119]
    s_add_u32 m0, s80, 0
    s_add_u32 s69, s68, s71
    ds_read_b64_tr_b16 a[74:75], v16 offset:18944
    v_cvt_pk_bf16_f32 v50, v50, v6
    v_mfma_f32_16x16x32_bf16 v[120:123], a[88:91], a[48:51], v[120:123]
    s_sub_u32 s77, s16, s15
    buffer_load_dwordx4 v1, s[44:47], s68 offen offset:0 sc1 lds
    v_mfma_f32_16x16x32_bf16 v[120:123], a[92:95], a[52:55], v[120:123]
    s_add_u32 s15, s15, 65536
    ds_read_b64_tr_b16 a[76:77], v16 offset:26624
    v_accvgpr_read_b32 v51, a178
    v_mfma_f32_16x16x32_bf16 v[124:127], a[88:91], a[56:59], v[124:127]
    s_lshl_b32 s57, s91, 14
    v_accvgpr_read_b32 v6, a179
    v_cvt_pk_bf16_f32 v51, v51, v6
    v_mfma_f32_16x16x32_bf16 v[124:127], a[92:95], a[60:63], v[124:127]
    s_waitcnt lgkmcnt(5)
    ds_read_b64_tr_b16 a[78:79], v16 offset:27136
    buffer_load_dwordx4 v1, s[44:47], s68 offen offset:1024 sc1 lds
    v_mfma_f32_16x16x32_bf16 v[128:131], a[64:67], a[32:35], v[128:131]
    s_waitcnt lgkmcnt(4)
    v_accvgpr_read_b32 v52, a164
    v_accvgpr_read_b32 v6, a165
    v_mfma_f32_16x16x32_bf16 v[128:131], a[68:71], a[36:39], v[128:131]
    s_add_u32 s57, s57, 38797312
    ds_read_b64_tr_b16 a[80:81], v17 offset:16384
    v_cvt_pk_bf16_f32 v52, v52, v6
    v_mfma_f32_16x16x32_bf16 v[132:135], a[64:67], a[40:43], v[132:135]
    s_lshl_b32 s56, s52, 11
    buffer_load_dwordx4 v1, s[44:47], s68 offen offset:2048 sc1 lds
    v_mfma_f32_16x16x32_bf16 v[132:135], a[68:71], a[44:47], v[132:135]
    s_sub_u32 s55, 15, s54
    ds_read_b64_tr_b16 a[82:83], v17 offset:16896
    v_accvgpr_read_b32 v53, a166
    v_mfma_f32_16x16x32_bf16 v[136:139], a[64:67], a[48:51], v[136:139]
    s_mul_i32 s89, s55, 1490944
    v_accvgpr_read_b32 v6, a167
    v_cvt_pk_bf16_f32 v53, v53, v6
    v_mfma_f32_16x16x32_bf16 v[136:139], a[68:71], a[52:55], v[136:139]
    s_add_u32 s89, s89, s57
    ds_read_b64_tr_b16 a[84:85], v17 offset:24576
    buffer_load_dwordx4 v1, s[44:47], s68 offen offset:3072 sc1 lds
    v_mfma_f32_16x16x32_bf16 v[140:143], a[64:67], a[56:59], v[140:143]
    s_branch L_pado10
L_pad10:
    s_branch L_tour_ret2
L_pado10:
    s_add_u32 s89, s89, s56
    v_accvgpr_read_b32 v54, a180
    v_accvgpr_read_b32 v6, a181
    v_mfma_f32_16x16x32_bf16 v[140:143], a[68:71], a[60:63], v[140:143]
    s_waitcnt lgkmcnt(5)
    s_add_u32 m0, s59, 0
    s_add_u32 s68, s68, s70
    ds_read_b64_tr_b16 a[86:87], v17 offset:25088
    v_cvt_pk_bf16_f32 v54, v54, v6
    v_mfma_f32_16x16x32_bf16 v[144:147], a[72:75], a[32:35], v[144:147]
    s_waitcnt lgkmcnt(4)
    buffer_load_dwordx4 v1, s[44:47], s69 offen offset:0 sc1 lds
    v_mfma_f32_16x16x32_bf16 v[144:147], a[76:79], a[36:39], v[144:147]
    s_mul_i32 s90, s54, 1490944
    ds_read_b64_tr_b16 a[88:89], v17 offset:18432
    v_accvgpr_read_b32 v55, a182
    v_mfma_f32_16x16x32_bf16 v[148:151], a[72:75], a[40:43], v[148:151]
    s_add_u32 s90, s90, s57
    v_accvgpr_read_b32 v6, a183
    v_cvt_pk_bf16_f32 v55, v55, v6
    v_mfma_f32_16x16x32_bf16 v[148:151], a[76:79], a[44:47], v[148:151]
    s_add_u32 s90, s90, 6144
    ds_read_b64_tr_b16 a[90:91], v17 offset:18944
    buffer_load_dwordx4 v1, s[44:47], s69 offen offset:1024 sc1 lds
    v_mfma_f32_16x16x32_bf16 v[152:155], a[72:75], a[48:51], v[152:155]
    s_sub_u32 s90, s90, s56
    v_accvgpr_read_b32 v56, a168
    v_accvgpr_read_b32 v6, a169
    v_mfma_f32_16x16x32_bf16 v[152:155], a[76:79], a[52:55], v[152:155]
    s_sub_u32 s56, 15, s54
    ds_read_b64_tr_b16 a[92:93], v17 offset:26624
    v_cvt_pk_bf16_f32 v56, v56, v6
    v_mfma_f32_16x16x32_bf16 v[156:159], a[72:75], a[56:59], v[156:159]
    s_lshl_b32 s87, s56, 2
    v_accvgpr_read_b32 v57, a170
    v_accvgpr_read_b32 v6, a171
    v_mfma_f32_16x16x32_bf16 v[156:159], a[76:79], a[60:63], v[156:159]
    s_waitcnt lgkmcnt(5)
    ds_read_b64_tr_b16 a[94:95], v17 offset:27136
    buffer_load_dwordx4 v1, s[44:47], s69 offen offset:2048 sc1 lds
    v_mfma_f32_16x16x32_bf16 v[160:163], a[80:83], a[32:35], v[160:163]
    s_waitcnt lgkmcnt(4)
    v_cvt_pk_bf16_f32 v57, v57, v6
    v_accvgpr_read_b32 v58, a184
    v_mfma_f32_16x16x32_bf16 v[160:163], a[84:87], a[36:39], v[160:163]
    s_add_u32 s87, s87, s52
    ds_read_b64_tr_b16 a[64:65], v18 offset:16384
    v_accvgpr_read_b32 v6, a185
    v_mfma_f32_16x16x32_bf16 v[164:167], a[80:83], a[40:43], v[164:167]
    s_mul_i32 s85, s56, 1490944
    buffer_load_dwordx4 v1, s[44:47], s69 offen offset:3072 sc1 lds
    v_mfma_f32_16x16x32_bf16 v[164:167], a[84:87], a[44:47], v[164:167]
    s_lshl_b32 s57, s53, 15
    ds_read_b64_tr_b16 a[66:67], v18 offset:16896
    v_cvt_pk_bf16_f32 v58, v58, v6
    v_mfma_f32_16x16x32_bf16 v[168:171], a[80:83], a[48:51], v[168:171]
    s_add_u32 m0, s80, 32768
    s_add_u32 s69, s68, s71
    v_accvgpr_read_b32 v59, a186
    v_accvgpr_read_b32 v6, a187
    v_mfma_f32_16x16x32_bf16 v[168:171], a[84:87], a[52:55], v[168:171]
    s_add_u32 s85, s85, s57
    ds_read_b64_tr_b16 a[68:69], v18 offset:24576
    buffer_load_dwordx4 v1, s[44:47], s68 offen offset:0 sc1 lds
    v_mfma_f32_16x16x32_bf16 v[172:175], a[80:83], a[56:59], v[172:175]
    s_lshl_b32 s57, s52, 11
    v_cvt_pk_bf16_f32 v59, v59, v6
    v_accvgpr_read_b32 v60, a172
    v_mfma_f32_16x16x32_bf16 v[172:175], a[84:87], a[60:63], v[172:175]
    s_waitcnt lgkmcnt(5)
    ds_read_b64_tr_b16 a[70:71], v18 offset:25088
    v_accvgpr_read_b32 v6, a173
    v_mfma_f32_16x16x32_bf16 v[176:179], a[88:91], a[32:35], v[176:179]
    s_waitcnt lgkmcnt(4)
    buffer_load_dwordx4 v1, s[44:47], s68 offen offset:1024 sc1 lds
    v_mfma_f32_16x16x32_bf16 v[176:179], a[92:95], a[36:39], v[176:179]
    s_add_u32 s85, s85, s57
    ds_read_b64_tr_b16 a[72:73], v18 offset:18432
    v_cvt_pk_bf16_f32 v60, v60, v6
    v_mfma_f32_16x16x32_bf16 v[180:183], a[88:91], a[40:43], v[180:183]
    s_add_u32 s85, s85, 37748736
    v_accvgpr_read_b32 v61, a174
    v_accvgpr_read_b32 v6, a175
    v_mfma_f32_16x16x32_bf16 v[180:183], a[92:95], a[44:47], v[180:183]
    s_mov_b32 s81, -1
    ds_read_b64_tr_b16 a[74:75], v18 offset:18944
    buffer_load_dwordx4 v1, s[44:47], s68 offen offset:2048 sc1 lds
    v_mfma_f32_16x16x32_bf16 v[184:187], a[88:91], a[48:51], v[184:187]
    s_mov_b32 s88, 1
    v_cvt_pk_bf16_f32 v61, v61, v6
    v_accvgpr_read_b32 v62, a188
    v_mfma_f32_16x16x32_bf16 v[184:187], a[92:95], a[52:55], v[184:187]
    s_mov_b64 s[82:83], 0
    ds_read_b64_tr_b16 a[76:77], v18 offset:26624
    v_accvgpr_read_b32 v6, a189
    v_mfma_f32_16x16x32_bf16 v[188:191], a[88:91], a[56:59], v[188:191]
    s_lshl_b32 s56, s56, 2
    buffer_load_dwordx4 v1, s[44:47], s68 offen offset:3072 sc1 lds
    v_mfma_f32_16x16x32_bf16 v[188:191], a[92:95], a[60:63], v[188:191]
    s_waitcnt lgkmcnt(5)
    ds_read_b64_tr_b16 a[78:79], v18 offset:27136
    v_cvt_pk_bf16_f32 v62, v62, v6
    v_mfma_f32_16x16x32_bf16 v[192:195], a[64:67], a[32:35], v[192:195]
    s_waitcnt lgkmcnt(4)
    s_add_u32 m0, s59, 32768
    s_add_u32 s68, s68, s70
    v_accvgpr_read_b32 v63, a190
    v_accvgpr_read_b32 v6, a191
    v_mfma_f32_16x16x32_bf16 v[192:195], a[68:71], a[36:39], v[192:195]
    s_sub_u32 s0, s56, 5
    ds_read_b64_tr_b16 a[80:81], v19 offset:16384
    buffer_load_dwordx4 v1, s[44:47], s69 offen offset:0 sc1 lds
    v_mfma_f32_16x16x32_bf16 v[196:199], a[64:67], a[40:43], v[196:199]
    s_sub_u32 s1, s56, 3
    ds_read_b64_tr_b16 a[88:89], v19 offset:18432
    v_cvt_pk_bf16_f32 v63, v63, v6
    v_mfma_f32_16x16x32_bf16 v[196:199], a[68:71], a[44:47], v[196:199]
    s_sub_u32 s38, s56, 2
    ds_read_b64_tr_b16 a[82:83], v19 offset:16896
    v_cvt_pk_bf16_f32 v64, v64, v65
    v_mfma_f32_16x16x32_bf16 v[200:203], a[64:67], a[48:51], v[200:203]
    s_sub_u32 s99, s87, 2
    ds_read_b64_tr_b16 a[90:91], v19 offset:18944
    buffer_load_dwordx4 v1, s[44:47], s69 offen offset:1024 sc1 lds
    v_mfma_f32_16x16x32_bf16 v[200:203], a[68:71], a[52:55], v[200:203]
    s_sub_u32 s58, s87, 1
    ds_read_b64_tr_b16 a[84:85], v19 offset:24576
    v_cvt_pk_bf16_f32 v65, v66, v67
    v_mfma_f32_16x16x32_bf16 v[204:207], a[64:67], a[56:59], v[204:207]
    s_sub_u32 s48, s36, 2
    ds_read_b64_tr_b16 a[92:93], v19 offset:26624
    v_cvt_pk_bf16_f32 v66, v80, v81
    v_mfma_f32_16x16x32_bf16 v[204:207], a[68:71], a[60:63], v[204:207]
    s_waitcnt lgkmcnt(8)
    ds_read_b64_tr_b16 a[86:87], v19 offset:25088
    buffer_load_dwordx4 v1, s[44:47], s69 offen offset:2048 sc1 lds
    v_mfma_f32_16x16x32_bf16 v[208:211], a[72:75], a[32:35], v[208:211]
    s_waitcnt lgkmcnt(7)
    ds_read_b64_tr_b16 a[94:95], v19 offset:27136
    v_cvt_pk_bf16_f32 v67, v82, v83
    v_mfma_f32_16x16x32_bf16 v[208:211], a[76:79], a[36:39], v[208:211]
    s_sub_u32 s49, s36, 1
    v_cvt_pk_bf16_f32 v68, v68, v69
    v_cvt_pk_bf16_f32 v69, v70, v71
    v_mfma_f32_16x16x32_bf16 v[212:215], a[72:75], a[40:43], v[212:215]
    s_andn2_b32 s50, s36, 1
    buffer_load_dwordx4 v1, s[44:47], s69 offen offset:3072 sc1 lds
    v_mfma_f32_16x16x32_bf16 v[212:215], a[76:79], a[44:47], v[212:215]
    s_add_u32 s98, s50, 2
    v_cvt_pk_bf16_f32 v70, v84, v85
    v_cvt_pk_bf16_f32 v71, v86, v87
    v_mfma_f32_16x16x32_bf16 v[216:219], a[72:75], a[48:51], v[216:219]
    s_cmp_le_u32 s52, 1
    s_cselect_b32 s98, 127, s98
    v_cvt_pk_bf16_f32 v72, v72, v73
    v_cvt_pk_bf16_f32 v73, v74, v75
    v_mfma_f32_16x16x32_bf16 v[216:219], a[76:79], a[52:55], v[216:219]
    s_cmp_eq_u32 s52, 0
    s_cselect_b32 s50, 127, s50
    v_cvt_pk_bf16_f32 v74, v88, v89
    v_cvt_pk_bf16_f32 v75, v90, v91
    v_mfma_f32_16x16x32_bf16 v[220:223], a[72:75], a[56:59], v[220:223]
    s_cmp_eq_u32 s52, 0
    s_cselect_b32 s51, 2, 127
    v_cvt_pk_bf16_f32 v76, v76, v77
    v_cvt_pk_bf16_f32 v77, v78, v79
    v_mfma_f32_16x16x32_bf16 v[220:223], a[76:79], a[60:63], v[220:223]
    s_waitcnt lgkmcnt(5)
    v_cvt_pk_bf16_f32 v78, v92, v93
    v_cvt_pk_bf16_f32 v79, v94, v95
    v_mfma_f32_16x16x32_bf16 v[224:227], a[80:83], a[32:35], v[224:227]
    s_waitcnt lgkmcnt(0)
    s_barrier
    v_cvt_pk_bf16_f32 v80, v96, v97
    v_cvt_pk_bf16_f32 v81, v98, v99
    v_mfma_f32_16x16x32_bf16 v[224:227], a[84:87], a[36:39], v[224:227]
    s_add_u32 m0, s80, 65536
    s_add_u32 s69, s68, s71
    v_cvt_pk_bf16_f32 v82, v112, v113
    v_cvt_pk_bf16_f32 v83, v114, v115
    v_mfma_f32_16x16x32_bf16 v[228:231], a[80:83], a[40:43], v[228:231]
    s_mov_b32 s84, 0
    buffer_load_dwordx4 v1, s[44:47], s68 offen offset:0 sc1 lds
    v_mfma_f32_16x16x32_bf16 v[228:231], a[84:87], a[44:47], v[228:231]
    s_bitset1_b64 s[82:83], s0
    v_cvt_pk_bf16_f32 v84, v100, v101
    v_cvt_pk_bf16_f32 v85, v102, v103
    v_mfma_f32_16x16x32_bf16 v[232:235], a[80:83], a[48:51], v[232:235]
    s_bitset1_b64 s[82:83], s1
    buffer_load_dwordx4 v1, s[44:47], s68 offen offset:1024 sc1 lds
    v_mfma_f32_16x16x32_bf16 v[232:235], a[84:87], a[52:55], v[232:235]
    s_bitset1_b64 s[82:83], s38
    buffer_load_dwordx4 v1, s[44:47], s68 offen offset:2048 sc1 lds
    v_mfma_f32_16x16x32_bf16 v[236:239], a[80:83], a[56:59], v[236:239]
    s_bitset1_b64 s[82:83], s99
    v_cvt_pk_bf16_f32 v86, v116, v117
    v_cvt_pk_bf16_f32 v87, v118, v119
    v_mfma_f32_16x16x32_bf16 v[236:239], a[84:87], a[60:63], v[236:239]
    s_bitset1_b64 s[82:83], s48
    buffer_load_dwordx4 v1, s[44:47], s68 offen offset:3072 sc1 lds
    v_mfma_f32_16x16x32_bf16 v[240:243], a[88:91], a[32:35], v[240:243]
    s_add_u32 m0, s59, 65536
    s_add_u32 s68, s68, s70
    v_cvt_pk_bf16_f32 v88, v104, v105
    v_cvt_pk_bf16_f32 v89, v106, v107
    v_mfma_f32_16x16x32_bf16 v[240:243], a[92:95], a[36:39], v[240:243]
    s_bitset1_b64 s[82:83], s49
    buffer_load_dwordx4 v1, s[44:47], s69 offen offset:0 sc1 lds
    v_mfma_f32_16x16x32_bf16 v[244:247], a[88:91], a[40:43], v[244:247]
    s_bitset1_b64 s[82:83], s50
    v_cvt_pk_bf16_f32 v90, v120, v121
    v_cvt_pk_bf16_f32 v91, v122, v123
    v_mfma_f32_16x16x32_bf16 v[244:247], a[92:95], a[44:47], v[244:247]
    s_bitset1_b64 s[82:83], s98
    buffer_load_dwordx4 v1, s[44:47], s69 offen offset:1024 sc1 lds
    v_mfma_f32_16x16x32_bf16 v[248:251], a[88:91], a[48:51], v[248:251]
    s_bitset1_b64 s[82:83], s51
    buffer_load_dwordx4 v1, s[44:47], s69 offen offset:2048 sc1 lds
    v_mfma_f32_16x16x32_bf16 v[248:251], a[92:95], a[52:55], v[248:251]
    s_bitset1_b64 s[82:83], s58
    v_cvt_pk_bf16_f32 v92, v108, v109
    v_cvt_pk_bf16_f32 v93, v110, v111
    v_mfma_f32_16x16x32_bf16 v[252:255], a[88:91], a[56:59], v[252:255]
    buffer_load_dwordx4 v1, s[44:47], s69 offen offset:3072 sc1 lds
    v_mfma_f32_16x16x32_bf16 v[252:255], a[92:95], a[60:63], v[252:255]
    v_cvt_pk_bf16_f32 v94, v124, v125
    v_cvt_pk_bf16_f32 v95, v126, v127
    s_nop 7
    v_lshrrev_b32 v108, 4, v2
    v_xor_b32 v108, v108, v2
    v_bfe_u32 v108, v108, 1, 1
    v_add_u32 v108, -1, v108
    v_and_b32 v108, 0x3f803f80, v108
    v_bfe_i32 v111, v2, 0, 1
    v_and_b32 v111, 0xaaaaaaaa, v111
    v_or_b32 v111, 0x44444444, v111
    v_mov_b32 v121, -1
    v_mov_b32 v120, v1
    v_add_u32 v4, 98304, v1
    v_lshlrev_b32 v122, 9, v0
    v_add_u32 v122, 83886080, v122
    v_accvgpr_write_b32 a216, v108
    v_accvgpr_write_b32 a217, v108
    v_accvgpr_write_b32 a218, v108
    v_accvgpr_write_b32 a219, v108
    v_lshrrev_b32 v109, 4, v2
    v_lshlrev_b32 v109, 2, v109
    v_and_b32 v110, 15, v2
    v_sub_u32 v109, v110, v109
    v_cmp_gt_i32 s[60:61], 0, v109
    v_cmp_gt_i32 s[62:63], 1, v109
    v_cmp_gt_i32 s[64:65], 2, v109
    v_cmp_gt_i32 s[66:67], 3, v109
    v_mov_b32 v116, 0xf149f2ca
    v_mov_b32 v117, 0xf149f2ca
    v_mov_b32 v118, 0xf149f2ca
    v_mov_b32 v119, 0xf149f2ca
    v_cndmask_b32 v112, 0, v116, s[60:61]
    v_cndmask_b32 v113, 0, v116, s[62:63]
    v_cndmask_b32 v114, 0, v116, s[64:65]
    v_cndmask_b32 v115, 0, v116, s[66:67]
L_geglu:
    s_cmp_ge_u32 s91, 27
    s_cbranch_scc1 L_nogu
    s_mov_b32 s92, 0xc2469614
    s_mov_b32 s94, 0x3c853526
    v_mov_b32 v96, 0xc1906ebb
    v_mov_b32 v98, 0x3c853526
    v_pk_mul_f32 v[100:101], v[128:129], v[128:129]
    v_pk_mul_f32 v[102:103], v[130:131], v[130:131]
    v_pk_mul_f32 v[104:105], v[160:161], v[160:161]
    v_pk_mul_f32 v[106:107], v[162:163], v[162:163]
    v_pk_fma_f32 v[100:101], v[100:101], s[92:93], v[96:97] op_sel_hi:[1,0,0]
    v_pk_fma_f32 v[102:103], v[102:103], s[92:93], v[96:97] op_sel_hi:[1,0,0]
    v_pk_fma_f32 v[104:105], v[104:105], s[92:93], v[96:97] op_sel_hi:[1,0,0]
    v_pk_fma_f32 v[106:107], v[106:107], s[92:93], v[96:97] op_sel_hi:[1,0,0]
    v_pk_mul_f32 v[100:101], v[100:101], v[128:129]
    v_pk_mul_f32 v[102:103], v[102:103], v[130:131]
    v_pk_mul_f32 v[104:105], v[104:105], v[160:161]
    v_pk_mul_f32 v[106:107], v[106:107], v[162:163]
    v_exp_f32 v100, v100
    v_exp_f32 v101, v101
    v_pk_mul_f32 v[144:145], v[144:145], v[128:129]
    v_exp_f32 v102, v102
    v_exp_f32 v103, v103
    v_pk_mul_f32 v[146:147], v[146:147], v[130:131]
    v_exp_f32 v104, v104
    v_exp_f32 v105, v105
    v_pk_mul_f32 v[176:177], v[176:177], v[160:161]
    v_exp_f32 v106, v106
    v_exp_f32 v107, v107
    v_pk_mul_f32 v[178:179], v[178:179], v[162:163]
    v_pk_fma_f32 v[100:101], v[100:101], s[94:95], v[98:99] op_sel_hi:[1,0,0]
    v_pk_fma_f32 v[102:103], v[102:103], s[94:95], v[98:99] op_sel_hi:[1,0,0]
    v_pk_fma_f32 v[104:105], v[104:105], s[94:95], v[98:99] op_sel_hi:[1,0,0]
    v_pk_fma_f32 v[106:107], v[106:107], s[94:95], v[98:99] op_sel_hi:[1,0,0]
    v_rcp_f32 v100, v100
    v_rcp_f32 v101, v101
    v_rcp_f32 v102, v102
    v_rcp_f32 v103, v103
    v_rcp_f32 v104, v104
    v_rcp_f32 v105, v105
    v_rcp_f32 v106, v106
    v_rcp_f32 v107, v107
    v_pk_mul_f32 v[144:145], v[144:145], v[100:101]
    v_pk_mul_f32 v[146:147], v[146:147], v[102:103]
    v_pk_mul_f32 v[176:177], v[176:177], v[104:105]
    v_pk_mul_f32 v[178:179], v[178:179], v[106:107]
    v_cvt_pk_bf16_f32 v128, v144, v145
    v_cvt_pk_bf16_f32 v129, v146, v147
    v_cvt_pk_bf16_f32 v130, v176, v177
    v_cvt_pk_bf16_f32 v131, v178, v179
    v_pk_mul_f32 v[100:101], v[132:133], v[132:133]
    v_pk_mul_f32 v[102:103], v[134:135], v[134:135]
    v_pk_mul_f32 v[104:105], v[164:165], v[164:165]
    v_pk_mul_f32 v[106:107], v[166:167], v[166:167]
    v_pk_fma_f32 v[100:101], v[100:101], s[92:93], v[96:97] op_sel_hi:[1,0,0]
    v_pk_fma_f32 v[102:103], v[102:103], s[92:93], v[96:97] op_sel_hi:[1,0,0]
    v_pk_fma_f32 v[104:105], v[104:105], s[92:93], v[96:97] op_sel_hi:[1,0,0]
    v_pk_fma_f32 v[106:107], v[106:107], s[92:93], v[96:97] op_sel_hi:[1,0,0]
    v_pk_mul_f32 v[100:101], v[100:101], v[132:133]
    v_pk_mul_f32 v[102:103], v[102:103], v[134:135]
    v_pk_mul_f32 v[104:105], v[104:105], v[164:165]
    v_pk_mul_f32 v[106:107], v[106:107], v[166:167]
    v_exp_f32 v100, v100
    v_exp_f32 v101, v101
    v_pk_mul_f32 v[148:149], v[148:149], v[132:133]
    v_exp_f32 v102, v102
    v_exp_f32 v103, v103
    v_pk_mul_f32 v[150:151], v[150:151], v[134:135]
    v_exp_f32 v104, v104
    v_exp_f32 v105, v105
    v_pk_mul_f32 v[180:181], v[180:181], v[164:165]
    v_exp_f32 v106, v106
    v_exp_f32 v107, v107
    v_pk_mul_f32 v[182:183], v[182:183], v[166:167]
    v_pk_fma_f32 v[100:101], v[100:101], s[94:95], v[98:99] op_sel_hi:[1,0,0]
    v_pk_fma_f32 v[102:103], v[102:103], s[94:95], v[98:99] op_sel_hi:[1,0,0]
    v_pk_fma_f32 v[104:105], v[104:105], s[94:95], v[98:99] op_sel_hi:[1,0,0]
    v_pk_fma_f32 v[106:107], v[106:107], s[94:95], v[98:99] op_sel_hi:[1,0,0]
    v_rcp_f32 v100, v100
    v_rcp_f32 v101, v101
    v_rcp_f32 v102, v102
    v_rcp_f32 v103, v103
    v_rcp_f32 v104, v104
    v_rcp_f32 v105, v105
    v_rcp_f32 v106, v106
    v_rcp_f32 v107, v107
    v_pk_mul_f32 v[148:149], v[148:149], v[100:101]
    v_pk_mul_f32 v[150:151], v[150:151], v[102:103]
    v_pk_mul_f32 v[180:181], v[180:181], v[104:105]
    v_pk_mul_f32 v[182:183], v[182:183], v[106:107]
    v_cvt_pk_bf16_f32 v132, v148, v149
    v_cvt_pk_bf16_f32 v133, v150, v151
    v_cvt_pk_bf16_f32 v134, v180, v181
    v_cvt_pk_bf16_f32 v135, v182, v183
    buffer_store_dwordx4 v[128:131], v1, s[44:47], s89 offen offset:0 sc1
    buffer_store_dwordx4 v[132:135], v1, s[44:47], s89 offen offset:1024 sc1
    v_pk_mul_f32 v[100:101], v[136:137], v[136:137]
    v_pk_mul_f32 v[102:103], v[138:139], v[138:139]
    v_pk_mul_f32 v[104:105], v[168:169], v[168:169]
    v_pk_mul_f32 v[106:107], v[170:171], v[170:171]
    v_pk_fma_f32 v[100:101], v[100:101], s[92:93], v[96:97] op_sel_hi:[1,0,0]
    v_pk_fma_f32 v[102:103], v[102:103], s[92:93], v[96:97] op_sel_hi:[1,0,0]
    v_pk_fma_f32 v[104:105], v[104:105], s[92:93], v[96:97] op_sel_hi:[1,0,0]
    v_pk_fma_f32 v[106:107], v[106:107], s[92:93], v[96:97] op_sel_hi:[1,0,0]
    v_pk_mul_f32 v[100:101], v[100:101], v[136:137]
    v_pk_mul_f32 v[102:103], v[102:103], v[138:139]
    v_pk_mul_f32 v[104:105], v[104:105], v[168:169]
    v_pk_mul_f32 v[106:107], v[106:107], v[170:171]
    v_exp_f32 v100, v100
    v_exp_f32 v101, v101
    v_pk_mul_f32 v[152:153], v[152:153], v[136:137]
    v_exp_f32 v102, v102
    v_exp_f32 v103, v103
    v_pk_mul_f32 v[154:155], v[154:155], v[138:139]
    v_exp_f32 v104, v104
    v_exp_f32 v105, v105
    v_pk_mul_f32 v[184:185], v[184:185], v[168:169]
    v_exp_f32 v106, v106
    v_exp_f32 v107, v107
    v_pk_mul_f32 v[186:187], v[186:187], v[170:171]
    v_pk_fma_f32 v[100:101], v[100:101], s[94:95], v[98:99] op_sel_hi:[1,0,0]
    v_pk_fma_f32 v[102:103], v[102:103], s[94:95], v[98:99] op_sel_hi:[1,0,0]
    v_pk_fma_f32 v[104:105], v[104:105], s[94:95], v[98:99] op_sel_hi:[1,0,0]
    v_pk_fma_f32 v[106:107], v[106:107], s[94:95], v[98:99] op_sel_hi:[1,0,0]
    v_rcp_f32 v100, v100
    v_rcp_f32 v101, v101
    v_rcp_f32 v102, v102
    v_rcp_f32 v103, v103
    v_rcp_f32 v104, v104
    v_rcp_f32 v105, v105
    v_rcp_f32 v106, v106
    v_rcp_f32 v107, v107
    v_pk_mul_f32 v[152:153], v[152:153], v[100:101]
    v_pk_mul_f32 v[154:155], v[154:155], v[102:103]
    v_pk_mul_f32 v[184:185], v[184:185], v[104:105]
    v_pk_mul_f32 v[186:187], v[186:187], v[106:107]
    v_cvt_pk_bf16_f32 v136, v152, v153
    v_cvt_pk_bf16_f32 v137, v154, v155
    v_cvt_pk_bf16_f32 v138, v184, v185
    v_cvt_pk_bf16_f32 v139, v186, v187
    v_pk_mul_f32 v[100:101], v[140:141], v[140:141]
    v_pk_mul_f32 v[102:103], v[142:143], v[142:143]
    v_pk_mul_f32 v[104:105], v[172:173], v[172:173]
    v_pk_mul_f32 v[106:107], v[174:175], v[174:175]
    v_pk_fma_f32 v[100:101], v[100:101], s[92:93], v[96:97] op_sel_hi:[1,0,0]
    v_pk_fma_f32 v[102:103], v[102:103], s[92:93], v[96:97] op_sel_hi:[1,0,0]
    v_pk_fma_f32 v[104:105], v[104:105], s[92:93], v[96:97] op_sel_hi:[1,0,0]
    v_pk_fma_f32 v[106:107], v[106:107], s[92:93], v[96:97] op_sel_hi:[1,0,0]
    v_pk_mul_f32 v[100:101], v[100:101], v[140:141]
    v_pk_mul_f32 v[102:103], v[102:103], v[142:143]
    v_pk_mul_f32 v[104:105], v[104:105], v[172:173]
    v_pk_mul_f32 v[106:107], v[106:107], v[174:175]
    v_exp_f32 v100, v100
    v_exp_f32 v101, v101
    v_pk_mul_f32 v[156:157], v[156:157], v[140:141]
    v_exp_f32 v102, v102
    v_exp_f32 v103, v103
    v_pk_mul_f32 v[158:159], v[158:159], v[142:143]
    v_exp_f32 v104, v104
    v_exp_f32 v105, v105
    v_pk_mul_f32 v[188:189], v[188:189], v[172:173]
    v_exp_f32 v106, v106
    v_exp_f32 v107, v107
    v_pk_mul_f32 v[190:191], v[190:191], v[174:175]
    v_pk_fma_f32 v[100:101], v[100:101], s[94:95], v[98:99] op_sel_hi:[1,0,0]
    v_pk_fma_f32 v[102:103], v[102:103], s[94:95], v[98:99] op_sel_hi:[1,0,0]
    v_pk_fma_f32 v[104:105], v[104:105], s[94:95], v[98:99] op_sel_hi:[1,0,0]
    v_pk_fma_f32 v[106:107], v[106:107], s[94:95], v[98:99] op_sel_hi:[1,0,0]
    v_rcp_f32 v100, v100
    v_rcp_f32 v101, v101
    v_rcp_f32 v102, v102
    v_rcp_f32 v103, v103
    v_rcp_f32 v104, v104
    v_rcp_f32 v105, v105
    v_rcp_f32 v106, v106
    v_rcp_f32 v107, v107
    v_pk_mul_f32 v[156:157], v[156:157], v[100:101]
    v_pk_mul_f32 v[158:159], v[158:159], v[102:103]
    v_pk_mul_f32 v[188:189], v[188:189], v[104:105]
    v_pk_mul_f32 v[190:191], v[190:191], v[106:107]
    v_cvt_pk_bf16_f32 v140, v156, v157
    v_cvt_pk_bf16_f32 v141, v158, v159
    v_cvt_pk_bf16_f32 v142, v188, v189
    v_cvt_pk_bf16_f32 v143, v190, v191
    buffer_store_dwordx4 v[136:139], v1, s[44:47], s90 offen offset:0 sc1
    buffer_store_dwordx4 v[140:143], v1, s[44:47], s90 offen offset:1024 sc1
    v_pk_mul_f32 v[100:101], v[192:193], v[192:193]
    v_pk_mul_f32 v[102:103], v[194:195], v[194:195]
    v_pk_mul_f32 v[104:105], v[224:225], v[224:225]
    v_pk_mul_f32 v[106:107], v[226:227], v[226:227]
    v_pk_fma_f32 v[100:101], v[100:101], s[92:93], v[96:97] op_sel_hi:[1,0,0]
    v_pk_fma_f32 v[102:103], v[102:103], s[92:93], v[96:97] op_sel_hi:[1,0,0]
    v_pk_fma_f32 v[104:105], v[104:105], s[92:93], v[96:97] op_sel_hi:[1,0,0]
    v_pk_fma_f32 v[106:107], v[106:107], s[92:93], v[96:97] op_sel_hi:[1,0,0]
    v_pk_mul_f32 v[100:101], v[100:101], v[192:193]
    v_pk_mul_f32 v[102:103], v[102:103], v[194:195]
    v_pk_mul_f32 v[104:105], v[104:105], v[224:225]
    v_pk_mul_f32 v[106:107], v[106:107], v[226:227]
    v_exp_f32 v100, v100
    v_exp_f32 v101, v101
    v_pk_mul_f32 v[208:209], v[208:209], v[192:193]
    v_exp_f32 v102, v102
    v_exp_f32 v103, v103
    v_pk_mul_f32 v[210:211], v[210:211], v[194:195]
    v_exp_f32 v104, v104
    v_exp_f32 v105, v105
    v_pk_mul_f32 v[240:241], v[240:241], v[224:225]
    v_exp_f32 v106, v106
    v_exp_f32 v107, v107
    v_pk_mul_f32 v[242:243], v[242:243], v[226:227]
    v_pk_fma_f32 v[100:101], v[100:101], s[94:95], v[98:99] op_sel_hi:[1,0,0]
    v_pk_fma_f32 v[102:103], v[102:103], s[94:95], v[98:99] op_sel_hi:[1,0,0]
    v_pk_fma_f32 v[104:105], v[104:105], s[94:95], v[98:99] op_sel_hi:[1,0,0]
    v_pk_fma_f32 v[106:107], v[106:107], s[94:95], v[98:99] op_sel_hi:[1,0,0]
    v_rcp_f32 v100, v100
    v_rcp_f32 v101, v101
    v_rcp_f32 v102, v102
    v_rcp_f32 v103, v103
    v_rcp_f32 v104, v104
    v_rcp_f32 v105, v105
    v_rcp_f32 v106, v106
    v_rcp_f32 v107, v107
    s_add_u32 s89, s89, 8192
    s_add_u32 s90, s90, 8192
    v_pk_mul_f32 v[208:209], v[208:209], v[100:101]
    v_pk_mul_f32 v[210:211], v[210:211], v[102:103]
    v_pk_mul_f32 v[240:241], v[240:241], v[104:105]
    v_pk_mul_f32 v[242:243], v[242:243], v[106:107]
    v_cvt_pk_bf16_f32 v192, v208, v209
    v_cvt_pk_bf16_f32 v193, v210, v211
    v_cvt_pk_bf16_f32 v194, v240, v241
    v_cvt_pk_bf16_f32 v195, v242, v243
    v_pk_mul_f32 v[100:101], v[196:197], v[196:197]
    v_pk_mul_f32 v[102:103], v[198:199], v[198:199]
    v_pk_mul_f32 v[104:105], v[228:229], v[228:229]
    v_pk_mul_f32 v[106:107], v[230:231], v[230:231]
    v_pk_fma_f32 v[100:101], v[100:101], s[92:93], v[96:97] op_sel_hi:[1,0,0]
    v_pk_fma_f32 v[102:103], v[102:103], s[92:93], v[96:97] op_sel_hi:[1,0,0]
    v_pk_fma_f32 v[104:105], v[104:105], s[92:93], v[96:97] op_sel_hi:[1,0,0]
    v_pk_fma_f32 v[106:107], v[106:107], s[92:93], v[96:97] op_sel_hi:[1,0,0]
    v_pk_mul_f32 v[100:101], v[100:101], v[196:197]
    v_pk_mul_f32 v[102:103], v[102:103], v[198:199]
    v_pk_mul_f32 v[104:105], v[104:105], v[228:229]
    v_pk_mul_f32 v[106:107], v[106:107], v[230:231]
    v_exp_f32 v100, v100
    v_exp_f32 v101, v101
    v_pk_mul_f32 v[212:213], v[212:213], v[196:197]
    v_exp_f32 v102, v102
    v_exp_f32 v103, v103
    v_pk_mul_f32 v[214:215], v[214:215], v[198:199]
    v_exp_f32 v104, v104
    v_exp_f32 v105, v105
    v_pk_mul_f32 v[244:245], v[244:245], v[228:229]
    v_exp_f32 v106, v106
    v_exp_f32 v107, v107
    v_pk_mul_f32 v[246:247], v[246:247], v[230:231]
    v_pk_fma_f32 v[100:101], v[100:101], s[94:95], v[98:99] op_sel_hi:[1,0,0]
    v_pk_fma_f32 v[102:103], v[102:103], s[94:95], v[98:99] op_sel_hi:[1,0,0]
    v_pk_fma_f32 v[104:105], v[104:105], s[94:95], v[98:99] op_sel_hi:[1,0,0]
    v_pk_fma_f32 v[106:107], v[106:107], s[94:95], v[98:99] op_sel_hi:[1,0,0]
    v_rcp_f32 v100, v100
    v_rcp_f32 v101, v101
    v_rcp_f32 v102, v102
    v_rcp_f32 v103, v103
    v_rcp_f32 v104, v104
    v_rcp_f32 v105, v105
    v_rcp_f32 v106, v106
    v_rcp_f32 v107, v107
    v_pk_mul_f32 v[212:213], v[212:213], v[100:101]
    v_pk_mul_f32 v[214:215], v[214:215], v[102:103]
    v_pk_mul_f32 v[244:245], v[244:245], v[104:105]
    v_pk_mul_f32 v[246:247], v[246:247], v[106:107]
    v_cvt_pk_bf16_f32 v196, v212, v213
    v_cvt_pk_bf16_f32 v197, v214, v215
    v_cvt_pk_bf16_f32 v198, v244, v245
    v_cvt_pk_bf16_f32 v199, v246, v247
    buffer_store_dwordx4 v[192:195], v1, s[44:47], s89 offen offset:0 sc1
    buffer_store_dwordx4 v[196:199], v1, s[44:47], s89 offen offset:1024 sc1
    v_pk_mul_f32 v[100:101], v[200:201], v[200:201]
    v_pk_mul_f32 v[102:103], v[202:203], v[202:203]
    v_pk_mul_f32 v[104:105], v[232:233], v[232:233]
    v_pk_mul_f32 v[106:107], v[234:235], v[234:235]
    v_pk_fma_f32 v[100:101], v[100:101], s[92:93], v[96:97] op_sel_hi:[1,0,0]
    v_pk_fma_f32 v[102:103], v[102:103], s[92:93], v[96:97] op_sel_hi:[1,0,0]
    v_pk_fma_f32 v[104:105], v[104:105], s[92:93], v[96:97] op_sel_hi:[1,0,0]
    v_pk_fma_f32 v[106:107], v[106:107], s[92:93], v[96:97] op_sel_hi:[1,0,0]
    v_pk_mul_f32 v[100:101], v[100:101], v[200:201]
    v_pk_mul_f32 v[102:103], v[102:103], v[202:203]
    v_pk_mul_f32 v[104:105], v[104:105], v[232:233]
    v_pk_mul_f32 v[106:107], v[106:107], v[234:235]
    v_exp_f32 v100, v100
    v_exp_f32 v101, v101
    v_pk_mul_f32 v[216:217], v[216:217], v[200:201]
    v_exp_f32 v102, v102
    v_exp_f32 v103, v103
    v_pk_mul_f32 v[218:219], v[218:219], v[202:203]
    v_exp_f32 v104, v104
    v_exp_f32 v105, v105
    v_pk_mul_f32 v[248:249], v[248:249], v[232:233]
    v_exp_f32 v106, v106
    v_exp_f32 v107, v107
    v_pk_mul_f32 v[250:251], v[250:251], v[234:235]
    v_pk_fma_f32 v[100:101], v[100:101], s[94:95], v[98:99] op_sel_hi:[1,0,0]
    v_pk_fma_f32 v[102:103], v[102:103], s[94:95], v[98:99] op_sel_hi:[1,0,0]
    v_pk_fma_f32 v[104:105], v[104:105], s[94:95], v[98:99] op_sel_hi:[1,0,0]
    v_pk_fma_f32 v[106:107], v[106:107], s[94:95], v[98:99] op_sel_hi:[1,0,0]
    v_rcp_f32 v100, v100
    v_rcp_f32 v101, v101
    v_rcp_f32 v102, v102
    v_rcp_f32 v103, v103
    v_rcp_f32 v104, v104
    v_rcp_f32 v105, v105
    v_rcp_f32 v106, v106
    v_rcp_f32 v107, v107
    v_pk_mul_f32 v[216:217], v[216:217], v[100:101]
    v_pk_mul_f32 v[218:219], v[218:219], v[102:103]
    v_pk_mul_f32 v[248:249], v[248:249], v[104:105]
    v_pk_mul_f32 v[250:251], v[250:251], v[106:107]
    v_cvt_pk_bf16_f32 v200, v216, v217
    v_cvt_pk_bf16_f32 v201, v218, v219
    v_cvt_pk_bf16_f32 v202, v248, v249
    v_cvt_pk_bf16_f32 v203, v250, v251
    buffer_store_dwordx4 v[200:203], v1, s[44:47], s90 offen offset:0 sc1
    s_waitcnt vmcnt(23)
    s_barrier
    ds_read_b128 a[72:75], v4 offset:0
    ds_read_b128 a[76:79], v4 offset:1024
    ds_read_b128 a[80:83], v4 offset:2048
    ds_read_b128 a[84:87], v4 offset:3072
    v_pk_mul_f32 v[100:101], v[204:205], v[204:205]
    v_pk_mul_f32 v[102:103], v[206:207], v[206:207]
    v_pk_mul_f32 v[104:105], v[236:237], v[236:237]
    v_pk_mul_f32 v[106:107], v[238:239], v[238:239]
    v_pk_fma_f32 v[100:101], v[100:101], s[92:93], v[96:97] op_sel_hi:[1,0,0]
    v_pk_fma_f32 v[102:103], v[102:103], s[92:93], v[96:97] op_sel_hi:[1,0,0]
    v_pk_fma_f32 v[104:105], v[104:105], s[92:93], v[96:97] op_sel_hi:[1,0,0]
    v_pk_fma_f32 v[106:107], v[106:107], s[92:93], v[96:97] op_sel_hi:[1,0,0]
    v_pk_mul_f32 v[100:101], v[100:101], v[204:205]
    v_pk_mul_f32 v[102:103], v[102:103], v[206:207]
    v_pk_mul_f32 v[104:105], v[104:105], v[236:237]
    s_branch L_pado11
L_pad11:
    s_branch L_tour_ret2
L_pado11:
    v_pk_mul_f32 v[106:107], v[106:107], v[238:239]
    v_exp_f32 v100, v100
    v_exp_f32 v101, v101
    v_pk_mul_f32 v[220:221], v[220:221], v[204:205]
    v_exp_f32 v102, v102
    v_exp_f32 v103, v103
    v_pk_mul_f32 v[222:223], v[222:223], v[206:207]
    v_exp_f32 v104, v104
    v_exp_f32 v105, v105
    v_pk_mul_f32 v[252:253], v[252:253], v[236:237]
    v_exp_f32 v106, v106
    v_exp_f32 v107, v107
    v_pk_mul_f32 v[254:255], v[254:255], v[238:239]
    v_pk_fma_f32 v[100:101], v[100:101], s[94:95], v[98:99] op_sel_hi:[1,0,0]
    v_pk_fma_f32 v[102:103], v[102:103], s[94:95], v[98:99] op_sel_hi:[1,0,0]
    v_pk_fma_f32 v[104:105], v[104:105], s[94:95], v[98:99] op_sel_hi:[1,0,0]
    v_pk_fma_f32 v[106:107], v[106:107], s[94:95], v[98:99] op_sel_hi:[1,0,0]
    ds_read_b128 a[88:91], v4 offset:8192
    ds_read_b128 a[92:95], v4 offset:9216
    ds_read_b128 a[96:99], v4 offset:10240
    ds_read_b128 a[100:103], v4 offset:11264
    v_rcp_f32 v100, v100
    v_rcp_f32 v101, v101
    v_rcp_f32 v102, v102
    v_rcp_f32 v103, v103
    v_rcp_f32 v104, v104
    v_rcp_f32 v105, v105
    v_rcp_f32 v106, v106
    v_rcp_f32 v107, v107
    v_pk_mul_f32 v[220:221], v[220:221], v[100:101]
    v_pk_mul_f32 v[222:223], v[222:223], v[102:103]
    v_pk_mul_f32 v[252:253], v[252:253], v[104:105]
    v_pk_mul_f32 v[254:255], v[254:255], v[106:107]
    v_cvt_pk_bf16_f32 v204, v220, v221
    v_cvt_pk_bf16_f32 v205, v222, v223
    v_cvt_pk_bf16_f32 v206, v252, v253
    v_cvt_pk_bf16_f32 v207, v254, v255
    buffer_store_dwordx4 v[204:207], v1, s[44:47], s90 offen offset:1024 sc1
L_attn:
    s_waitcnt lgkmcnt(7)
    v_mfma_f32_16x16x32_bf16 v[200:203], a[72:75], v[32:35], 0
    s_waitcnt lgkmcnt(6)
    v_mov_b64 v[16:17], 0
    v_mov_b64 v[18:19], 0
    v_mfma_f32_16x16x32_bf16 v[200:203], a[76:79], v[48:51], v[200:203]
    s_waitcnt lgkmcnt(5)
    ds_read_b128 a[32:35], v120 offset:0
    v_mov_b64 v[20:21], 0
    v_mfma_f32_16x16x32_bf16 v[200:203], a[80:83], v[64:67], v[200:203]
    s_waitcnt lgkmcnt(5)
    v_mov_b64 v[22:23], 0
    v_mov_b64 v[24:25], 0
    v_mfma_f32_16x16x32_bf16 v[200:203], a[84:87], v[80:83], v[200:203]
    ds_read_b128 a[36:39], v120 offset:1024
    v_mov_b64 v[26:27], 0
    v_mfma_f32_16x16x32_bf16 v[204:207], a[72:75], v[36:39], 0
    v_mov_b64 v[28:29], 0
    v_mov_b64 v[30:31], 0
    v_mfma_f32_16x16x32_bf16 v[204:207], a[76:79], v[52:55], v[204:207]
    ds_read_b128 a[40:43], v120 offset:2048
    v_mov_b64 v[128:129], 0
    v_mfma_f32_16x16x32_bf16 v[204:207], a[80:83], v[68:71], v[204:207]
    v_mov_b64 v[130:131], 0
    v_mov_b64 v[132:133], 0
    v_mfma_f32_16x16x32_bf16 v[204:207], a[84:87], v[84:87], v[204:207]
    s_waitcnt lgkmcnt(6)
    ds_read_b128 a[44:47], v120 offset:3072
    v_mov_b64 v[134:135], 0
    v_mfma_f32_16x16x32_bf16 v[208:211], a[88:91], v[32:35], 0
    s_waitcnt lgkmcnt(6)
    v_mov_b64 v[136:137], 0
    v_mov_b64 v[138:139], 0
    v_mfma_f32_16x16x32_bf16 v[208:211], a[92:95], v[48:51], v[208:211]
    s_waitcnt lgkmcnt(5)
    ds_read_b128 a[48:51], v120 offset:4096
    v_mov_b64 v[140:141], 0
    v_mfma_f32_16x16x32_bf16 v[208:211], a[96:99], v[64:67], v[208:211]
    s_waitcnt lgkmcnt(5)
    v_mov_b64 v[142:143], 0
    v_mov_b64 v[144:145], 0
    v_mfma_f32_16x16x32_bf16 v[208:211], a[100:103], v[80:83], v[208:211]
    ds_read_b128 a[52:55], v120 offset:5120
    v_mov_b64 v[146:147], 0
    v_mfma_f32_16x16x32_bf16 v[212:215], a[88:91], v[36:39], 0
    v_mov_b64 v[148:149], 0
    v_mov_b64 v[150:151], 0
    v_mfma_f32_16x16x32_bf16 v[212:215], a[92:95], v[52:55], v[212:215]
    ds_read_b128 a[56:59], v120 offset:6144
    v_mov_b64 v[152:153], 0
    v_mfma_f32_16x16x32_bf16 v[212:215], a[96:99], v[68:71], v[212:215]
    s_cmp_eq_u32 s36, 0
    v_mov_b64 v[154:155], 0
    v_mov_b64 v[156:157], 0
    v_mfma_f32_16x16x32_bf16 v[212:215], a[100:103], v[84:87], v[212:215]
    s_cbranch_scc1 L_mask0
L_mask0_back:
    v_mfma_f32_16x16x32_bf16 v[216:219], a[72:75], v[40:43], v[16:19]
    ds_read_b128 a[60:63], v120 offset:7168
    v_mov_b64 v[158:159], 0
    v_mfma_f32_16x16x32_bf16 v[216:219], a[76:79], v[56:59], v[216:219]
    v_mov_b64 v[160:161], 0
    v_mov_b64 v[162:163], 0
    v_mfma_f32_16x16x32_bf16 v[216:219], a[80:83], v[72:75], v[216:219]
    ds_read_b128 a[0:3], v4 offset:16384
    v_mov_b64 v[164:165], 0
    v_mfma_f32_16x16x32_bf16 v[216:219], a[84:87], v[88:91], v[216:219]
    v_mov_b64 v[166:167], 0
    v_mov_b64 v[168:169], 0
    v_mfma_f32_16x16x32_bf16 v[220:223], a[72:75], v[44:47], v[20:23]
    ds_read_b128 a[4:7], v4 offset:17408
    v_mov_b64 v[170:171], 0
    v_mfma_f32_16x16x32_bf16 v[220:223], a[76:79], v[60:63], v[220:223]
    v_mov_b64 v[172:173], 0
    v_mov_b64 v[174:175], 0
    v_mfma_f32_16x16x32_bf16 v[220:223], a[80:83], v[76:79], v[220:223]
    ds_read_b128 a[8:11], v4 offset:18432
    v_mov_b64 v[176:177], 0
    v_mfma_f32_16x16x32_bf16 v[220:223], a[84:87], v[92:95], v[220:223]
    v_mov_b64 v[178:179], 0
    v_mov_b64 v[180:181], 0
    v_mfma_f32_16x16x32_bf16 v[224:227], a[88:91], v[40:43], v[24:27]
    ds_read_b128 a[12:15], v4 offset:19456
    v_mov_b64 v[182:183], 0
    v_mfma_f32_16x16x32_bf16 v[224:227], a[92:95], v[56:59], v[224:227]
    v_mov_b64 v[184:185], 0
    v_mov_b64 v[186:187], 0
    v_mfma_f32_16x16x32_bf16 v[224:227], a[96:99], v[72:75], v[224:227]
    ds_read_b128 a[16:19], v4 offset:24576
    v_mov_b64 v[188:189], 0
    v_mfma_f32_16x16x32_bf16 v[224:227], a[100:103], v[88:91], v[224:227]
    v_mov_b64 v[190:191], 0
    v_mov_b64 v[192:193], 0
    v_mfma_f32_16x16x32_bf16 v[228:231], a[88:91], v[44:47], v[28:31]
    ds_read_b128 a[20:23], v4 offset:25600
    v_mov_b64 v[194:195], 0
    v_mfma_f32_16x16x32_bf16 v[228:231], a[92:95], v[60:63], v[228:231]
    v_accvgpr_write_b32 a208, 0
    v_accvgpr_write_b32 a209, 0
    v_mfma_f32_16x16x32_bf16 v[228:231], a[96:99], v[76:79], v[228:231]
    ds_read_b128 a[24:27], v4 offset:26624
    v_accvgpr_write_b32 a210, 0
    v_mfma_f32_16x16x32_bf16 v[228:231], a[100:103], v[92:95], v[228:231]
    ds_read_b128 a[28:31], v4 offset:27648
    v_accvgpr_write_b32 a211, 0
    v_max3_f32 v100, v200, v201, v202
    v_max3_f32 v102, v203, v208, v209
    v_max3_f32 v101, v204, v205, v206
    v_max3_f32 v103, v207, v212, v213
    v_max3_f32 v100, v100, v210, v211
    v_max3_f32 v101, v101, v214, v215
    v_max_f32 v100, v100, v102
    v_max_f32 v101, v101, v103
    v_max3_f32 v104, v216, v217, v218
    v_max3_f32 v106, v219, v224, v225
    v_max3_f32 v105, v220, v221, v222
    v_max3_f32 v107, v223, v228, v229
    v_max3_f32 v104, v104, v226, v227
    v_max3_f32 v105, v105, v230, v231
    v_max_f32 v104, v104, v106
    v_max_f32 v105, v105, v107
    v_mov_b64 v[102:103], v[100:101]
    v_mov_b64 v[106:107], v[104:105]
    s_nop 0
    v_permlane16_swap_b32 v100, v102
    v_permlane16_swap_b32 v101, v103
    v_permlane16_swap_b32 v104, v106
    v_permlane16_swap_b32 v105, v107
    v_max_f32 v100, v100, v102
    v_max_f32 v101, v101, v103
    v_max_f32 v104, v104, v106
    v_max_f32 v105, v105, v107
    v_mov_b64 v[102:103], v[100:101]
    v_mov_b64 v[106:107], v[104:105]
    s_nop 0
    v_permlane32_swap_b32 v100, v102
    v_permlane32_swap_b32 v101, v103
    v_permlane32_swap_b32 v104, v106
    v_permlane32_swap_b32 v105, v107
    v_max_f32 v100, v100, v102
    v_max_f32 v101, v101, v103
    v_max_f32 v104, v104, v106
    v_max_f32 v105, v105, v107
    v_sub_f32 v106, 0, v105
    v_sub_f32 v107, 0, v105
    v_sub_f32 v105, 0, v104
    v_sub_f32 v104, 0, v104
    v_sub_f32 v102, 0, v101
    v_sub_f32 v103, 0, v101
    v_sub_f32 v101, 0, v100
    v_sub_f32 v100, 0, v100
    v_pk_add_f32 v[216:217], v[216:217], v[104:105]
    v_pk_add_f32 v[218:219], v[218:219], v[104:105]
    v_pk_add_f32 v[220:221], v[220:221], v[106:107]
    v_pk_add_f32 v[222:223], v[222:223], v[106:107]
    v_pk_add_f32 v[224:225], v[224:225], v[104:105]
    v_pk_add_f32 v[226:227], v[226:227], v[104:105]
    v_pk_add_f32 v[228:229], v[228:229], v[106:107]
    v_pk_add_f32 v[230:231], v[230:231], v[106:107]
    v_pk_add_f32 v[200:201], v[200:201], v[100:101]
    v_pk_add_f32 v[202:203], v[202:203], v[100:101]
    v_pk_add_f32 v[204:205], v[204:205], v[102:103]
    v_pk_add_f32 v[206:207], v[206:207], v[102:103]
    v_pk_add_f32 v[208:209], v[208:209], v[100:101]
    v_pk_add_f32 v[210:211], v[210:211], v[100:101]
    v_pk_add_f32 v[212:213], v[212:213], v[102:103]
    v_pk_add_f32 v[214:215], v[214:215], v[102:103]
    v_exp_f32 v216, v216
    v_exp_f32 v217, v217
    v_exp_f32 v218, v218
    v_exp_f32 v219, v219
    v_exp_f32 v220, v220
    v_exp_f32 v221, v221
    v_exp_f32 v222, v222
    v_exp_f32 v223, v223
    v_exp_f32 v224, v224
    v_exp_f32 v225, v225
    v_exp_f32 v226, v226
    v_exp_f32 v227, v227
    v_exp_f32 v228, v228
    v_exp_f32 v229, v229
    v_exp_f32 v230, v230
    v_exp_f32 v231, v231
    v_cvt_pk_bf16_f32 v232, v216, v217
    v_cvt_pk_bf16_f32 v233, v218, v219
    v_cvt_pk_bf16_f32 v236, v220, v221
    v_cvt_pk_bf16_f32 v237, v222, v223
    v_cvt_pk_bf16_f32 v234, v224, v225
    v_cvt_pk_bf16_f32 v235, v226, v227
    v_cvt_pk_bf16_f32 v238, v228, v229
    v_cvt_pk_bf16_f32 v239, v230, v231
    v_mov_b64 v[16:17], v[104:105]
    v_mov_b64 v[18:19], v[104:105]
    v_mov_b64 v[20:21], v[106:107]
    v_mov_b64 v[22:23], v[106:107]
    v_mov_b64 v[24:25], v[104:105]
    v_mov_b64 v[26:27], v[104:105]
    v_mov_b64 v[28:29], v[106:107]
    v_mov_b64 v[30:31], v[106:107]
    s_waitcnt lgkmcnt(0)
    v_mfma_f32_16x16x32_bf16 a[144:147], a[32:35], v[232:235], 0
    v_mov_b64 v[240:241], v[100:101]
    v_mov_b64 v[242:243], v[100:101]
    v_mfma_f32_16x16x32_bf16 a[148:151], a[32:35], v[236:239], 0
    v_mov_b64 v[244:245], v[102:103]
    v_mov_b64 v[246:247], v[102:103]
    v_mfma_f32_16x16x32_bf16 a[152:155], a[36:39], v[232:235], 0
    v_mov_b64 v[248:249], v[100:101]
    v_mov_b64 v[250:251], v[100:101]
    v_mfma_f32_16x16x32_bf16 a[156:159], a[36:39], v[236:239], 0
    v_mov_b64 v[252:253], v[102:103]
    v_mov_b64 v[254:255], v[102:103]
    v_mfma_f32_16x16x32_bf16 a[160:163], a[40:43], v[232:235], 0
    v_exp_f32 v216, v200
    v_mfma_f32_16x16x32_bf16 a[164:167], a[40:43], v[236:239], 0
    v_exp_f32 v217, v201
    v_mfma_f32_16x16x32_bf16 a[168:171], a[44:47], v[232:235], 0
    v_exp_f32 v218, v202
    v_mfma_f32_16x16x32_bf16 a[172:175], a[44:47], v[236:239], 0
    v_exp_f32 v219, v203
    v_mfma_f32_16x16x32_bf16 a[176:179], a[48:51], v[232:235], 0
    v_exp_f32 v220, v204
    v_mfma_f32_16x16x32_bf16 a[180:183], a[48:51], v[236:239], 0
    v_exp_f32 v221, v205
    v_mfma_f32_16x16x32_bf16 a[184:187], a[52:55], v[232:235], 0
    v_exp_f32 v222, v206
    v_mfma_f32_16x16x32_bf16 a[188:191], a[52:55], v[236:239], 0
    v_exp_f32 v223, v207
    v_mfma_f32_16x16x32_bf16 a[192:195], a[56:59], v[232:235], 0
    v_exp_f32 v224, v208
    v_mfma_f32_16x16x32_bf16 a[196:199], a[56:59], v[236:239], 0
    v_exp_f32 v225, v209
    v_mfma_f32_16x16x32_bf16 a[200:203], a[60:63], v[232:235], 0
    v_exp_f32 v226, v210
    v_mfma_f32_16x16x32_bf16 a[204:207], a[60:63], v[236:239], 0
    v_exp_f32 v227, v211
    v_smfmac_f32_16x16x64_bf16 a[208:211], a[216:219], v[232:239], v111
    v_exp_f32 v228, v212
    s_cmp_le_u32 s36, 1
    s_cbranch_scc1 L_s3d
.p2align 3
L_dloop:
    v_mfma_f32_16x16x32_bf16 v[200:203], a[0:3], v[40:43], v[16:19]
    v_cvt_pk_bf16_f32 v232, v216, v217
    v_mfma_f32_16x16x32_bf16 v[200:203], a[4:7], v[56:59], v[200:203]
    v_exp_f32 v229, v213
    v_mfma_f32_16x16x32_bf16 v[200:203], a[8:11], v[72:75], v[200:203]
    v_cvt_pk_bf16_f32 v233, v218, v219
    v_mfma_f32_16x16x32_bf16 v[200:203], a[12:15], v[88:91], v[200:203]
    v_exp_f32 v230, v214
    v_mfma_f32_16x16x32_bf16 v[204:207], a[0:3], v[44:47], v[20:23]
    s_add_u32 m0, s79, s80
    v_cvt_pk_bf16_f32 v236, v220, v221
    v_mfma_f32_16x16x32_bf16 v[204:207], a[4:7], v[60:63], v[204:207]
    v_exp_f32 v231, v215
    v_mfma_f32_16x16x32_bf16 v[204:207], a[8:11], v[76:79], v[204:207]
    s_waitcnt lgkmcnt(0)
    v_cvt_pk_bf16_f32 v237, v222, v223
    v_mfma_f32_16x16x32_bf16 v[204:207], a[12:15], v[92:95], v[204:207]
    s_add_u32 s69, s68, s71
    v_exp_f32 v216, v200
    v_mfma_f32_16x16x32_bf16 v[208:211], a[16:19], v[40:43], v[24:27]
    s_add_u32 s81, s81, 1
    v_cvt_pk_bf16_f32 v234, v224, v225
    v_mfma_f32_16x16x32_bf16 v[208:211], a[20:23], v[56:59], v[208:211]
    v_exp_f32 v217, v201
    v_mfma_f32_16x16x32_bf16 v[208:211], a[24:27], v[72:75], v[208:211]
    v_cvt_pk_bf16_f32 v235, v226, v227
    v_mfma_f32_16x16x32_bf16 v[208:211], a[28:31], v[88:91], v[208:211]
    v_exp_f32 v218, v202
    v_mfma_f32_16x16x32_bf16 v[212:215], a[16:19], v[44:47], v[28:31]
    v_cvt_pk_bf16_f32 v238, v228, v229
    v_mfma_f32_16x16x32_bf16 v[212:215], a[20:23], v[60:63], v[212:215]
    v_exp_f32 v219, v203
    v_mfma_f32_16x16x32_bf16 v[212:215], a[24:27], v[76:79], v[212:215]
    v_cvt_pk_bf16_f32 v239, v230, v231
    v_mfma_f32_16x16x32_bf16 v[212:215], a[28:31], v[92:95], v[212:215]
    v_exp_f32 v220, v204
    v_mfma_f32_16x16x32_bf16 v[128:131], a[32:35], v[232:235], v[128:131]
    s_waitcnt vmcnt(8)
    s_barrier
    v_mfma_f32_16x16x32_bf16 v[132:135], a[32:35], v[236:239], v[132:135]
    v_exp_f32 v221, v205
    v_mfma_f32_16x16x32_bf16 v[136:139], a[36:39], v[232:235], v[136:139]
    buffer_load_dwordx4 v1, s[44:47], s68 offen offset:0 sc1 lds
    v_mfma_f32_16x16x32_bf16 v[140:143], a[36:39], v[236:239], v[140:143]
    v_exp_f32 v222, v206
    v_mfma_f32_16x16x32_bf16 v[144:147], a[40:43], v[232:235], v[144:147]
    v_mfma_f32_16x16x32_bf16 v[148:151], a[40:43], v[236:239], v[148:151]
    v_exp_f32 v223, v207
    v_mfma_f32_16x16x32_bf16 v[152:155], a[44:47], v[232:235], v[152:155]
    buffer_load_dwordx4 v1, s[44:47], s68 offen offset:1024 sc1 lds
    v_mfma_f32_16x16x32_bf16 v[156:159], a[44:47], v[236:239], v[156:159]
    v_exp_f32 v224, v208
    v_mfma_f32_16x16x32_bf16 v[160:163], a[48:51], v[232:235], v[160:163]
    v_mfma_f32_16x16x32_bf16 v[164:167], a[48:51], v[236:239], v[164:167]
    v_exp_f32 v225, v209
    v_mfma_f32_16x16x32_bf16 v[168:171], a[52:55], v[232:235], v[168:171]
    v_mfma_f32_16x16x32_bf16 v[172:175], a[52:55], v[236:239], v[172:175]
    v_exp_f32 v226, v210
    v_mfma_f32_16x16x32_bf16 v[176:179], a[56:59], v[232:235], v[176:179]
    buffer_load_dwordx4 v1, s[44:47], s68 offen offset:2048 sc1 lds
    v_mfma_f32_16x16x32_bf16 v[180:183], a[56:59], v[236:239], v[180:183]
    v_exp_f32 v227, v211
    v_mfma_f32_16x16x32_bf16 v[184:187], a[60:63], v[232:235], v[184:187]
    v_mfma_f32_16x16x32_bf16 v[188:191], a[60:63], v[236:239], v[188:191]
    v_exp_f32 v228, v212
    v_smfmac_f32_16x16x64_bf16 v[192:195], a[216:219], v[232:239], v111
    buffer_load_dwordx4 v1, s[44:47], s68 offen offset:3072 sc1 lds
    v_mfma_f32_16x16x32_bf16 v[200:203], a[0:3], v[32:35], v[240:243]
    ds_read_b128 a[32:35], v120 offset:16384
    v_cvt_pk_bf16_f32 v232, v216, v217
    v_mfma_f32_16x16x32_bf16 v[200:203], a[4:7], v[48:51], v[200:203]
    v_exp_f32 v229, v213
    v_mfma_f32_16x16x32_bf16 v[200:203], a[8:11], v[64:67], v[200:203]
    ds_read_b128 a[36:39], v120 offset:17408
    v_cvt_pk_bf16_f32 v233, v218, v219
    v_mfma_f32_16x16x32_bf16 v[200:203], a[12:15], v[80:83], v[200:203]
    v_exp_f32 v230, v214
    v_mfma_f32_16x16x32_bf16 v[204:207], a[0:3], v[36:39], v[244:247]
    ds_read_b128 a[40:43], v120 offset:18432
    v_cvt_pk_bf16_f32 v236, v220, v221
    v_mfma_f32_16x16x32_bf16 v[204:207], a[4:7], v[52:55], v[204:207]
    v_exp_f32 v231, v215
    v_mfma_f32_16x16x32_bf16 v[204:207], a[8:11], v[68:71], v[204:207]
    ds_read_b128 a[44:47], v120 offset:19456
    v_cvt_pk_bf16_f32 v237, v222, v223
    v_mfma_f32_16x16x32_bf16 v[204:207], a[12:15], v[84:87], v[204:207]
    v_exp_f32 v216, v200
    v_mfma_f32_16x16x32_bf16 v[208:211], a[16:19], v[32:35], v[248:251]
    ds_read_b128 a[48:51], v120 offset:20480
    v_cvt_pk_bf16_f32 v234, v224, v225
    v_mfma_f32_16x16x32_bf16 v[208:211], a[20:23], v[48:51], v[208:211]
    v_exp_f32 v217, v201
    v_mfma_f32_16x16x32_bf16 v[208:211], a[24:27], v[64:67], v[208:211]
    ds_read_b128 a[52:55], v120 offset:21504
    v_cvt_pk_bf16_f32 v235, v226, v227
    v_mfma_f32_16x16x32_bf16 v[208:211], a[28:31], v[80:83], v[208:211]
    v_exp_f32 v218, v202
    v_mfma_f32_16x16x32_bf16 v[212:215], a[16:19], v[36:39], v[252:255]
    ds_read_b128 a[56:59], v120 offset:22528
    v_cvt_pk_bf16_f32 v238, v228, v229
    v_mfma_f32_16x16x32_bf16 v[212:215], a[20:23], v[52:55], v[212:215]
    v_exp_f32 v219, v203
    v_mfma_f32_16x16x32_bf16 v[212:215], a[24:27], v[68:71], v[212:215]
    ds_read_b128 a[60:63], v120 offset:23552
    v_cvt_pk_bf16_f32 v239, v230, v231
    v_mfma_f32_16x16x32_bf16 v[212:215], a[28:31], v[84:87], v[212:215]
    s_waitcnt lgkmcnt(6)
    v_exp_f32 v220, v204
    v_mfma_f32_16x16x32_bf16 a[144:147], a[32:35], v[232:235], a[144:147]
    ds_read_b128 a[0:3], v120 offset:8192
    v_mfma_f32_16x16x32_bf16 a[148:151], a[32:35], v[236:239], a[148:151]
    v_exp_f32 v221, v205
    v_mfma_f32_16x16x32_bf16 a[152:155], a[36:39], v[232:235], a[152:155]
    ds_read_b128 a[4:7], v120 offset:9216
    v_mfma_f32_16x16x32_bf16 a[156:159], a[36:39], v[236:239], a[156:159]
    s_waitcnt lgkmcnt(6)
    v_exp_f32 v222, v206
    v_mfma_f32_16x16x32_bf16 a[160:163], a[40:43], v[232:235], a[160:163]
    ds_read_b128 a[8:11], v120 offset:10240
    v_mfma_f32_16x16x32_bf16 a[164:167], a[40:43], v[236:239], a[164:167]
    v_exp_f32 v223, v207
    v_mfma_f32_16x16x32_bf16 a[168:171], a[44:47], v[232:235], a[168:171]
    ds_read_b128 a[12:15], v120 offset:11264
    v_mfma_f32_16x16x32_bf16 a[172:175], a[44:47], v[236:239], a[172:175]
    s_waitcnt lgkmcnt(6)
    v_exp_f32 v224, v208
    v_mfma_f32_16x16x32_bf16 a[176:179], a[48:51], v[232:235], a[176:179]
    ds_read_b128 a[16:19], v120 offset:12288
    v_mfma_f32_16x16x32_bf16 a[180:183], a[48:51], v[236:239], a[180:183]
    v_exp_f32 v225, v209
    v_mfma_f32_16x16x32_bf16 a[184:187], a[52:55], v[232:235], a[184:187]
    ds_read_b128 a[20:23], v120 offset:13312
    v_mfma_f32_16x16x32_bf16 a[188:191], a[52:55], v[236:239], a[188:191]
    s_waitcnt lgkmcnt(6)
    v_exp_f32 v226, v210
    v_mfma_f32_16x16x32_bf16 a[192:195], a[56:59], v[232:235], a[192:195]
    ds_read_b128 a[24:27], v120 offset:14336
    v_mfma_f32_16x16x32_bf16 a[196:199], a[56:59], v[236:239], a[196:199]
    v_exp_f32 v227, v211
    v_mfma_f32_16x16x32_bf16 a[200:203], a[60:63], v[232:235], a[200:203]
    s_bitcmp1_b64 s[82:83], s81
    ds_read_b128 a[28:31], v120 offset:15360
    v_mfma_f32_16x16x32_bf16 a[204:207], a[60:63], v[236:239], a[204:207]
    s_waitcnt lgkmcnt(4)
    v_exp_f32 v228, v212
    v_smfmac_f32_16x16x64_bf16 a[208:211], a[216:219], v[232:239], v111
    s_cbranch_scc1 L_dp0
L_dh1:
    v_mfma_f32_16x16x32_bf16 v[200:203], a[0:3], v[40:43], v[16:19]
    v_cvt_pk_bf16_f32 v232, v216, v217
    v_mfma_f32_16x16x32_bf16 v[200:203], a[4:7], v[56:59], v[200:203]
    v_exp_f32 v229, v213
    v_mfma_f32_16x16x32_bf16 v[200:203], a[8:11], v[72:75], v[200:203]
    v_cvt_pk_bf16_f32 v233, v218, v219
    v_mfma_f32_16x16x32_bf16 v[200:203], a[12:15], v[88:91], v[200:203]
    v_exp_f32 v230, v214
    v_mfma_f32_16x16x32_bf16 v[204:207], a[0:3], v[44:47], v[20:23]
    s_add_u32 m0, s79, s59
    v_cvt_pk_bf16_f32 v236, v220, v221
    v_mfma_f32_16x16x32_bf16 v[204:207], a[4:7], v[60:63], v[204:207]
    v_exp_f32 v231, v215
    v_mfma_f32_16x16x32_bf16 v[204:207], a[8:11], v[76:79], v[204:207]
    s_waitcnt lgkmcnt(0)
    v_cvt_pk_bf16_f32 v237, v222, v223
    v_mfma_f32_16x16x32_bf16 v[204:207], a[12:15], v[92:95], v[204:207]
    s_add_u32 s81, s81, 1
    v_exp_f32 v216, v200
    v_mfma_f32_16x16x32_bf16 v[208:211], a[16:19], v[40:43], v[24:27]
    s_mov_b32 s79, s78
    v_cvt_pk_bf16_f32 v234, v224, v225
    v_mfma_f32_16x16x32_bf16 v[208:211], a[20:23], v[56:59], v[208:211]
    s_add_u32 s78, s78, 32768
    v_exp_f32 v217, v201
    v_mfma_f32_16x16x32_bf16 v[208:211], a[24:27], v[72:75], v[208:211]
    s_and_b32 s78, s78, 0x1ffff
    v_cvt_pk_bf16_f32 v235, v226, v227
    v_mfma_f32_16x16x32_bf16 v[208:211], a[28:31], v[88:91], v[208:211]
    s_add_u32 s68, s68, s70
    v_exp_f32 v218, v202
    v_mfma_f32_16x16x32_bf16 v[212:215], a[16:19], v[44:47], v[28:31]
    s_add_u32 s71, s71, s72
    v_cvt_pk_bf16_f32 v238, v228, v229
    v_mfma_f32_16x16x32_bf16 v[212:215], a[20:23], v[60:63], v[212:215]
    s_add_u32 s73, s73, 1
    v_exp_f32 v219, v203
    v_mfma_f32_16x16x32_bf16 v[212:215], a[24:27], v[76:79], v[212:215]
    s_cmp_eq_u32 s73, s74
    v_cvt_pk_bf16_f32 v239, v230, v231
    v_mfma_f32_16x16x32_bf16 v[212:215], a[28:31], v[92:95], v[212:215]
    s_cselect_b32 s68, s86, s68
    v_exp_f32 v220, v204
    v_mfma_f32_16x16x32_bf16 v[128:131], a[32:35], v[232:235], v[128:131]
    s_cmp_eq_u32 s73, s75
    v_add_u32 v109, s78, v1
    v_mfma_f32_16x16x32_bf16 v[132:135], a[32:35], v[236:239], v[132:135]
    s_cselect_b32 s68, s76, s68
    v_exp_f32 v221, v205
    v_mfma_f32_16x16x32_bf16 v[136:139], a[36:39], v[232:235], v[136:139]
    s_cselect_b32 s70, 0x4000, s70
    buffer_load_dwordx4 v1, s[44:47], s69 offen offset:0 sc1 lds
    v_mfma_f32_16x16x32_bf16 v[140:143], a[36:39], v[236:239], v[140:143]
    s_cselect_b32 s71, s77, s71
    v_exp_f32 v222, v206
    v_mfma_f32_16x16x32_bf16 v[144:147], a[40:43], v[232:235], v[144:147]
    s_cselect_b32 s72, 0x10000, s72
    v_mfma_f32_16x16x32_bf16 v[148:151], a[40:43], v[236:239], v[148:151]
    v_exp_f32 v223, v207
    v_mfma_f32_16x16x32_bf16 v[152:155], a[44:47], v[232:235], v[152:155]
    buffer_load_dwordx4 v1, s[44:47], s69 offen offset:1024 sc1 lds
    v_mfma_f32_16x16x32_bf16 v[156:159], a[44:47], v[236:239], v[156:159]
    v_exp_f32 v224, v208
    v_mfma_f32_16x16x32_bf16 v[160:163], a[48:51], v[232:235], v[160:163]
    v_mfma_f32_16x16x32_bf16 v[164:167], a[48:51], v[236:239], v[164:167]
    v_exp_f32 v225, v209
    v_mfma_f32_16x16x32_bf16 v[168:171], a[52:55], v[232:235], v[168:171]
    v_mfma_f32_16x16x32_bf16 v[172:175], a[52:55], v[236:239], v[172:175]
    v_exp_f32 v226, v210
    v_mfma_f32_16x16x32_bf16 v[176:179], a[56:59], v[232:235], v[176:179]
    buffer_load_dwordx4 v1, s[44:47], s69 offen offset:2048 sc1 lds
    v_mfma_f32_16x16x32_bf16 v[180:183], a[56:59], v[236:239], v[180:183]
    v_exp_f32 v227, v211
    v_mfma_f32_16x16x32_bf16 v[184:187], a[60:63], v[232:235], v[184:187]
    v_mfma_f32_16x16x32_bf16 v[188:191], a[60:63], v[236:239], v[188:191]
    v_exp_f32 v228, v212
    v_smfmac_f32_16x16x64_bf16 v[192:195], a[216:219], v[232:239], v111
    buffer_load_dwordx4 v1, s[44:47], s69 offen offset:3072 sc1 lds
    v_mfma_f32_16x16x32_bf16 v[200:203], a[0:3], v[32:35], v[240:243]
    ds_read_b128 a[32:35], v109 offset:0
    v_cvt_pk_bf16_f32 v232, v216, v217
    v_mfma_f32_16x16x32_bf16 v[200:203], a[4:7], v[48:51], v[200:203]
    v_exp_f32 v229, v213
    v_mfma_f32_16x16x32_bf16 v[200:203], a[8:11], v[64:67], v[200:203]
    ds_read_b128 a[36:39], v109 offset:1024
    v_cvt_pk_bf16_f32 v233, v218, v219
    v_mfma_f32_16x16x32_bf16 v[200:203], a[12:15], v[80:83], v[200:203]
    v_exp_f32 v230, v214
    v_mfma_f32_16x16x32_bf16 v[204:207], a[0:3], v[36:39], v[244:247]
    ds_read_b128 a[40:43], v109 offset:2048
    v_cvt_pk_bf16_f32 v236, v220, v221
    v_mfma_f32_16x16x32_bf16 v[204:207], a[4:7], v[52:55], v[204:207]
    v_exp_f32 v231, v215
    v_mfma_f32_16x16x32_bf16 v[204:207], a[8:11], v[68:71], v[204:207]
    ds_read_b128 a[44:47], v109 offset:3072
    v_cvt_pk_bf16_f32 v237, v222, v223
    v_mfma_f32_16x16x32_bf16 v[204:207], a[12:15], v[84:87], v[204:207]
    v_exp_f32 v216, v200
    v_mfma_f32_16x16x32_bf16 v[208:211], a[16:19], v[32:35], v[248:251]
    ds_read_b128 a[48:51], v109 offset:4096
    v_cvt_pk_bf16_f32 v234, v224, v225
    v_mfma_f32_16x16x32_bf16 v[208:211], a[20:23], v[48:51], v[208:211]
    v_exp_f32 v217, v201
    v_mfma_f32_16x16x32_bf16 v[208:211], a[24:27], v[64:67], v[208:211]
    ds_read_b128 a[52:55], v109 offset:5120
    v_cvt_pk_bf16_f32 v235, v226, v227
    v_mfma_f32_16x16x32_bf16 v[208:211], a[28:31], v[80:83], v[208:211]
    v_exp_f32 v218, v202
    v_mfma_f32_16x16x32_bf16 v[212:215], a[16:19], v[36:39], v[252:255]
    ds_read_b128 a[56:59], v109 offset:6144
    v_cvt_pk_bf16_f32 v238, v228, v229
    v_mfma_f32_16x16x32_bf16 v[212:215], a[20:23], v[52:55], v[212:215]
    v_exp_f32 v219, v203
    v_mfma_f32_16x16x32_bf16 v[212:215], a[24:27], v[68:71], v[212:215]
    ds_read_b128 a[60:63], v109 offset:7168
    v_cvt_pk_bf16_f32 v239, v230, v231
    v_mfma_f32_16x16x32_bf16 v[212:215], a[28:31], v[84:87], v[212:215]
    s_waitcnt lgkmcnt(6)
    v_exp_f32 v220, v204
    v_mfma_f32_16x16x32_bf16 a[144:147], a[32:35], v[232:235], a[144:147]
    ds_read_b128 a[0:3], v120 offset:24576
    v_mfma_f32_16x16x32_bf16 a[148:151], a[32:35], v[236:239], a[148:151]
    v_exp_f32 v221, v205
    v_mfma_f32_16x16x32_bf16 a[152:155], a[36:39], v[232:235], a[152:155]
    ds_read_b128 a[4:7], v120 offset:25600
    v_mfma_f32_16x16x32_bf16 a[156:159], a[36:39], v[236:239], a[156:159]
    s_waitcnt lgkmcnt(6)
    v_exp_f32 v222, v206
    v_mfma_f32_16x16x32_bf16 a[160:163], a[40:43], v[232:235], a[160:163]
    ds_read_b128 a[8:11], v120 offset:26624
    v_mfma_f32_16x16x32_bf16 a[164:167], a[40:43], v[236:239], a[164:167]
    v_exp_f32 v223, v207
    v_mfma_f32_16x16x32_bf16 a[168:171], a[44:47], v[232:235], a[168:171]
    ds_read_b128 a[12:15], v120 offset:27648
    v_mfma_f32_16x16x32_bf16 a[172:175], a[44:47], v[236:239], a[172:175]
    s_waitcnt lgkmcnt(6)
    v_exp_f32 v224, v208
    v_mfma_f32_16x16x32_bf16 a[176:179], a[48:51], v[232:235], a[176:179]
    ds_read_b128 a[16:19], v120 offset:28672
    v_mfma_f32_16x16x32_bf16 a[180:183], a[48:51], v[236:239], a[180:183]
    v_exp_f32 v225, v209
    v_mfma_f32_16x16x32_bf16 a[184:187], a[52:55], v[232:235], a[184:187]
    ds_read_b128 a[20:23], v120 offset:29696
    v_mfma_f32_16x16x32_bf16 a[188:191], a[52:55], v[236:239], a[188:191]
    s_waitcnt lgkmcnt(6)
    v_exp_f32 v226, v210
    v_mfma_f32_16x16x32_bf16 a[192:195], a[56:59], v[232:235], a[192:195]
    ds_read_b128 a[24:27], v120 offset:30720
    v_mfma_f32_16x16x32_bf16 a[196:199], a[56:59], v[236:239], a[196:199]
    v_exp_f32 v227, v211
    v_mfma_f32_16x16x32_bf16 a[200:203], a[60:63], v[232:235], a[200:203]
    s_bitcmp1_b64 s[82:83], s81
    ds_read_b128 a[28:31], v120 offset:31744
    v_mov_b32 v120, v109
    v_mfma_f32_16x16x32_bf16 a[204:207], a[60:63], v[236:239], a[204:207]
    s_waitcnt lgkmcnt(4)
    v_exp_f32 v228, v212
    v_smfmac_f32_16x16x64_bf16 a[208:211], a[216:219], v[232:239], v111
    s_cbranch_scc0 L_dloop
L_dp1:
    s_cmp_eq_u32 s81, s0
    s_cbranch_scc1 L_pod
    s_cmp_eq_u32 s81, s1
    s_cbranch_scc1 L_chd
L_s3d:
    s_cmp_eq_u32 s81, s49
    s_cbranch_scc1 L_loop
    s_cmp_eq_u32 s81, s48
    s_cbranch_scc0 L_dloop
    v_pk_add_f32 v[16:17], v[16:17], v[112:113]
    v_pk_add_f32 v[18:19], v[18:19], v[114:115]
    v_pk_add_f32 v[28:29], v[28:29], v[112:113]
    v_pk_add_f32 v[30:31], v[30:31], v[114:115]
    v_mov_b64 v[24:25], v[116:117]
    v_mov_b64 v[26:27], v[116:117]
    s_nop 0
    s_branch L_dloop
L_pod:
    buffer_load_dword v108, v122, s[44:47], 0 offen offset:4 sc1
    s_branch L_s3d
L_chd:
    s_waitcnt vmcnt(8)
    v_cmp_ne_u32 vcc, -1, v108
    s_nop 1
    s_cbranch_vccz L_s3d
    s_branch L_spin3d
L_dp0:
    s_cmp_eq_u32 s81, s51
    s_cbranch_scc0 L_npre
    buffer_store_dword v121, off, s[44:47], s100 offset:4 sc1
L_npre:
    s_cmp_eq_u32 s81, s49
    s_cbranch_scc1 L_sp0b
    s_cmp_eq_u32 s81, s48
    s_cbranch_scc0 L_dh1
    v_pk_add_f32 v[16:17], v[16:17], v[112:113]
    v_pk_add_f32 v[18:19], v[18:19], v[114:115]
    v_pk_add_f32 v[28:29], v[28:29], v[112:113]
    v_pk_add_f32 v[30:31], v[30:31], v[114:115]
    v_mov_b64 v[24:25], v[116:117]
    v_mov_b64 v[26:27], v[116:117]
    s_nop 0
    s_branch L_dh1
.p2align 3
    s_branch L_pado12
.p2align 12
L_pad12:
    s_branch L_tour_ret3
.p2align 3
L_pado12:
L_loop:
    v_mfma_f32_16x16x32_bf16 v[200:203], a[0:3], v[32:35], v[240:243]
    ds_read_b128 a[32:35], v120 offset:0
    v_cvt_pk_bf16_f32 v232, v216, v217
    v_mfma_f32_16x16x32_bf16 v[200:203], a[4:7], v[48:51], v[200:203]
    v_exp_f32 v229, v213
    v_mfma_f32_16x16x32_bf16 v[200:203], a[8:11], v[64:67], v[200:203]
    ds_read_b128 a[36:39], v120 offset:1024
    v_cvt_pk_bf16_f32 v233, v218, v219
    v_mfma_f32_16x16x32_bf16 v[200:203], a[12:15], v[80:83], v[200:203]
    v_exp_f32 v230, v214
    v_mfma_f32_16x16x32_bf16 v[204:207], a[0:3], v[36:39], v[244:247]
    s_add_u32 m0, s79, s80
    ds_read_b128 a[40:43], v120 offset:2048
    v_cvt_pk_bf16_f32 v236, v220, v221
    v_mfma_f32_16x16x32_bf16 v[204:207], a[4:7], v[52:55], v[204:207]
    v_exp_f32 v231, v215
    v_mfma_f32_16x16x32_bf16 v[204:207], a[8:11], v[68:71], v[204:207]
    s_waitcnt lgkmcnt(3)
    ds_read_b128 a[44:47], v120 offset:3072
    v_cvt_pk_bf16_f32 v237, v222, v223
    v_mfma_f32_16x16x32_bf16 v[204:207], a[12:15], v[84:87], v[204:207]
    s_add_u32 s69, s68, s71
    v_exp_f32 v216, v200
    v_mfma_f32_16x16x32_bf16 v[208:211], a[16:19], v[32:35], v[248:251]
    s_add_u32 s81, s81, 1
    ds_read_b128 a[48:51], v120 offset:4096
    v_cvt_pk_bf16_f32 v234, v224, v225
    v_mfma_f32_16x16x32_bf16 v[208:211], a[20:23], v[48:51], v[208:211]
    v_exp_f32 v217, v201
    v_mfma_f32_16x16x32_bf16 v[208:211], a[24:27], v[64:67], v[208:211]
    ds_read_b128 a[52:55], v120 offset:5120
    v_cvt_pk_bf16_f32 v235, v226, v227
    v_mfma_f32_16x16x32_bf16 v[208:211], a[28:31], v[80:83], v[208:211]
    v_exp_f32 v218, v202
    v_mfma_f32_16x16x32_bf16 v[212:215], a[16:19], v[36:39], v[252:255]
    ds_read_b128 a[56:59], v120 offset:6144
    v_cvt_pk_bf16_f32 v238, v228, v229
    v_mfma_f32_16x16x32_bf16 v[212:215], a[20:23], v[52:55], v[212:215]
    v_exp_f32 v219, v203
    v_mfma_f32_16x16x32_bf16 v[212:215], a[24:27], v[68:71], v[212:215]
    ds_read_b128 a[60:63], v120 offset:7168
    v_cvt_pk_bf16_f32 v239, v230, v231
    v_mfma_f32_16x16x32_bf16 v[212:215], a[28:31], v[84:87], v[212:215]
    s_waitcnt lgkmcnt(6)
    v_exp_f32 v220, v204
    v_mfma_f32_16x16x32_bf16 v[128:131], a[32:35], v[232:235], v[128:131]
    ds_read_b128 a[0:3], v120 offset:8192
    ds_read_b128 a[4:7], v120 offset:9216
    v_mfma_f32_16x16x32_bf16 v[132:135], a[32:35], v[236:239], v[132:135]
    s_waitcnt vmcnt(8)
    v_exp_f32 v221, v205
    v_mfma_f32_16x16x32_bf16 v[136:139], a[36:39], v[232:235], v[136:139]
    s_barrier
    buffer_load_dwordx4 v1, s[44:47], s68 offen offset:0 sc1 lds
    v_mfma_f32_16x16x32_bf16 v[140:143], a[36:39], v[236:239], v[140:143]
    s_waitcnt lgkmcnt(6)
    v_exp_f32 v222, v206
    v_mfma_f32_16x16x32_bf16 v[144:147], a[40:43], v[232:235], v[144:147]
    ds_read_b128 a[8:11], v120 offset:10240
    ds_read_b128 a[12:15], v120 offset:11264
    v_mfma_f32_16x16x32_bf16 v[148:151], a[40:43], v[236:239], v[148:151]
    v_exp_f32 v223, v207
    v_mfma_f32_16x16x32_bf16 v[152:155], a[44:47], v[232:235], v[152:155]
    buffer_load_dwordx4 v1, s[44:47], s68 offen offset:1024 sc1 lds
    v_mfma_f32_16x16x32_bf16 v[156:159], a[44:47], v[236:239], v[156:159]
    s_waitcnt lgkmcnt(6)
    v_exp_f32 v224, v208
    v_mfma_f32_16x16x32_bf16 v[160:163], a[48:51], v[232:235], v[160:163]
    ds_read_b128 a[16:19], v120 offset:12288
    ds_read_b128 a[20:23], v120 offset:13312
    v_mfma_f32_16x16x32_bf16 v[164:167], a[48:51], v[236:239], v[164:167]
    v_exp_f32 v225, v209
    v_mfma_f32_16x16x32_bf16 v[168:171], a[52:55], v[232:235], v[168:171]
    buffer_load_dwordx4 v1, s[44:47], s68 offen offset:2048 sc1 lds
    v_mfma_f32_16x16x32_bf16 v[172:175], a[52:55], v[236:239], v[172:175]
    s_waitcnt lgkmcnt(6)
    v_exp_f32 v226, v210
    v_mfma_f32_16x16x32_bf16 v[176:179], a[56:59], v[232:235], v[176:179]
    ds_read_b128 a[24:27], v120 offset:14336
    ds_read_b128 a[28:31], v120 offset:15360
    v_mfma_f32_16x16x32_bf16 v[180:183], a[56:59], v[236:239], v[180:183]
    v_exp_f32 v227, v211
    v_mfma_f32_16x16x32_bf16 v[184:187], a[60:63], v[232:235], v[184:187]
    s_bitcmp1_b64 s[82:83], s81
    buffer_load_dwordx4 v1, s[44:47], s68 offen offset:3072 sc1 lds
    v_mfma_f32_16x16x32_bf16 v[188:191], a[60:63], v[236:239], v[188:191]
    s_waitcnt lgkmcnt(4)
    v_exp_f32 v228, v212
    v_smfmac_f32_16x16x64_bf16 v[192:195], a[216:219], v[232:239], v111
    s_cbranch_scc1 L_sp0
L_h1:
    v_mfma_f32_16x16x32_bf16 v[200:203], a[0:3], v[32:35], v[240:243]
    ds_read_b128 a[32:35], v120 offset:16384
    v_cvt_pk_bf16_f32 v232, v216, v217
    v_mfma_f32_16x16x32_bf16 v[200:203], a[4:7], v[48:51], v[200:203]
    v_exp_f32 v229, v213
    v_mfma_f32_16x16x32_bf16 v[200:203], a[8:11], v[64:67], v[200:203]
    ds_read_b128 a[36:39], v120 offset:17408
    v_cvt_pk_bf16_f32 v233, v218, v219
    v_mfma_f32_16x16x32_bf16 v[200:203], a[12:15], v[80:83], v[200:203]
    v_exp_f32 v230, v214
    v_mfma_f32_16x16x32_bf16 v[204:207], a[0:3], v[36:39], v[244:247]
    s_add_u32 m0, s79, s59
    ds_read_b128 a[40:43], v120 offset:18432
    v_cvt_pk_bf16_f32 v236, v220, v221
    v_mfma_f32_16x16x32_bf16 v[204:207], a[4:7], v[52:55], v[204:207]
    v_exp_f32 v231, v215
    v_mfma_f32_16x16x32_bf16 v[204:207], a[8:11], v[68:71], v[204:207]
    s_waitcnt lgkmcnt(3)
    ds_read_b128 a[44:47], v120 offset:19456
    v_cvt_pk_bf16_f32 v237, v222, v223
    v_mfma_f32_16x16x32_bf16 v[204:207], a[12:15], v[84:87], v[204:207]
    s_add_u32 s81, s81, 1
    v_exp_f32 v216, v200
    v_mfma_f32_16x16x32_bf16 v[208:211], a[16:19], v[32:35], v[248:251]
    s_mov_b32 s79, s78
    ds_read_b128 a[48:51], v120 offset:20480
    v_cvt_pk_bf16_f32 v234, v224, v225
    v_mfma_f32_16x16x32_bf16 v[208:211], a[20:23], v[48:51], v[208:211]
    s_add_u32 s78, s78, 32768
    v_exp_f32 v217, v201
    v_mfma_f32_16x16x32_bf16 v[208:211], a[24:27], v[64:67], v[208:211]
    s_and_b32 s78, s78, 0x1ffff
    ds_read_b128 a[52:55], v120 offset:21504
    v_cvt_pk_bf16_f32 v235, v226, v227
    v_mfma_f32_16x16x32_bf16 v[208:211], a[28:31], v[80:83], v[208:211]
    s_add_u32 s68, s68, s70
    v_exp_f32 v218, v202
    v_mfma_f32_16x16x32_bf16 v[212:215], a[16:19], v[36:39], v[252:255]
    s_add_u32 s71, s71, s72
    ds_read_b128 a[56:59], v120 offset:22528
    v_cvt_pk_bf16_f32 v238, v228, v229
    v_mfma_f32_16x16x32_bf16 v[212:215], a[20:23], v[52:55], v[212:215]
    s_add_u32 s73, s73, 1
    v_exp_f32 v219, v203
    v_mfma_f32_16x16x32_bf16 v[212:215], a[24:27], v[68:71], v[212:215]
    s_cmp_eq_u32 s73, s74
    ds_read_b128 a[60:63], v120 offset:23552
    v_cvt_pk_bf16_f32 v239, v230, v231
    v_mfma_f32_16x16x32_bf16 v[212:215], a[28:31], v[84:87], v[212:215]
    s_waitcnt lgkmcnt(6)
    v_exp_f32 v220, v204
    v_mfma_f32_16x16x32_bf16 v[128:131], a[32:35], v[232:235], v[128:131]
    s_cselect_b32 s68, s86, s68
    ds_read_b128 a[0:3], v120 offset:24576
    ds_read_b128 a[4:7], v120 offset:25600
    v_mfma_f32_16x16x32_bf16 v[132:135], a[32:35], v[236:239], v[132:135]
    s_cmp_eq_u32 s73, s75
    v_exp_f32 v221, v205
    v_mfma_f32_16x16x32_bf16 v[136:139], a[36:39], v[232:235], v[136:139]
    s_cselect_b32 s68, s76, s68
    buffer_load_dwordx4 v1, s[44:47], s69 offen offset:0 sc1 lds
    v_mfma_f32_16x16x32_bf16 v[140:143], a[36:39], v[236:239], v[140:143]
    s_waitcnt lgkmcnt(6)
    v_exp_f32 v222, v206
    v_mfma_f32_16x16x32_bf16 v[144:147], a[40:43], v[232:235], v[144:147]
    s_cselect_b32 s70, 0x4000, s70
    ds_read_b128 a[8:11], v120 offset:26624
    ds_read_b128 a[12:15], v120 offset:27648
    v_mfma_f32_16x16x32_bf16 v[148:151], a[40:43], v[236:239], v[148:151]
    s_cselect_b32 s71, s77, s71
    v_exp_f32 v223, v207
    v_mfma_f32_16x16x32_bf16 v[152:155], a[44:47], v[232:235], v[152:155]
    s_cselect_b32 s72, 0x10000, s72
    buffer_load_dwordx4 v1, s[44:47], s69 offen offset:1024 sc1 lds
    v_mfma_f32_16x16x32_bf16 v[156:159], a[44:47], v[236:239], v[156:159]
    s_waitcnt lgkmcnt(6)
    v_exp_f32 v224, v208
    v_mfma_f32_16x16x32_bf16 v[160:163], a[48:51], v[232:235], v[160:163]
    ds_read_b128 a[16:19], v120 offset:28672
    ds_read_b128 a[20:23], v120 offset:29696
    v_mfma_f32_16x16x32_bf16 v[164:167], a[48:51], v[236:239], v[164:167]
    v_exp_f32 v225, v209
    v_mfma_f32_16x16x32_bf16 v[168:171], a[52:55], v[232:235], v[168:171]
    buffer_load_dwordx4 v1, s[44:47], s69 offen offset:2048 sc1 lds
    v_mfma_f32_16x16x32_bf16 v[172:175], a[52:55], v[236:239], v[172:175]
    s_waitcnt lgkmcnt(6)
    v_exp_f32 v226, v210
    v_mfma_f32_16x16x32_bf16 v[176:179], a[56:59], v[232:235], v[176:179]
    ds_read_b128 a[24:27], v120 offset:30720
    ds_read_b128 a[28:31], v120 offset:31744
    v_mfma_f32_16x16x32_bf16 v[180:183], a[56:59], v[236:239], v[180:183]
    v_exp_f32 v227, v211
    v_mfma_f32_16x16x32_bf16 v[184:187], a[60:63], v[232:235], v[184:187]
    s_bitcmp1_b64 s[82:83], s81
    buffer_load_dwordx4 v1, s[44:47], s69 offen offset:3072 sc1 lds
    v_add_u32 v120, s78, v1
    v_mfma_f32_16x16x32_bf16 v[188:191], a[60:63], v[236:239], v[188:191]
    s_waitcnt lgkmcnt(4)
    v_exp_f32 v228, v212
    v_smfmac_f32_16x16x64_bf16 v[192:195], a[216:219], v[232:239], v111
    s_cbranch_scc0 L_loop
L_sp1:
    s_cmp_eq_u32 s81, s58
    s_cbranch_scc1 L_last0
    s_cmp_eq_u32 s81, s0
    s_cbranch_scc1 L_pos
    s_cmp_eq_u32 s81, s1
    s_cbranch_scc1 L_chs
L_s3s:
    s_cmp_eq_u32 s81, s99
    s_cbranch_scc0 L_loop
    v_pk_add_f32 v[240:241], v[240:241], v[112:113]
    v_pk_add_f32 v[242:243], v[242:243], v[114:115]
    v_pk_add_f32 v[252:253], v[252:253], v[112:113]
    v_pk_add_f32 v[254:255], v[254:255], v[114:115]
    v_mov_b64 v[248:249], v[116:117]
    v_mov_b64 v[250:251], v[116:117]
    s_nop 0
    s_branch L_loop
L_pos:
    buffer_load_dword v108, v122, s[44:47], 0 offen offset:4 sc1
    s_branch L_s3s
L_chs:
    s_waitcnt vmcnt(8)
    v_cmp_ne_u32 vcc, -1, v108
    s_nop 1
    s_cbranch_vccz L_s3s
    s_branch L_spin3s
L_sp0:
    s_cmp_eq_u32 s81, s58
    s_cbranch_scc1 L_last1
L_sp0b:
    s_cmp_eq_u32 s81, s38
    s_cbranch_scc0 L_nx
    s_add_u32 m0, s26, 0
    s_add_u32 s17, s16, 4096
    buffer_load_dwordx4 v1, s[8:11], s17 offen offset:0 sc1 lds
    s_add_u32 m0, s26, 4096
    s_add_u32 s17, s16, 86016
    buffer_load_dwordx4 v1, s[8:11], s17 offen offset:0 sc1 lds
    s_add_u32 m0, s26, 8192
    s_add_u32 s17, s16, 167936
    buffer_load_dwordx4 v1, s[8:11], s17 offen offset:0 sc1 lds
    s_add_u32 m0, s26, 12288
    s_add_u32 s17, s16, 249856
    buffer_load_dwordx4 v1, s[8:11], s17 offen offset:0 sc1 lds
    s_add_u32 s16, s16, 327680
L_nx:
    s_cmp_eq_u32 s81, s99
    s_cbranch_scc0 L_nm
    v_pk_add_f32 v[240:241], v[240:241], v[112:113]
    v_pk_add_f32 v[242:243], v[242:243], v[114:115]
    v_pk_add_f32 v[252:253], v[252:253], v[112:113]
    v_pk_add_f32 v[254:255], v[254:255], v[114:115]
    v_mov_b64 v[248:249], v[116:117]
    v_mov_b64 v[250:251], v[116:117]
L_nm:
    s_cmp_eq_u32 s81, s98
    s_cbranch_scc1 L_eb2
    s_cmp_eq_u32 s81, s50
    s_cbranch_scc0 L_h1
L_eb:
    s_and_b32 s64, s54, 1
    s_lshl_b32 s64, s64, 16
    s_xor_b32 s60, s64, 0
    s_xor_b32 s61, s64, 32768
    s_xor_b32 s62, s64, 65536
    s_xor_b32 s63, s64, 98304
    v_add_u32 v10, s30, v1
    v_add_u32 v11, s31, v1
    v_add_u32 v12, s32, v1
    v_add_u32 v13, s33, v1
    v_add_u32 v14, s34, v1
    v_add_u32 v15, s35, v1
    v_add_u32 v8, s60, v14
    v_add_u32 v9, 0, v15
    v_add_u32 v4, s60, v10
    v_add_u32 v5, s60, v11
    v_add_u32 v6, s60, v12
    v_add_u32 v7, s60, v13
    v_accvgpr_read_b32 v96, a208
    v_accvgpr_read_b32 v97, a209
    v_accvgpr_read_b32 v98, a210
    v_accvgpr_read_b32 v99, a211
    s_mov_b32 s88, 2
    v_add_f32 v96, v96, v97
    v_add_f32 v98, v98, v99
    s_mov_b32 s55, 0x53800000
    v_add_f32 v101, v96, v98
    v_cmp_ngt_f32 vcc, s55, v101
    s_nop 1
    s_cbranch_vccnz L_eb_x
    v_rcp_f32 v96, v96
    v_rcp_f32 v98, v98
    s_mov_b32 s88, 0
    v_accvgpr_read_b32 v40, a144
    v_accvgpr_read_b32 v41, a145
    v_accvgpr_read_b32 v42, a146
    v_accvgpr_read_b32 v43, a147
    v_accvgpr_read_b32 v44, a152
    v_accvgpr_read_b32 v45, a153
    v_accvgpr_read_b32 v46, a154
    v_accvgpr_read_b32 v47, a155
    v_pk_mul_f32 v[40:41], v[40:41], v[96:97] op_sel_hi:[1,0]
    v_pk_mul_f32 v[42:43], v[42:43], v[96:97] op_sel_hi:[1,0]
    v_pk_mul_f32 v[44:45], v[44:45], v[96:97] op_sel_hi:[1,0]
    v_pk_mul_f32 v[46:47], v[46:47], v[96:97] op_sel_hi:[1,0]
    v_cvt_pk_bf16_f32 v40, v40, v41
    v_cvt_pk_bf16_f32 v41, v42, v43
    v_cvt_pk_bf16_f32 v42, v44, v45
    v_cvt_pk_bf16_f32 v43, v46, v47
    v_accvgpr_read_b32 v56, a148
    v_accvgpr_read_b32 v57, a149
    v_accvgpr_read_b32 v58, a150
    v_accvgpr_read_b32 v59, a151
    v_accvgpr_read_b32 v60, a156
    v_accvgpr_read_b32 v61, a157
    v_accvgpr_read_b32 v62, a158
    v_accvgpr_read_b32 v63, a159
    v_pk_mul_f32 v[56:57], v[56:57], v[98:99] op_sel_hi:[1,0]
    v_pk_mul_f32 v[58:59], v[58:59], v[98:99] op_sel_hi:[1,0]
    v_pk_mul_f32 v[60:61], v[60:61], v[98:99] op_sel_hi:[1,0]
    v_pk_mul_f32 v[62:63], v[62:63], v[98:99] op_sel_hi:[1,0]
    v_cvt_pk_bf16_f32 v56, v56, v57
    v_cvt_pk_bf16_f32 v57, v58, v59
    v_cvt_pk_bf16_f32 v58, v60, v61
    v_cvt_pk_bf16_f32 v59, v62, v63
    v_accvgpr_read_b32 v72, a160
    v_accvgpr_read_b32 v73, a161
    v_accvgpr_read_b32 v74, a162
    v_accvgpr_read_b32 v75, a163
    v_accvgpr_read_b32 v76, a168
    v_accvgpr_read_b32 v77, a169
    v_accvgpr_read_b32 v78, a170
    v_accvgpr_read_b32 v79, a171
    v_pk_mul_f32 v[72:73], v[72:73], v[96:97] op_sel_hi:[1,0]
    v_pk_mul_f32 v[74:75], v[74:75], v[96:97] op_sel_hi:[1,0]
    v_pk_mul_f32 v[76:77], v[76:77], v[96:97] op_sel_hi:[1,0]
    v_pk_mul_f32 v[78:79], v[78:79], v[96:97] op_sel_hi:[1,0]
    v_cvt_pk_bf16_f32 v72, v72, v73
    v_cvt_pk_bf16_f32 v73, v74, v75
    v_cvt_pk_bf16_f32 v74, v76, v77
    v_cvt_pk_bf16_f32 v75, v78, v79
    v_accvgpr_read_b32 v88, a164
    v_accvgpr_read_b32 v89, a165
    v_accvgpr_read_b32 v90, a166
    v_accvgpr_read_b32 v91, a167
    v_accvgpr_read_b32 v92, a172
    v_accvgpr_read_b32 v93, a173
    v_accvgpr_read_b32 v94, a174
    v_accvgpr_read_b32 v95, a175
    v_pk_mul_f32 v[88:89], v[88:89], v[98:99] op_sel_hi:[1,0]
    v_pk_mul_f32 v[90:91], v[90:91], v[98:99] op_sel_hi:[1,0]
    v_pk_mul_f32 v[92:93], v[92:93], v[98:99] op_sel_hi:[1,0]
    v_pk_mul_f32 v[94:95], v[94:95], v[98:99] op_sel_hi:[1,0]
    v_cvt_pk_bf16_f32 v88, v88, v89
    v_cvt_pk_bf16_f32 v89, v90, v91
    v_cvt_pk_bf16_f32 v90, v92, v93
    v_cvt_pk_bf16_f32 v91, v94, v95
    buffer_store_dwordx4 v[40:43], v1, s[44:47], s37 offen offset:0 sc1
    buffer_store_dwordx4 v[56:59], v1, s[44:47], s37 offen offset:1024 sc1
    s_add_u32 s37, s37, 8192
    buffer_store_dwordx4 v[72:75], v1, s[44:47], s37 offen offset:0 sc1
    buffer_store_dwordx4 v[88:91], v1, s[44:47], s37 offen offset:1024 sc1
    s_add_u32 s37, s37, 8192
    s_cmp_eq_u32 s81, s87
    s_cbranch_scc0 L_h1
L_eb2:
    s_cmp_eq_u32 s88, 2
    s_cbranch_scc1 L_eb_x
    v_accvgpr_read_b32 v40, a176
    v_accvgpr_read_b32 v41, a177
    v_accvgpr_read_b32 v42, a178
    v_accvgpr_read_b32 v43, a179
    v_accvgpr_read_b32 v44, a184
    v_accvgpr_read_b32 v45, a185
    v_accvgpr_read_b32 v46, a186
    v_accvgpr_read_b32 v47, a187
    v_pk_mul_f32 v[40:41], v[40:41], v[96:97] op_sel_hi:[1,0]
    v_pk_mul_f32 v[42:43], v[42:43], v[96:97] op_sel_hi:[1,0]
    v_pk_mul_f32 v[44:45], v[44:45], v[96:97] op_sel_hi:[1,0]
    v_pk_mul_f32 v[46:47], v[46:47], v[96:97] op_sel_hi:[1,0]
    v_cvt_pk_bf16_f32 v40, v40, v41
    v_cvt_pk_bf16_f32 v41, v42, v43
    v_cvt_pk_bf16_f32 v42, v44, v45
    v_cvt_pk_bf16_f32 v43, v46, v47
    v_accvgpr_read_b32 v56, a180
    v_accvgpr_read_b32 v57, a181
    v_accvgpr_read_b32 v58, a182
    v_accvgpr_read_b32 v59, a183
    v_accvgpr_read_b32 v60, a188
    v_accvgpr_read_b32 v61, a189
    v_accvgpr_read_b32 v62, a190
    v_accvgpr_read_b32 v63, a191
    v_pk_mul_f32 v[56:57], v[56:57], v[98:99] op_sel_hi:[1,0]
    v_pk_mul_f32 v[58:59], v[58:59], v[98:99] op_sel_hi:[1,0]
    v_pk_mul_f32 v[60:61], v[60:61], v[98:99] op_sel_hi:[1,0]
    v_pk_mul_f32 v[62:63], v[62:63], v[98:99] op_sel_hi:[1,0]
    v_cvt_pk_bf16_f32 v56, v56, v57
    v_cvt_pk_bf16_f32 v57, v58, v59
    v_cvt_pk_bf16_f32 v58, v60, v61
    v_cvt_pk_bf16_f32 v59, v62, v63
    v_accvgpr_read_b32 v72, a192
    v_accvgpr_read_b32 v73, a193
    v_accvgpr_read_b32 v74, a194
    v_accvgpr_read_b32 v75, a195
    v_accvgpr_read_b32 v76, a200
    v_accvgpr_read_b32 v77, a201
    v_accvgpr_read_b32 v78, a202
    v_accvgpr_read_b32 v79, a203
    v_pk_mul_f32 v[72:73], v[72:73], v[96:97] op_sel_hi:[1,0]
    v_pk_mul_f32 v[74:75], v[74:75], v[96:97] op_sel_hi:[1,0]
    v_pk_mul_f32 v[76:77], v[76:77], v[96:97] op_sel_hi:[1,0]
    v_pk_mul_f32 v[78:79], v[78:79], v[96:97] op_sel_hi:[1,0]
    v_cvt_pk_bf16_f32 v72, v72, v73
    v_cvt_pk_bf16_f32 v73, v74, v75
    v_cvt_pk_bf16_f32 v74, v76, v77
    v_cvt_pk_bf16_f32 v75, v78, v79
    v_accvgpr_read_b32 v88, a196
    v_accvgpr_read_b32 v89, a197
    v_accvgpr_read_b32 v90, a198
    v_accvgpr_read_b32 v91, a199
    v_accvgpr_read_b32 v92, a204
    v_accvgpr_read_b32 v93, a205
    v_accvgpr_read_b32 v94, a206
    v_accvgpr_read_b32 v95, a207
    v_pk_mul_f32 v[88:89], v[88:89], v[98:99] op_sel_hi:[1,0]
    v_pk_mul_f32 v[90:91], v[90:91], v[98:99] op_sel_hi:[1,0]
    v_pk_mul_f32 v[92:93], v[92:93], v[98:99] op_sel_hi:[1,0]
    v_pk_mul_f32 v[94:95], v[94:95], v[98:99] op_sel_hi:[1,0]
    v_cvt_pk_bf16_f32 v88, v88, v89
    v_cvt_pk_bf16_f32 v89, v90, v91
    v_cvt_pk_bf16_f32 v90, v92, v93
    v_cvt_pk_bf16_f32 v91, v94, v95
    buffer_store_dwordx4 v[40:43], v1, s[44:47], s37 offen offset:0 sc1
    buffer_store_dwordx4 v[56:59], v1, s[44:47], s37 offen offset:1024 sc1
    s_add_u32 s37, s37, 8192
    buffer_store_dwordx4 v[72:75], v1, s[44:47], s37 offen offset:0 sc1
    buffer_store_dwordx4 v[88:91], v1, s[44:47], s37 offen offset:1024 sc1
L_eb_x:
    s_cmp_eq_u32 s81, s87
    s_cbranch_scc0 L_h1
    s_branch L_fin
L_exit00:
    s_add_u32 m0, s79, s80
    s_add_u32 s69, s68, s71
    s_waitcnt vmcnt(16)
    s_barrier
    buffer_load_dwordx4 v1, s[44:47], s68 offen offset:0 sc1 lds
    buffer_load_dwordx4 v1, s[44:47], s68 offen offset:1024 sc1 lds
    buffer_load_dwordx4 v1, s[44:47], s68 offen offset:2048 sc1 lds
    buffer_load_dwordx4 v1, s[44:47], s68 offen offset:3072 sc1 lds
    s_add_u32 m0, s79, s59
    s_mov_b32 s79, s78
    buffer_load_dwordx4 v1, s[44:47], s69 offen offset:0 sc1 lds
    s_add_u32 s78, s78, 32768
    s_and_b32 s78, s78, 0x1ffff
    s_add_u32 s68, s68, s70
    s_add_u32 s71, s71, s72
    buffer_load_dwordx4 v1, s[44:47], s69 offen offset:1024 sc1 lds
    s_add_u32 s73, s73, 1
    s_cmp_eq_u32 s73, s74
    s_cselect_b32 s68, s86, s68
    buffer_load_dwordx4 v1, s[44:47], s69 offen offset:2048 sc1 lds
    s_cmp_eq_u32 s73, s75
    s_cselect_b32 s68, s76, s68
    s_cselect_b32 s70, 0x4000, s70
    s_cselect_b32 s71, s77, s71
    s_cselect_b32 s72, 0x10000, s72
    buffer_load_dwordx4 v1, s[44:47], s69 offen offset:3072 sc1 lds
    v_add_u32 v120, s78, v1
    s_branch L_eb
L_last1:
    s_add_u32 s81, s81, 1
    ds_read_b128 a[32:35], v120 offset:16384
    ds_read_b128 a[36:39], v120 offset:17408
    ds_read_b128 a[40:43], v120 offset:18432
    ds_read_b128 a[44:47], v120 offset:19456
    ds_read_b128 a[48:51], v120 offset:20480
    ds_read_b128 a[52:55], v120 offset:21504
    ds_read_b128 a[56:59], v120 offset:22528
    ds_read_b128 a[60:63], v120 offset:23552
    v_exp_f32 v229, v213
    v_exp_f32 v230, v214
    v_exp_f32 v231, v215
    s_add_u32 m0, s79, s59
    v_cvt_pk_bf16_f32 v232, v216, v217
    v_cvt_pk_bf16_f32 v233, v218, v219
    v_cvt_pk_bf16_f32 v236, v220, v221
    v_cvt_pk_bf16_f32 v237, v222, v223
    v_cvt_pk_bf16_f32 v234, v224, v225
    v_cvt_pk_bf16_f32 v235, v226, v227
    v_cvt_pk_bf16_f32 v238, v228, v229
    v_cvt_pk_bf16_f32 v239, v230, v231
    s_waitcnt lgkmcnt(7)
    s_nop 0
    v_mfma_f32_16x16x32_bf16 v[128:131], a[32:35], v[232:235], v[128:131]
    s_mov_b32 s79, s78
    v_mfma_f32_16x16x32_bf16 v[132:135], a[32:35], v[236:239], v[132:135]
    s_waitcnt lgkmcnt(6)
    s_add_u32 s78, s78, 32768
    buffer_load_dwordx4 v1, s[44:47], s69 offen offset:0 sc1 lds
    v_mfma_f32_16x16x32_bf16 v[136:139], a[36:39], v[232:235], v[136:139]
    s_and_b32 s78, s78, 0x1ffff
    v_mfma_f32_16x16x32_bf16 v[140:143], a[36:39], v[236:239], v[140:143]
    s_waitcnt lgkmcnt(5)
    s_add_u32 s68, s68, s70
    v_mfma_f32_16x16x32_bf16 v[144:147], a[40:43], v[232:235], v[144:147]
    s_add_u32 s71, s71, s72
    v_mfma_f32_16x16x32_bf16 v[148:151], a[40:43], v[236:239], v[148:151]
    s_waitcnt lgkmcnt(4)
    s_add_u32 s73, s73, 1
    buffer_load_dwordx4 v1, s[44:47], s69 offen offset:1024 sc1 lds
    v_mfma_f32_16x16x32_bf16 v[152:155], a[44:47], v[232:235], v[152:155]
    s_cmp_eq_u32 s73, s74
    v_mfma_f32_16x16x32_bf16 v[156:159], a[44:47], v[236:239], v[156:159]
    s_waitcnt lgkmcnt(3)
    s_cselect_b32 s68, s86, s68
    v_mfma_f32_16x16x32_bf16 v[160:163], a[48:51], v[232:235], v[160:163]
    s_cmp_eq_u32 s73, s75
    v_mfma_f32_16x16x32_bf16 v[164:167], a[48:51], v[236:239], v[164:167]
    s_waitcnt lgkmcnt(2)
    s_cselect_b32 s68, s76, s68
    buffer_load_dwordx4 v1, s[44:47], s69 offen offset:2048 sc1 lds
    v_mfma_f32_16x16x32_bf16 v[168:171], a[52:55], v[232:235], v[168:171]
    s_cselect_b32 s70, 0x4000, s70
    v_mfma_f32_16x16x32_bf16 v[172:175], a[52:55], v[236:239], v[172:175]
    s_waitcnt lgkmcnt(1)
    s_cselect_b32 s71, s77, s71
    v_mfma_f32_16x16x32_bf16 v[176:179], a[56:59], v[232:235], v[176:179]
    s_cselect_b32 s72, 0x10000, s72
    v_mfma_f32_16x16x32_bf16 v[180:183], a[56:59], v[236:239], v[180:183]
    s_waitcnt lgkmcnt(0)
    buffer_load_dwordx4 v1, s[44:47], s69 offen offset:3072 sc1 lds
    v_mfma_f32_16x16x32_bf16 v[184:187], a[60:63], v[232:235], v[184:187]
    v_mfma_f32_16x16x32_bf16 v[188:191], a[60:63], v[236:239], v[188:191]
    v_add_u32 v120, s78, v1
    v_smfmac_f32_16x16x64_bf16 v[192:195], a[216:219], v[232:239], v111
    s_cmp_eq_u32 s52, 3
    s_cbranch_scc1 L_ea
    s_add_u32 m0, s79, s80
    s_add_u32 s69, s68, s71
    s_waitcnt vmcnt(8)
    s_barrier
    buffer_load_dwordx4 v1, s[44:47], s68 offen offset:0 sc1 lds
    buffer_load_dwordx4 v1, s[44:47], s68 offen offset:1024 sc1 lds
    buffer_load_dwordx4 v1, s[44:47], s68 offen offset:2048 sc1 lds
    buffer_load_dwordx4 v1, s[44:47], s68 offen offset:3072 sc1 lds
    s_branch L_exit0
L_last0:
    s_add_u32 s81, s81, 1
    ds_read_b128 a[32:35], v120 offset:0
    ds_read_b128 a[36:39], v120 offset:1024
    ds_read_b128 a[40:43], v120 offset:2048
    ds_read_b128 a[44:47], v120 offset:3072
    ds_read_b128 a[48:51], v120 offset:4096
    ds_read_b128 a[52:55], v120 offset:5120
    ds_read_b128 a[56:59], v120 offset:6144
    ds_read_b128 a[60:63], v120 offset:7168
    v_exp_f32 v229, v213
    v_exp_f32 v230, v214
    v_exp_f32 v231, v215
    s_add_u32 m0, s79, s80
    v_cvt_pk_bf16_f32 v232, v216, v217
    v_cvt_pk_bf16_f32 v233, v218, v219
    v_cvt_pk_bf16_f32 v236, v220, v221
    v_cvt_pk_bf16_f32 v237, v222, v223
    v_cvt_pk_bf16_f32 v234, v224, v225
    v_cvt_pk_bf16_f32 v235, v226, v227
    v_cvt_pk_bf16_f32 v238, v228, v229
    v_cvt_pk_bf16_f32 v239, v230, v231
    s_add_u32 s69, s68, s71
    s_waitcnt vmcnt(8) lgkmcnt(7)
    s_barrier
    s_waitcnt lgkmcnt(7)
    s_nop 0
    v_mfma_f32_16x16x32_bf16 v[128:131], a[32:35], v[232:235], v[128:131]
    v_mfma_f32_16x16x32_bf16 v[132:135], a[32:35], v[236:239], v[132:135]
    s_waitcnt lgkmcnt(6)
    buffer_load_dwordx4 v1, s[44:47], s68 offen offset:0 sc1 lds
    v_mfma_f32_16x16x32_bf16 v[136:139], a[36:39], v[232:235], v[136:139]
    v_mfma_f32_16x16x32_bf16 v[140:143], a[36:39], v[236:239], v[140:143]
    s_waitcnt lgkmcnt(5)
    v_mfma_f32_16x16x32_bf16 v[144:147], a[40:43], v[232:235], v[144:147]
    v_mfma_f32_16x16x32_bf16 v[148:151], a[40:43], v[236:239], v[148:151]
    s_waitcnt lgkmcnt(4)
    buffer_load_dwordx4 v1, s[44:47], s68 offen offset:1024 sc1 lds
    v_mfma_f32_16x16x32_bf16 v[152:155], a[44:47], v[232:235], v[152:155]
    v_mfma_f32_16x16x32_bf16 v[156:159], a[44:47], v[236:239], v[156:159]
    s_waitcnt lgkmcnt(3)
    v_mfma_f32_16x16x32_bf16 v[160:163], a[48:51], v[232:235], v[160:163]
    v_mfma_f32_16x16x32_bf16 v[164:167], a[48:51], v[236:239], v[164:167]
    s_waitcnt lgkmcnt(2)
    buffer_load_dwordx4 v1, s[44:47], s68 offen offset:2048 sc1 lds
    v_mfma_f32_16x16x32_bf16 v[168:171], a[52:55], v[232:235], v[168:171]
    v_mfma_f32_16x16x32_bf16 v[172:175], a[52:55], v[236:239], v[172:175]
    s_waitcnt lgkmcnt(1)
    v_mfma_f32_16x16x32_bf16 v[176:179], a[56:59], v[232:235], v[176:179]
    v_mfma_f32_16x16x32_bf16 v[180:183], a[56:59], v[236:239], v[180:183]
    s_waitcnt lgkmcnt(0)
    buffer_load_dwordx4 v1, s[44:47], s68 offen offset:3072 sc1 lds
    v_mfma_f32_16x16x32_bf16 v[184:187], a[60:63], v[232:235], v[184:187]
    v_mfma_f32_16x16x32_bf16 v[188:191], a[60:63], v[236:239], v[188:191]
    v_smfmac_f32_16x16x64_bf16 v[192:195], a[216:219], v[232:239], v111
L_exit0:
    s_add_u32 m0, s79, s59
    s_mov_b32 s79, s78
    buffer_load_dwordx4 v1, s[44:47], s69 offen offset:0 sc1 lds
    s_add_u32 s78, s78, 32768
    s_and_b32 s78, s78, 0x1ffff
    s_add_u32 s68, s68, s70
    s_add_u32 s71, s71, s72
    buffer_load_dwordx4 v1, s[44:47], s69 offen offset:1024 sc1 lds
    s_add_u32 s73, s73, 1
    s_cmp_eq_u32 s73, s74
    s_cselect_b32 s68, s86, s68
    buffer_load_dwordx4 v1, s[44:47], s69 offen offset:2048 sc1 lds
    s_cmp_eq_u32 s73, s75
    s_cselect_b32 s68, s76, s68
    s_cselect_b32 s70, 0x4000, s70
    s_cselect_b32 s71, s77, s71
    s_cselect_b32 s72, 0x10000, s72
    buffer_load_dwordx4 v1, s[44:47], s69 offen offset:3072 sc1 lds
    v_add_u32 v120, s78, v1
L_ea:
    s_nop 5
    v_add_f32 v196, v192, v193
    v_add_f32 v197, v194, v195
    s_mov_b32 s55, 0x53800000
    v_add_f32 v101, v196, v197
    v_cmp_ngt_f32 vcc, s55, v101
    s_nop 1
    s_cbranch_vccnz L_slow
L_norm1:
    v_rcp_f32 v100, v196
    v_rcp_f32 v102, v197
    s_nop 0
    v_pk_mul_f32 v[128:129], v[128:129], v[100:101] op_sel_hi:[1,0]
    v_pk_mul_f32 v[130:131], v[130:131], v[100:101] op_sel_hi:[1,0]
    v_pk_mul_f32 v[132:133], v[132:133], v[102:103] op_sel_hi:[1,0]
    v_pk_mul_f32 v[134:135], v[134:135], v[102:103] op_sel_hi:[1,0]
    v_pk_mul_f32 v[136:137], v[136:137], v[100:101] op_sel_hi:[1,0]
    v_pk_mul_f32 v[138:139], v[138:139], v[100:101] op_sel_hi:[1,0]
    v_pk_mul_f32 v[140:141], v[140:141], v[102:103] op_sel_hi:[1,0]
    v_pk_mul_f32 v[142:143], v[142:143], v[102:103] op_sel_hi:[1,0]
    s_branch L_pado13
L_pad13:
    s_branch L_tour_ret3
L_pado13:
    v_pk_mul_f32 v[144:145], v[144:145], v[100:101] op_sel_hi:[1,0]
    v_pk_mul_f32 v[146:147], v[146:147], v[100:101] op_sel_hi:[1,0]
    v_pk_mul_f32 v[148:149], v[148:149], v[102:103] op_sel_hi:[1,0]
    v_pk_mul_f32 v[150:151], v[150:151], v[102:103] op_sel_hi:[1,0]
    v_pk_mul_f32 v[152:153], v[152:153], v[100:101] op_sel_hi:[1,0]
    v_pk_mul_f32 v[154:155], v[154:155], v[100:101] op_sel_hi:[1,0]
    v_pk_mul_f32 v[156:157], v[156:157], v[102:103] op_sel_hi:[1,0]
    v_pk_mul_f32 v[158:159], v[158:159], v[102:103] op_sel_hi:[1,0]
    v_pk_mul_f32 v[160:161], v[160:161], v[100:101] op_sel_hi:[1,0]
    v_pk_mul_f32 v[162:163], v[162:163], v[100:101] op_sel_hi:[1,0]
    v_pk_mul_f32 v[164:165], v[164:165], v[102:103] op_sel_hi:[1,0]
    v_pk_mul_f32 v[166:167], v[166:167], v[102:103] op_sel_hi:[1,0]
    v_pk_mul_f32 v[168:169], v[168:169], v[100:101] op_sel_hi:[1,0]
    v_pk_mul_f32 v[170:171], v[170:171], v[100:101] op_sel_hi:[1,0]
    v_pk_mul_f32 v[172:173], v[172:173], v[102:103] op_sel_hi:[1,0]
    v_pk_mul_f32 v[174:175], v[174:175], v[102:103] op_sel_hi:[1,0]
    v_pk_mul_f32 v[176:177], v[176:177], v[100:101] op_sel_hi:[1,0]
    v_pk_mul_f32 v[178:179], v[178:179], v[100:101] op_sel_hi:[1,0]
    v_pk_mul_f32 v[180:181], v[180:181], v[102:103] op_sel_hi:[1,0]
    v_pk_mul_f32 v[182:183], v[182:183], v[102:103] op_sel_hi:[1,0]
    v_pk_mul_f32 v[184:185], v[184:185], v[100:101] op_sel_hi:[1,0]
    v_pk_mul_f32 v[186:187], v[186:187], v[100:101] op_sel_hi:[1,0]
    v_pk_mul_f32 v[188:189], v[188:189], v[102:103] op_sel_hi:[1,0]
    v_pk_mul_f32 v[190:191], v[190:191], v[102:103] op_sel_hi:[1,0]
    v_cvt_pk_bf16_f32 v128, v128, v129
    v_cvt_pk_bf16_f32 v129, v130, v131
    v_cvt_pk_bf16_f32 v130, v136, v137
    v_cvt_pk_bf16_f32 v131, v138, v139
    v_cvt_pk_bf16_f32 v132, v132, v133
    v_cvt_pk_bf16_f32 v133, v134, v135
    v_cvt_pk_bf16_f32 v134, v140, v141
    v_cvt_pk_bf16_f32 v135, v142, v143
    buffer_store_dwordx4 v[128:131], v1, s[44:47], s85 offen offset:0 sc1
    buffer_store_dwordx4 v[132:135], v1, s[44:47], s85 offen offset:1024 sc1
    s_add_u32 s85, s85, 8192
    v_cvt_pk_bf16_f32 v144, v144, v145
    v_cvt_pk_bf16_f32 v145, v146, v147
    v_cvt_pk_bf16_f32 v146, v152, v153
    v_cvt_pk_bf16_f32 v147, v154, v155
    v_cvt_pk_bf16_f32 v148, v148, v149
    v_cvt_pk_bf16_f32 v149, v150, v151
    v_cvt_pk_bf16_f32 v150, v156, v157
    v_cvt_pk_bf16_f32 v151, v158, v159
    buffer_store_dwordx4 v[144:147], v1, s[44:47], s85 offen offset:0 sc1
    buffer_store_dwordx4 v[148:151], v1, s[44:47], s85 offen offset:1024 sc1
    s_add_u32 s85, s85, 8192
    v_cvt_pk_bf16_f32 v160, v160, v161
    v_cvt_pk_bf16_f32 v161, v162, v163
    v_cvt_pk_bf16_f32 v162, v168, v169
    v_cvt_pk_bf16_f32 v163, v170, v171
    v_cvt_pk_bf16_f32 v164, v164, v165
    v_cvt_pk_bf16_f32 v165, v166, v167
    v_cvt_pk_bf16_f32 v166, v172, v173
    v_cvt_pk_bf16_f32 v167, v174, v175
    buffer_store_dwordx4 v[160:163], v1, s[44:47], s85 offen offset:0 sc1
    buffer_store_dwordx4 v[164:167], v1, s[44:47], s85 offen offset:1024 sc1
    s_add_u32 s85, s85, 8192
    v_cvt_pk_bf16_f32 v176, v176, v177
    v_cvt_pk_bf16_f32 v177, v178, v179
    v_cvt_pk_bf16_f32 v178, v184, v185
    v_cvt_pk_bf16_f32 v179, v186, v187
    v_cvt_pk_bf16_f32 v180, v180, v181
    v_cvt_pk_bf16_f32 v181, v182, v183
    v_cvt_pk_bf16_f32 v182, v188, v189
    v_cvt_pk_bf16_f32 v183, v190, v191
    buffer_store_dwordx4 v[176:179], v1, s[44:47], s85 offen offset:0 sc1
    buffer_store_dwordx4 v[180:183], v1, s[44:47], s85 offen offset:1024 sc1
    s_cmp_eq_u32 s84, 1
    s_cbranch_scc1 L_slowb_x
    s_cmp_eq_u32 s52, 1
    s_cbranch_scc1 L_eb2
    s_cmp_eq_u32 s52, 0
    s_cbranch_scc1 L_exit00
L_fin:
    ds_read_b128 a[104:107], v8 offset:0
    ds_read_b128 a[108:111], v8 offset:16384
    ds_read_b128 a[72:75], v4 offset:0
    ds_read_b128 a[76:79], v4 offset:16384
    ds_read_b128 a[80:83], v5 offset:0
    ds_read_b128 a[84:87], v5 offset:16384
    ds_read_b128 a[88:91], v6 offset:0
    ds_read_b128 a[92:95], v6 offset:16384
    ds_read_b128 a[96:99], v7 offset:0
    ds_read_b128 a[100:103], v7 offset:16384
    ds_read_b128 a[112:115], v8 offset:1024
    ds_read_b128 a[116:119], v8 offset:17408
    ds_read_b128 a[120:123], v8 offset:2048
    ds_read_b128 a[124:127], v8 offset:18432
    ds_read_b128 a[128:131], v8 offset:3072
    ds_read_b128 a[132:135], v8 offset:19456
    ds_read_b128 a[136:139], v9 offset:0
    ds_read_b128 a[140:143], v9 offset:2048
    v_add_u32 v8, s61, v14
    v_add_u32 v9, 4096, v15
    v_add_u32 v4, s61, v10
    v_add_u32 v5, s61, v11
    v_add_u32 v6, s61, v12
    v_add_u32 v7, s61, v13
    s_cmp_eq_u32 s88, 2
    s_cbranch_scc1 L_slowb
L_post_x:
L_attn_done:
    s_waitcnt lgkmcnt(0)
    v_mfma_f32_16x16x32_bf16 v[32:35], a[104:107], a[72:75], 0
    s_waitcnt vmcnt(16)
    s_barrier
    v_mfma_f32_16x16x32_bf16 v[32:35], a[108:111], a[76:79], v[32:35]
    s_add_u32 m0, s79, s80
    ds_read_b128 a[176:179], v8 offset:0
    v_mov_b32 v29, -1
    v_mfma_f32_16x16x32_bf16 v[52:55], a[104:107], a[80:83], 0
    buffer_load_dwordx4 v1, s[44:47], s68 offen offset:0 sc1 lds
    v_mfma_f32_16x16x32_bf16 v[52:55], a[108:111], a[84:87], v[52:55]
    ds_read_b128 a[180:183], v8 offset:16384
    v_cmp_gt_u32 vcc, 8, v2
    v_mfma_f32_16x16x32_bf16 v[72:75], a[104:107], a[88:91], 0
    ds_read_b128 a[144:147], v4 offset:0
    v_and_b32 v20, 3, v2
    v_mfma_f32_16x16x32_bf16 v[72:75], a[108:111], a[92:95], v[72:75]
    buffer_load_dwordx4 v1, s[44:47], s68 offen offset:1024 sc1 lds
    v_mfma_f32_16x16x32_bf16 v[92:95], a[104:107], a[96:99], 0
    ds_read_b128 a[148:151], v4 offset:16384
    v_bfe_u32 v21, v2, 2, 1
    v_mfma_f32_16x16x32_bf16 v[92:95], a[108:111], a[100:103], v[92:95]
    ds_read_b128 a[152:155], v5 offset:0
    v_lshl_add_u32 v20, v20, 3, v21
    v_mfma_f32_16x16x32_bf16 v[36:39], a[112:115], a[72:75], 0
    buffer_load_dwordx4 v1, s[44:47], s68 offen offset:2048 sc1 lds
    v_mfma_f32_16x16x32_bf16 v[36:39], a[116:119], a[76:79], v[36:39]
    ds_read_b128 a[156:159], v5 offset:16384
    v_lshl_add_u32 v19, v20, 9, s27
    v_mfma_f32_16x16x32_bf16 v[56:59], a[112:115], a[80:83], 0
    ds_read_b128 a[160:163], v6 offset:0
    v_mov_b32 v20, 0x7fff0000
    v_mfma_f32_16x16x32_bf16 v[56:59], a[116:119], a[84:87], v[56:59]
    buffer_load_dwordx4 v1, s[44:47], s68 offen offset:3072 sc1 lds
    v_mfma_f32_16x16x32_bf16 v[76:79], a[112:115], a[88:91], 0
    s_add_u32 s69, s68, s71
    ds_read_b128 a[164:167], v6 offset:16384
    v_cndmask_b32 v19, v20, v19, vcc
    v_mfma_f32_16x16x32_bf16 v[76:79], a[116:119], a[92:95], v[76:79]
    s_add_u32 m0, s79, s59
    ds_read_b128 a[168:171], v7 offset:0
    v_cndmask_b32 v17, 0, v29, vcc
    v_mfma_f32_16x16x32_bf16 v[96:99], a[112:115], a[96:99], 0
    buffer_load_dwordx4 v1, s[44:47], s69 offen offset:0 sc1 lds
    v_mfma_f32_16x16x32_bf16 v[96:99], a[116:119], a[100:103], v[96:99]
    ds_read_b128 a[172:175], v7 offset:16384
    v_and_b32 v20, 15, v2
    v_mfma_f32_16x16x32_bf16 v[40:43], a[120:123], a[72:75], 0
    ds_read_b128 a[184:187], v8 offset:1024
    v_mul_u32_u24 v20, 160, v20
    v_mfma_f32_16x16x32_bf16 v[40:43], a[124:127], a[76:79], v[40:43]
    buffer_load_dwordx4 v1, s[44:47], s69 offen offset:1024 sc1 lds
    v_mfma_f32_16x16x32_bf16 v[60:63], a[120:123], a[80:83], 0
    ds_read_b128 a[188:191], v8 offset:17408
    v_lshrrev_b32 v21, 4, v2
    v_mfma_f32_16x16x32_bf16 v[60:63], a[124:127], a[84:87], v[60:63]
    ds_read_b128 a[192:195], v8 offset:2048
    v_lshl_add_u32 v20, v21, 3, v20
    v_mfma_f32_16x16x32_bf16 v[80:83], a[120:123], a[88:91], 0
    buffer_load_dwordx4 v1, s[44:47], s69 offen offset:2048 sc1 lds
    v_mfma_f32_16x16x32_bf16 v[80:83], a[124:127], a[92:95], v[80:83]
    ds_read_b128 a[196:199], v8 offset:18432
    v_add_u32 v16, s39, v20
    v_mfma_f32_16x16x32_bf16 v[100:103], a[120:123], a[96:99], 0
    ds_read_b128 a[200:203], v8 offset:3072
    v_lshlrev_b32 v18, 3, v2
    v_mfma_f32_16x16x32_bf16 v[100:103], a[124:127], a[100:103], v[100:103]
    buffer_load_dwordx4 v1, s[44:47], s69 offen offset:3072 sc1 lds
    v_mfma_f32_16x16x32_bf16 v[44:47], a[128:131], a[72:75], 0
    s_nop 0
    ds_read_b128 a[204:207], v8 offset:19456
    v_min_u32 v20, 2, v2
    v_mfma_f32_16x16x32_bf16 v[44:47], a[132:135], a[76:79], v[44:47]
    s_add_u32 m0, s60, s80
    ds_read_b128 a[208:211], v9 offset:0
    v_add_u32 v20, s12, v20
    v_mfma_f32_16x16x32_bf16 v[64:67], a[128:131], a[80:83], 0
    buffer_load_dwordx4 v1, s[8:11], s15 offen offset:0 sc1 lds
    v_mfma_f32_16x16x32_bf16 v[64:67], a[132:135], a[84:87], v[64:67]
    ds_read_b128 a[212:215], v9 offset:2048
    v_add_u32 v20, 1, v20
    v_mfma_f32_16x16x32_bf16 v[84:87], a[128:131], a[88:91], 0
    v_add_u32 v8, s62, v14
    v_add_u32 v9, 8192, v15
    v_mfma_f32_16x16x32_bf16 v[84:87], a[132:135], a[92:95], v[84:87]
    buffer_load_dwordx4 v1, s[8:11], s15 offen offset:1024 sc1 lds
    v_mfma_f32_16x16x32_bf16 v[104:107], a[128:131], a[96:99], 0
    v_add_u32 v4, s62, v10
    v_add_u32 v5, s62, v11
    v_mfma_f32_16x16x32_bf16 v[104:107], a[132:135], a[100:103], v[104:107]
    v_add_u32 v6, s62, v12
    v_add_u32 v7, s62, v13
    v_mfma_f32_16x16x32_bf16 v[48:51], a[136:139], a[72:75], 0
    buffer_load_dwordx4 v1, s[8:11], s15 offen offset:2048 sc1 lds
    v_mfma_f32_16x16x32_bf16 v[48:51], a[140:143], a[76:79], v[48:51]
    v_and_b32 v20, 3, v20
    v_lshl_add_u32 v30, v20, 10, s24
    v_mfma_f32_16x16x32_bf16 v[68:71], a[136:139], a[80:83], 0
    v_cmp_gt_u32 vcc, 32, v2
    v_add_u32 v20, 0, v2
    v_mfma_f32_16x16x32_bf16 v[68:71], a[140:143], a[84:87], v[68:71]
    buffer_load_dwordx4 v1, s[8:11], s15 offen offset:3072 sc1 lds
    v_mfma_f32_16x16x32_bf16 v[88:91], a[136:139], a[88:91], 0
    s_add_u32 s15, s15, 16384
    v_mul_u32_u24 v20, 6554, v20
    v_lshrrev_b32 v20, 16, v20
    v_mfma_f32_16x16x32_bf16 v[88:91], a[140:143], a[92:95], v[88:91]
    v_mul_u32_u24 v20, 1120, v20
    v_add_u32 v124, v20, v1
    v_mfma_f32_16x16x32_bf16 v[108:111], a[136:139], a[96:99], 0
    s_waitcnt lgkmcnt(0)
    v_add_u32 v20, 64, v2
    v_mul_u32_u24 v20, 6554, v20
    v_mfma_f32_16x16x32_bf16 v[108:111], a[140:143], a[100:103], v[108:111]
    v_lshrrev_b32 v20, 16, v20
    v_mul_u32_u24 v20, 1120, v20
    v_mfma_f32_16x16x32_bf16 v[32:35], a[176:179], a[144:147], v[32:35]
    s_waitcnt vmcnt(20)
    s_barrier
    v_mfma_f32_16x16x32_bf16 v[32:35], a[180:183], a[148:151], v[32:35]
    s_add_u32 m0, s60, s59
    ds_read_b128 a[104:107], v8 offset:0
    v_add_u32 v125, v20, v1
    v_mfma_f32_16x16x32_bf16 v[52:55], a[176:179], a[152:155], v[52:55]
    buffer_load_dwordx4 v1, s[8:11], s16 offen offset:0 sc1 lds
    v_mfma_f32_16x16x32_bf16 v[52:55], a[180:183], a[156:159], v[52:55]
    ds_read_b128 a[108:111], v8 offset:16384
    v_add_u32 v20, 128, v2
    v_mfma_f32_16x16x32_bf16 v[72:75], a[176:179], a[160:163], v[72:75]
    buffer_load_dwordx4 v1, s[8:11], s16 offen offset:1024 sc1 lds
    v_mfma_f32_16x16x32_bf16 v[72:75], a[180:183], a[164:167], v[72:75]
    ds_read_b128 a[72:75], v4 offset:0
    v_mul_u32_u24 v20, 6554, v20
    v_mfma_f32_16x16x32_bf16 v[92:95], a[176:179], a[168:171], v[92:95]
    ds_read_b128 a[76:79], v4 offset:16384
    v_lshrrev_b32 v20, 16, v20
    v_mfma_f32_16x16x32_bf16 v[92:95], a[180:183], a[172:175], v[92:95]
    buffer_load_dwordx4 v1, s[8:11], s16 offen offset:2048 sc1 lds
    v_mfma_f32_16x16x32_bf16 v[36:39], a[184:187], a[144:147], v[36:39]
    ds_read_b128 a[80:83], v5 offset:0
    v_mul_u32_u24 v20, 1120, v20
    v_mfma_f32_16x16x32_bf16 v[36:39], a[188:191], a[148:151], v[36:39]
    buffer_load_dwordx4 v1, s[8:11], s16 offen offset:3072 sc1 lds
    v_mfma_f32_16x16x32_bf16 v[56:59], a[184:187], a[152:155], v[56:59]
    s_add_u32 s17, s16, 4096
    ds_read_b128 a[84:87], v5 offset:16384
    v_add_u32 v126, v20, v1
    v_mfma_f32_16x16x32_bf16 v[56:59], a[188:191], a[156:159], v[56:59]
    s_add_u32 m0, s26, 0
    ds_read_b128 a[88:91], v6 offset:0
    v_mov_b32 v20, 0x7fff0000
    v_mfma_f32_16x16x32_bf16 v[76:79], a[184:187], a[160:163], v[76:79]
    buffer_load_dwordx4 v1, s[8:11], s17 offen offset:0 sc1 lds
    v_mfma_f32_16x16x32_bf16 v[76:79], a[188:191], a[164:167], v[76:79]
    s_add_u32 s16, s16, 81920
    s_add_u32 m0, s61, s80
    ds_read_b128 a[92:95], v6 offset:16384
    v_cndmask_b32 v126, v20, v126, vcc
    v_mfma_f32_16x16x32_bf16 v[96:99], a[184:187], a[168:171], v[96:99]
    buffer_load_dwordx4 v1, s[8:11], s15 offen offset:0 sc1 lds
    v_mfma_f32_16x16x32_bf16 v[96:99], a[188:191], a[172:175], v[96:99]
    ds_read_b128 a[96:99], v7 offset:0
    v_add_u32 v127, s39, v1
    v_mfma_f32_16x16x32_bf16 v[40:43], a[192:195], a[144:147], v[40:43]
    s_waitcnt vmcnt(18)
    ds_read_b128 a[100:103], v7 offset:16384
    buffer_store_dword v29, off, s[44:47], s100 offset:12 sc1
    v_mfma_f32_16x16x32_bf16 v[40:43], a[196:199], a[148:151], v[40:43]
    buffer_load_dwordx4 v1, s[8:11], s15 offen offset:1024 sc1 lds
    v_mfma_f32_16x16x32_bf16 v[60:63], a[192:195], a[152:155], v[60:63]
    ds_read_b128 a[112:115], v8 offset:1024
    v_mfma_f32_16x16x32_bf16 v[60:63], a[196:199], a[156:159], v[60:63]
    buffer_load_dwordx4 v1, s[8:11], s15 offen offset:2048 sc1 lds
    v_mfma_f32_16x16x32_bf16 v[80:83], a[192:195], a[160:163], v[80:83]
    ds_read_b128 a[116:119], v8 offset:17408
    v_mfma_f32_16x16x32_bf16 v[80:83], a[196:199], a[164:167], v[80:83]
    ds_read_b128 a[120:123], v8 offset:2048
    v_mfma_f32_16x16x32_bf16 v[100:103], a[192:195], a[168:171], v[100:103]
    buffer_load_dwordx4 v1, s[8:11], s15 offen offset:3072 sc1 lds
    v_mfma_f32_16x16x32_bf16 v[100:103], a[196:199], a[172:175], v[100:103]
    s_add_u32 s15, s15, 16384
    s_add_u32 m0, s61, s59
    ds_read_b128 a[124:127], v8 offset:18432
    v_mfma_f32_16x16x32_bf16 v[44:47], a[200:203], a[144:147], v[44:47]
    buffer_load_dwordx4 v1, s[8:11], s16 offen offset:0 sc1 lds
    v_mfma_f32_16x16x32_bf16 v[44:47], a[204:207], a[148:151], v[44:47]
    ds_read_b128 a[128:131], v8 offset:3072
    v_mfma_f32_16x16x32_bf16 v[64:67], a[200:203], a[152:155], v[64:67]
    ds_read_b128 a[132:135], v8 offset:19456
    v_mfma_f32_16x16x32_bf16 v[64:67], a[204:207], a[156:159], v[64:67]
    buffer_load_dwordx4 v1, s[8:11], s16 offen offset:1024 sc1 lds
    v_mfma_f32_16x16x32_bf16 v[84:87], a[200:203], a[160:163], v[84:87]
    ds_read_b128 a[136:139], v9 offset:0
    v_mfma_f32_16x16x32_bf16 v[84:87], a[204:207], a[164:167], v[84:87]
    buffer_load_dwordx4 v1, s[8:11], s16 offen offset:2048 sc1 lds
    v_mfma_f32_16x16x32_bf16 v[104:107], a[200:203], a[168:171], v[104:107]
    ds_read_b128 a[140:143], v9 offset:2048
    v_mfma_f32_16x16x32_bf16 v[104:107], a[204:207], a[172:175], v[104:107]
    v_add_u32 v8, s63, v14
    v_add_u32 v9, 12288, v15
    v_mfma_f32_16x16x32_bf16 v[48:51], a[208:211], a[144:147], v[48:51]
    buffer_load_dwordx4 v1, s[8:11], s16 offen offset:3072 sc1 lds
    v_mfma_f32_16x16x32_bf16 v[48:51], a[212:215], a[148:151], v[48:51]
    s_add_u32 s17, s16, 4096
    s_add_u32 m0, s26, 4096
    v_add_u32 v4, s63, v10
    v_add_u32 v5, s63, v11
    v_mfma_f32_16x16x32_bf16 v[68:71], a[208:211], a[152:155], v[68:71]
    buffer_load_dwordx4 v1, s[8:11], s17 offen offset:0 sc1 lds
    v_mfma_f32_16x16x32_bf16 v[68:71], a[212:215], a[156:159], v[68:71]
    s_add_u32 s16, s16, 81920
    v_add_u32 v6, s63, v12
    v_add_u32 v7, s63, v13
    v_mfma_f32_16x16x32_bf16 v[88:91], a[208:211], a[160:163], v[88:91]
    v_mfma_f32_16x16x32_bf16 v[88:91], a[212:215], a[164:167], v[88:91]
    v_mfma_f32_16x16x32_bf16 v[108:111], a[208:211], a[168:171], v[108:111]
    s_waitcnt lgkmcnt(0)
    s_cmp_eq_u32 s12, 3
    s_cselect_b32 s10, 0, s10
    v_mfma_f32_16x16x32_bf16 v[108:111], a[212:215], a[172:175], v[108:111]
    v_mfma_f32_16x16x32_bf16 v[32:35], a[104:107], a[72:75], v[32:35]
    s_waitcnt vmcnt(19)
    s_barrier
    v_mfma_f32_16x16x32_bf16 v[32:35], a[108:111], a[76:79], v[32:35]
    s_add_u32 m0, s62, s80
    ds_read_b128 a[176:179], v8 offset:0
    v_mfma_f32_16x16x32_bf16 v[52:55], a[104:107], a[80:83], v[52:55]
    buffer_load_dwordx4 v1, s[8:11], s15 offen offset:0 sc1 lds
    v_mfma_f32_16x16x32_bf16 v[52:55], a[108:111], a[84:87], v[52:55]
    ds_read_b128 a[180:183], v8 offset:16384
    v_mfma_f32_16x16x32_bf16 v[72:75], a[104:107], a[88:91], v[72:75]
    ds_read_b128 a[144:147], v4 offset:0
    v_mfma_f32_16x16x32_bf16 v[72:75], a[108:111], a[92:95], v[72:75]
    buffer_load_dwordx4 v1, s[8:11], s15 offen offset:1024 sc1 lds
    v_mfma_f32_16x16x32_bf16 v[92:95], a[104:107], a[96:99], v[92:95]
    ds_read_b128 a[148:151], v4 offset:16384
    v_mfma_f32_16x16x32_bf16 v[92:95], a[108:111], a[100:103], v[92:95]
    ds_read_b128 a[152:155], v5 offset:0
    v_mfma_f32_16x16x32_bf16 v[36:39], a[112:115], a[72:75], v[36:39]
    ds_read_b128 a[156:159], v5 offset:16384
    v_mfma_f32_16x16x32_bf16 v[36:39], a[116:119], a[76:79], v[36:39]
    buffer_load_dwordx4 v1, s[8:11], s15 offen offset:2048 sc1 lds
    v_mfma_f32_16x16x32_bf16 v[56:59], a[112:115], a[80:83], v[56:59]
    ds_read_b128 a[160:163], v6 offset:0
    v_mfma_f32_16x16x32_bf16 v[56:59], a[116:119], a[84:87], v[56:59]
    ds_read_b128 a[164:167], v6 offset:16384
    v_mfma_f32_16x16x32_bf16 v[76:79], a[112:115], a[88:91], v[76:79]
    ds_read_b128 a[168:171], v7 offset:0
    v_mfma_f32_16x16x32_bf16 v[76:79], a[116:119], a[92:95], v[76:79]
    buffer_load_dwordx4 v1, s[8:11], s15 offen offset:3072 sc1 lds
    v_mfma_f32_16x16x32_bf16 v[96:99], a[112:115], a[96:99], v[96:99]
    s_add_u32 s15, s15, 16384
    ds_read_b128 a[172:175], v7 offset:16384
    v_mfma_f32_16x16x32_bf16 v[96:99], a[116:119], a[100:103], v[96:99]
    ds_read_b128 a[184:187], v8 offset:1024
    v_mfma_f32_16x16x32_bf16 v[40:43], a[120:123], a[72:75], v[40:43]
    s_add_u32 m0, s62, s59
    ds_read_b128 a[188:191], v8 offset:17408
    v_mfma_f32_16x16x32_bf16 v[40:43], a[124:127], a[76:79], v[40:43]
    buffer_load_dwordx4 v1, s[8:11], s16 offen offset:0 sc1 lds
    v_mfma_f32_16x16x32_bf16 v[60:63], a[120:123], a[80:83], v[60:63]
    ds_read_b128 a[192:195], v8 offset:2048
    v_mfma_f32_16x16x32_bf16 v[60:63], a[124:127], a[84:87], v[60:63]
    ds_read_b128 a[196:199], v8 offset:18432
    v_mfma_f32_16x16x32_bf16 v[80:83], a[120:123], a[88:91], v[80:83]
    buffer_load_dwordx4 v1, s[8:11], s16 offen offset:1024 sc1 lds
    v_mfma_f32_16x16x32_bf16 v[80:83], a[124:127], a[92:95], v[80:83]
    ds_read_b128 a[200:203], v8 offset:3072
    v_mfma_f32_16x16x32_bf16 v[100:103], a[120:123], a[96:99], v[100:103]
    ds_read_b128 a[204:207], v8 offset:19456
    v_mfma_f32_16x16x32_bf16 v[100:103], a[124:127], a[100:103], v[100:103]
    ds_read_b128 a[208:211], v9 offset:0
    v_mfma_f32_16x16x32_bf16 v[44:47], a[128:131], a[72:75], v[44:47]
    buffer_load_dwordx4 v1, s[8:11], s16 offen offset:2048 sc1 lds
    v_mfma_f32_16x16x32_bf16 v[44:47], a[132:135], a[76:79], v[44:47]
    ds_read_b128 a[212:215], v9 offset:2048
    v_mfma_f32_16x16x32_bf16 v[64:67], a[128:131], a[80:83], v[64:67]
    v_add_u32 v8, s60, v14
    v_add_u32 v9, 0, v15
    v_mfma_f32_16x16x32_bf16 v[64:67], a[132:135], a[84:87], v[64:67]
    v_add_u32 v4, s60, v10
    v_add_u32 v5, s60, v11
    v_mfma_f32_16x16x32_bf16 v[84:87], a[128:131], a[88:91], v[84:87]
    buffer_load_dwordx4 v1, s[8:11], s16 offen offset:3072 sc1 lds
    v_mfma_f32_16x16x32_bf16 v[84:87], a[132:135], a[92:95], v[84:87]
    s_add_u32 s17, s16, 4096
    v_add_u32 v6, s60, v12
    v_add_u32 v7, s60, v13
    v_mfma_f32_16x16x32_bf16 v[104:107], a[128:131], a[96:99], v[104:107]
    v_mfma_f32_16x16x32_bf16 v[104:107], a[132:135], a[100:103], v[104:107]
    s_add_u32 m0, s26, 8192
    v_mfma_f32_16x16x32_bf16 v[48:51], a[136:139], a[72:75], v[48:51]
    buffer_load_dwordx4 v1, s[8:11], s17 offen offset:0 sc1 lds
    v_mfma_f32_16x16x32_bf16 v[48:51], a[140:143], a[76:79], v[48:51]
    s_add_u32 s16, s16, 81920
    v_mfma_f32_16x16x32_bf16 v[68:71], a[136:139], a[80:83], v[68:71]
    v_mfma_f32_16x16x32_bf16 v[68:71], a[140:143], a[84:87], v[68:71]
    v_mfma_f32_16x16x32_bf16 v[88:91], a[136:139], a[88:91], v[88:91]
    v_mfma_f32_16x16x32_bf16 v[88:91], a[140:143], a[92:95], v[88:91]
    s_mov_b32 s10, 268435456
    v_mfma_f32_16x16x32_bf16 v[108:111], a[136:139], a[96:99], v[108:111]
    s_waitcnt lgkmcnt(0)
    s_mov_b32 s16, s19
    v_mfma_f32_16x16x32_bf16 v[108:111], a[140:143], a[100:103], v[108:111]
    s_mov_b32 s15, s18
    v_mfma_f32_16x16x32_bf16 v[32:35], a[176:179], a[144:147], v[32:35]
    s_waitcnt vmcnt(19)
    s_barrier
    v_mfma_f32_16x16x32_bf16 v[32:35], a[180:183], a[148:151], v[32:35]
    s_add_u32 m0, s63, s80
    ds_read_b128 a[104:107], v8 offset:0
    v_mfma_f32_16x16x32_bf16 v[52:55], a[176:179], a[152:155], v[52:55]
    buffer_load_dwordx4 v1, s[8:11], s15 offen offset:0 sc1 lds
    v_mfma_f32_16x16x32_bf16 v[52:55], a[180:183], a[156:159], v[52:55]
    ds_read_b128 a[108:111], v8 offset:16384
    v_mfma_f32_16x16x32_bf16 v[72:75], a[176:179], a[160:163], v[72:75]
    ds_read_b128 a[72:75], v4 offset:0
    v_mfma_f32_16x16x32_bf16 v[72:75], a[180:183], a[164:167], v[72:75]
    buffer_load_dwordx4 v1, s[8:11], s15 offen offset:1024 sc1 lds
    v_mfma_f32_16x16x32_bf16 v[92:95], a[176:179], a[168:171], v[92:95]
    ds_read_b128 a[76:79], v4 offset:16384
    v_mfma_f32_16x16x32_bf16 v[92:95], a[180:183], a[172:175], v[92:95]
    ds_read_b128 a[80:83], v5 offset:0
    v_mfma_f32_16x16x32_bf16 v[36:39], a[184:187], a[144:147], v[36:39]
    ds_read_b128 a[84:87], v5 offset:16384
    v_mfma_f32_16x16x32_bf16 v[36:39], a[188:191], a[148:151], v[36:39]
    buffer_load_dwordx4 v1, s[8:11], s15 offen offset:2048 sc1 lds
    v_mfma_f32_16x16x32_bf16 v[56:59], a[184:187], a[152:155], v[56:59]
    ds_read_b128 a[88:91], v6 offset:0
    buffer_load_dword v31, v19, s[44:47], 0 offen offset:0 sc1
    v_mfma_f32_16x16x32_bf16 v[56:59], a[188:191], a[156:159], v[56:59]
    ds_read_b128 a[92:95], v6 offset:16384
    v_mfma_f32_16x16x32_bf16 v[76:79], a[184:187], a[160:163], v[76:79]
    ds_read_b128 a[96:99], v7 offset:0
    v_mfma_f32_16x16x32_bf16 v[76:79], a[188:191], a[164:167], v[76:79]
    buffer_load_dwordx4 v1, s[8:11], s15 offen offset:3072 sc1 lds
    v_mfma_f32_16x16x32_bf16 v[96:99], a[184:187], a[168:171], v[96:99]
    s_add_u32 s15, s15, 16384
    ds_read_b128 a[100:103], v7 offset:16384
    v_mfma_f32_16x16x32_bf16 v[96:99], a[188:191], a[172:175], v[96:99]
    ds_read_b128 a[112:115], v8 offset:1024
    v_mfma_f32_16x16x32_bf16 v[40:43], a[192:195], a[144:147], v[40:43]
    s_add_u32 m0, s63, s59
    ds_read_b128 a[116:119], v8 offset:17408
    v_mfma_f32_16x16x32_bf16 v[40:43], a[196:199], a[148:151], v[40:43]
    buffer_load_dwordx4 v1, s[8:11], s16 offen offset:0 sc1 lds
    v_mfma_f32_16x16x32_bf16 v[60:63], a[192:195], a[152:155], v[60:63]
    ds_read_b128 a[120:123], v8 offset:2048
    v_mfma_f32_16x16x32_bf16 v[60:63], a[196:199], a[156:159], v[60:63]
    ds_read_b128 a[124:127], v8 offset:18432
    v_mfma_f32_16x16x32_bf16 v[80:83], a[192:195], a[160:163], v[80:83]
    buffer_load_dwordx4 v1, s[8:11], s16 offen offset:1024 sc1 lds
    v_mfma_f32_16x16x32_bf16 v[80:83], a[196:199], a[164:167], v[80:83]
    ds_read_b128 a[128:131], v8 offset:3072
    v_mfma_f32_16x16x32_bf16 v[100:103], a[192:195], a[168:171], v[100:103]
    ds_read_b128 a[132:135], v8 offset:19456
    v_mfma_f32_16x16x32_bf16 v[100:103], a[196:199], a[172:175], v[100:103]
    ds_read_b128 a[136:139], v9 offset:0
    v_mfma_f32_16x16x32_bf16 v[44:47], a[200:203], a[144:147], v[44:47]
    buffer_load_dwordx4 v1, s[8:11], s16 offen offset:2048 sc1 lds
    v_mfma_f32_16x16x32_bf16 v[44:47], a[204:207], a[148:151], v[44:47]
    ds_read_b128 a[140:143], v9 offset:2048
    v_mfma_f32_16x16x32_bf16 v[64:67], a[200:203], a[152:155], v[64:67]
    v_add_u32 v8, s61, v14
    v_add_u32 v9, 4096, v15
    v_mfma_f32_16x16x32_bf16 v[64:67], a[204:207], a[156:159], v[64:67]
    v_add_u32 v4, s61, v10
    v_add_u32 v5, s61, v11
    v_mfma_f32_16x16x32_bf16 v[84:87], a[200:203], a[160:163], v[84:87]
    buffer_load_dwordx4 v1, s[8:11], s16 offen offset:3072 sc1 lds
    v_mfma_f32_16x16x32_bf16 v[84:87], a[204:207], a[164:167], v[84:87]
    s_add_u32 s17, s16, 4096
    v_add_u32 v6, s61, v12
    v_add_u32 v7, s61, v13
    v_mfma_f32_16x16x32_bf16 v[104:107], a[200:203], a[168:171], v[104:107]
    v_mfma_f32_16x16x32_bf16 v[104:107], a[204:207], a[172:175], v[104:107]
    s_add_u32 m0, s26, 12288
    v_mfma_f32_16x16x32_bf16 v[48:51], a[208:211], a[144:147], v[48:51]
    buffer_load_dwordx4 v1, s[8:11], s17 offen offset:0 sc1 lds
    v_mfma_f32_16x16x32_bf16 v[48:51], a[212:215], a[148:151], v[48:51]
    s_add_u32 s16, s16, 81920
    v_mfma_f32_16x16x32_bf16 v[68:71], a[208:211], a[152:155], v[68:71]
    v_mfma_f32_16x16x32_bf16 v[68:71], a[212:215], a[156:159], v[68:71]
    v_mfma_f32_16x16x32_bf16 v[88:91], a[208:211], a[160:163], v[88:91]
    v_mfma_f32_16x16x32_bf16 v[88:91], a[212:215], a[164:167], v[88:91]
    v_mfma_f32_16x16x32_bf16 v[108:111], a[208:211], a[168:171], v[108:111]
    s_waitcnt lgkmcnt(0)
    v_mfma_f32_16x16x32_bf16 v[108:111], a[212:215], a[172:175], v[108:111]
    v_mfma_f32_16x16x32_bf16 v[32:35], a[104:107], a[72:75], v[32:35]
    s_waitcnt vmcnt(19)
    s_barrier
    v_mfma_f32_16x16x32_bf16 v[32:35], a[108:111], a[76:79], v[32:35]
    s_add_u32 m0, s60, s80
    ds_read_b128 a[176:179], v8 offset:0
    v_mfma_f32_16x16x32_bf16 v[52:55], a[104:107], a[80:83], v[52:55]
    buffer_load_dwordx4 v1, s[8:11], s15 offen offset:0 sc1 lds
    v_mfma_f32_16x16x32_bf16 v[52:55], a[108:111], a[84:87], v[52:55]
    ds_read_b128 a[180:183], v8 offset:16384
    v_mfma_f32_16x16x32_bf16 v[72:75], a[104:107], a[88:91], v[72:75]
    ds_read_b128 a[144:147], v4 offset:0
    v_mfma_f32_16x16x32_bf16 v[72:75], a[108:111], a[92:95], v[72:75]
    buffer_load_dwordx4 v1, s[8:11], s15 offen offset:1024 sc1 lds
    v_mfma_f32_16x16x32_bf16 v[92:95], a[104:107], a[96:99], v[92:95]
    ds_read_b128 a[148:151], v4 offset:16384
    v_mfma_f32_16x16x32_bf16 v[92:95], a[108:111], a[100:103], v[92:95]
    ds_read_b128 a[152:155], v5 offset:0
    v_mfma_f32_16x16x32_bf16 v[36:39], a[112:115], a[72:75], v[36:39]
    ds_read_b128 a[156:159], v5 offset:16384
    v_mfma_f32_16x16x32_bf16 v[36:39], a[116:119], a[76:79], v[36:39]
    buffer_load_dwordx4 v1, s[8:11], s15 offen offset:2048 sc1 lds
    v_mfma_f32_16x16x32_bf16 v[56:59], a[112:115], a[80:83], v[56:59]
    ds_read_b128 a[160:163], v6 offset:0
    v_mfma_f32_16x16x32_bf16 v[56:59], a[116:119], a[84:87], v[56:59]
    ds_read_b128 a[164:167], v6 offset:16384
    v_mfma_f32_16x16x32_bf16 v[76:79], a[112:115], a[88:91], v[76:79]
    ds_read_b128 a[168:171], v7 offset:0
    v_mfma_f32_16x16x32_bf16 v[76:79], a[116:119], a[92:95], v[76:79]
    buffer_load_dwordx4 v1, s[8:11], s15 offen offset:3072 sc1 lds
    v_mfma_f32_16x16x32_bf16 v[96:99], a[112:115], a[96:99], v[96:99]
    s_add_u32 s15, s15, 16384
    ds_read_b128 a[172:175], v7 offset:16384
    v_mfma_f32_16x16x32_bf16 v[96:99], a[116:119], a[100:103], v[96:99]
    ds_read_b128 a[184:187], v8 offset:1024
    v_mfma_f32_16x16x32_bf16 v[40:43], a[120:123], a[72:75], v[40:43]
    s_add_u32 m0, s60, s59
    ds_read_b128 a[188:191], v8 offset:17408
    v_mfma_f32_16x16x32_bf16 v[40:43], a[124:127], a[76:79], v[40:43]
    buffer_load_dwordx4 v1, s[8:11], s16 offen offset:0 sc1 lds
    v_mfma_f32_16x16x32_bf16 v[60:63], a[120:123], a[80:83], v[60:63]
    ds_read_b128 a[192:195], v8 offset:2048
    v_mfma_f32_16x16x32_bf16 v[60:63], a[124:127], a[84:87], v[60:63]
    ds_read_b128 a[196:199], v8 offset:18432
    v_mfma_f32_16x16x32_bf16 v[80:83], a[120:123], a[88:91], v[80:83]
    buffer_load_dwordx4 v1, s[8:11], s16 offen offset:1024 sc1 lds
    v_mfma_f32_16x16x32_bf16 v[80:83], a[124:127], a[92:95], v[80:83]
    ds_read_b128 a[200:203], v8 offset:3072
    v_mfma_f32_16x16x32_bf16 v[100:103], a[120:123], a[96:99], v[100:103]
    ds_read_b128 a[204:207], v8 offset:19456
    v_mfma_f32_16x16x32_bf16 v[100:103], a[124:127], a[100:103], v[100:103]
    ds_read_b128 a[208:211], v9 offset:0
    v_mfma_f32_16x16x32_bf16 v[44:47], a[128:131], a[72:75], v[44:47]
    buffer_load_dwordx4 v1, s[8:11], s16 offen offset:2048 sc1 lds
    v_mfma_f32_16x16x32_bf16 v[44:47], a[132:135], a[76:79], v[44:47]
    ds_read_b128 a[212:215], v9 offset:2048
    v_mfma_f32_16x16x32_bf16 v[64:67], a[128:131], a[80:83], v[64:67]
    v_add_u32 v8, s62, v14
    v_add_u32 v9, 8192, v15
    v_mfma_f32_16x16x32_bf16 v[64:67], a[132:135], a[84:87], v[64:67]
    v_add_u32 v4, s62, v10
    v_add_u32 v5, s62, v11
    v_mfma_f32_16x16x32_bf16 v[84:87], a[128:131], a[88:91], v[84:87]
    buffer_load_dwordx4 v1, s[8:11], s16 offen offset:3072 sc1 lds
    v_mfma_f32_16x16x32_bf16 v[84:87], a[132:135], a[92:95], v[84:87]
    s_add_u32 s17, s16, 4096
    v_add_u32 v6, s62, v12
    v_add_u32 v7, s62, v13
    v_mfma_f32_16x16x32_bf16 v[104:107], a[128:131], a[96:99], v[104:107]
    v_mfma_f32_16x16x32_bf16 v[104:107], a[132:135], a[100:103], v[104:107]
    s_add_u32 m0, s26, 0
    v_mfma_f32_16x16x32_bf16 v[48:51], a[136:139], a[72:75], v[48:51]
    buffer_load_dwordx4 v1, s[8:11], s17 offen offset:0 sc1 lds
    v_mfma_f32_16x16x32_bf16 v[48:51], a[140:143], a[76:79], v[48:51]
    s_branch L_pado14
L_pad14:
    s_branch L_tour_ret3
L_pado14:
    s_add_u32 s16, s16, 81920
    s_waitcnt vmcnt(15)
    v_cmp_ne_u32 vcc, v17, v31
    v_mfma_f32_16x16x32_bf16 v[68:71], a[136:139], a[80:83], v[68:71]
    s_add_u32 s28, s28, 1
    v_mfma_f32_16x16x32_bf16 v[68:71], a[140:143], a[84:87], v[68:71]
    s_sub_u32 s18, s15, 262144
    v_mfma_f32_16x16x32_bf16 v[88:91], a[136:139], a[88:91], v[88:91]
    s_sub_u32 s19, s16, 1310720
    v_mfma_f32_16x16x32_bf16 v[88:91], a[140:143], a[92:95], v[88:91]
    s_cmp_eq_u32 s28, 8
    s_cselect_b32 s15, s18, s15
    s_cselect_b32 s16, s19, s16
    v_mfma_f32_16x16x32_bf16 v[108:111], a[136:139], a[96:99], v[108:111]
    s_waitcnt lgkmcnt(0)
    v_mfma_f32_16x16x32_bf16 v[108:111], a[140:143], a[100:103], v[108:111]
    s_cbranch_vccnz L_spin4
L_spin4_back:
    v_mfma_f32_16x16x32_bf16 v[32:35], a[176:179], a[144:147], v[32:35]
    s_waitcnt vmcnt(19)
    s_barrier
    v_mfma_f32_16x16x32_bf16 v[32:35], a[180:183], a[148:151], v[32:35]
    s_add_u32 m0, s61, s80
    ds_read_b128 a[104:107], v8 offset:0
    v_mfma_f32_16x16x32_bf16 v[52:55], a[176:179], a[152:155], v[52:55]
    buffer_load_dwordx4 v1, s[8:11], s15 offen offset:0 sc1 lds
    v_mfma_f32_16x16x32_bf16 v[52:55], a[180:183], a[156:159], v[52:55]
    ds_read_b128 a[108:111], v8 offset:16384
    v_mfma_f32_16x16x32_bf16 v[72:75], a[176:179], a[160:163], v[72:75]
    ds_read_b128 a[72:75], v4 offset:0
    v_mfma_f32_16x16x32_bf16 v[72:75], a[180:183], a[164:167], v[72:75]
    buffer_load_dwordx4 v1, s[8:11], s15 offen offset:1024 sc1 lds
    v_mfma_f32_16x16x32_bf16 v[92:95], a[176:179], a[168:171], v[92:95]
    ds_read_b128 a[76:79], v4 offset:16384
    v_mfma_f32_16x16x32_bf16 v[92:95], a[180:183], a[172:175], v[92:95]
    ds_read_b128 a[80:83], v5 offset:0
    v_mfma_f32_16x16x32_bf16 v[36:39], a[184:187], a[144:147], v[36:39]
    ds_read_b128 a[84:87], v5 offset:16384
    v_mfma_f32_16x16x32_bf16 v[36:39], a[188:191], a[148:151], v[36:39]
    buffer_load_dwordx4 v1, s[8:11], s15 offen offset:2048 sc1 lds
    v_mfma_f32_16x16x32_bf16 v[56:59], a[184:187], a[152:155], v[56:59]
    ds_read_b128 a[88:91], v6 offset:0
    v_mfma_f32_16x16x32_bf16 v[56:59], a[188:191], a[156:159], v[56:59]
    ds_read_b128 a[92:95], v6 offset:16384
    v_mfma_f32_16x16x32_bf16 v[76:79], a[184:187], a[160:163], v[76:79]
    ds_read_b128 a[96:99], v7 offset:0
    v_mfma_f32_16x16x32_bf16 v[76:79], a[188:191], a[164:167], v[76:79]
    buffer_load_dwordx4 v1, s[8:11], s15 offen offset:3072 sc1 lds
    v_mfma_f32_16x16x32_bf16 v[96:99], a[184:187], a[168:171], v[96:99]
    s_add_u32 s15, s15, 16384
    ds_read_b128 a[100:103], v7 offset:16384
    v_mfma_f32_16x16x32_bf16 v[96:99], a[188:191], a[172:175], v[96:99]
    ds_read_b128 a[112:115], v8 offset:1024
    v_mfma_f32_16x16x32_bf16 v[40:43], a[192:195], a[144:147], v[40:43]
    s_add_u32 m0, s61, s59
    ds_read_b128 a[116:119], v8 offset:17408
    v_mfma_f32_16x16x32_bf16 v[40:43], a[196:199], a[148:151], v[40:43]
    buffer_load_dwordx4 v1, s[8:11], s16 offen offset:0 sc1 lds
    v_mfma_f32_16x16x32_bf16 v[60:63], a[192:195], a[152:155], v[60:63]
    ds_read_b128 a[120:123], v8 offset:2048
    v_mfma_f32_16x16x32_bf16 v[60:63], a[196:199], a[156:159], v[60:63]
    ds_read_b128 a[124:127], v8 offset:18432
    v_mfma_f32_16x16x32_bf16 v[80:83], a[192:195], a[160:163], v[80:83]
    buffer_load_dwordx4 v1, s[8:11], s16 offen offset:1024 sc1 lds
    v_mfma_f32_16x16x32_bf16 v[80:83], a[196:199], a[164:167], v[80:83]
    ds_read_b128 a[128:131], v8 offset:3072
    v_mfma_f32_16x16x32_bf16 v[100:103], a[192:195], a[168:171], v[100:103]
    ds_read_b128 a[132:135], v8 offset:19456
    v_mfma_f32_16x16x32_bf16 v[100:103], a[196:199], a[172:175], v[100:103]
    ds_read_b128 a[136:139], v9 offset:0
    v_mfma_f32_16x16x32_bf16 v[44:47], a[200:203], a[144:147], v[44:47]
    buffer_load_dwordx4 v1, s[8:11], s16 offen offset:2048 sc1 lds
    v_mfma_f32_16x16x32_bf16 v[44:47], a[204:207], a[148:151], v[44:47]
    ds_read_b128 a[140:143], v9 offset:2048
    v_mfma_f32_16x16x32_bf16 v[64:67], a[200:203], a[152:155], v[64:67]
    v_add_u32 v8, s63, v14
    v_add_u32 v9, 12288, v15
    v_mfma_f32_16x16x32_bf16 v[64:67], a[204:207], a[156:159], v[64:67]
    v_add_u32 v4, s63, v10
    v_add_u32 v5, s63, v11
    v_mfma_f32_16x16x32_bf16 v[84:87], a[200:203], a[160:163], v[84:87]
    buffer_load_dwordx4 v1, s[8:11], s16 offen offset:3072 sc1 lds
    v_mfma_f32_16x16x32_bf16 v[84:87], a[204:207], a[164:167], v[84:87]
    s_add_u32 s17, s16, 4096
    v_add_u32 v6, s63, v12
    v_add_u32 v7, s63, v13
    v_mfma_f32_16x16x32_bf16 v[104:107], a[200:203], a[168:171], v[104:107]
    v_mfma_f32_16x16x32_bf16 v[104:107], a[204:207], a[172:175], v[104:107]
    s_add_u32 m0, s26, 4096
    v_mfma_f32_16x16x32_bf16 v[48:51], a[208:211], a[144:147], v[48:51]
    buffer_load_dwordx4 v1, s[8:11], s17 offen offset:0 sc1 lds
    v_mfma_f32_16x16x32_bf16 v[48:51], a[212:215], a[148:151], v[48:51]
    s_add_u32 s16, s16, 81920
    v_mfma_f32_16x16x32_bf16 v[68:71], a[208:211], a[152:155], v[68:71]
    v_mfma_f32_16x16x32_bf16 v[68:71], a[212:215], a[156:159], v[68:71]
    v_mfma_f32_16x16x32_bf16 v[88:91], a[208:211], a[160:163], v[88:91]
    v_mfma_f32_16x16x32_bf16 v[88:91], a[212:215], a[164:167], v[88:91]
    v_mfma_f32_16x16x32_bf16 v[108:111], a[208:211], a[168:171], v[108:111]
    s_waitcnt lgkmcnt(0)
    v_mfma_f32_16x16x32_bf16 v[108:111], a[212:215], a[172:175], v[108:111]
    v_mfma_f32_16x16x32_bf16 v[32:35], a[104:107], a[72:75], v[32:35]
    s_waitcnt vmcnt(18)
    s_barrier
    v_mfma_f32_16x16x32_bf16 v[32:35], a[108:111], a[76:79], v[32:35]
    s_add_u32 m0, s62, s80
    ds_read_b128 a[176:179], v8 offset:0
    v_mfma_f32_16x16x32_bf16 v[52:55], a[104:107], a[80:83], v[52:55]
    buffer_load_dwordx4 v1, s[8:11], s15 offen offset:0 sc1 lds
    v_mfma_f32_16x16x32_bf16 v[52:55], a[108:111], a[84:87], v[52:55]
    ds_read_b128 a[180:183], v8 offset:16384
    v_mfma_f32_16x16x32_bf16 v[72:75], a[104:107], a[88:91], v[72:75]
    ds_read_b128 a[144:147], v4 offset:0
    v_mfma_f32_16x16x32_bf16 v[72:75], a[108:111], a[92:95], v[72:75]
    buffer_load_dwordx4 v1, s[8:11], s15 offen offset:1024 sc1 lds
    v_mfma_f32_16x16x32_bf16 v[92:95], a[104:107], a[96:99], v[92:95]
    ds_read_b128 a[148:151], v4 offset:16384
    v_mfma_f32_16x16x32_bf16 v[92:95], a[108:111], a[100:103], v[92:95]
    ds_read_b128 a[152:155], v5 offset:0
    v_mfma_f32_16x16x32_bf16 v[36:39], a[112:115], a[72:75], v[36:39]
    ds_read_b128 a[156:159], v5 offset:16384
    v_mfma_f32_16x16x32_bf16 v[36:39], a[116:119], a[76:79], v[36:39]
    buffer_load_dwordx4 v1, s[8:11], s15 offen offset:2048 sc1 lds
    v_mfma_f32_16x16x32_bf16 v[56:59], a[112:115], a[80:83], v[56:59]
    s_mov_b32 s20, 98304
    ds_read_b128 a[160:163], v6 offset:0
    v_mfma_f32_16x16x32_bf16 v[56:59], a[116:119], a[84:87], v[56:59]
    s_mov_b32 s21, 0
    ds_read_b128 a[164:167], v6 offset:16384
    v_mfma_f32_16x16x32_bf16 v[76:79], a[112:115], a[88:91], v[76:79]
    s_mov_b32 s22, 0
    ds_read_b128 a[168:171], v7 offset:0
    v_mfma_f32_16x16x32_bf16 v[76:79], a[116:119], a[92:95], v[76:79]
    buffer_load_dwordx4 v1, s[8:11], s15 offen offset:3072 sc1 lds
    v_mfma_f32_16x16x32_bf16 v[96:99], a[112:115], a[96:99], v[96:99]
    s_add_u32 s15, s15, 16384
    ds_read_b128 a[172:175], v7 offset:16384
    v_mfma_f32_16x16x32_bf16 v[96:99], a[116:119], a[100:103], v[96:99]
    s_mov_b32 s65, s63
    ds_read_b128 a[184:187], v8 offset:1024
    v_mfma_f32_16x16x32_bf16 v[40:43], a[120:123], a[72:75], v[40:43]
    s_add_u32 m0, s62, s59
    ds_read_b128 a[188:191], v8 offset:17408
    v_mfma_f32_16x16x32_bf16 v[40:43], a[124:127], a[76:79], v[40:43]
    buffer_load_dwordx4 v1, s[8:11], s16 offen offset:0 sc1 lds
    v_mfma_f32_16x16x32_bf16 v[60:63], a[120:123], a[80:83], v[60:63]
    ds_read_b128 a[192:195], v8 offset:2048
    v_mfma_f32_16x16x32_bf16 v[60:63], a[124:127], a[84:87], v[60:63]
    ds_read_b128 a[196:199], v8 offset:18432
    v_mfma_f32_16x16x32_bf16 v[80:83], a[120:123], a[88:91], v[80:83]
    buffer_load_dwordx4 v1, s[8:11], s16 offen offset:1024 sc1 lds
    v_mfma_f32_16x16x32_bf16 v[80:83], a[124:127], a[92:95], v[80:83]
    ds_read_b128 a[200:203], v8 offset:3072
    v_mfma_f32_16x16x32_bf16 v[100:103], a[120:123], a[96:99], v[100:103]
    ds_read_b128 a[204:207], v8 offset:19456
    v_mfma_f32_16x16x32_bf16 v[100:103], a[124:127], a[100:103], v[100:103]
    ds_read_b128 a[208:211], v9 offset:0
    v_mfma_f32_16x16x32_bf16 v[44:47], a[128:131], a[72:75], v[44:47]
    buffer_load_dwordx4 v1, s[8:11], s16 offen offset:2048 sc1 lds
    v_mfma_f32_16x16x32_bf16 v[44:47], a[132:135], a[76:79], v[44:47]
    ds_read_b128 a[212:215], v9 offset:2048
    v_mfma_f32_16x16x32_bf16 v[64:67], a[128:131], a[80:83], v[64:67]
    v_add_u32 v8, s60, v14
    v_add_u32 v9, 0, v15
    v_mfma_f32_16x16x32_bf16 v[64:67], a[132:135], a[84:87], v[64:67]
    v_add_u32 v4, s60, v10
    v_add_u32 v5, s60, v11
    v_mfma_f32_16x16x32_bf16 v[84:87], a[128:131], a[88:91], v[84:87]
    buffer_load_dwordx4 v1, s[8:11], s16 offen offset:3072 sc1 lds
    v_mfma_f32_16x16x32_bf16 v[84:87], a[132:135], a[92:95], v[84:87]
    s_add_u32 s17, s16, 4096
    v_add_u32 v6, s60, v12
    v_add_u32 v7, s60, v13
    v_mfma_f32_16x16x32_bf16 v[104:107], a[128:131], a[96:99], v[104:107]
    v_mfma_f32_16x16x32_bf16 v[104:107], a[132:135], a[100:103], v[104:107]
    s_add_u32 m0, s26, 8192
    v_mfma_f32_16x16x32_bf16 v[48:51], a[136:139], a[72:75], v[48:51]
    buffer_load_dwordx4 v1, s[8:11], s17 offen offset:0 sc1 lds
    v_mfma_f32_16x16x32_bf16 v[48:51], a[140:143], a[76:79], v[48:51]
    s_add_u32 s16, s16, 81920
    v_mfma_f32_16x16x32_bf16 v[68:71], a[136:139], a[80:83], v[68:71]
    s_add_u32 s28, s28, 1
    v_mfma_f32_16x16x32_bf16 v[68:71], a[140:143], a[84:87], v[68:71]
    s_sub_u32 s18, s15, 262144
    v_mfma_f32_16x16x32_bf16 v[88:91], a[136:139], a[88:91], v[88:91]
    s_sub_u32 s19, s16, 1310720
    v_mfma_f32_16x16x32_bf16 v[88:91], a[140:143], a[92:95], v[88:91]
    s_cmp_eq_u32 s28, 8
    s_cselect_b32 s15, s18, s15
    s_cselect_b32 s16, s19, s16
    v_mfma_f32_16x16x32_bf16 v[108:111], a[136:139], a[96:99], v[108:111]
    s_waitcnt lgkmcnt(0)
    v_mfma_f32_16x16x32_bf16 v[108:111], a[140:143], a[100:103], v[108:111]
.p2align 3
L_k3_loop:
    v_mfma_f32_16x16x32_bf16 v[32:35], a[176:179], a[144:147], v[32:35]
    s_waitcnt vmcnt(18)
    s_barrier
    v_mfma_f32_16x16x32_bf16 v[32:35], a[180:183], a[148:151], v[32:35]
    s_add_u32 m0, s65, s80
    ds_read_b128 a[104:107], v8 offset:0
    v_mfma_f32_16x16x32_bf16 v[52:55], a[176:179], a[152:155], v[52:55]
    buffer_load_dwordx4 v1, s[8:11], s15 offen offset:0 sc1 lds
    v_mfma_f32_16x16x32_bf16 v[52:55], a[180:183], a[156:159], v[52:55]
    s_add_u32 s21, s21, 32768
    ds_read_b128 a[108:111], v8 offset:16384
    v_mfma_f32_16x16x32_bf16 v[72:75], a[176:179], a[160:163], v[72:75]
    s_and_b32 s21, s21, 0x1ffff
    ds_read_b128 a[72:75], v4 offset:0
    v_mfma_f32_16x16x32_bf16 v[72:75], a[180:183], a[164:167], v[72:75]
    buffer_load_dwordx4 v1, s[8:11], s15 offen offset:1024 sc1 lds
    v_mfma_f32_16x16x32_bf16 v[92:95], a[176:179], a[168:171], v[92:95]
    s_lshr_b32 s55, s21, 3
    ds_read_b128 a[76:79], v4 offset:16384
    v_mfma_f32_16x16x32_bf16 v[92:95], a[180:183], a[172:175], v[92:95]
    s_lshr_b32 s29, s20, 3
    ds_read_b128 a[80:83], v5 offset:0
    v_mfma_f32_16x16x32_bf16 v[36:39], a[184:187], a[144:147], v[36:39]
    s_xor_b32 s56, s21, s64
    ds_read_b128 a[84:87], v5 offset:16384
    v_mfma_f32_16x16x32_bf16 v[36:39], a[188:191], a[148:151], v[36:39]
    buffer_load_dwordx4 v1, s[8:11], s15 offen offset:2048 sc1 lds
    v_mfma_f32_16x16x32_bf16 v[56:59], a[184:187], a[152:155], v[56:59]
    ds_read_b128 a[88:91], v6 offset:0
    v_mfma_f32_16x16x32_bf16 v[56:59], a[188:191], a[156:159], v[56:59]
    ds_read_b128 a[92:95], v6 offset:16384
    v_mfma_f32_16x16x32_bf16 v[76:79], a[184:187], a[160:163], v[76:79]
    ds_read_b128 a[96:99], v7 offset:0
    v_mfma_f32_16x16x32_bf16 v[76:79], a[188:191], a[164:167], v[76:79]
    buffer_load_dwordx4 v1, s[8:11], s15 offen offset:3072 sc1 lds
    v_mfma_f32_16x16x32_bf16 v[96:99], a[184:187], a[168:171], v[96:99]
    s_add_u32 s15, s15, 16384
    ds_read_b128 a[100:103], v7 offset:16384
    v_mfma_f32_16x16x32_bf16 v[96:99], a[188:191], a[172:175], v[96:99]
    ds_read_b128 a[112:115], v8 offset:1024
    v_mfma_f32_16x16x32_bf16 v[40:43], a[192:195], a[144:147], v[40:43]
    s_add_u32 m0, s65, s59
    ds_read_b128 a[116:119], v8 offset:17408
    v_mfma_f32_16x16x32_bf16 v[40:43], a[196:199], a[148:151], v[40:43]
    buffer_load_dwordx4 v1, s[8:11], s16 offen offset:0 sc1 lds
    v_mfma_f32_16x16x32_bf16 v[60:63], a[192:195], a[152:155], v[60:63]
    ds_read_b128 a[120:123], v8 offset:2048
    v_mfma_f32_16x16x32_bf16 v[60:63], a[196:199], a[156:159], v[60:63]
    ds_read_b128 a[124:127], v8 offset:18432
    v_mfma_f32_16x16x32_bf16 v[80:83], a[192:195], a[160:163], v[80:83]
    buffer_load_dwordx4 v1, s[8:11], s16 offen offset:1024 sc1 lds
    v_mfma_f32_16x16x32_bf16 v[80:83], a[196:199], a[164:167], v[80:83]
    ds_read_b128 a[128:131], v8 offset:3072
    v_mfma_f32_16x16x32_bf16 v[100:103], a[192:195], a[168:171], v[100:103]
    s_add_u32 s20, s20, 32768
    ds_read_b128 a[132:135], v8 offset:19456
    v_mfma_f32_16x16x32_bf16 v[100:103], a[196:199], a[172:175], v[100:103]
    s_and_b32 s20, s20, 0x1ffff
    ds_read_b128 a[136:139], v9 offset:0
    v_mfma_f32_16x16x32_bf16 v[44:47], a[200:203], a[144:147], v[44:47]
    buffer_load_dwordx4 v1, s[8:11], s16 offen offset:2048 sc1 lds
    v_mfma_f32_16x16x32_bf16 v[44:47], a[204:207], a[148:151], v[44:47]
    s_xor_b32 s65, s20, s64
    ds_read_b128 a[140:143], v9 offset:2048
    v_mfma_f32_16x16x32_bf16 v[64:67], a[200:203], a[152:155], v[64:67]
    v_add_u32 v8, s56, v14
    v_add_u32 v9, s55, v15
    v_mfma_f32_16x16x32_bf16 v[64:67], a[204:207], a[156:159], v[64:67]
    v_add_u32 v4, s56, v10
    v_add_u32 v5, s56, v11
    v_mfma_f32_16x16x32_bf16 v[84:87], a[200:203], a[160:163], v[84:87]
    buffer_load_dwordx4 v1, s[8:11], s16 offen offset:3072 sc1 lds
    v_mfma_f32_16x16x32_bf16 v[84:87], a[204:207], a[164:167], v[84:87]
    s_add_u32 s17, s16, 4096
    v_add_u32 v6, s56, v12
    v_add_u32 v7, s56, v13
    v_mfma_f32_16x16x32_bf16 v[104:107], a[200:203], a[168:171], v[104:107]
    v_mfma_f32_16x16x32_bf16 v[104:107], a[204:207], a[172:175], v[104:107]
    s_add_u32 m0, s29, s26
    v_mfma_f32_16x16x32_bf16 v[48:51], a[208:211], a[144:147], v[48:51]
    buffer_load_dwordx4 v1, s[8:11], s17 offen offset:0 sc1 lds
    v_mfma_f32_16x16x32_bf16 v[48:51], a[212:215], a[148:151], v[48:51]
    s_add_u32 s16, s16, 81920
    v_mfma_f32_16x16x32_bf16 v[68:71], a[208:211], a[152:155], v[68:71]
    v_mfma_f32_16x16x32_bf16 v[68:71], a[212:215], a[156:159], v[68:71]
    v_mfma_f32_16x16x32_bf16 v[88:91], a[208:211], a[160:163], v[88:91]
    v_mfma_f32_16x16x32_bf16 v[88:91], a[212:215], a[164:167], v[88:91]
    v_mfma_f32_16x16x32_bf16 v[108:111], a[208:211], a[168:171], v[108:111]
    s_waitcnt lgkmcnt(0)
    v_mfma_f32_16x16x32_bf16 v[108:111], a[212:215], a[172:175], v[108:111]
    v_mfma_f32_16x16x32_bf16 v[32:35], a[104:107], a[72:75], v[32:35]
    s_waitcnt vmcnt(18)
    s_barrier
    v_mfma_f32_16x16x32_bf16 v[32:35], a[108:111], a[76:79], v[32:35]
    s_add_u32 m0, s65, s80
    ds_read_b128 a[176:179], v8 offset:0
    v_mfma_f32_16x16x32_bf16 v[52:55], a[104:107], a[80:83], v[52:55]
    buffer_load_dwordx4 v1, s[8:11], s15 offen offset:0 sc1 lds
    v_mfma_f32_16x16x32_bf16 v[52:55], a[108:111], a[84:87], v[52:55]
    s_add_u32 s21, s21, 32768
    ds_read_b128 a[180:183], v8 offset:16384
    v_mfma_f32_16x16x32_bf16 v[72:75], a[104:107], a[88:91], v[72:75]
    s_and_b32 s21, s21, 0x1ffff
    ds_read_b128 a[144:147], v4 offset:0
    v_mfma_f32_16x16x32_bf16 v[72:75], a[108:111], a[92:95], v[72:75]
    buffer_load_dwordx4 v1, s[8:11], s15 offen offset:1024 sc1 lds
    v_mfma_f32_16x16x32_bf16 v[92:95], a[104:107], a[96:99], v[92:95]
    s_lshr_b32 s55, s21, 3
    ds_read_b128 a[148:151], v4 offset:16384
    v_mfma_f32_16x16x32_bf16 v[92:95], a[108:111], a[100:103], v[92:95]
    s_lshr_b32 s29, s20, 3
    ds_read_b128 a[152:155], v5 offset:0
    v_mfma_f32_16x16x32_bf16 v[36:39], a[112:115], a[72:75], v[36:39]
    s_xor_b32 s56, s21, s64
    ds_read_b128 a[156:159], v5 offset:16384
    v_mfma_f32_16x16x32_bf16 v[36:39], a[116:119], a[76:79], v[36:39]
    buffer_load_dwordx4 v1, s[8:11], s15 offen offset:2048 sc1 lds
    v_mfma_f32_16x16x32_bf16 v[56:59], a[112:115], a[80:83], v[56:59]
    s_add_u32 s22, s22, 1
    ds_read_b128 a[160:163], v6 offset:0
    v_mfma_f32_16x16x32_bf16 v[56:59], a[116:119], a[84:87], v[56:59]
    ds_read_b128 a[164:167], v6 offset:16384
    v_mfma_f32_16x16x32_bf16 v[76:79], a[112:115], a[88:91], v[76:79]
    ds_read_b128 a[168:171], v7 offset:0
    v_mfma_f32_16x16x32_bf16 v[76:79], a[116:119], a[92:95], v[76:79]
    buffer_load_dwordx4 v1, s[8:11], s15 offen offset:3072 sc1 lds
    v_mfma_f32_16x16x32_bf16 v[96:99], a[112:115], a[96:99], v[96:99]
    s_add_u32 s15, s15, 16384
    ds_read_b128 a[172:175], v7 offset:16384
    v_mfma_f32_16x16x32_bf16 v[96:99], a[116:119], a[100:103], v[96:99]
    ds_read_b128 a[184:187], v8 offset:1024
    v_mfma_f32_16x16x32_bf16 v[40:43], a[120:123], a[72:75], v[40:43]
    s_add_u32 m0, s65, s59
    ds_read_b128 a[188:191], v8 offset:17408
    v_mfma_f32_16x16x32_bf16 v[40:43], a[124:127], a[76:79], v[40:43]
    buffer_load_dwordx4 v1, s[8:11], s16 offen offset:0 sc1 lds
    v_mfma_f32_16x16x32_bf16 v[60:63], a[120:123], a[80:83], v[60:63]
    ds_read_b128 a[192:195], v8 offset:2048
    v_mfma_f32_16x16x32_bf16 v[60:63], a[124:127], a[84:87], v[60:63]
    ds_read_b128 a[196:199], v8 offset:18432
    v_mfma_f32_16x16x32_bf16 v[80:83], a[120:123], a[88:91], v[80:83]
    buffer_load_dwordx4 v1, s[8:11], s16 offen offset:1024 sc1 lds
    v_mfma_f32_16x16x32_bf16 v[80:83], a[124:127], a[92:95], v[80:83]
    ds_read_b128 a[200:203], v8 offset:3072
    v_mfma_f32_16x16x32_bf16 v[100:103], a[120:123], a[96:99], v[100:103]
    s_add_u32 s20, s20, 32768
    ds_read_b128 a[204:207], v8 offset:19456
    v_mfma_f32_16x16x32_bf16 v[100:103], a[124:127], a[100:103], v[100:103]
    s_and_b32 s20, s20, 0x1ffff
    ds_read_b128 a[208:211], v9 offset:0
    v_mfma_f32_16x16x32_bf16 v[44:47], a[128:131], a[72:75], v[44:47]
    buffer_load_dwordx4 v1, s[8:11], s16 offen offset:2048 sc1 lds
    v_mfma_f32_16x16x32_bf16 v[44:47], a[132:135], a[76:79], v[44:47]
    s_xor_b32 s65, s20, s64
    ds_read_b128 a[212:215], v9 offset:2048
    v_mfma_f32_16x16x32_bf16 v[64:67], a[128:131], a[80:83], v[64:67]
    v_add_u32 v8, s56, v14
    v_add_u32 v9, s55, v15
    v_mfma_f32_16x16x32_bf16 v[64:67], a[132:135], a[84:87], v[64:67]
    v_add_u32 v4, s56, v10
    v_add_u32 v5, s56, v11
    v_mfma_f32_16x16x32_bf16 v[84:87], a[128:131], a[88:91], v[84:87]
    buffer_load_dwordx4 v1, s[8:11], s16 offen offset:3072 sc1 lds
    v_mfma_f32_16x16x32_bf16 v[84:87], a[132:135], a[92:95], v[84:87]
    s_add_u32 s17, s16, 4096
    v_add_u32 v6, s56, v12
    v_add_u32 v7, s56, v13
    v_mfma_f32_16x16x32_bf16 v[104:107], a[128:131], a[96:99], v[104:107]
    v_mfma_f32_16x16x32_bf16 v[104:107], a[132:135], a[100:103], v[104:107]
    s_add_u32 m0, s29, s26
    v_mfma_f32_16x16x32_bf16 v[48:51], a[136:139], a[72:75], v[48:51]
    buffer_load_dwordx4 v1, s[8:11], s17 offen offset:0 sc1 lds
    v_mfma_f32_16x16x32_bf16 v[48:51], a[140:143], a[76:79], v[48:51]
    s_add_u32 s16, s16, 81920
    v_mfma_f32_16x16x32_bf16 v[68:71], a[136:139], a[80:83], v[68:71]
    s_add_u32 s28, s28, 1
    v_mfma_f32_16x16x32_bf16 v[68:71], a[140:143], a[84:87], v[68:71]
    s_sub_u32 s18, s15, 262144
    v_mfma_f32_16x16x32_bf16 v[88:91], a[136:139], a[88:91], v[88:91]
    s_sub_u32 s19, s16, 1310720
    v_mfma_f32_16x16x32_bf16 v[88:91], a[140:143], a[92:95], v[88:91]
    s_cmp_eq_u32 s28, 8
    s_cselect_b32 s15, s18, s15
    s_cselect_b32 s16, s19, s16
    v_mfma_f32_16x16x32_bf16 v[108:111], a[136:139], a[96:99], v[108:111]
    s_waitcnt lgkmcnt(0)
    s_cmp_lt_u32 s22, 6
    v_mfma_f32_16x16x32_bf16 v[108:111], a[140:143], a[100:103], v[108:111]
    s_cbranch_scc1 L_k3_loop
L_k3_tail:
    v_mfma_f32_16x16x32_bf16 v[52:55], a[176:179], a[152:155], v[52:55]
    s_waitcnt vmcnt(18)
    s_barrier
    v_mfma_f32_16x16x32_bf16 v[52:55], a[180:183], a[156:159], v[52:55]
    ds_read_b128 a[104:107], v8 offset:0
    v_mfma_f32_16x16x32_bf16 v[72:75], a[176:179], a[160:163], v[72:75]
    ds_read_b128 a[108:111], v8 offset:16384
    v_mfma_f32_16x16x32_bf16 v[72:75], a[180:183], a[164:167], v[72:75]
    ds_read_b128 a[72:75], v4 offset:0
    v_mfma_f32_16x16x32_bf16 v[92:95], a[176:179], a[168:171], v[92:95]
    ds_read_b128 a[76:79], v4 offset:16384
    v_mfma_f32_16x16x32_bf16 v[92:95], a[180:183], a[172:175], v[92:95]
    ds_read_b128 a[80:83], v5 offset:0
    v_mfma_f32_16x16x32_bf16 v[56:59], a[184:187], a[152:155], v[56:59]
    ds_read_b128 a[84:87], v5 offset:16384
    v_mfma_f32_16x16x32_bf16 v[56:59], a[188:191], a[156:159], v[56:59]
    ds_read_b128 a[88:91], v6 offset:0
    v_mfma_f32_16x16x32_bf16 v[76:79], a[184:187], a[160:163], v[76:79]
    ds_read_b128 a[92:95], v6 offset:16384
    v_mfma_f32_16x16x32_bf16 v[76:79], a[188:191], a[164:167], v[76:79]
    ds_read_b128 a[96:99], v7 offset:0
    v_mfma_f32_16x16x32_bf16 v[96:99], a[184:187], a[168:171], v[96:99]
    ds_read_b128 a[100:103], v7 offset:16384
    v_mfma_f32_16x16x32_bf16 v[96:99], a[188:191], a[172:175], v[96:99]
    ds_read_b128 a[112:115], v8 offset:1024
    v_mfma_f32_16x16x32_bf16 v[60:63], a[192:195], a[152:155], v[60:63]
    ds_read_b128 a[116:119], v8 offset:17408
    v_mfma_f32_16x16x32_bf16 v[60:63], a[196:199], a[156:159], v[60:63]
    ds_read_b128 a[120:123], v8 offset:2048
    v_mfma_f32_16x16x32_bf16 v[80:83], a[192:195], a[160:163], v[80:83]
    ds_read_b128 a[124:127], v8 offset:18432
    v_mfma_f32_16x16x32_bf16 v[80:83], a[196:199], a[164:167], v[80:83]
    ds_read_b128 a[128:131], v8 offset:3072
    v_mfma_f32_16x16x32_bf16 v[100:103], a[192:195], a[168:171], v[100:103]
    ds_read_b128 a[132:135], v8 offset:19456
    v_mfma_f32_16x16x32_bf16 v[100:103], a[196:199], a[172:175], v[100:103]
    ds_read_b128 a[136:139], v9 offset:0
    v_mfma_f32_16x16x32_bf16 v[64:67], a[200:203], a[152:155], v[64:67]
    ds_read_b128 a[140:143], v9 offset:2048
    v_mfma_f32_16x16x32_bf16 v[64:67], a[204:207], a[156:159], v[64:67]
    v_add_u32 v8, s61, v14
    v_add_u32 v9, 4096, v15
    v_mfma_f32_16x16x32_bf16 v[84:87], a[200:203], a[160:163], v[84:87]
    v_add_u32 v4, s61, v10
    v_add_u32 v5, s61, v11
    v_mfma_f32_16x16x32_bf16 v[84:87], a[204:207], a[164:167], v[84:87]
    s_mov_b32 m0, s39
    v_add_u32 v6, s61, v12
    v_add_u32 v7, s61, v13
    v_mfma_f32_16x16x32_bf16 v[104:107], a[200:203], a[168:171], v[104:107]
    buffer_load_dwordx4 v124, s[4:7], s25 offen offset:0 lds
    v_mfma_f32_16x16x32_bf16 v[104:107], a[204:207], a[172:175], v[104:107]
    v_mfma_f32_16x16x32_bf16 v[68:71], a[208:211], a[152:155], v[68:71]
    buffer_load_dwordx4 v125, s[4:7], s25 offen offset:1024 lds
    v_mfma_f32_16x16x32_bf16 v[68:71], a[212:215], a[156:159], v[68:71]
    v_mfma_f32_16x16x32_bf16 v[88:91], a[208:211], a[160:163], v[88:91]
    buffer_load_dwordx4 v126, s[4:7], s25 offen offset:2048 lds
    v_mfma_f32_16x16x32_bf16 v[88:91], a[212:215], a[164:167], v[88:91]
    v_mfma_f32_16x16x32_bf16 v[108:111], a[208:211], a[168:171], v[108:111]
    s_waitcnt lgkmcnt(0)
    v_mfma_f32_16x16x32_bf16 v[108:111], a[212:215], a[172:175], v[108:111]
    v_mfma_f32_16x16x32_bf16 v[52:55], a[104:107], a[80:83], v[52:55]
    s_waitcnt vmcnt(12)
    s_barrier
    v_mfma_f32_16x16x32_bf16 v[52:55], a[108:111], a[84:87], v[52:55]
    ds_read_b128 a[32:35], v8 offset:0
    v_mfma_f32_16x16x32_bf16 v[72:75], a[104:107], a[88:91], v[72:75]
    ds_read_b128 a[36:39], v8 offset:16384
    v_mfma_f32_16x16x32_bf16 v[72:75], a[108:111], a[92:95], v[72:75]
    ds_read_b128 a[0:3], v4 offset:0
    v_mfma_f32_16x16x32_bf16 v[92:95], a[104:107], a[96:99], v[92:95]
    ds_read_b128 a[4:7], v4 offset:16384
    v_mfma_f32_16x16x32_bf16 v[92:95], a[108:111], a[100:103], v[92:95]
    ds_read_b128 a[8:11], v5 offset:0
    v_mfma_f32_16x16x32_bf16 v[56:59], a[112:115], a[80:83], v[56:59]
    ds_read_b128 a[12:15], v5 offset:16384
    v_mfma_f32_16x16x32_bf16 v[56:59], a[116:119], a[84:87], v[56:59]
    s_add_u32 s18, s12, 1
    ds_read_b128 a[16:19], v6 offset:0
    v_mfma_f32_16x16x32_bf16 v[76:79], a[112:115], a[88:91], v[76:79]
    s_and_b32 s18, s18, 3
    ds_read_b128 a[20:23], v6 offset:16384
    v_mfma_f32_16x16x32_bf16 v[76:79], a[116:119], a[92:95], v[76:79]
    s_mul_i32 s18, s18, 30720
    ds_read_b128 a[24:27], v7 offset:0
    v_mfma_f32_16x16x32_bf16 v[96:99], a[112:115], a[96:99], v[96:99]
    s_add_u32 s18, s18, s23
    ds_read_b128 a[28:31], v7 offset:16384
    v_mfma_f32_16x16x32_bf16 v[96:99], a[116:119], a[100:103], v[96:99]
    s_add_u32 s18, s18, 0
    ds_read_b128 a[40:43], v8 offset:1024
    v_mfma_f32_16x16x32_bf16 v[60:63], a[120:123], a[80:83], v[60:63]
    s_add_u32 s19, s12, 2
    ds_read_b128 a[44:47], v8 offset:17408
    v_mfma_f32_16x16x32_bf16 v[60:63], a[124:127], a[84:87], v[60:63]
    s_and_b32 s19, s19, 3
    ds_read_b128 a[48:51], v8 offset:2048
    v_mfma_f32_16x16x32_bf16 v[80:83], a[120:123], a[88:91], v[80:83]
    s_mul_i32 s19, s19, 30720
    ds_read_b128 a[52:55], v8 offset:18432
    v_mfma_f32_16x16x32_bf16 v[80:83], a[124:127], a[92:95], v[80:83]
    s_add_u32 s19, s19, s23
    ds_read_b128 a[56:59], v8 offset:3072
    v_mfma_f32_16x16x32_bf16 v[100:103], a[120:123], a[96:99], v[100:103]
    s_add_u32 s19, s19, 10240
    ds_read_b128 a[60:63], v8 offset:19456
    v_mfma_f32_16x16x32_bf16 v[100:103], a[124:127], a[100:103], v[100:103]
    s_add_u32 s17, s12, 3
    ds_read_b128 a[64:67], v9 offset:0
    v_mfma_f32_16x16x32_bf16 v[64:67], a[128:131], a[80:83], v[64:67]
    s_and_b32 s17, s17, 3
    ds_read_b128 a[68:71], v9 offset:2048
    v_mfma_f32_16x16x32_bf16 v[64:67], a[132:135], a[84:87], v[64:67]
    s_mul_i32 s17, s17, 30720
    v_add_u32 v8, s62, v14
    v_add_u32 v9, 8192, v15
    v_mfma_f32_16x16x32_bf16 v[84:87], a[128:131], a[88:91], v[84:87]
    s_add_u32 s17, s17, s23
    v_add_u32 v4, s62, v10
    v_add_u32 v5, s62, v11
    v_mfma_f32_16x16x32_bf16 v[84:87], a[132:135], a[92:95], v[84:87]
    s_add_u32 s17, s17, 20480
    v_add_u32 v6, s62, v12
    v_add_u32 v7, s62, v13
    v_mfma_f32_16x16x32_bf16 v[104:107], a[128:131], a[96:99], v[104:107]
    v_mfma_f32_16x16x32_bf16 v[104:107], a[132:135], a[100:103], v[104:107]
    v_mfma_f32_16x16x32_bf16 v[68:71], a[136:139], a[80:83], v[68:71]
    v_mfma_f32_16x16x32_bf16 v[68:71], a[140:143], a[84:87], v[68:71]
    v_mfma_f32_16x16x32_bf16 v[88:91], a[136:139], a[88:91], v[88:91]
    v_mfma_f32_16x16x32_bf16 v[88:91], a[140:143], a[92:95], v[88:91]
    v_mfma_f32_16x16x32_bf16 v[108:111], a[136:139], a[96:99], v[108:111]
    s_waitcnt lgkmcnt(0)
    v_mfma_f32_16x16x32_bf16 v[108:111], a[140:143], a[100:103], v[108:111]
    v_mfma_f32_16x16x32_bf16 v[52:55], a[32:35], a[8:11], v[52:55]
    s_waitcnt vmcnt(3)
    s_barrier
    v_mfma_f32_16x16x32_bf16 v[52:55], a[36:39], a[12:15], v[52:55]
    s_waitcnt vmcnt(0)
    ds_read_b64 v[112:113], v16 offset:0
    ds_read_b128 v[160:163], v8 offset:0
    v_mfma_f32_16x16x32_bf16 v[72:75], a[32:35], a[16:19], v[72:75]
    ds_read_b64 v[114:115], v16 offset:32
    ds_read_b128 v[164:167], v8 offset:16384
    v_mfma_f32_16x16x32_bf16 v[72:75], a[36:39], a[20:23], v[72:75]
    ds_read_b64 v[116:117], v16 offset:64
    ds_read_b128 v[128:131], v4 offset:0
    v_mfma_f32_16x16x32_bf16 v[92:95], a[32:35], a[24:27], v[92:95]
    ds_read_b64 v[118:119], v16 offset:96
    ds_read_b128 v[132:135], v4 offset:16384
    v_mfma_f32_16x16x32_bf16 v[92:95], a[36:39], a[28:31], v[92:95]
    ds_read_b64 v[120:121], v16 offset:128
    ds_read_b128 v[136:139], v5 offset:0
    v_mfma_f32_16x16x32_bf16 v[56:59], a[40:43], a[8:11], v[56:59]
    ds_read_b128 v[140:143], v5 offset:16384
    v_mfma_f32_16x16x32_bf16 v[56:59], a[44:47], a[12:15], v[56:59]
    ds_read_b128 v[144:147], v6 offset:0
    v_mfma_f32_16x16x32_bf16 v[76:79], a[40:43], a[16:19], v[76:79]
    ds_read_b128 v[148:151], v6 offset:16384
    v_mfma_f32_16x16x32_bf16 v[76:79], a[44:47], a[20:23], v[76:79]
    ds_read_b128 v[152:155], v7 offset:0
    v_mfma_f32_16x16x32_bf16 v[96:99], a[40:43], a[24:27], v[96:99]
    ds_read_b128 v[156:159], v7 offset:16384
    v_mfma_f32_16x16x32_bf16 v[96:99], a[44:47], a[28:31], v[96:99]
    ds_read_b128 v[168:171], v8 offset:1024
    v_mfma_f32_16x16x32_bf16 v[60:63], a[48:51], a[8:11], v[60:63]
    ds_read_b128 v[172:175], v8 offset:17408
    v_mfma_f32_16x16x32_bf16 v[60:63], a[52:55], a[12:15], v[60:63]
    ds_read_b128 v[176:179], v8 offset:2048
    v_mfma_f32_16x16x32_bf16 v[80:83], a[48:51], a[16:19], v[80:83]
    ds_read_b128 v[180:183], v8 offset:18432
    v_mfma_f32_16x16x32_bf16 v[80:83], a[52:55], a[20:23], v[80:83]
    ds_read_b128 v[184:187], v8 offset:3072
    v_mfma_f32_16x16x32_bf16 v[100:103], a[48:51], a[24:27], v[100:103]
    ds_read_b128 v[188:191], v8 offset:19456
    v_mfma_f32_16x16x32_bf16 v[100:103], a[52:55], a[28:31], v[100:103]
    ds_read_b128 v[192:195], v9 offset:0
    v_mfma_f32_16x16x32_bf16 v[64:67], a[56:59], a[8:11], v[64:67]
    ds_read_b128 v[196:199], v9 offset:2048
    v_mfma_f32_16x16x32_bf16 v[64:67], a[60:63], a[12:15], v[64:67]
    s_waitcnt lgkmcnt(13)
    v_lshlrev_b32 v20, 16, v112
    v_and_b32 v21, 0xffff0000, v112
    v_mfma_f32_16x16x32_bf16 v[84:87], a[56:59], a[16:19], v[84:87]
    v_add_f32 v32, v32, v20
    v_add_f32 v33, v33, v21
    v_mfma_f32_16x16x32_bf16 v[84:87], a[60:63], a[20:23], v[84:87]
    s_branch L_pado15
L_pad15:
    s_branch L_tour_ret3
L_pado15:
    v_lshlrev_b32 v20, 16, v113
    v_and_b32 v21, 0xffff0000, v113
    v_mfma_f32_16x16x32_bf16 v[104:107], a[56:59], a[24:27], v[104:107]
    v_add_f32 v34, v34, v20
    v_add_f32 v35, v35, v21
    v_mfma_f32_16x16x32_bf16 v[104:107], a[60:63], a[28:31], v[104:107]
    v_lshlrev_b32 v20, 16, v114
    v_and_b32 v21, 0xffff0000, v114
    v_mfma_f32_16x16x32_bf16 v[68:71], a[64:67], a[8:11], v[68:71]
    v_add_f32 v36, v36, v20
    v_add_f32 v37, v37, v21
    v_mfma_f32_16x16x32_bf16 v[68:71], a[68:71], a[12:15], v[68:71]
    v_lshlrev_b32 v20, 16, v115
    v_and_b32 v21, 0xffff0000, v115
    v_mfma_f32_16x16x32_bf16 v[88:91], a[64:67], a[16:19], v[88:91]
    v_add_f32 v38, v38, v20
    v_add_f32 v39, v39, v21
    v_mfma_f32_16x16x32_bf16 v[88:91], a[68:71], a[20:23], v[88:91]
    v_lshlrev_b32 v20, 16, v116
    v_and_b32 v21, 0xffff0000, v116
    v_mfma_f32_16x16x32_bf16 v[108:111], a[64:67], a[24:27], v[108:111]
    s_waitcnt lgkmcnt(0)
    v_add_f32 v40, v40, v20
    v_add_f32 v41, v41, v21
    v_mfma_f32_16x16x32_bf16 v[108:111], a[68:71], a[28:31], v[108:111]
    v_lshlrev_b32 v20, 16, v117
    v_and_b32 v21, 0xffff0000, v117
    v_mfma_f32_16x16x32_bf16 v[52:55], v[160:163], v[136:139], v[52:55]
    v_add_f32 v42, v42, v20
    v_add_f32 v43, v43, v21
    v_mfma_f32_16x16x32_bf16 v[52:55], v[164:167], v[140:143], v[52:55]
    v_lshlrev_b32 v20, 16, v118
    v_and_b32 v21, 0xffff0000, v118
    v_mfma_f32_16x16x32_bf16 v[56:59], v[168:171], v[136:139], v[56:59]
    v_add_f32 v44, v44, v20
    v_add_f32 v45, v45, v21
    v_mfma_f32_16x16x32_bf16 v[56:59], v[172:175], v[140:143], v[56:59]
    v_lshlrev_b32 v20, 16, v119
    v_and_b32 v21, 0xffff0000, v119
    v_mfma_f32_16x16x32_bf16 v[60:63], v[176:179], v[136:139], v[60:63]
    v_add_f32 v46, v46, v20
    v_add_f32 v47, v47, v21
    v_mfma_f32_16x16x32_bf16 v[60:63], v[180:183], v[140:143], v[60:63]
    v_lshlrev_b32 v20, 16, v120
    v_and_b32 v21, 0xffff0000, v120
    v_mfma_f32_16x16x32_bf16 v[64:67], v[184:187], v[136:139], v[64:67]
    v_add_f32 v48, v48, v20
    v_add_f32 v49, v49, v21
    v_mfma_f32_16x16x32_bf16 v[64:67], v[188:191], v[140:143], v[64:67]
    v_lshlrev_b32 v20, 16, v121
    v_and_b32 v21, 0xffff0000, v121
    v_mfma_f32_16x16x32_bf16 v[68:71], v[192:195], v[136:139], v[68:71]
    v_add_f32 v50, v50, v20
    v_add_f32 v51, v51, v21
    v_mfma_f32_16x16x32_bf16 v[68:71], v[196:199], v[140:143], v[68:71]
    v_cvt_pk_bf16_f32 v52, v52, v53
    v_cvt_pk_bf16_f32 v53, v54, v55
    v_mfma_f32_16x16x32_bf16 v[72:75], v[160:163], v[144:147], v[72:75]
    v_cvt_pk_bf16_f32 v54, v56, v57
    v_cvt_pk_bf16_f32 v55, v58, v59
    v_mfma_f32_16x16x32_bf16 v[72:75], v[164:167], v[148:151], v[72:75]
    buffer_store_dwordx4 v[52:55], v1, s[44:47], s18 offen offset:0 sc1
    v_mfma_f32_16x16x32_bf16 v[76:79], v[168:171], v[144:147], v[76:79]
    v_cvt_pk_bf16_f32 v56, v60, v61
    v_cvt_pk_bf16_f32 v57, v62, v63
    v_mfma_f32_16x16x32_bf16 v[76:79], v[172:175], v[148:151], v[76:79]
    v_cvt_pk_bf16_f32 v58, v64, v65
    v_cvt_pk_bf16_f32 v59, v66, v67
    v_mfma_f32_16x16x32_bf16 v[80:83], v[176:179], v[144:147], v[80:83]
    buffer_store_dwordx4 v[56:59], v1, s[44:47], s18 offen offset:1024 sc1
    v_mfma_f32_16x16x32_bf16 v[80:83], v[180:183], v[148:151], v[80:83]
    v_cvt_pk_bf16_f32 v60, v68, v69
    v_cvt_pk_bf16_f32 v61, v70, v71
    v_mfma_f32_16x16x32_bf16 v[84:87], v[184:187], v[144:147], v[84:87]
    buffer_store_dwordx2 v[60:61], v18, s[44:47], s18 offen offset:2048 sc1
    v_mfma_f32_16x16x32_bf16 v[84:87], v[188:191], v[148:151], v[84:87]
    v_cvt_pk_bf16_f32 v72, v72, v73
    v_cvt_pk_bf16_f32 v73, v74, v75
    v_mfma_f32_16x16x32_bf16 v[88:91], v[192:195], v[144:147], v[88:91]
    v_cvt_pk_bf16_f32 v74, v76, v77
    v_cvt_pk_bf16_f32 v75, v78, v79
    v_mfma_f32_16x16x32_bf16 v[88:91], v[196:199], v[148:151], v[88:91]
    buffer_store_dwordx4 v[72:75], v1, s[44:47], s19 offen offset:0 sc1
    v_mfma_f32_16x16x32_bf16 v[92:95], v[160:163], v[152:155], v[92:95]
    v_cvt_pk_bf16_f32 v76, v80, v81
    v_cvt_pk_bf16_f32 v77, v82, v83
    v_mfma_f32_16x16x32_bf16 v[92:95], v[164:167], v[156:159], v[92:95]
    v_mfma_f32_16x16x32_bf16 v[96:99], v[168:171], v[152:155], v[96:99]
    v_cvt_pk_bf16_f32 v78, v84, v85
    v_cvt_pk_bf16_f32 v79, v86, v87
    v_mfma_f32_16x16x32_bf16 v[96:99], v[172:175], v[156:159], v[96:99]
    buffer_store_dwordx4 v[76:79], v1, s[44:47], s19 offen offset:1024 sc1
    v_mfma_f32_16x16x32_bf16 v[100:103], v[176:179], v[152:155], v[100:103]
    v_cvt_pk_bf16_f32 v80, v88, v89
    v_cvt_pk_bf16_f32 v81, v90, v91
    v_mfma_f32_16x16x32_bf16 v[100:103], v[180:183], v[156:159], v[100:103]
    buffer_store_dwordx2 v[80:81], v18, s[44:47], s19 offen offset:2048 sc1
    v_mfma_f32_16x16x32_bf16 v[104:107], v[184:187], v[152:155], v[104:107]
    v_cvt_pk_bf16_f32 v92, v92, v93
    v_cvt_pk_bf16_f32 v93, v94, v95
    v_mfma_f32_16x16x32_bf16 v[104:107], v[188:191], v[156:159], v[104:107]
    v_mfma_f32_16x16x32_bf16 v[108:111], v[192:195], v[152:155], v[108:111]
    v_cvt_pk_bf16_f32 v94, v96, v97
    v_cvt_pk_bf16_f32 v95, v98, v99
    v_mfma_f32_16x16x32_bf16 v[108:111], v[196:199], v[156:159], v[108:111]
    buffer_store_dwordx4 v[92:95], v1, s[44:47], s17 offen offset:0 sc1
    v_mfma_f32_16x16x32_bf16 v[32:35], a[176:179], a[144:147], v[32:35]
    v_cvt_pk_bf16_f32 v96, v100, v101
    v_cvt_pk_bf16_f32 v97, v102, v103
    v_mfma_f32_16x16x32_bf16 v[32:35], a[180:183], a[148:151], v[32:35]
    v_mfma_f32_16x16x32_bf16 v[32:35], a[104:107], a[72:75], v[32:35]
    v_cvt_pk_bf16_f32 v98, v104, v105
    v_cvt_pk_bf16_f32 v99, v106, v107
    v_mfma_f32_16x16x32_bf16 v[32:35], a[108:111], a[76:79], v[32:35]
    buffer_store_dwordx4 v[96:99], v1, s[44:47], s17 offen offset:1024 sc1
    v_mfma_f32_16x16x32_bf16 v[32:35], a[32:35], a[0:3], v[32:35]
    v_cvt_pk_bf16_f32 v100, v108, v109
    v_cvt_pk_bf16_f32 v101, v110, v111
    v_mfma_f32_16x16x32_bf16 v[32:35], a[36:39], a[4:7], v[32:35]
    buffer_store_dwordx2 v[100:101], v18, s[44:47], s17 offen offset:2048 sc1
    v_mfma_f32_16x16x32_bf16 v[32:35], v[160:163], v[128:131], v[32:35]
    v_mfma_f32_16x16x32_bf16 v[32:35], v[164:167], v[132:135], v[32:35]
    s_mul_i32 s57, s12, 30720
    v_mfma_f32_16x16x32_bf16 v[36:39], a[184:187], a[144:147], v[36:39]
    s_add_u32 s23, s23, s57
    v_mfma_f32_16x16x32_bf16 v[36:39], a[188:191], a[148:151], v[36:39]
    v_mfma_f32_16x16x32_bf16 v[36:39], a[112:115], a[72:75], v[36:39]
    v_mfma_f32_16x16x32_bf16 v[36:39], a[116:119], a[76:79], v[36:39]
    v_mfma_f32_16x16x32_bf16 v[36:39], a[40:43], a[0:3], v[36:39]
    v_mfma_f32_16x16x32_bf16 v[36:39], a[44:47], a[4:7], v[36:39]
    v_mfma_f32_16x16x32_bf16 v[36:39], v[168:171], v[128:131], v[36:39]
    v_mfma_f32_16x16x32_bf16 v[36:39], v[172:175], v[132:135], v[36:39]
    v_mfma_f32_16x16x32_bf16 v[40:43], a[192:195], a[144:147], v[40:43]
    v_mfma_f32_16x16x32_bf16 v[40:43], a[196:199], a[148:151], v[40:43]
    v_mfma_f32_16x16x32_bf16 v[40:43], a[120:123], a[72:75], v[40:43]
    v_mfma_f32_16x16x32_bf16 v[40:43], a[124:127], a[76:79], v[40:43]
    v_mfma_f32_16x16x32_bf16 v[40:43], a[48:51], a[0:3], v[40:43]
    v_mfma_f32_16x16x32_bf16 v[40:43], a[52:55], a[4:7], v[40:43]
    v_mfma_f32_16x16x32_bf16 v[40:43], v[176:179], v[128:131], v[40:43]
    v_mfma_f32_16x16x32_bf16 v[40:43], v[180:183], v[132:135], v[40:43]
    v_mfma_f32_16x16x32_bf16 v[44:47], a[200:203], a[144:147], v[44:47]
    v_mfma_f32_16x16x32_bf16 v[44:47], a[204:207], a[148:151], v[44:47]
    v_mfma_f32_16x16x32_bf16 v[44:47], a[128:131], a[72:75], v[44:47]
    v_mfma_f32_16x16x32_bf16 v[44:47], a[132:135], a[76:79], v[44:47]
    v_mfma_f32_16x16x32_bf16 v[44:47], a[56:59], a[0:3], v[44:47]
    v_mfma_f32_16x16x32_bf16 v[44:47], a[60:63], a[4:7], v[44:47]
    v_mfma_f32_16x16x32_bf16 v[44:47], v[184:187], v[128:131], v[44:47]
    v_mfma_f32_16x16x32_bf16 v[44:47], v[188:191], v[132:135], v[44:47]
    v_mfma_f32_16x16x32_bf16 v[48:51], a[208:211], a[144:147], v[48:51]
    v_mfma_f32_16x16x32_bf16 v[48:51], a[212:215], a[148:151], v[48:51]
    v_mfma_f32_16x16x32_bf16 v[48:51], a[136:139], a[72:75], v[48:51]
    v_mfma_f32_16x16x32_bf16 v[48:51], a[140:143], a[76:79], v[48:51]
    v_mfma_f32_16x16x32_bf16 v[48:51], a[64:67], a[0:3], v[48:51]
    v_mfma_f32_16x16x32_bf16 v[48:51], a[68:71], a[4:7], v[48:51]
    v_mfma_f32_16x16x32_bf16 v[48:51], v[192:195], v[128:131], v[48:51]
    v_mfma_f32_16x16x32_bf16 v[48:51], v[196:199], v[132:135], v[48:51]
    s_waitcnt vmcnt(0)
    buffer_store_dword v29, off, s[44:47], s100 offset:16 sc1
L_spin5:
    s_mov_b32 s3, 0
L_spin5_l:
    buffer_load_dword v31, v30, s[44:47], 0 offen offset:16 sc1
    s_add_u32 s3, s3, 1
    s_waitcnt vmcnt(0)
    v_cmp_ne_u32 vcc, -1, v31
    s_cmp_ge_u32 s3, 131072
    s_cbranch_scc1 L_k3_go
    s_nop 0
    s_cbranch_vccz L_k3_go
    s_branch L_spin5_l
L_spin4:
    s_mov_b32 s3, 0
L_spin4_l:
    buffer_load_dword v31, v19, s[44:47], 0 offen offset:0 sc1
    s_add_u32 s3, s3, 1
    s_waitcnt vmcnt(0)
    v_cmp_ne_u32 vcc, v17, v31
    s_cmp_ge_u32 s3, 131072
    s_cbranch_scc1 L_spin4_back
    s_nop 0
    s_cbranch_vccz L_spin4_back
    s_branch L_spin4_l
L_k3_go:
    buffer_load_dwordx4 v[200:203], v1, s[44:47], s23 offen sc1
    buffer_load_dwordx4 v[204:207], v1, s[44:47], s23 offen offset:1024 sc1
    buffer_load_dwordx2 v[208:209], v18, s[44:47], s23 offen offset:2048 sc1
    s_add_u32 s23, s23, 10240
    buffer_load_dwordx4 v[212:215], v1, s[44:47], s23 offen sc1
    buffer_load_dwordx4 v[216:219], v1, s[44:47], s23 offen offset:1024 sc1
    buffer_load_dwordx2 v[220:221], v18, s[44:47], s23 offen offset:2048 sc1
    s_add_u32 s23, s23, 10240
    buffer_load_dwordx4 v[224:227], v1, s[44:47], s23 offen sc1
    buffer_load_dwordx4 v[228:231], v1, s[44:47], s23 offen offset:1024 sc1
    buffer_load_dwordx2 v[232:233], v18, s[44:47], s23 offen offset:2048 sc1
    s_waitcnt vmcnt(6)
    v_lshlrev_b32 v20, 16, v200
    v_and_b32 v21, 0xffff0000, v200
    v_pk_add_f32 v[32:33], v[32:33], v[20:21]
    v_lshlrev_b32 v22, 16, v201
    v_and_b32 v23, 0xffff0000, v201
    v_pk_add_f32 v[34:35], v[34:35], v[22:23]
    v_lshlrev_b32 v24, 16, v202
    v_and_b32 v25, 0xffff0000, v202
    v_pk_add_f32 v[36:37], v[36:37], v[24:25]
    v_lshlrev_b32 v26, 16, v203
    v_and_b32 v27, 0xffff0000, v203
    v_pk_add_f32 v[38:39], v[38:39], v[26:27]
    v_lshlrev_b32 v20, 16, v204
    v_and_b32 v21, 0xffff0000, v204
    v_pk_add_f32 v[40:41], v[40:41], v[20:21]
    v_lshlrev_b32 v22, 16, v205
    v_and_b32 v23, 0xffff0000, v205
    v_pk_add_f32 v[42:43], v[42:43], v[22:23]
    v_lshlrev_b32 v24, 16, v206
    v_and_b32 v25, 0xffff0000, v206
    v_pk_add_f32 v[44:45], v[44:45], v[24:25]
    v_lshlrev_b32 v26, 16, v207
    v_and_b32 v27, 0xffff0000, v207
    v_pk_add_f32 v[46:47], v[46:47], v[26:27]
    v_lshlrev_b32 v20, 16, v208
    v_and_b32 v21, 0xffff0000, v208
    v_pk_add_f32 v[48:49], v[48:49], v[20:21]
    v_lshlrev_b32 v22, 16, v209
    v_and_b32 v23, 0xffff0000, v209
    v_pk_add_f32 v[50:51], v[50:51], v[22:23]
    s_waitcnt vmcnt(3)
    v_lshlrev_b32 v20, 16, v212
    v_and_b32 v21, 0xffff0000, v212
    v_pk_add_f32 v[32:33], v[32:33], v[20:21]
    v_lshlrev_b32 v22, 16, v213
    v_and_b32 v23, 0xffff0000, v213
    v_pk_add_f32 v[34:35], v[34:35], v[22:23]
    v_lshlrev_b32 v24, 16, v214
    v_and_b32 v25, 0xffff0000, v214
    v_pk_add_f32 v[36:37], v[36:37], v[24:25]
    v_lshlrev_b32 v26, 16, v215
    v_and_b32 v27, 0xffff0000, v215
    v_pk_add_f32 v[38:39], v[38:39], v[26:27]
    v_lshlrev_b32 v20, 16, v216
    v_and_b32 v21, 0xffff0000, v216
    v_pk_add_f32 v[40:41], v[40:41], v[20:21]
    v_lshlrev_b32 v22, 16, v217
    v_and_b32 v23, 0xffff0000, v217
    v_pk_add_f32 v[42:43], v[42:43], v[22:23]
    v_lshlrev_b32 v24, 16, v218
    v_and_b32 v25, 0xffff0000, v218
    v_pk_add_f32 v[44:45], v[44:45], v[24:25]
    v_lshlrev_b32 v26, 16, v219
    v_and_b32 v27, 0xffff0000, v219
    v_pk_add_f32 v[46:47], v[46:47], v[26:27]
    v_lshlrev_b32 v20, 16, v220
    v_and_b32 v21, 0xffff0000, v220
    v_pk_add_f32 v[48:49], v[48:49], v[20:21]
    v_lshlrev_b32 v22, 16, v221
    v_and_b32 v23, 0xffff0000, v221
    v_pk_add_f32 v[50:51], v[50:51], v[22:23]
    s_waitcnt vmcnt(0)
    v_lshlrev_b32 v20, 16, v224
    v_and_b32 v21, 0xffff0000, v224
    v_pk_add_f32 v[32:33], v[32:33], v[20:21]
    v_lshlrev_b32 v22, 16, v225
    v_and_b32 v23, 0xffff0000, v225
    v_pk_add_f32 v[34:35], v[34:35], v[22:23]
    v_lshlrev_b32 v24, 16, v226
    v_and_b32 v25, 0xffff0000, v226
    v_pk_add_f32 v[36:37], v[36:37], v[24:25]
    v_lshlrev_b32 v26, 16, v227
    v_and_b32 v27, 0xffff0000, v227
    v_pk_add_f32 v[38:39], v[38:39], v[26:27]
    v_lshlrev_b32 v20, 16, v228
    v_and_b32 v21, 0xffff0000, v228
    v_pk_add_f32 v[40:41], v[40:41], v[20:21]
    v_lshlrev_b32 v22, 16, v229
    v_and_b32 v23, 0xffff0000, v229
    v_pk_add_f32 v[42:43], v[42:43], v[22:23]
    v_lshlrev_b32 v24, 16, v230
    v_and_b32 v25, 0xffff0000, v230
    v_pk_add_f32 v[44:45], v[44:45], v[24:25]
    v_lshlrev_b32 v26, 16, v231
    v_and_b32 v27, 0xffff0000, v231
    v_pk_add_f32 v[46:47], v[46:47], v[26:27]
    v_lshlrev_b32 v20, 16, v232
    v_and_b32 v21, 0xffff0000, v232
    v_pk_add_f32 v[48:49], v[48:49], v[20:21]
    v_lshlrev_b32 v22, 16, v233
    v_and_b32 v23, 0xffff0000, v233
    v_pk_add_f32 v[50:51], v[50:51], v[22:23]
    v_cvt_pk_bf16_f32 v32, v32, v33
    v_cvt_pk_bf16_f32 v33, v34, v35
    v_cvt_pk_bf16_f32 v34, v36, v37
    v_cvt_pk_bf16_f32 v35, v38, v39
    v_cvt_pk_bf16_f32 v36, v40, v41
    v_cvt_pk_bf16_f32 v37, v42, v43
    v_cvt_pk_bf16_f32 v38, v44, v45
    v_cvt_pk_bf16_f32 v39, v46, v47
    v_cvt_pk_bf16_f32 v40, v48, v49
    v_cvt_pk_bf16_f32 v41, v50, v51
    ds_write_b64 v16, v[32:33] offset:0
    ds_write_b64 v16, v[34:35] offset:32
    ds_write_b64 v16, v[36:37] offset:64
    ds_write_b64 v16, v[38:39] offset:96
    ds_write_b64 v16, v[40:41] offset:128
    s_waitcnt lgkmcnt(0)
    ds_read_b128 v[44:47], v127 offset:0
    ds_read_b128 v[48:51], v127 offset:1024
    ds_read_b128 v[52:55], v127 offset:2048
    s_waitcnt lgkmcnt(2)
    buffer_store_dwordx4 v[44:47], v124, s[40:43], s25 offen offset:0
    s_waitcnt lgkmcnt(1)
    buffer_store_dwordx4 v[48:51], v125, s[40:43], s25 offen offset:1024
    s_waitcnt lgkmcnt(0)
    buffer_store_dwordx4 v[52:55], v126, s[40:43], s25 offen offset:2048
L_end:
    s_endpgm
L_slow:
    v_mov_b64 v[128:129], 0
    v_mov_b64 v[130:131], 0
    v_mov_b64 v[132:133], 0
    v_mov_b64 v[134:135], 0
    v_mov_b64 v[136:137], 0
    v_mov_b64 v[138:139], 0
    v_mov_b64 v[140:141], 0
    v_mov_b64 v[142:143], 0
    v_mov_b64 v[144:145], 0
    v_mov_b64 v[146:147], 0
    v_mov_b64 v[148:149], 0
    v_mov_b64 v[150:151], 0
    v_mov_b64 v[152:153], 0
    v_mov_b64 v[154:155], 0
    v_mov_b64 v[156:157], 0
    v_mov_b64 v[158:159], 0
    v_mov_b64 v[160:161], 0
    v_mov_b64 v[162:163], 0
    v_mov_b64 v[164:165], 0
    v_mov_b64 v[166:167], 0
    v_mov_b64 v[168:169], 0
    v_mov_b64 v[170:171], 0
    v_mov_b64 v[172:173], 0
    v_mov_b64 v[174:175], 0
    v_mov_b64 v[176:177], 0
    v_mov_b64 v[178:179], 0
    v_mov_b64 v[180:181], 0
    v_mov_b64 v[182:183], 0
    v_mov_b64 v[184:185], 0
    v_mov_b64 v[186:187], 0
    v_mov_b64 v[188:189], 0
    v_mov_b64 v[190:191], 0
    v_mov_b64 v[192:193], 0
    v_mov_b64 v[194:195], 0
    v_mov_b32 v104, v116
    v_mov_b32 v105, v116
    s_mov_b32 s56, 0
    s_mov_b32 s57, s86
L_slow_loop:
    buffer_load_dwordx4 a[0:3], v1, s[44:47], s57 offen offset:0 sc1
    buffer_load_dwordx4 a[4:7], v1, s[44:47], s57 offen offset:1024 sc1
    buffer_load_dwordx4 a[8:11], v1, s[44:47], s57 offen offset:2048 sc1
    buffer_load_dwordx4 a[12:15], v1, s[44:47], s57 offen offset:3072 sc1
    s_add_u32 s57, s57, 4096
    buffer_load_dwordx4 a[16:19], v1, s[44:47], s57 offen offset:0 sc1
    buffer_load_dwordx4 a[20:23], v1, s[44:47], s57 offen offset:1024 sc1
    buffer_load_dwordx4 a[24:27], v1, s[44:47], s57 offen offset:2048 sc1
    buffer_load_dwordx4 a[28:31], v1, s[44:47], s57 offen offset:3072 sc1
    s_add_u32 s57, s57, 4096
    buffer_load_dwordx4 a[32:35], v1, s[44:47], s57 offen offset:0 sc1
    buffer_load_dwordx4 a[36:39], v1, s[44:47], s57 offen offset:1024 sc1
    buffer_load_dwordx4 a[40:43], v1, s[44:47], s57 offen offset:2048 sc1
    buffer_load_dwordx4 a[44:47], v1, s[44:47], s57 offen offset:3072 sc1
    s_add_u32 s57, s57, 4096
    buffer_load_dwordx4 a[48:51], v1, s[44:47], s57 offen offset:0 sc1
    buffer_load_dwordx4 a[52:55], v1, s[44:47], s57 offen offset:1024 sc1
    buffer_load_dwordx4 a[56:59], v1, s[44:47], s57 offen offset:2048 sc1
    buffer_load_dwordx4 a[60:63], v1, s[44:47], s57 offen offset:3072 sc1
    s_add_u32 s57, s57, 4096
    v_mov_b64 v[240:241], 0
    v_mov_b64 v[242:243], 0
    v_mov_b64 v[244:245], 0
    v_mov_b64 v[246:247], 0
    v_mov_b64 v[248:249], 0
    v_mov_b64 v[250:251], 0
    v_mov_b64 v[252:253], 0
    v_mov_b64 v[254:255], 0
    s_cmp_lg_u32 s56, s87
    s_cbranch_scc1 L_slow_nm
    v_pk_add_f32 v[240:241], v[240:241], v[112:113]
    v_pk_add_f32 v[242:243], v[242:243], v[114:115]
    v_pk_add_f32 v[252:253], v[252:253], v[112:113]
    v_pk_add_f32 v[254:255], v[254:255], v[114:115]
    v_mov_b64 v[248:249], v[116:117]
    v_mov_b64 v[250:251], v[116:117]
L_slow_nm:
    s_waitcnt vmcnt(0)
    s_nop 1
    v_mfma_f32_16x16x32_bf16 v[200:203], a[0:3], v[32:35], v[240:243]
    v_mfma_f32_16x16x32_bf16 v[200:203], a[4:7], v[48:51], v[200:203]
    v_mfma_f32_16x16x32_bf16 v[200:203], a[8:11], v[64:67], v[200:203]
    v_mfma_f32_16x16x32_bf16 v[200:203], a[12:15], v[80:83], v[200:203]
    v_mfma_f32_16x16x32_bf16 v[204:207], a[0:3], v[36:39], v[244:247]
    v_mfma_f32_16x16x32_bf16 v[204:207], a[4:7], v[52:55], v[204:207]
    v_mfma_f32_16x16x32_bf16 v[204:207], a[8:11], v[68:71], v[204:207]
    v_mfma_f32_16x16x32_bf16 v[204:207], a[12:15], v[84:87], v[204:207]
    v_mfma_f32_16x16x32_bf16 v[208:211], a[16:19], v[32:35], v[248:251]
    v_mfma_f32_16x16x32_bf16 v[208:211], a[20:23], v[48:51], v[208:211]
    v_mfma_f32_16x16x32_bf16 v[208:211], a[24:27], v[64:67], v[208:211]
    v_mfma_f32_16x16x32_bf16 v[208:211], a[28:31], v[80:83], v[208:211]
    v_mfma_f32_16x16x32_bf16 v[212:215], a[16:19], v[36:39], v[252:255]
    v_mfma_f32_16x16x32_bf16 v[212:215], a[20:23], v[52:55], v[212:215]
    v_mfma_f32_16x16x32_bf16 v[212:215], a[24:27], v[68:71], v[212:215]
    v_mfma_f32_16x16x32_bf16 v[212:215], a[28:31], v[84:87], v[212:215]
    s_nop 7
    v_max3_f32 v100, v200, v201, v202
    v_max3_f32 v102, v203, v208, v209
    v_max3_f32 v101, v204, v205, v206
    v_max3_f32 v103, v207, v212, v213
    v_max3_f32 v100, v100, v210, v211
    v_max3_f32 v101, v101, v214, v215
    v_max_f32 v100, v100, v102
    v_max_f32 v101, v101, v103
    v_mov_b64 v[102:103], v[100:101]
    s_nop 1
    v_permlane16_swap_b32 v100, v102
    v_permlane16_swap_b32 v101, v103
    v_max_f32 v100, v100, v102
    v_max_f32 v101, v101, v103
    v_mov_b64 v[102:103], v[100:101]
    s_nop 1
    v_permlane32_swap_b32 v100, v102
    v_permlane32_swap_b32 v101, v103
    v_max_f32 v100, v100, v102
    v_max_f32 v101, v101, v103
    v_max_f32 v100, v100, v104
    v_sub_f32 v106, v104, v100
    v_mov_b32 v104, v100
    v_exp_f32 v106, v106
    v_max_f32 v101, v101, v105
    v_sub_f32 v107, v105, v101
    v_mov_b32 v105, v101
    v_exp_f32 v107, v107
    s_nop 0
    v_mul_f32 v128, v128, v106
    v_mul_f32 v129, v129, v106
    v_mul_f32 v130, v130, v106
    v_mul_f32 v131, v131, v106
    v_mul_f32 v136, v136, v106
    v_mul_f32 v137, v137, v106
    v_mul_f32 v138, v138, v106
    v_mul_f32 v139, v139, v106
    v_mul_f32 v144, v144, v106
    v_mul_f32 v145, v145, v106
    v_mul_f32 v146, v146, v106
    v_mul_f32 v147, v147, v106
    v_mul_f32 v152, v152, v106
    v_mul_f32 v153, v153, v106
    v_mul_f32 v154, v154, v106
    v_mul_f32 v155, v155, v106
    v_mul_f32 v160, v160, v106
    v_mul_f32 v161, v161, v106
    v_mul_f32 v162, v162, v106
    v_mul_f32 v163, v163, v106
    v_mul_f32 v168, v168, v106
    v_mul_f32 v169, v169, v106
    v_mul_f32 v170, v170, v106
    v_mul_f32 v171, v171, v106
    v_mul_f32 v176, v176, v106
    v_mul_f32 v177, v177, v106
    v_mul_f32 v178, v178, v106
    v_mul_f32 v179, v179, v106
    v_mul_f32 v184, v184, v106
    v_mul_f32 v185, v185, v106
    v_mul_f32 v186, v186, v106
    v_mul_f32 v187, v187, v106
    v_mul_f32 v192, v192, v106
    v_mul_f32 v193, v193, v106
    v_mul_f32 v132, v132, v107
    v_mul_f32 v133, v133, v107
    v_mul_f32 v134, v134, v107
    v_mul_f32 v135, v135, v107
    v_mul_f32 v140, v140, v107
    v_mul_f32 v141, v141, v107
    v_mul_f32 v142, v142, v107
    v_mul_f32 v143, v143, v107
    v_mul_f32 v148, v148, v107
    v_mul_f32 v149, v149, v107
    v_mul_f32 v150, v150, v107
    v_mul_f32 v151, v151, v107
    v_mul_f32 v156, v156, v107
    v_mul_f32 v157, v157, v107
    v_mul_f32 v158, v158, v107
    v_mul_f32 v159, v159, v107
    v_mul_f32 v164, v164, v107
    v_mul_f32 v165, v165, v107
    v_mul_f32 v166, v166, v107
    v_mul_f32 v167, v167, v107
    v_mul_f32 v172, v172, v107
    v_mul_f32 v173, v173, v107
    v_mul_f32 v174, v174, v107
    v_mul_f32 v175, v175, v107
    v_mul_f32 v180, v180, v107
    v_mul_f32 v181, v181, v107
    v_mul_f32 v182, v182, v107
    v_mul_f32 v183, v183, v107
    v_mul_f32 v188, v188, v107
    v_mul_f32 v189, v189, v107
    v_mul_f32 v190, v190, v107
    v_mul_f32 v191, v191, v107
    v_mul_f32 v194, v194, v107
    v_mul_f32 v195, v195, v107
    v_sub_f32 v200, v200, v104
    v_sub_f32 v201, v201, v104
    v_sub_f32 v202, v202, v104
    v_sub_f32 v203, v203, v104
    v_sub_f32 v204, v204, v105
    v_sub_f32 v205, v205, v105
    v_sub_f32 v206, v206, v105
    v_sub_f32 v207, v207, v105
    v_sub_f32 v208, v208, v104
    v_sub_f32 v209, v209, v104
    v_sub_f32 v210, v210, v104
    v_sub_f32 v211, v211, v104
    v_sub_f32 v212, v212, v105
    v_sub_f32 v213, v213, v105
    v_sub_f32 v214, v214, v105
    v_sub_f32 v215, v215, v105
    v_exp_f32 v216, v200
    v_exp_f32 v217, v201
    v_exp_f32 v218, v202
    v_exp_f32 v219, v203
    v_exp_f32 v220, v204
    v_exp_f32 v221, v205
    v_exp_f32 v222, v206
    v_exp_f32 v223, v207
    v_exp_f32 v224, v208
    v_exp_f32 v225, v209
    v_exp_f32 v226, v210
    v_exp_f32 v227, v211
    v_exp_f32 v228, v212
    v_exp_f32 v229, v213
    v_exp_f32 v230, v214
    v_exp_f32 v231, v215
    s_nop 0
    v_cvt_pk_bf16_f32 v232, v216, v217
    v_cvt_pk_bf16_f32 v233, v218, v219
    v_cvt_pk_bf16_f32 v236, v220, v221
    v_cvt_pk_bf16_f32 v237, v222, v223
    v_cvt_pk_bf16_f32 v234, v224, v225
    v_cvt_pk_bf16_f32 v235, v226, v227
    v_cvt_pk_bf16_f32 v238, v228, v229
    v_cvt_pk_bf16_f32 v239, v230, v231
    s_nop 1
    v_mfma_f32_16x16x32_bf16 v[128:131], a[32:35], v[232:235], v[128:131]
    v_mfma_f32_16x16x32_bf16 v[132:135], a[32:35], v[236:239], v[132:135]
    v_mfma_f32_16x16x32_bf16 v[136:139], a[36:39], v[232:235], v[136:139]
    v_mfma_f32_16x16x32_bf16 v[140:143], a[36:39], v[236:239], v[140:143]
    v_mfma_f32_16x16x32_bf16 v[144:147], a[40:43], v[232:235], v[144:147]
    v_mfma_f32_16x16x32_bf16 v[148:151], a[40:43], v[236:239], v[148:151]
    v_mfma_f32_16x16x32_bf16 v[152:155], a[44:47], v[232:235], v[152:155]
    v_mfma_f32_16x16x32_bf16 v[156:159], a[44:47], v[236:239], v[156:159]
    v_mfma_f32_16x16x32_bf16 v[160:163], a[48:51], v[232:235], v[160:163]
    v_mfma_f32_16x16x32_bf16 v[164:167], a[48:51], v[236:239], v[164:167]
    v_mfma_f32_16x16x32_bf16 v[168:171], a[52:55], v[232:235], v[168:171]
    v_mfma_f32_16x16x32_bf16 v[172:175], a[52:55], v[236:239], v[172:175]
    v_mfma_f32_16x16x32_bf16 v[176:179], a[56:59], v[232:235], v[176:179]
    v_mfma_f32_16x16x32_bf16 v[180:183], a[56:59], v[236:239], v[180:183]
    v_mfma_f32_16x16x32_bf16 v[184:187], a[60:63], v[232:235], v[184:187]
    v_mfma_f32_16x16x32_bf16 v[188:191], a[60:63], v[236:239], v[188:191]
    v_smfmac_f32_16x16x64_bf16 v[192:195], a[216:219], v[232:239], v111
    s_add_u32 s56, s56, 1
    s_cmp_le_u32 s56, s87
    s_cbranch_scc1 L_slow_loop
    s_nop 7
    v_add_f32 v196, v192, v193
    v_add_f32 v197, v194, v195
    s_branch L_norm1
.section .rodata,"a"
.p2align 6
.amdhsa_kernel parallel_sum__compressed_kv_cla__geglu_ffn__prompt_kernel
      .amdhsa_next_free_vgpr 512
      .amdhsa_next_free_sgpr 102
      .amdhsa_accum_offset 256
      .amdhsa_group_segment_fixed_size 0
      .amdhsa_kernarg_size 104
      .amdhsa_user_sgpr_count 2
      .amdhsa_user_sgpr_kernarg_segment_ptr 1
      .amdhsa_system_sgpr_workgroup_id_x 1
      .amdhsa_float_denorm_mode_32 3
.end_amdhsa_kernel
```
